```python
import torch

def _softmax(x, axis=-1):
    return torch.softmax(x, dim=axis)

def _gelu(x):
    return torch.nn.functional.gelu(x, approximate='tanh')

def _silu(x):
    return torch.nn.functional.silu(x)

def _sigmoid(x):
    return torch.sigmoid(x)

def _layernorm(x, axis=-1, eps=1e-05):
    m = x.mean(dim=axis, keepdim=True)
    v = x.var(dim=axis, keepdim=True, unbiased=False)
    return (x - m) / torch.sqrt(v + eps)

def _scatter_add(tgt, idx, src, axis=0):
    return tgt.clone().index_add_(axis, idx, src)

def _segment_sum(src, seg, n):
    out = torch.zeros((n,) + src.shape[1:], dtype=src.dtype)
    return out.index_add_(0, seg, src)

def _pad(x, pw):
    flat = tuple((v for pair in reversed(pw) for v in pair))
    return torch.nn.functional.pad(x, flat)
kernel_name = 'gated_mix__memory_aug_recurrent_mem_tr__moe_arch_mod__prompt'

def setup_inputs():

    _w = lambda a: (lambda t: t.to(torch.bfloat16) if t.is_floating_point() else t)(torch.as_tensor(a))

    def _A_setup():
        B, S, Dm = (1, 2048, 1024)
        H, Dh = (32, 128)
        M, seg = (8, 32)
        seg = min(seg, S)
        S = S // seg * seg
        return {'x': _w((lambda *s: torch.randn(*s, dtype=torch.bfloat16) * 0.05)(B, S, Dm)), 'mem0': _w((lambda *s: torch.randn(*s, dtype=torch.bfloat16) * 0.8)(B, M, Dm)), 'Wq': _w((lambda *s: torch.randn(*s, dtype=torch.bfloat16) * 3.2)(Dm, H, Dh) * Dm ** (-0.5)), 'Wk': _w((lambda *s: torch.randn(*s, dtype=torch.bfloat16) * 3.2)(Dm, H, Dh) * Dm ** (-0.5)), 'Wv': _w((lambda *s: torch.randn(*s, dtype=torch.bfloat16) * 0.8)(Dm, H, Dh) * Dm ** (-0.5)), 'Wo': _w((lambda *s: torch.randn(*s, dtype=torch.bfloat16) * 0.8)(H, Dh, Dm) * (H * Dh) ** (-0.5)), 'seg_len': seg}
    _A_in = _A_setup()

    def _B_setup():
        B, S, D, F, C = (1, 2048, 1024, 3584, 2)
        return {'x': _w((lambda *s: torch.randn(*s, dtype=torch.bfloat16) * 0.05)(B, S, D)), 'w_r': _w((lambda *s: torch.randn(*s, dtype=torch.bfloat16) * 1.6)(D)), 'w_gate': _w((lambda *s: torch.randn(*s, dtype=torch.bfloat16) * 0.2)(D, F)), 'w_up': _w((lambda *s: torch.randn(*s, dtype=torch.bfloat16) * 0.2)(D, F)), 'w_down': _w((lambda *s: torch.randn(*s, dtype=torch.bfloat16) * 0.2)(F, D))}
    _B_in = _B_setup()
    return {'A_x': _A_in['x'], 'A_mem0': _A_in['mem0'], 'A_Wq': _A_in['Wq'], 'A_Wk': _A_in['Wk'], 'A_Wv': _A_in['Wv'], 'A_Wo': _A_in['Wo'], 'A_seg_len': _A_in['seg_len'], 'B_x': _B_in['x'], 'B_w_r': _B_in['w_r'], 'B_w_gate': _B_in['w_gate'], 'B_w_up': _B_in['w_up'], 'B_w_down': _B_in['w_down'], 'gate_w': _w((lambda *s: torch.randn(*s, dtype=torch.bfloat16) * 0.05)(1024) * 16.0)}

def reference(A_x, A_mem0, A_Wq, A_Wk, A_Wv, A_Wo, A_seg_len, B_x, B_w_r, B_w_gate, B_w_up, B_w_down, gate_w):

    def _A_ref(x, mem0, Wq, Wk, Wv, Wo, seg_len):
        B, S, Dm = x.shape
        H, Dh = (Wq.shape[1], Wq.shape[2])
        M = mem0.shape[1]
        scale = Dh ** (-0.5)
        n_seg = S // seg_len
        L = M + seg_len
        idx = torch.arange(L)
        mask = (idx[:, None] < M) | (idx[:, None] >= idx[None, :])
        mem = mem0
        outs = []
        for s in range(n_seg):
            xs = x[:, s * seg_len:(s + 1) * seg_len, :].clone()
            h = torch.concatenate([mem, xs], axis=1)
            q = torch.einsum('btd,dhe->bhte', h, Wq)
            k = torch.einsum('btd,dhe->bhte', h, Wk)
            v = torch.einsum('btd,dhe->bhte', h, Wv)
            scores = torch.einsum('bhqe,bhke->bhqk', q, k) * scale
            scores = torch.where(mask[None, None], scores, -1000000000.0)
            p = _softmax(scores, axis=-1)
            o = torch.einsum('bhqk,bhke->bhqe', p, v)
            o = torch.einsum('bhte,hed->btd', o, Wo)
            mem = o[:, :M, :].clone()
            outs.append(o[:, M:, :])
        return torch.concatenate(outs, axis=1)

    def _B_ref(x, w_r, w_gate, w_up, w_down):
        B, S, D = x.shape
        C = 2
        r = x @ w_r
        idx = torch.argsort(-r, axis=-1)[:, :C]
        idx_e = (lambda x, n, axis: torch.repeat_interleave(x, n, dim=axis))(idx.reshape(B, C, 1), D, axis=2)
        x_sel = (lambda x, i, axis: torch.take_along_dim(x, i, dim=axis))(x, idx_e, axis=1)
        g = _silu(x_sel @ w_gate)
        u = x_sel @ w_up
        y = g * u @ w_down
        r_sel = _sigmoid((lambda x, i, axis: torch.take_along_dim(x, i, dim=axis))(r, idx, axis=1))
        y = y * r_sel.reshape(B, C, 1)
        b_off = (torch.arange(B) * S).reshape(B, 1)
        flat_idx = (idx + b_off).reshape(B * C)
        zero = (x * 0.0).reshape(B * S, D)
        upd = _scatter_add(zero, flat_idx, y.reshape(B * C, D), axis=0)
        return x + upd.reshape(B, S, D)
    x = A_x
    g = _sigmoid((x * gate_w).sum(-1, keepdims=True))
    a = _A_ref(x, A_mem0, A_Wq, A_Wk, A_Wv, A_Wo, A_seg_len)
    b = _B_ref(x, B_w_r, B_w_gate, B_w_up, B_w_down)
    return g * a + (1 - g) * b
```

```asm
; @launch kernel=main_kernel grid=(256,1,1) block=(256,1,1) lds=163840
.amdgcn_target "amdgcn-amd-amdhsa--gfx950"
.text
.macro ROLES sf
s_cmp_ge_u32 s40, 4
s_cbranch_scc1 f_grole_\sf
s_lshr_b32 s49, s41, 2
s_lshl_b32 s45, s40, 3
s_add_u32 s49, s49, s45
s_and_b32 s50, s41, 3
s_cmp_eq_u32 s42, 1
s_cbranch_scc1 r_wave1_\sf
s_cmp_eq_u32 s42, 2
s_cbranch_scc1 r_wave2_\sf
s_cmp_eq_u32 s42, 3
s_cbranch_scc1 r_wave3_\sf
r_wave0_\sf:
s_lshl_b32 s45, s40, 16
.if \sf == 0
s_add_u32 s52, s45, 0x4800000
.else
s_add_u32 s52, s45, 0xc800000
.endif
s_lshl_b32 s46, s41, 9
s_add_u32 s47, s45, s46
.if \sf == 0
s_add_u32 s53, s47, 0x4800000
s_add_u32 s56, s45, 0x48c0000
s_add_u32 s57, s47, 0x48c0000
.else
s_add_u32 s53, s47, 0xc800000
s_add_u32 s56, s45, 0xc8c0000
s_add_u32 s57, s47, 0xc8c0000
.endif
s_lshl_b32 s45, s40, 17
s_lshr_b32 s46, s41, 2
s_lshl_b32 s46, s46, 12
s_add_u32 s45, s45, s46
.if \sf == 0
s_add_u32 s55, s45, 0x4840000
.else
s_add_u32 s55, s45, 0xc840000
.endif
s_lshl_b32 s46, s50, 9
s_add_u32 s54, s55, s46
s_lshl_b32 s45, s41, 16
s_add_u32 s58, s45, 0x4a00000
s_lshl_b32 s46, s40, 10
s_add_u32 s58, s58, s46
s_add_u32 s51, s58, 0x200000
v_add_u32 v7, 0x1000, v2
s_lshl_b32 s45, s49, 11
s_lshl_b32 s46, s50, 9
s_add_u32 s45, s45, s46
s_add_u32 s60, s45, 0x4400000
s_lshl_b32 s45, s49, 13
s_add_u32 s61, s45, 0x1000000
s_lshl_b32 s46, s50, 11
s_add_u32 s45, s45, s46
s_add_u32 s62, s45, 0x2000000
s_mov_b32 s65, 0x3e0293ee
s_mov_b32 s74, 0x7fffffff
s_mov_b32 s75, 0x7fffffff
s_mov_b32 s72, 0x7fffffff
s_mov_b32 s73, 0x7fffffff
s_add_u32 s45, s54, 0x0
.if \sf == 0
buffer_store_dwordx2 v[8:9], v6, s[8:11], s45 offen
.else
buffer_store_dwordx2 v[8:9], v6, s[8:11], s45 offen sc1
.endif
s_add_u32 s45, s54, 0x800
.if \sf == 0
buffer_store_dwordx2 v[8:9], v6, s[8:11], s45 offen
.else
buffer_store_dwordx2 v[8:9], v6, s[8:11], s45 offen sc1
.endif
s_add_u32 s45, s58, 0x0
buffer_store_dwordx4 v[8:11], v2, s[8:11], s45 offen sc1
s_add_u32 s45, s58, 0x2000
buffer_store_dwordx4 v[8:11], v2, s[8:11], s45 offen sc1
s_add_u32 s45, s53, 0x0
.if \sf == 0
buffer_store_dwordx2 v[8:9], v6, s[8:11], s45 offen
.else
buffer_store_dwordx2 v[8:9], v6, s[8:11], s45 offen sc1
.endif
s_add_u32 s45, s57, 0x0
.if \sf == 0
buffer_store_dwordx2 v[8:9], v6, s[8:11], s45 offen
.else
buffer_store_dwordx2 v[8:9], v6, s[8:11], s45 offen sc1
.endif
s_add_u32 s45, s54, 0x8000
.if \sf == 0
buffer_store_dwordx2 v[8:9], v6, s[8:11], s45 offen
.else
buffer_store_dwordx2 v[8:9], v6, s[8:11], s45 offen sc1
.endif
s_add_u32 s45, s54, 0x8800
.if \sf == 0
buffer_store_dwordx2 v[8:9], v6, s[8:11], s45 offen
.else
buffer_store_dwordx2 v[8:9], v6, s[8:11], s45 offen sc1
.endif
s_add_u32 s45, s58, 0x4000
buffer_store_dwordx4 v[8:11], v2, s[8:11], s45 offen sc1
s_add_u32 s45, s58, 0x6000
buffer_store_dwordx4 v[8:11], v2, s[8:11], s45 offen sc1
s_add_u32 s45, s53, 0x4000
.if \sf == 0
buffer_store_dwordx2 v[8:9], v6, s[8:11], s45 offen
.else
buffer_store_dwordx2 v[8:9], v6, s[8:11], s45 offen sc1
.endif
s_add_u32 s45, s57, 0x4000
.if \sf == 0
buffer_store_dwordx2 v[8:9], v6, s[8:11], s45 offen
.else
buffer_store_dwordx2 v[8:9], v6, s[8:11], s45 offen sc1
.endif
s_add_u32 s45, s54, 0x10000
.if \sf == 0
buffer_store_dwordx2 v[8:9], v6, s[8:11], s45 offen
.else
buffer_store_dwordx2 v[8:9], v6, s[8:11], s45 offen sc1
.endif
s_add_u32 s45, s54, 0x10800
.if \sf == 0
buffer_store_dwordx2 v[8:9], v6, s[8:11], s45 offen
.else
buffer_store_dwordx2 v[8:9], v6, s[8:11], s45 offen sc1
.endif
s_add_u32 s45, s58, 0x8000
buffer_store_dwordx4 v[8:11], v2, s[8:11], s45 offen sc1
s_add_u32 s45, s58, 0xa000
buffer_store_dwordx4 v[8:11], v2, s[8:11], s45 offen sc1
s_add_u32 s45, s53, 0x8000
.if \sf == 0
buffer_store_dwordx2 v[8:9], v6, s[8:11], s45 offen
.else
buffer_store_dwordx2 v[8:9], v6, s[8:11], s45 offen sc1
.endif
s_add_u32 s45, s57, 0x8000
.if \sf == 0
buffer_store_dwordx2 v[8:9], v6, s[8:11], s45 offen
.else
buffer_store_dwordx2 v[8:9], v6, s[8:11], s45 offen sc1
.endif
s_add_u32 s45, s54, 0x18000
.if \sf == 0
buffer_store_dwordx2 v[8:9], v6, s[8:11], s45 offen
.else
buffer_store_dwordx2 v[8:9], v6, s[8:11], s45 offen sc1
.endif
s_add_u32 s45, s54, 0x18800
.if \sf == 0
buffer_store_dwordx2 v[8:9], v6, s[8:11], s45 offen
.else
buffer_store_dwordx2 v[8:9], v6, s[8:11], s45 offen sc1
.endif
s_add_u32 s45, s58, 0xc000
buffer_store_dwordx4 v[8:11], v2, s[8:11], s45 offen sc1
s_add_u32 s45, s58, 0xe000
buffer_store_dwordx4 v[8:11], v2, s[8:11], s45 offen sc1
s_add_u32 s45, s53, 0xc000
.if \sf == 0
buffer_store_dwordx2 v[8:9], v6, s[8:11], s45 offen
.else
buffer_store_dwordx2 v[8:9], v6, s[8:11], s45 offen sc1
.endif
s_add_u32 s45, s57, 0xc000
.if \sf == 0
buffer_store_dwordx2 v[8:9], v6, s[8:11], s45 offen
.else
buffer_store_dwordx2 v[8:9], v6, s[8:11], s45 offen sc1
.endif
s_lshl_b32 s45, s49, 8
s_lshl_b32 s46, s50, 2
s_add_u32 s45, s45, s46
s_add_u32 s60, s45, 0x5500000
v_mov_b32 v12, 0
v_mov_b32 v13, 0
s_mov_b64 exec, 1
buffer_store_dword v12, v13, s[8:11], s60 offen sc1
s_mov_b64 exec, -1
v_lshrrev_b32 v12, 2, v1
v_and_b32 v13, 3, v1
v_lshlrev_b32 v13, 4, v13
v_lshl_add_u32 v14, v12, 13, v13
v_lshl_add_u32 v15, v12, 11, v13
s_lshl_b32 s45, s40, 21
s_lshl_b32 s46, s42, 19
s_add_u32 s45, s45, s46
s_lshl_b32 s46, s41, 6
s_add_u32 s45, s45, s46
buffer_load_dwordx4 a[192:195], v15, s[24:27], s45 offen
s_add_u32 s45, s45, 0x8000
buffer_load_dwordx4 a[196:199], v15, s[24:27], s45 offen
s_add_u32 s45, s45, 0x8000
buffer_load_dwordx4 a[200:203], v15, s[24:27], s45 offen
s_add_u32 s45, s45, 0x8000
buffer_load_dwordx4 a[204:207], v15, s[24:27], s45 offen
s_add_u32 s45, s45, 0x8000
buffer_load_dwordx4 a[208:211], v15, s[24:27], s45 offen
s_add_u32 s45, s45, 0x8000
buffer_load_dwordx4 a[212:215], v15, s[24:27], s45 offen
s_add_u32 s45, s45, 0x8000
buffer_load_dwordx4 a[216:219], v15, s[24:27], s45 offen
s_add_u32 s45, s45, 0x8000
buffer_load_dwordx4 a[220:223], v15, s[24:27], s45 offen
s_add_u32 s45, s45, 0x8000
buffer_load_dwordx4 a[224:227], v15, s[24:27], s45 offen
s_add_u32 s45, s45, 0x8000
buffer_load_dwordx4 a[228:231], v15, s[24:27], s45 offen
s_add_u32 s45, s45, 0x8000
buffer_load_dwordx4 a[232:235], v15, s[24:27], s45 offen
s_add_u32 s45, s45, 0x8000
buffer_load_dwordx4 a[236:239], v15, s[24:27], s45 offen
s_add_u32 s45, s45, 0x8000
buffer_load_dwordx4 a[240:243], v15, s[24:27], s45 offen
s_add_u32 s45, s45, 0x8000
buffer_load_dwordx4 a[244:247], v15, s[24:27], s45 offen
s_add_u32 s45, s45, 0x8000
buffer_load_dwordx4 a[248:251], v15, s[24:27], s45 offen
s_add_u32 s45, s45, 0x8000
buffer_load_dwordx4 a[252:255], v15, s[24:27], s45 offen
s_waitcnt vmcnt(16)
v_mov_b32 v144, 1
.if \sf == 0
v_mov_b32 v145, 136
.else
v_mov_b32 v145, 160
.endif
s_mov_b64 exec, 1
buffer_atomic_add v144, v145, s[32:35], 0 offen sc1
s_mov_b64 exec, -1
s_lshl_b32 s47, s42, 21
s_lshl_b32 s46, s49, 8
s_add_u32 s47, s47, s46
s_lshl_b32 s46, s50, 6
s_add_u32 s47, s47, s46
s_mov_b32 s45, s47
buffer_load_dwordx4 a[64:67], v14, s[16:19], s45 offen
s_add_u32 s45, s45, 0x20000
buffer_load_dwordx4 a[68:71], v14, s[16:19], s45 offen
s_add_u32 s45, s45, 0x20000
buffer_load_dwordx4 a[72:75], v14, s[16:19], s45 offen
s_add_u32 s45, s45, 0x20000
buffer_load_dwordx4 a[76:79], v14, s[16:19], s45 offen
s_add_u32 s45, s45, 0x20000
buffer_load_dwordx4 a[80:83], v14, s[16:19], s45 offen
s_add_u32 s45, s45, 0x20000
buffer_load_dwordx4 a[84:87], v14, s[16:19], s45 offen
s_add_u32 s45, s45, 0x20000
buffer_load_dwordx4 a[88:91], v14, s[16:19], s45 offen
s_add_u32 s45, s45, 0x20000
buffer_load_dwordx4 a[92:95], v14, s[16:19], s45 offen
s_add_u32 s45, s45, 0x20000
buffer_load_dwordx4 a[96:99], v14, s[16:19], s45 offen
s_add_u32 s45, s45, 0x20000
buffer_load_dwordx4 a[100:103], v14, s[16:19], s45 offen
s_add_u32 s45, s45, 0x20000
buffer_load_dwordx4 a[104:107], v14, s[16:19], s45 offen
s_add_u32 s45, s45, 0x20000
buffer_load_dwordx4 a[108:111], v14, s[16:19], s45 offen
s_add_u32 s45, s45, 0x20000
buffer_load_dwordx4 a[112:115], v14, s[16:19], s45 offen
s_add_u32 s45, s45, 0x20000
buffer_load_dwordx4 a[116:119], v14, s[16:19], s45 offen
s_add_u32 s45, s45, 0x20000
buffer_load_dwordx4 a[120:123], v14, s[16:19], s45 offen
s_add_u32 s45, s45, 0x20000
buffer_load_dwordx4 a[124:127], v14, s[16:19], s45 offen
s_mov_b32 s45, s47
buffer_load_dwordx4 a[128:131], v14, s[20:23], s45 offen
s_add_u32 s45, s45, 0x20000
buffer_load_dwordx4 a[132:135], v14, s[20:23], s45 offen
s_add_u32 s45, s45, 0x20000
buffer_load_dwordx4 a[136:139], v14, s[20:23], s45 offen
s_add_u32 s45, s45, 0x20000
buffer_load_dwordx4 a[140:143], v14, s[20:23], s45 offen
s_add_u32 s45, s45, 0x20000
buffer_load_dwordx4 a[144:147], v14, s[20:23], s45 offen
s_add_u32 s45, s45, 0x20000
buffer_load_dwordx4 a[148:151], v14, s[20:23], s45 offen
s_add_u32 s45, s45, 0x20000
buffer_load_dwordx4 a[152:155], v14, s[20:23], s45 offen
s_add_u32 s45, s45, 0x20000
buffer_load_dwordx4 a[156:159], v14, s[20:23], s45 offen
s_add_u32 s45, s45, 0x20000
buffer_load_dwordx4 a[160:163], v14, s[20:23], s45 offen
s_add_u32 s45, s45, 0x20000
buffer_load_dwordx4 a[164:167], v14, s[20:23], s45 offen
s_add_u32 s45, s45, 0x20000
buffer_load_dwordx4 a[168:171], v14, s[20:23], s45 offen
s_add_u32 s45, s45, 0x20000
buffer_load_dwordx4 a[172:175], v14, s[20:23], s45 offen
s_add_u32 s45, s45, 0x20000
buffer_load_dwordx4 a[176:179], v14, s[20:23], s45 offen
s_add_u32 s45, s45, 0x20000
buffer_load_dwordx4 a[180:183], v14, s[20:23], s45 offen
s_add_u32 s45, s45, 0x20000
buffer_load_dwordx4 a[184:187], v14, s[20:23], s45 offen
s_add_u32 s45, s45, 0x20000
buffer_load_dwordx4 a[188:191], v14, s[20:23], s45 offen
s_mov_b32 s45, s47
buffer_load_dwordx4 a[0:3], v14, s[12:15], s45 offen
s_add_u32 s45, s45, 0x20000
buffer_load_dwordx4 a[4:7], v14, s[12:15], s45 offen
s_add_u32 s45, s45, 0x20000
buffer_load_dwordx4 a[8:11], v14, s[12:15], s45 offen
s_add_u32 s45, s45, 0x20000
buffer_load_dwordx4 a[12:15], v14, s[12:15], s45 offen
s_add_u32 s45, s45, 0x20000
buffer_load_dwordx4 a[16:19], v14, s[12:15], s45 offen
s_add_u32 s45, s45, 0x20000
buffer_load_dwordx4 a[20:23], v14, s[12:15], s45 offen
s_add_u32 s45, s45, 0x20000
buffer_load_dwordx4 a[24:27], v14, s[12:15], s45 offen
s_add_u32 s45, s45, 0x20000
buffer_load_dwordx4 a[28:31], v14, s[12:15], s45 offen
s_add_u32 s45, s45, 0x20000
buffer_load_dwordx4 a[32:35], v14, s[12:15], s45 offen
s_add_u32 s45, s45, 0x20000
buffer_load_dwordx4 a[36:39], v14, s[12:15], s45 offen
s_add_u32 s45, s45, 0x20000
buffer_load_dwordx4 a[40:43], v14, s[12:15], s45 offen
s_add_u32 s45, s45, 0x20000
buffer_load_dwordx4 a[44:47], v14, s[12:15], s45 offen
s_add_u32 s45, s45, 0x20000
buffer_load_dwordx4 a[48:51], v14, s[12:15], s45 offen
s_add_u32 s45, s45, 0x20000
buffer_load_dwordx4 a[52:55], v14, s[12:15], s45 offen
s_add_u32 s45, s45, 0x20000
buffer_load_dwordx4 a[56:59], v14, s[12:15], s45 offen
s_add_u32 s45, s45, 0x20000
buffer_load_dwordx4 a[60:63], v14, s[12:15], s45 offen
s_lshl_b32 s45, s42, 14
v_add_u32 v144, s45, v2
v_lshrrev_b32 v12, 4, v1
v_bfe_u32 v13, v1, 2, 2
v_and_b32 v14, 3, v1
v_lshl_add_u32 v15, v12, 4, v13
v_lshlrev_b32 v15, 6, v15
v_lshl_add_u32 v15, v14, 3, v15
v_add_u32 v145, s45, v15
v_lshl_add_u32 v15, v12, 2, v13
v_lshlrev_b32 v15, 6, v15
v_lshl_add_u32 v15, v14, 4, v15
v_add_u32 v146, s45, v15
s_waitcnt vmcnt(48)
ds_write_b128 v144, a[192:195] offset:0
ds_write_b128 v144, a[196:199] offset:1024
ds_write_b128 v144, a[200:203] offset:2048
ds_write_b128 v144, a[204:207] offset:3072
ds_write_b128 v144, a[208:211] offset:4096
ds_write_b128 v144, a[212:215] offset:5120
ds_write_b128 v144, a[216:219] offset:6144
ds_write_b128 v144, a[220:223] offset:7168
ds_write_b128 v144, a[224:227] offset:8192
ds_write_b128 v144, a[228:231] offset:9216
ds_write_b128 v144, a[232:235] offset:10240
ds_write_b128 v144, a[236:239] offset:11264
ds_write_b128 v144, a[240:243] offset:12288
ds_write_b128 v144, a[244:247] offset:13312
ds_write_b128 v144, a[248:251] offset:14336
ds_write_b128 v144, a[252:255] offset:15360
s_waitcnt lgkmcnt(0)
ds_read_b64_tr_b16 a[192:193], v146 offset:0
ds_read_b64_tr_b16 a[194:195], v146 offset:1024
ds_read_b64_tr_b16 a[196:197], v146 offset:2048
ds_read_b64_tr_b16 a[198:199], v146 offset:3072
ds_read_b64_tr_b16 a[200:201], v146 offset:4096
ds_read_b64_tr_b16 a[202:203], v146 offset:5120
ds_read_b64_tr_b16 a[204:205], v146 offset:6144
ds_read_b64_tr_b16 a[206:207], v146 offset:7168
ds_read_b64_tr_b16 a[208:209], v146 offset:8192
ds_read_b64_tr_b16 a[210:211], v146 offset:9216
ds_read_b64_tr_b16 a[212:213], v146 offset:10240
ds_read_b64_tr_b16 a[214:215], v146 offset:11264
ds_read_b64_tr_b16 a[216:217], v146 offset:12288
ds_read_b64_tr_b16 a[218:219], v146 offset:13312
ds_read_b64_tr_b16 a[220:221], v146 offset:14336
ds_read_b64_tr_b16 a[222:223], v146 offset:15360
ds_read_b64_tr_b16 a[224:225], v146 offset:8
ds_read_b64_tr_b16 a[226:227], v146 offset:1032
ds_read_b64_tr_b16 a[228:229], v146 offset:2056
ds_read_b64_tr_b16 a[230:231], v146 offset:3080
ds_read_b64_tr_b16 a[232:233], v146 offset:4104
ds_read_b64_tr_b16 a[234:235], v146 offset:5128
ds_read_b64_tr_b16 a[236:237], v146 offset:6152
ds_read_b64_tr_b16 a[238:239], v146 offset:7176
ds_read_b64_tr_b16 a[240:241], v146 offset:8200
ds_read_b64_tr_b16 a[242:243], v146 offset:9224
ds_read_b64_tr_b16 a[244:245], v146 offset:10248
ds_read_b64_tr_b16 a[246:247], v146 offset:11272
ds_read_b64_tr_b16 a[248:249], v146 offset:12296
ds_read_b64_tr_b16 a[250:251], v146 offset:13320
ds_read_b64_tr_b16 a[252:253], v146 offset:14344
ds_read_b64_tr_b16 a[254:255], v146 offset:15368
s_waitcnt lgkmcnt(0)
s_waitcnt vmcnt(32)
ds_write_b128 v144, a[64:67] offset:0
ds_write_b128 v144, a[68:71] offset:1024
ds_write_b128 v144, a[72:75] offset:2048
ds_write_b128 v144, a[76:79] offset:3072
ds_write_b128 v144, a[80:83] offset:4096
ds_write_b128 v144, a[84:87] offset:5120
ds_write_b128 v144, a[88:91] offset:6144
ds_write_b128 v144, a[92:95] offset:7168
ds_write_b128 v144, a[96:99] offset:8192
ds_write_b128 v144, a[100:103] offset:9216
ds_write_b128 v144, a[104:107] offset:10240
ds_write_b128 v144, a[108:111] offset:11264
ds_write_b128 v144, a[112:115] offset:12288
ds_write_b128 v144, a[116:119] offset:13312
ds_write_b128 v144, a[120:123] offset:14336
ds_write_b128 v144, a[124:127] offset:15360
s_waitcnt lgkmcnt(0)
ds_read_b64_tr_b16 a[64:65], v145 offset:0
ds_read_b64_tr_b16 a[66:67], v145 offset:256
ds_read_b64_tr_b16 a[68:69], v145 offset:512
ds_read_b64_tr_b16 a[70:71], v145 offset:768
ds_read_b64_tr_b16 a[72:73], v145 offset:4096
ds_read_b64_tr_b16 a[74:75], v145 offset:4352
ds_read_b64_tr_b16 a[76:77], v145 offset:4608
ds_read_b64_tr_b16 a[78:79], v145 offset:4864
ds_read_b64_tr_b16 a[80:81], v145 offset:8192
ds_read_b64_tr_b16 a[82:83], v145 offset:8448
ds_read_b64_tr_b16 a[84:85], v145 offset:8704
ds_read_b64_tr_b16 a[86:87], v145 offset:8960
ds_read_b64_tr_b16 a[88:89], v145 offset:12288
ds_read_b64_tr_b16 a[90:91], v145 offset:12544
ds_read_b64_tr_b16 a[92:93], v145 offset:12800
ds_read_b64_tr_b16 a[94:95], v145 offset:13056
ds_read_b64_tr_b16 a[96:97], v145 offset:32
ds_read_b64_tr_b16 a[98:99], v145 offset:288
ds_read_b64_tr_b16 a[100:101], v145 offset:544
ds_read_b64_tr_b16 a[102:103], v145 offset:800
ds_read_b64_tr_b16 a[104:105], v145 offset:4128
ds_read_b64_tr_b16 a[106:107], v145 offset:4384
ds_read_b64_tr_b16 a[108:109], v145 offset:4640
ds_read_b64_tr_b16 a[110:111], v145 offset:4896
ds_read_b64_tr_b16 a[112:113], v145 offset:8224
ds_read_b64_tr_b16 a[114:115], v145 offset:8480
ds_read_b64_tr_b16 a[116:117], v145 offset:8736
ds_read_b64_tr_b16 a[118:119], v145 offset:8992
ds_read_b64_tr_b16 a[120:121], v145 offset:12320
ds_read_b64_tr_b16 a[122:123], v145 offset:12576
ds_read_b64_tr_b16 a[124:125], v145 offset:12832
ds_read_b64_tr_b16 a[126:127], v145 offset:13088
s_waitcnt lgkmcnt(0)
s_waitcnt vmcnt(16)
ds_write_b128 v144, a[128:131] offset:0
ds_write_b128 v144, a[132:135] offset:1024
ds_write_b128 v144, a[136:139] offset:2048
ds_write_b128 v144, a[140:143] offset:3072
ds_write_b128 v144, a[144:147] offset:4096
ds_write_b128 v144, a[148:151] offset:5120
ds_write_b128 v144, a[152:155] offset:6144
ds_write_b128 v144, a[156:159] offset:7168
ds_write_b128 v144, a[160:163] offset:8192
ds_write_b128 v144, a[164:167] offset:9216
ds_write_b128 v144, a[168:171] offset:10240
ds_write_b128 v144, a[172:175] offset:11264
ds_write_b128 v144, a[176:179] offset:12288
ds_write_b128 v144, a[180:183] offset:13312
ds_write_b128 v144, a[184:187] offset:14336
ds_write_b128 v144, a[188:191] offset:15360
s_waitcnt lgkmcnt(0)
ds_read_b64_tr_b16 a[128:129], v145 offset:0
ds_read_b64_tr_b16 a[130:131], v145 offset:256
ds_read_b64_tr_b16 a[132:133], v145 offset:512
ds_read_b64_tr_b16 a[134:135], v145 offset:768
ds_read_b64_tr_b16 a[136:137], v145 offset:4096
ds_read_b64_tr_b16 a[138:139], v145 offset:4352
ds_read_b64_tr_b16 a[140:141], v145 offset:4608
ds_read_b64_tr_b16 a[142:143], v145 offset:4864
ds_read_b64_tr_b16 a[144:145], v145 offset:8192
ds_read_b64_tr_b16 a[146:147], v145 offset:8448
ds_read_b64_tr_b16 a[148:149], v145 offset:8704
ds_read_b64_tr_b16 a[150:151], v145 offset:8960
ds_read_b64_tr_b16 a[152:153], v145 offset:12288
ds_read_b64_tr_b16 a[154:155], v145 offset:12544
ds_read_b64_tr_b16 a[156:157], v145 offset:12800
ds_read_b64_tr_b16 a[158:159], v145 offset:13056
ds_read_b64_tr_b16 a[160:161], v145 offset:32
ds_read_b64_tr_b16 a[162:163], v145 offset:288
ds_read_b64_tr_b16 a[164:165], v145 offset:544
ds_read_b64_tr_b16 a[166:167], v145 offset:800
ds_read_b64_tr_b16 a[168:169], v145 offset:4128
ds_read_b64_tr_b16 a[170:171], v145 offset:4384
ds_read_b64_tr_b16 a[172:173], v145 offset:4640
ds_read_b64_tr_b16 a[174:175], v145 offset:4896
ds_read_b64_tr_b16 a[176:177], v145 offset:8224
ds_read_b64_tr_b16 a[178:179], v145 offset:8480
ds_read_b64_tr_b16 a[180:181], v145 offset:8736
ds_read_b64_tr_b16 a[182:183], v145 offset:8992
ds_read_b64_tr_b16 a[184:185], v145 offset:12320
ds_read_b64_tr_b16 a[186:187], v145 offset:12576
ds_read_b64_tr_b16 a[188:189], v145 offset:12832
ds_read_b64_tr_b16 a[190:191], v145 offset:13088
s_waitcnt lgkmcnt(0)
s_waitcnt vmcnt(0)
ds_write_b128 v144, a[0:3] offset:0
ds_write_b128 v144, a[4:7] offset:1024
ds_write_b128 v144, a[8:11] offset:2048
ds_write_b128 v144, a[12:15] offset:3072
ds_write_b128 v144, a[16:19] offset:4096
ds_write_b128 v144, a[20:23] offset:5120
ds_write_b128 v144, a[24:27] offset:6144
ds_write_b128 v144, a[28:31] offset:7168
ds_write_b128 v144, a[32:35] offset:8192
ds_write_b128 v144, a[36:39] offset:9216
ds_write_b128 v144, a[40:43] offset:10240
ds_write_b128 v144, a[44:47] offset:11264
ds_write_b128 v144, a[48:51] offset:12288
ds_write_b128 v144, a[52:55] offset:13312
ds_write_b128 v144, a[56:59] offset:14336
ds_write_b128 v144, a[60:63] offset:15360
s_waitcnt lgkmcnt(0)
ds_read_b64_tr_b16 a[0:1], v145 offset:0
ds_read_b64_tr_b16 a[2:3], v145 offset:256
ds_read_b64_tr_b16 a[4:5], v145 offset:512
ds_read_b64_tr_b16 a[6:7], v145 offset:768
ds_read_b64_tr_b16 a[8:9], v145 offset:4096
ds_read_b64_tr_b16 a[10:11], v145 offset:4352
ds_read_b64_tr_b16 a[12:13], v145 offset:4608
ds_read_b64_tr_b16 a[14:15], v145 offset:4864
ds_read_b64_tr_b16 a[16:17], v145 offset:8192
ds_read_b64_tr_b16 a[18:19], v145 offset:8448
ds_read_b64_tr_b16 a[20:21], v145 offset:8704
ds_read_b64_tr_b16 a[22:23], v145 offset:8960
ds_read_b64_tr_b16 a[24:25], v145 offset:12288
ds_read_b64_tr_b16 a[26:27], v145 offset:12544
ds_read_b64_tr_b16 a[28:29], v145 offset:12800
ds_read_b64_tr_b16 a[30:31], v145 offset:13056
ds_read_b64_tr_b16 a[32:33], v145 offset:32
ds_read_b64_tr_b16 a[34:35], v145 offset:288
ds_read_b64_tr_b16 a[36:37], v145 offset:544
ds_read_b64_tr_b16 a[38:39], v145 offset:800
ds_read_b64_tr_b16 a[40:41], v145 offset:4128
ds_read_b64_tr_b16 a[42:43], v145 offset:4384
ds_read_b64_tr_b16 a[44:45], v145 offset:4640
ds_read_b64_tr_b16 a[46:47], v145 offset:4896
ds_read_b64_tr_b16 a[48:49], v145 offset:8224
ds_read_b64_tr_b16 a[50:51], v145 offset:8480
ds_read_b64_tr_b16 a[52:53], v145 offset:8736
ds_read_b64_tr_b16 a[54:55], v145 offset:8992
ds_read_b64_tr_b16 a[56:57], v145 offset:12320
ds_read_b64_tr_b16 a[58:59], v145 offset:12576
ds_read_b64_tr_b16 a[60:61], v145 offset:12832
ds_read_b64_tr_b16 a[62:63], v145 offset:13088
s_waitcnt lgkmcnt(0)
s_barrier
.if \sf == 0
v_mov_b32 v14, 136
.else
v_mov_b32 v14, 160
.endif
s_nop 1
iw_5_\sf:
buffer_load_dwordx2 v[12:13], v14, s[32:35], 0 offen sc1
s_waitcnt vmcnt(0)
v_cmp_gt_u32 vcc, 256, v12
s_cbranch_vccz iwd_6_\sf
s_sleep 2
s_add_u32 s44, s44, 1
s_cmp_lt_u32 s44, 0x40000
s_cbranch_scc1 iw_5_\sf
iwd_6_\sf:
.if \sf == 0
v_readfirstlane_b32 s45, v13
s_cmp_lg_u32 s45, 0
s_nop 3
s_cbranch_scc1 SAFE_ENTRY
.else
.endif
s_mov_b32 s59, 0
s_mov_b32 s6, 160
s_barrier
s_mov_b32 s43, 0
r_loop_w0_\sf:
s_and_b32 s63, s43, 3
s_add_u32 s64, s43, 2
s_and_b32 s64, s64, 3
s_lshl_b32 s66, s63, 14
s_add_u32 s66, s66, s52
s_lshl_b32 s67, s63, 14
s_add_u32 s67, s67, s56
s_lshl_b32 s68, s63, 15
s_add_u32 s68, s68, s54
s_lshl_b32 s69, s64, 15
s_add_u32 s69, s69, s54
s_barrier
buffer_load_dwordx4 v[64:67], v2, s[8:11], s66 offen offset:0 sc1
buffer_load_dwordx4 v[68:71], v2, s[8:11], s66 offen offset:1024 sc1
buffer_load_dwordx4 v[72:75], v2, s[8:11], s66 offen offset:2048 sc1
buffer_load_dwordx4 v[76:79], v2, s[8:11], s66 offen offset:3072 sc1
s_waitcnt vmcnt(3)
v_max3_u32 v12, v64, v65, v66
v_max_u32 v12, v12, v67
v_cmp_eq_u32 vcc, -1, v12
s_cbranch_vccnz ppr_7_\sf
ppo_8_\sf:
v_mfma_f32_16x16x32_bf16 v[80:83], a[0:3], v[64:67], 0
v_mfma_f32_16x16x32_bf16 v[84:87], a[4:7], v[64:67], 0
s_waitcnt vmcnt(2)
v_mfma_f32_16x16x32_bf16 v[88:91], a[32:35], v[64:67], 0
v_max3_u32 v12, v68, v69, v70
v_mfma_f32_16x16x32_bf16 v[92:95], a[36:39], v[64:67], 0
v_max_u32 v12, v12, v71
v_mfma_f32_16x16x32_bf16 v[96:99], a[64:67], v[64:67], 0
v_cmp_eq_u32 vcc, -1, v12
v_mfma_f32_16x16x32_bf16 v[100:103], a[68:71], v[64:67], 0
v_mfma_f32_16x16x32_bf16 v[104:107], a[96:99], v[64:67], 0
v_mfma_f32_16x16x32_bf16 v[108:111], a[100:103], v[64:67], 0
s_cbranch_vccnz ppr_9_\sf
ppo_10_\sf:
v_mfma_f32_16x16x32_bf16 v[80:83], a[8:11], v[68:71], v[80:83]
v_mfma_f32_16x16x32_bf16 v[84:87], a[12:15], v[68:71], v[84:87]
s_waitcnt vmcnt(1)
v_mfma_f32_16x16x32_bf16 v[88:91], a[40:43], v[68:71], v[88:91]
v_max3_u32 v12, v72, v73, v74
v_mfma_f32_16x16x32_bf16 v[92:95], a[44:47], v[68:71], v[92:95]
v_max_u32 v12, v12, v75
v_mfma_f32_16x16x32_bf16 v[96:99], a[72:75], v[68:71], v[96:99]
v_cmp_eq_u32 vcc, -1, v12
v_mfma_f32_16x16x32_bf16 v[100:103], a[76:79], v[68:71], v[100:103]
v_mfma_f32_16x16x32_bf16 v[104:107], a[104:107], v[68:71], v[104:107]
v_mfma_f32_16x16x32_bf16 v[108:111], a[108:111], v[68:71], v[108:111]
s_cbranch_vccnz ppr_11_\sf
ppo_12_\sf:
v_mfma_f32_16x16x32_bf16 v[80:83], a[16:19], v[72:75], v[80:83]
v_mfma_f32_16x16x32_bf16 v[84:87], a[20:23], v[72:75], v[84:87]
s_waitcnt vmcnt(0)
v_mfma_f32_16x16x32_bf16 v[88:91], a[48:51], v[72:75], v[88:91]
v_max3_u32 v12, v76, v77, v78
v_mfma_f32_16x16x32_bf16 v[92:95], a[52:55], v[72:75], v[92:95]
v_max_u32 v12, v12, v79
v_mfma_f32_16x16x32_bf16 v[96:99], a[80:83], v[72:75], v[96:99]
v_cmp_eq_u32 vcc, -1, v12
v_mfma_f32_16x16x32_bf16 v[100:103], a[84:87], v[72:75], v[100:103]
s_cbranch_vccnz ppr_13_\sf
ppo_14_\sf:
v_mfma_f32_16x16x32_bf16 v[80:83], a[24:27], v[76:79], v[80:83]
v_mfma_f32_16x16x32_bf16 v[84:87], a[28:31], v[76:79], v[84:87]
v_mfma_f32_16x16x32_bf16 v[88:91], a[56:59], v[76:79], v[88:91]
v_mfma_f32_16x16x32_bf16 v[92:95], a[60:63], v[76:79], v[92:95]
v_mfma_f32_16x16x32_bf16 v[104:107], a[112:115], v[72:75], v[104:107]
v_mfma_f32_16x16x32_bf16 v[108:111], a[116:119], v[72:75], v[108:111]
v_mfma_f32_16x16x32_bf16 v[96:99], a[88:91], v[76:79], v[96:99]
s_nop 2
v_add_f32_dpp v128, v84, v80 row_ror:8 row_mask:0xf bank_mask:0x3
v_add_f32_dpp v129, v85, v81 row_ror:8 row_mask:0xf bank_mask:0x3
v_mfma_f32_16x16x32_bf16 v[100:103], a[92:95], v[76:79], v[100:103]
v_add_f32_dpp v130, v86, v82 row_ror:8 row_mask:0xf bank_mask:0x3
v_add_f32_dpp v131, v87, v83 row_ror:8 row_mask:0xf bank_mask:0x3
v_mfma_f32_16x16x32_bf16 v[104:107], a[120:123], v[76:79], v[104:107]
v_add_f32_dpp v128, v88, v92 row_ror:8 row_mask:0xf bank_mask:0xc
v_add_f32_dpp v129, v89, v93 row_ror:8 row_mask:0xf bank_mask:0xc
v_mfma_f32_16x16x32_bf16 v[108:111], a[124:127], v[76:79], v[108:111]
v_add_f32_dpp v130, v90, v94 row_ror:8 row_mask:0xf bank_mask:0xc
v_add_f32_dpp v131, v91, v95 row_ror:8 row_mask:0xf bank_mask:0xc
v_add_f32_dpp v132, v100, v96 row_ror:8 row_mask:0xf bank_mask:0x3
v_add_f32_dpp v133, v101, v97 row_ror:8 row_mask:0xf bank_mask:0x3
v_add_f32_dpp v134, v102, v98 row_ror:8 row_mask:0xf bank_mask:0x3
v_add_f32_dpp v135, v103, v99 row_ror:8 row_mask:0xf bank_mask:0x3
s_nop 1
v_add_f32_dpp v132, v104, v108 row_ror:8 row_mask:0xf bank_mask:0xc
v_add_f32_dpp v133, v105, v109 row_ror:8 row_mask:0xf bank_mask:0xc
v_add_f32_dpp v134, v106, v110 row_ror:8 row_mask:0xf bank_mask:0xc
v_add_f32_dpp v135, v107, v111 row_ror:8 row_mask:0xf bank_mask:0xc
ds_write_b128 v2, v[132:135] offset:4096
s_waitcnt lgkmcnt(0)
s_barrier
ds_read_b128 v[144:147], v2 offset:1024
ds_read_b128 v[148:151], v2 offset:2048
ds_read_b128 v[152:155], v2 offset:3072
s_waitcnt lgkmcnt(2)
v_pk_add_f32 v[128:129], v[128:129], v[144:145]
v_pk_add_f32 v[130:131], v[130:131], v[146:147]
s_waitcnt lgkmcnt(0)
v_pk_add_f32 v[148:149], v[148:149], v[152:153]
v_pk_add_f32 v[150:151], v[150:151], v[154:155]
v_pk_add_f32 v[128:129], v[128:129], v[148:149]
v_pk_add_f32 v[130:131], v[130:131], v[150:151]
v_cvt_pk_bf16_f32 v128, v128, v129
v_cvt_pk_bf16_f32 v129, v130, v131
v_min_u32 v128, -2, v128
v_min_u32 v129, -2, v129
.if \sf == 0
buffer_store_dwordx2 v[128:129], v3, s[8:11], s68 offen
buffer_store_dwordx2 v[8:9], v6, s[8:11], s69 offen
.else
buffer_store_dwordx2 v[128:129], v3, s[8:11], s68 offen sc1
buffer_store_dwordx2 v[8:9], v6, s[8:11], s69 offen sc1
.endif
v_mfma_f32_16x16x32_bf16 v[112:115], v[64:67], a[128:131], 0
v_mfma_f32_16x16x32_bf16 v[116:119], v[64:67], a[132:135], 0
v_mfma_f32_16x16x32_bf16 v[112:115], v[68:71], a[136:139], v[112:115]
v_mfma_f32_16x16x32_bf16 v[116:119], v[68:71], a[140:143], v[116:119]
v_mfma_f32_16x16x32_bf16 v[112:115], v[72:75], a[144:147], v[112:115]
v_mfma_f32_16x16x32_bf16 v[116:119], v[72:75], a[148:151], v[116:119]
v_mfma_f32_16x16x32_bf16 v[112:115], v[76:79], a[152:155], v[112:115]
v_mfma_f32_16x16x32_bf16 v[116:119], v[76:79], a[156:159], v[116:119]
v_mfma_f32_16x16x32_bf16 v[120:123], v[64:67], a[160:163], 0
v_mfma_f32_16x16x32_bf16 v[124:127], v[64:67], a[164:167], 0
v_mfma_f32_16x16x32_bf16 v[120:123], v[68:71], a[168:171], v[120:123]
v_mfma_f32_16x16x32_bf16 v[124:127], v[68:71], a[172:175], v[124:127]
v_mfma_f32_16x16x32_bf16 v[120:123], v[72:75], a[176:179], v[120:123]
v_mfma_f32_16x16x32_bf16 v[124:127], v[72:75], a[180:183], v[124:127]
v_mfma_f32_16x16x32_bf16 v[120:123], v[76:79], a[184:187], v[120:123]
v_mfma_f32_16x16x32_bf16 v[124:127], v[76:79], a[188:191], v[124:127]
s_nop 6
v_permlane32_swap_b32 v112, v120
v_permlane32_swap_b32 v116, v124
v_permlane32_swap_b32 v113, v121
v_permlane32_swap_b32 v117, v125
v_permlane32_swap_b32 v114, v122
v_permlane32_swap_b32 v118, v126
v_permlane32_swap_b32 v115, v123
v_permlane32_swap_b32 v119, v127
v_add_f32 v136, v112, v124
v_add_f32 v137, v113, v125
v_add_f32 v138, v114, v126
v_add_f32 v139, v115, v127
ds_write_b128 v2, v[136:139] offset:8192
s_waitcnt lgkmcnt(0)
s_barrier
s_cmp_eq_u32 s43, 63
s_cbranch_scc1 r_end_w0_\sf
s_add_u32 s45, s43, 0
v_mov_b32 v12, s45
v_mov_b32 v13, 0
s_mov_b64 exec, 1
buffer_store_dword v12, v13, s[8:11], s60 offen sc1
s_mov_b64 exec, -1
s_cmp_lg_u32 s43, 4
s_cbranch_scc1 nosw_15_\sf
v_mov_b32 v13, 132
s_nop 1
ch_16_\sf:
buffer_load_dword v12, v13, s[32:35], 0 offen sc1
s_waitcnt vmcnt(0)
v_readfirstlane_b32 s45, v12
s_cmp_lg_u32 s45, 0
s_cbranch_scc1 chd_17_\sf
s_add_u32 s44, s44, 1
s_cmp_lt_u32 s44, 0x40000
s_cbranch_scc1 ch_16_\sf
chd_17_\sf:
s_and_b32 s46, s45, 1
s_lshl_b32 s46, s46, 13
s_add_u32 s58, s58, s46
s_and_b32 s46, s45, 2
s_lshl_b32 s46, s46, 12
s_add_u32 s51, s51, s46
nosw_15_\sf:
s_add_u32 s47, s43, 1
s_and_b32 s47, s47, 3
s_lshl_b32 s68, s47, 14
s_add_u32 s68, s68, s58
s_lshl_b32 s69, s47, 14
s_add_u32 s69, s69, s51
s_add_u32 s47, s43, 3
s_and_b32 s47, s47, 3
s_lshl_b32 s36, s47, 14
s_add_u32 s36, s36, s58
s_lshl_b32 s37, s47, 14
s_add_u32 s37, s37, s51
buffer_store_dwordx4 v[8:11], v2, s[8:11], s36 offen sc1
s_barrier
buffer_load_dwordx4 v[64:67], v5, s[8:11], s67 offen offset:0 sc1
buffer_load_dwordx4 v[68:71], v5, s[8:11], s67 offen offset:1024 sc1
buffer_load_dwordx4 v[72:75], v5, s[8:11], s67 offen offset:2048 sc1
buffer_load_dwordx4 v[76:79], v5, s[8:11], s67 offen offset:3072 sc1
s_waitcnt vmcnt(3)
v_max3_u32 v12, v64, v65, v66
v_max_u32 v12, v12, v67
v_cmp_eq_u32 vcc, -1, v12
s_cbranch_vccnz ppr_18_\sf
ppo_19_\sf:
v_mfma_f32_16x16x32_bf16 v[80:83], a[192:195], v[64:67], 0
s_waitcnt vmcnt(2)
v_max3_u32 v12, v68, v69, v70
v_mfma_f32_16x16x32_bf16 v[84:87], a[196:199], v[64:67], 0
v_max_u32 v12, v12, v71
v_cmp_eq_u32 vcc, -1, v12
v_mfma_f32_16x16x32_bf16 v[88:91], a[224:227], v[64:67], 0
v_mfma_f32_16x16x32_bf16 v[92:95], a[228:231], v[64:67], 0
s_cbranch_vccnz ppr_20_\sf
ppo_21_\sf:
v_mfma_f32_16x16x32_bf16 v[80:83], a[200:203], v[68:71], v[80:83]
s_waitcnt vmcnt(1)
v_max3_u32 v12, v72, v73, v74
v_mfma_f32_16x16x32_bf16 v[84:87], a[204:207], v[68:71], v[84:87]
v_max_u32 v12, v12, v75
v_cmp_eq_u32 vcc, -1, v12
v_mfma_f32_16x16x32_bf16 v[88:91], a[232:235], v[68:71], v[88:91]
v_mfma_f32_16x16x32_bf16 v[92:95], a[236:239], v[68:71], v[92:95]
s_cbranch_vccnz ppr_22_\sf
ppo_23_\sf:
v_mfma_f32_16x16x32_bf16 v[80:83], a[208:211], v[72:75], v[80:83]
s_waitcnt vmcnt(0)
v_max3_u32 v12, v76, v77, v78
v_mfma_f32_16x16x32_bf16 v[84:87], a[212:215], v[72:75], v[84:87]
v_max_u32 v12, v12, v79
v_cmp_eq_u32 vcc, -1, v12
v_mfma_f32_16x16x32_bf16 v[88:91], a[240:243], v[72:75], v[88:91]
v_mfma_f32_16x16x32_bf16 v[92:95], a[244:247], v[72:75], v[92:95]
s_cbranch_vccnz ppr_24_\sf
ppo_25_\sf:
v_mfma_f32_16x16x32_bf16 v[80:83], a[216:219], v[76:79], v[80:83]
v_mfma_f32_16x16x32_bf16 v[84:87], a[220:223], v[76:79], v[84:87]
v_mfma_f32_16x16x32_bf16 v[88:91], a[248:251], v[76:79], v[88:91]
v_mfma_f32_16x16x32_bf16 v[92:95], a[252:255], v[76:79], v[92:95]
s_nop 5
v_add_f32_dpp v140, v84, v80 row_ror:8 row_mask:0xf bank_mask:0x3
v_add_f32_dpp v141, v85, v81 row_ror:8 row_mask:0xf bank_mask:0x3
v_add_f32_dpp v142, v86, v82 row_ror:8 row_mask:0xf bank_mask:0x3
v_add_f32_dpp v143, v87, v83 row_ror:8 row_mask:0xf bank_mask:0x3
v_add_f32_dpp v140, v88, v92 row_ror:8 row_mask:0xf bank_mask:0xc
v_add_f32_dpp v141, v89, v93 row_ror:8 row_mask:0xf bank_mask:0xc
v_add_f32_dpp v142, v90, v94 row_ror:8 row_mask:0xf bank_mask:0xc
v_add_f32_dpp v143, v91, v95 row_ror:8 row_mask:0xf bank_mask:0xc
s_waitcnt lgkmcnt(0)
s_barrier
ds_read_b128 v[144:147], v2 offset:13312
ds_read_b128 v[148:151], v2 offset:14336
ds_read_b128 v[152:155], v2 offset:15360
s_waitcnt lgkmcnt(2)
v_pk_add_f32 v[140:141], v[140:141], v[144:145]
v_pk_add_f32 v[142:143], v[142:143], v[146:147]
s_waitcnt lgkmcnt(0)
v_pk_add_f32 v[148:149], v[148:149], v[152:153]
v_pk_add_f32 v[150:151], v[150:151], v[154:155]
v_pk_add_f32 v[140:141], v[140:141], v[148:149]
v_pk_add_f32 v[142:143], v[142:143], v[150:151]
v_min_u32 v140, -2, v140
v_min_u32 v141, -2, v141
v_min_u32 v142, -2, v142
v_min_u32 v143, -2, v143
buffer_store_dwordx4 v[140:143], v2, s[8:11], s68 offen sc1
s_or_b32 s45, s40, s41
s_cmp_lg_u32 s45, 0
s_cbranch_scc1 noprobe_26_\sf
s_cmp_gt_u32 s43, 3
s_cbranch_scc1 noprobe_26_\sf
s_cmp_eq_u32 s43, 3
s_cbranch_scc1 pubch_27_\sf
s_waitcnt vmcnt(0)
s_sleep 2
s_mov_b32 s68, s36
s_add_u32 s46, s43, 0
s_and_b32 s46, s46, 1
s_lshl_b32 s45, s46, 13
s_add_u32 s45, s45, s68
s_memtime s[96:97]
s_waitcnt lgkmcnt(0)
buffer_store_dwordx4 v[8:11], v2, s[8:11], s45 offen sc1
s_waitcnt vmcnt(0)
s_memtime s[98:99]
s_waitcnt lgkmcnt(0)
s_sub_u32 s48, s98, s96
s_min_u32 s45, s74, s48
s_cmp_eq_u32 s46, 0
s_cselect_b32 s74, s45, s74
s_min_u32 s45, s75, s48
s_cmp_eq_u32 s46, 1
s_cselect_b32 s75, s45, s75
s_min_u32 s45, s72, s48
s_cmp_eq_u32 s46, 2
s_cselect_b32 s72, s45, s72
s_min_u32 s45, s73, s48
s_cmp_eq_u32 s46, 3
s_cselect_b32 s73, s45, s73
s_add_u32 s46, s43, 1
s_and_b32 s46, s46, 1
s_lshl_b32 s45, s46, 13
s_add_u32 s45, s45, s68
s_memtime s[96:97]
s_waitcnt lgkmcnt(0)
buffer_store_dwordx4 v[8:11], v2, s[8:11], s45 offen sc1
s_waitcnt vmcnt(0)
s_memtime s[98:99]
s_waitcnt lgkmcnt(0)
s_sub_u32 s48, s98, s96
s_min_u32 s45, s74, s48
s_cmp_eq_u32 s46, 0
s_cselect_b32 s74, s45, s74
s_min_u32 s45, s75, s48
s_cmp_eq_u32 s46, 1
s_cselect_b32 s75, s45, s75
s_min_u32 s45, s72, s48
s_cmp_eq_u32 s46, 2
s_cselect_b32 s72, s45, s72
s_min_u32 s45, s73, s48
s_cmp_eq_u32 s46, 3
s_cselect_b32 s73, s45, s73
s_branch noprobe_26_\sf
pubch_27_\sf:
s_cmp_lt_u32 s75, s74
s_cselect_b32 s45, 5, 4
s_cmp_lt_u32 s73, s72
s_cselect_b32 s46, 2, 0
s_or_b32 s45, s45, s46
v_mov_b32 v12, s45
v_mov_b32 v13, 132
s_mov_b64 exec, 1
buffer_store_dword v12, v13, s[32:35], 0 offen sc1
s_mov_b64 exec, -1
noprobe_26_\sf:
s_add_u32 s43, s43, 1
s_branch r_loop_w0_\sf
ppr_7_\sf:
s_nop 7
buffer_load_dwordx4 v[64:67], v2, s[8:11], s66 offen offset:0 sc1
buffer_load_dwordx4 v[68:71], v2, s[8:11], s66 offen offset:1024 sc1
buffer_load_dwordx4 v[72:75], v2, s[8:11], s66 offen offset:2048 sc1
buffer_load_dwordx4 v[76:79], v2, s[8:11], s66 offen offset:3072 sc1
s_add_u32 s44, s44, 1
s_waitcnt vmcnt(3)
v_max3_u32 v12, v64, v65, v66
v_max_u32 v12, v12, v67
v_cmp_eq_u32 vcc, -1, v12
s_cbranch_vccz ppo_8_\sf
s_cmp_lt_u32 s44, 0x40000
s_cbranch_scc1 ppr_7_\sf
s_branch ppo_8_\sf
s_nop 0
ppr_9_\sf:
s_nop 7
buffer_load_dwordx4 v[68:71], v2, s[8:11], s66 offen offset:1024 sc1
buffer_load_dwordx4 v[72:75], v2, s[8:11], s66 offen offset:2048 sc1
buffer_load_dwordx4 v[76:79], v2, s[8:11], s66 offen offset:3072 sc1
s_add_u32 s44, s44, 1
s_waitcnt vmcnt(2)
v_max3_u32 v12, v68, v69, v70
v_max_u32 v12, v12, v71
v_cmp_eq_u32 vcc, -1, v12
s_cbranch_vccz ppo_10_\sf
s_cmp_lt_u32 s44, 0x40000
s_cbranch_scc1 ppr_9_\sf
s_branch ppo_10_\sf
s_nop 0
ppr_11_\sf:
s_nop 7
buffer_load_dwordx4 v[72:75], v2, s[8:11], s66 offen offset:2048 sc1
buffer_load_dwordx4 v[76:79], v2, s[8:11], s66 offen offset:3072 sc1
s_add_u32 s44, s44, 1
s_waitcnt vmcnt(1)
v_max3_u32 v12, v72, v73, v74
v_max_u32 v12, v12, v75
v_cmp_eq_u32 vcc, -1, v12
s_cbranch_vccz ppo_12_\sf
s_cmp_lt_u32 s44, 0x40000
s_cbranch_scc1 ppr_11_\sf
s_branch ppo_12_\sf
s_nop 0
ppr_13_\sf:
s_nop 7
buffer_load_dwordx4 v[76:79], v2, s[8:11], s66 offen offset:3072 sc1
s_add_u32 s44, s44, 1
s_waitcnt vmcnt(0)
v_max3_u32 v12, v76, v77, v78
v_max_u32 v12, v12, v79
v_cmp_eq_u32 vcc, -1, v12
s_cbranch_vccz ppo_14_\sf
s_cmp_lt_u32 s44, 0x40000
s_cbranch_scc1 ppr_13_\sf
s_branch ppo_14_\sf
s_nop 0
ppr_18_\sf:
s_nop 7
buffer_load_dwordx4 v[64:67], v5, s[8:11], s67 offen offset:0 sc1
buffer_load_dwordx4 v[68:71], v5, s[8:11], s67 offen offset:1024 sc1
buffer_load_dwordx4 v[72:75], v5, s[8:11], s67 offen offset:2048 sc1
buffer_load_dwordx4 v[76:79], v5, s[8:11], s67 offen offset:3072 sc1
s_add_u32 s44, s44, 1
s_waitcnt vmcnt(3)
v_max3_u32 v12, v64, v65, v66
v_max_u32 v12, v12, v67
v_cmp_eq_u32 vcc, -1, v12
s_cbranch_vccz ppo_19_\sf
s_cmp_lt_u32 s44, 0x40000
s_cbranch_scc1 ppr_18_\sf
s_branch ppo_19_\sf
s_nop 0
ppr_20_\sf:
s_nop 7
buffer_load_dwordx4 v[68:71], v5, s[8:11], s67 offen offset:1024 sc1
buffer_load_dwordx4 v[72:75], v5, s[8:11], s67 offen offset:2048 sc1
buffer_load_dwordx4 v[76:79], v5, s[8:11], s67 offen offset:3072 sc1
s_add_u32 s44, s44, 1
s_waitcnt vmcnt(2)
v_max3_u32 v12, v68, v69, v70
v_max_u32 v12, v12, v71
v_cmp_eq_u32 vcc, -1, v12
s_cbranch_vccz ppo_21_\sf
s_cmp_lt_u32 s44, 0x40000
s_cbranch_scc1 ppr_20_\sf
s_branch ppo_21_\sf
s_nop 0
ppr_22_\sf:
s_nop 7
buffer_load_dwordx4 v[72:75], v5, s[8:11], s67 offen offset:2048 sc1
buffer_load_dwordx4 v[76:79], v5, s[8:11], s67 offen offset:3072 sc1
s_add_u32 s44, s44, 1
s_waitcnt vmcnt(1)
v_max3_u32 v12, v72, v73, v74
v_max_u32 v12, v12, v75
v_cmp_eq_u32 vcc, -1, v12
s_cbranch_vccz ppo_23_\sf
s_cmp_lt_u32 s44, 0x40000
s_cbranch_scc1 ppr_22_\sf
s_branch ppo_23_\sf
s_nop 0
ppr_24_\sf:
s_nop 7
buffer_load_dwordx4 v[76:79], v5, s[8:11], s67 offen offset:3072 sc1
s_add_u32 s44, s44, 1
s_waitcnt vmcnt(0)
v_max3_u32 v12, v76, v77, v78
v_max_u32 v12, v12, v79
v_cmp_eq_u32 vcc, -1, v12
s_cbranch_vccz ppo_25_\sf
s_cmp_lt_u32 s44, 0x40000
s_cbranch_scc1 ppr_24_\sf
s_branch ppo_25_\sf
s_nop 0
r_end_w0_\sf:
s_waitcnt vmcnt(0)
s_barrier
v_mov_b32 v12, 64
v_mov_b32 v13, 0
s_mov_b64 exec, 1
buffer_store_dword v12, v13, s[8:11], s60 offen sc1
s_mov_b64 exec, -1
s_endpgm
r_wave1_\sf:
s_lshl_b32 s45, s40, 16
.if \sf == 0
s_add_u32 s52, s45, 0x4801000
.else
s_add_u32 s52, s45, 0xc801000
.endif
s_lshl_b32 s46, s41, 9
s_add_u32 s47, s45, s46
.if \sf == 0
s_add_u32 s53, s47, 0x4800000
s_add_u32 s56, s45, 0x48c1000
s_add_u32 s57, s47, 0x48c0000
.else
s_add_u32 s53, s47, 0xc800000
s_add_u32 s56, s45, 0xc8c1000
s_add_u32 s57, s47, 0xc8c0000
.endif
s_lshl_b32 s45, s40, 17
s_lshr_b32 s46, s41, 2
s_lshl_b32 s46, s46, 12
s_add_u32 s45, s45, s46
.if \sf == 0
s_add_u32 s55, s45, 0x4840000
.else
s_add_u32 s55, s45, 0xc840000
.endif
s_lshl_b32 s46, s50, 9
s_add_u32 s54, s55, s46
s_add_u32 s54, s54, 2048
s_lshl_b32 s45, s41, 16
s_add_u32 s58, s45, 0x4a00000
s_add_u32 s51, s58, 0x200000
v_add_u32 v7, 0x1000, v2
s_lshl_b32 s45, s49, 11
s_lshl_b32 s46, s50, 9
s_add_u32 s45, s45, s46
s_add_u32 s60, s45, 0x4000000
s_lshl_b32 s45, s49, 13
s_add_u32 s61, s45, 0x1000000
s_lshl_b32 s46, s50, 11
s_add_u32 s45, s45, s46
s_add_u32 s62, s45, 0x2000000
s_mov_b32 s65, 0x3e0293ee
s_mov_b32 s74, 0x7fffffff
s_mov_b32 s75, 0x7fffffff
s_mov_b32 s72, 0x7fffffff
s_mov_b32 s73, 0x7fffffff
v_add_u32 v12, 0, v1
v_lshlrev_b32 v232, 3, v12
v_add_u32 v236, 0x1000, v232
v_lshrrev_b32 v13, 1, v12
v_and_b32 v14, 7, v13
v_lshrrev_b32 v15, 4, v13
v_lshl_add_u32 v233, v15, 3, v14
v_lshlrev_b32 v233, 4, v233
v_bfe_u32 v15, v13, 3, 1
v_lshl_add_u32 v233, v15, 3, v233
v_and_b32 v15, 1, v1
v_lshl_add_u32 v233, v15, 2, v233
v_lshrrev_b32 v13, 3, v13
v_lshlrev_b32 v13, 3, v13
v_lshl_add_u32 v13, v15, 2, v13
v_lshl_add_u32 v12, v14, 11, v13
s_lshl_b32 s45, s41, 6
buffer_load_dword v224, v12, s[28:31], s45 offen
v_mov_b32 v234, 0
v_mov_b32 v235, 0
v_lshrrev_b32 v12, 2, v1
v_and_b32 v13, 3, v1
v_lshlrev_b32 v13, 4, v13
v_lshl_add_u32 v14, v12, 13, v13
v_lshl_add_u32 v15, v12, 11, v13
s_lshl_b32 s45, s40, 21
s_lshl_b32 s46, s42, 19
s_add_u32 s45, s45, s46
s_lshl_b32 s46, s41, 6
s_add_u32 s45, s45, s46
buffer_load_dwordx4 a[192:195], v15, s[24:27], s45 offen
s_add_u32 s45, s45, 0x8000
buffer_load_dwordx4 a[196:199], v15, s[24:27], s45 offen
s_add_u32 s45, s45, 0x8000
buffer_load_dwordx4 a[200:203], v15, s[24:27], s45 offen
s_add_u32 s45, s45, 0x8000
buffer_load_dwordx4 a[204:207], v15, s[24:27], s45 offen
s_add_u32 s45, s45, 0x8000
buffer_load_dwordx4 a[208:211], v15, s[24:27], s45 offen
s_add_u32 s45, s45, 0x8000
buffer_load_dwordx4 a[212:215], v15, s[24:27], s45 offen
s_add_u32 s45, s45, 0x8000
buffer_load_dwordx4 a[216:219], v15, s[24:27], s45 offen
s_add_u32 s45, s45, 0x8000
buffer_load_dwordx4 a[220:223], v15, s[24:27], s45 offen
s_add_u32 s45, s45, 0x8000
buffer_load_dwordx4 a[224:227], v15, s[24:27], s45 offen
s_add_u32 s45, s45, 0x8000
buffer_load_dwordx4 a[228:231], v15, s[24:27], s45 offen
s_add_u32 s45, s45, 0x8000
buffer_load_dwordx4 a[232:235], v15, s[24:27], s45 offen
s_add_u32 s45, s45, 0x8000
buffer_load_dwordx4 a[236:239], v15, s[24:27], s45 offen
s_add_u32 s45, s45, 0x8000
buffer_load_dwordx4 a[240:243], v15, s[24:27], s45 offen
s_add_u32 s45, s45, 0x8000
buffer_load_dwordx4 a[244:247], v15, s[24:27], s45 offen
s_add_u32 s45, s45, 0x8000
buffer_load_dwordx4 a[248:251], v15, s[24:27], s45 offen
s_add_u32 s45, s45, 0x8000
buffer_load_dwordx4 a[252:255], v15, s[24:27], s45 offen
s_lshl_b32 s47, s42, 21
s_lshl_b32 s46, s49, 8
s_add_u32 s47, s47, s46
s_lshl_b32 s46, s50, 6
s_add_u32 s47, s47, s46
s_mov_b32 s45, s47
buffer_load_dwordx4 a[64:67], v14, s[16:19], s45 offen
s_add_u32 s45, s45, 0x20000
buffer_load_dwordx4 a[68:71], v14, s[16:19], s45 offen
s_add_u32 s45, s45, 0x20000
buffer_load_dwordx4 a[72:75], v14, s[16:19], s45 offen
s_add_u32 s45, s45, 0x20000
buffer_load_dwordx4 a[76:79], v14, s[16:19], s45 offen
s_add_u32 s45, s45, 0x20000
buffer_load_dwordx4 a[80:83], v14, s[16:19], s45 offen
s_add_u32 s45, s45, 0x20000
buffer_load_dwordx4 a[84:87], v14, s[16:19], s45 offen
s_add_u32 s45, s45, 0x20000
buffer_load_dwordx4 a[88:91], v14, s[16:19], s45 offen
s_add_u32 s45, s45, 0x20000
buffer_load_dwordx4 a[92:95], v14, s[16:19], s45 offen
s_add_u32 s45, s45, 0x20000
buffer_load_dwordx4 a[96:99], v14, s[16:19], s45 offen
s_add_u32 s45, s45, 0x20000
buffer_load_dwordx4 a[100:103], v14, s[16:19], s45 offen
s_add_u32 s45, s45, 0x20000
buffer_load_dwordx4 a[104:107], v14, s[16:19], s45 offen
s_add_u32 s45, s45, 0x20000
buffer_load_dwordx4 a[108:111], v14, s[16:19], s45 offen
s_add_u32 s45, s45, 0x20000
buffer_load_dwordx4 a[112:115], v14, s[16:19], s45 offen
s_add_u32 s45, s45, 0x20000
buffer_load_dwordx4 a[116:119], v14, s[16:19], s45 offen
s_add_u32 s45, s45, 0x20000
buffer_load_dwordx4 a[120:123], v14, s[16:19], s45 offen
s_add_u32 s45, s45, 0x20000
buffer_load_dwordx4 a[124:127], v14, s[16:19], s45 offen
s_mov_b32 s45, s47
buffer_load_dwordx4 a[128:131], v14, s[20:23], s45 offen
s_add_u32 s45, s45, 0x20000
buffer_load_dwordx4 a[132:135], v14, s[20:23], s45 offen
s_add_u32 s45, s45, 0x20000
buffer_load_dwordx4 a[136:139], v14, s[20:23], s45 offen
s_add_u32 s45, s45, 0x20000
buffer_load_dwordx4 a[140:143], v14, s[20:23], s45 offen
s_add_u32 s45, s45, 0x20000
buffer_load_dwordx4 a[144:147], v14, s[20:23], s45 offen
s_add_u32 s45, s45, 0x20000
buffer_load_dwordx4 a[148:151], v14, s[20:23], s45 offen
s_add_u32 s45, s45, 0x20000
buffer_load_dwordx4 a[152:155], v14, s[20:23], s45 offen
s_add_u32 s45, s45, 0x20000
buffer_load_dwordx4 a[156:159], v14, s[20:23], s45 offen
s_add_u32 s45, s45, 0x20000
buffer_load_dwordx4 a[160:163], v14, s[20:23], s45 offen
s_add_u32 s45, s45, 0x20000
buffer_load_dwordx4 a[164:167], v14, s[20:23], s45 offen
s_add_u32 s45, s45, 0x20000
buffer_load_dwordx4 a[168:171], v14, s[20:23], s45 offen
s_add_u32 s45, s45, 0x20000
buffer_load_dwordx4 a[172:175], v14, s[20:23], s45 offen
s_add_u32 s45, s45, 0x20000
buffer_load_dwordx4 a[176:179], v14, s[20:23], s45 offen
s_add_u32 s45, s45, 0x20000
buffer_load_dwordx4 a[180:183], v14, s[20:23], s45 offen
s_add_u32 s45, s45, 0x20000
buffer_load_dwordx4 a[184:187], v14, s[20:23], s45 offen
s_add_u32 s45, s45, 0x20000
buffer_load_dwordx4 a[188:191], v14, s[20:23], s45 offen
s_mov_b32 s45, s47
buffer_load_dwordx4 a[0:3], v14, s[12:15], s45 offen
s_add_u32 s45, s45, 0x20000
buffer_load_dwordx4 a[4:7], v14, s[12:15], s45 offen
s_add_u32 s45, s45, 0x20000
buffer_load_dwordx4 a[8:11], v14, s[12:15], s45 offen
s_add_u32 s45, s45, 0x20000
buffer_load_dwordx4 a[12:15], v14, s[12:15], s45 offen
s_add_u32 s45, s45, 0x20000
buffer_load_dwordx4 a[16:19], v14, s[12:15], s45 offen
s_add_u32 s45, s45, 0x20000
buffer_load_dwordx4 a[20:23], v14, s[12:15], s45 offen
s_add_u32 s45, s45, 0x20000
buffer_load_dwordx4 a[24:27], v14, s[12:15], s45 offen
s_add_u32 s45, s45, 0x20000
buffer_load_dwordx4 a[28:31], v14, s[12:15], s45 offen
s_add_u32 s45, s45, 0x20000
buffer_load_dwordx4 a[32:35], v14, s[12:15], s45 offen
s_add_u32 s45, s45, 0x20000
buffer_load_dwordx4 a[36:39], v14, s[12:15], s45 offen
s_add_u32 s45, s45, 0x20000
buffer_load_dwordx4 a[40:43], v14, s[12:15], s45 offen
s_add_u32 s45, s45, 0x20000
buffer_load_dwordx4 a[44:47], v14, s[12:15], s45 offen
s_add_u32 s45, s45, 0x20000
buffer_load_dwordx4 a[48:51], v14, s[12:15], s45 offen
s_add_u32 s45, s45, 0x20000
buffer_load_dwordx4 a[52:55], v14, s[12:15], s45 offen
s_add_u32 s45, s45, 0x20000
buffer_load_dwordx4 a[56:59], v14, s[12:15], s45 offen
s_add_u32 s45, s45, 0x20000
buffer_load_dwordx4 a[60:63], v14, s[12:15], s45 offen
s_lshl_b32 s45, s42, 14
v_add_u32 v144, s45, v2
v_lshrrev_b32 v12, 4, v1
v_bfe_u32 v13, v1, 2, 2
v_and_b32 v14, 3, v1
v_lshl_add_u32 v15, v12, 4, v13
v_lshlrev_b32 v15, 6, v15
v_lshl_add_u32 v15, v14, 3, v15
v_add_u32 v145, s45, v15
v_lshl_add_u32 v15, v12, 2, v13
v_lshlrev_b32 v15, 6, v15
v_lshl_add_u32 v15, v14, 4, v15
v_add_u32 v146, s45, v15
s_waitcnt vmcnt(48)
ds_write_b128 v144, a[192:195] offset:0
ds_write_b128 v144, a[196:199] offset:1024
ds_write_b128 v144, a[200:203] offset:2048
ds_write_b128 v144, a[204:207] offset:3072
ds_write_b128 v144, a[208:211] offset:4096
ds_write_b128 v144, a[212:215] offset:5120
ds_write_b128 v144, a[216:219] offset:6144
ds_write_b128 v144, a[220:223] offset:7168
ds_write_b128 v144, a[224:227] offset:8192
ds_write_b128 v144, a[228:231] offset:9216
ds_write_b128 v144, a[232:235] offset:10240
ds_write_b128 v144, a[236:239] offset:11264
ds_write_b128 v144, a[240:243] offset:12288
ds_write_b128 v144, a[244:247] offset:13312
ds_write_b128 v144, a[248:251] offset:14336
ds_write_b128 v144, a[252:255] offset:15360
s_waitcnt lgkmcnt(0)
ds_read_b64_tr_b16 a[192:193], v146 offset:0
ds_read_b64_tr_b16 a[194:195], v146 offset:1024
ds_read_b64_tr_b16 a[196:197], v146 offset:2048
ds_read_b64_tr_b16 a[198:199], v146 offset:3072
ds_read_b64_tr_b16 a[200:201], v146 offset:4096
ds_read_b64_tr_b16 a[202:203], v146 offset:5120
ds_read_b64_tr_b16 a[204:205], v146 offset:6144
ds_read_b64_tr_b16 a[206:207], v146 offset:7168
ds_read_b64_tr_b16 a[208:209], v146 offset:8192
ds_read_b64_tr_b16 a[210:211], v146 offset:9216
ds_read_b64_tr_b16 a[212:213], v146 offset:10240
ds_read_b64_tr_b16 a[214:215], v146 offset:11264
ds_read_b64_tr_b16 a[216:217], v146 offset:12288
ds_read_b64_tr_b16 a[218:219], v146 offset:13312
ds_read_b64_tr_b16 a[220:221], v146 offset:14336
ds_read_b64_tr_b16 a[222:223], v146 offset:15360
ds_read_b64_tr_b16 a[224:225], v146 offset:8
ds_read_b64_tr_b16 a[226:227], v146 offset:1032
ds_read_b64_tr_b16 a[228:229], v146 offset:2056
ds_read_b64_tr_b16 a[230:231], v146 offset:3080
ds_read_b64_tr_b16 a[232:233], v146 offset:4104
ds_read_b64_tr_b16 a[234:235], v146 offset:5128
ds_read_b64_tr_b16 a[236:237], v146 offset:6152
ds_read_b64_tr_b16 a[238:239], v146 offset:7176
ds_read_b64_tr_b16 a[240:241], v146 offset:8200
ds_read_b64_tr_b16 a[242:243], v146 offset:9224
ds_read_b64_tr_b16 a[244:245], v146 offset:10248
ds_read_b64_tr_b16 a[246:247], v146 offset:11272
ds_read_b64_tr_b16 a[248:249], v146 offset:12296
ds_read_b64_tr_b16 a[250:251], v146 offset:13320
ds_read_b64_tr_b16 a[252:253], v146 offset:14344
ds_read_b64_tr_b16 a[254:255], v146 offset:15368
s_waitcnt lgkmcnt(0)
s_waitcnt vmcnt(32)
ds_write_b128 v144, a[64:67] offset:0
ds_write_b128 v144, a[68:71] offset:1024
ds_write_b128 v144, a[72:75] offset:2048
ds_write_b128 v144, a[76:79] offset:3072
ds_write_b128 v144, a[80:83] offset:4096
ds_write_b128 v144, a[84:87] offset:5120
ds_write_b128 v144, a[88:91] offset:6144
ds_write_b128 v144, a[92:95] offset:7168
ds_write_b128 v144, a[96:99] offset:8192
ds_write_b128 v144, a[100:103] offset:9216
ds_write_b128 v144, a[104:107] offset:10240
ds_write_b128 v144, a[108:111] offset:11264
ds_write_b128 v144, a[112:115] offset:12288
ds_write_b128 v144, a[116:119] offset:13312
ds_write_b128 v144, a[120:123] offset:14336
ds_write_b128 v144, a[124:127] offset:15360
s_waitcnt lgkmcnt(0)
ds_read_b64_tr_b16 a[64:65], v145 offset:0
ds_read_b64_tr_b16 a[66:67], v145 offset:256
ds_read_b64_tr_b16 a[68:69], v145 offset:512
ds_read_b64_tr_b16 a[70:71], v145 offset:768
ds_read_b64_tr_b16 a[72:73], v145 offset:4096
ds_read_b64_tr_b16 a[74:75], v145 offset:4352
ds_read_b64_tr_b16 a[76:77], v145 offset:4608
ds_read_b64_tr_b16 a[78:79], v145 offset:4864
ds_read_b64_tr_b16 a[80:81], v145 offset:8192
ds_read_b64_tr_b16 a[82:83], v145 offset:8448
ds_read_b64_tr_b16 a[84:85], v145 offset:8704
ds_read_b64_tr_b16 a[86:87], v145 offset:8960
ds_read_b64_tr_b16 a[88:89], v145 offset:12288
ds_read_b64_tr_b16 a[90:91], v145 offset:12544
ds_read_b64_tr_b16 a[92:93], v145 offset:12800
ds_read_b64_tr_b16 a[94:95], v145 offset:13056
ds_read_b64_tr_b16 a[96:97], v145 offset:32
ds_read_b64_tr_b16 a[98:99], v145 offset:288
ds_read_b64_tr_b16 a[100:101], v145 offset:544
ds_read_b64_tr_b16 a[102:103], v145 offset:800
ds_read_b64_tr_b16 a[104:105], v145 offset:4128
ds_read_b64_tr_b16 a[106:107], v145 offset:4384
ds_read_b64_tr_b16 a[108:109], v145 offset:4640
ds_read_b64_tr_b16 a[110:111], v145 offset:4896
ds_read_b64_tr_b16 a[112:113], v145 offset:8224
ds_read_b64_tr_b16 a[114:115], v145 offset:8480
ds_read_b64_tr_b16 a[116:117], v145 offset:8736
ds_read_b64_tr_b16 a[118:119], v145 offset:8992
ds_read_b64_tr_b16 a[120:121], v145 offset:12320
ds_read_b64_tr_b16 a[122:123], v145 offset:12576
ds_read_b64_tr_b16 a[124:125], v145 offset:12832
ds_read_b64_tr_b16 a[126:127], v145 offset:13088
s_waitcnt lgkmcnt(0)
s_waitcnt vmcnt(16)
ds_write_b128 v144, a[128:131] offset:0
ds_write_b128 v144, a[132:135] offset:1024
ds_write_b128 v144, a[136:139] offset:2048
ds_write_b128 v144, a[140:143] offset:3072
ds_write_b128 v144, a[144:147] offset:4096
ds_write_b128 v144, a[148:151] offset:5120
ds_write_b128 v144, a[152:155] offset:6144
ds_write_b128 v144, a[156:159] offset:7168
ds_write_b128 v144, a[160:163] offset:8192
ds_write_b128 v144, a[164:167] offset:9216
ds_write_b128 v144, a[168:171] offset:10240
ds_write_b128 v144, a[172:175] offset:11264
ds_write_b128 v144, a[176:179] offset:12288
ds_write_b128 v144, a[180:183] offset:13312
ds_write_b128 v144, a[184:187] offset:14336
ds_write_b128 v144, a[188:191] offset:15360
s_waitcnt lgkmcnt(0)
ds_read_b64_tr_b16 a[128:129], v145 offset:0
ds_read_b64_tr_b16 a[130:131], v145 offset:256
ds_read_b64_tr_b16 a[132:133], v145 offset:512
ds_read_b64_tr_b16 a[134:135], v145 offset:768
ds_read_b64_tr_b16 a[136:137], v145 offset:4096
ds_read_b64_tr_b16 a[138:139], v145 offset:4352
ds_read_b64_tr_b16 a[140:141], v145 offset:4608
ds_read_b64_tr_b16 a[142:143], v145 offset:4864
ds_read_b64_tr_b16 a[144:145], v145 offset:8192
ds_read_b64_tr_b16 a[146:147], v145 offset:8448
ds_read_b64_tr_b16 a[148:149], v145 offset:8704
ds_read_b64_tr_b16 a[150:151], v145 offset:8960
ds_read_b64_tr_b16 a[152:153], v145 offset:12288
ds_read_b64_tr_b16 a[154:155], v145 offset:12544
ds_read_b64_tr_b16 a[156:157], v145 offset:12800
ds_read_b64_tr_b16 a[158:159], v145 offset:13056
ds_read_b64_tr_b16 a[160:161], v145 offset:32
ds_read_b64_tr_b16 a[162:163], v145 offset:288
ds_read_b64_tr_b16 a[164:165], v145 offset:544
ds_read_b64_tr_b16 a[166:167], v145 offset:800
ds_read_b64_tr_b16 a[168:169], v145 offset:4128
ds_read_b64_tr_b16 a[170:171], v145 offset:4384
ds_read_b64_tr_b16 a[172:173], v145 offset:4640
ds_read_b64_tr_b16 a[174:175], v145 offset:4896
ds_read_b64_tr_b16 a[176:177], v145 offset:8224
ds_read_b64_tr_b16 a[178:179], v145 offset:8480
ds_read_b64_tr_b16 a[180:181], v145 offset:8736
ds_read_b64_tr_b16 a[182:183], v145 offset:8992
ds_read_b64_tr_b16 a[184:185], v145 offset:12320
ds_read_b64_tr_b16 a[186:187], v145 offset:12576
ds_read_b64_tr_b16 a[188:189], v145 offset:12832
ds_read_b64_tr_b16 a[190:191], v145 offset:13088
s_waitcnt lgkmcnt(0)
s_waitcnt vmcnt(0)
ds_write_b128 v144, a[0:3] offset:0
ds_write_b128 v144, a[4:7] offset:1024
ds_write_b128 v144, a[8:11] offset:2048
ds_write_b128 v144, a[12:15] offset:3072
ds_write_b128 v144, a[16:19] offset:4096
ds_write_b128 v144, a[20:23] offset:5120
ds_write_b128 v144, a[24:27] offset:6144
ds_write_b128 v144, a[28:31] offset:7168
ds_write_b128 v144, a[32:35] offset:8192
ds_write_b128 v144, a[36:39] offset:9216
ds_write_b128 v144, a[40:43] offset:10240
ds_write_b128 v144, a[44:47] offset:11264
ds_write_b128 v144, a[48:51] offset:12288
ds_write_b128 v144, a[52:55] offset:13312
ds_write_b128 v144, a[56:59] offset:14336
ds_write_b128 v144, a[60:63] offset:15360
s_waitcnt lgkmcnt(0)
ds_read_b64_tr_b16 a[0:1], v145 offset:0
ds_read_b64_tr_b16 a[2:3], v145 offset:256
ds_read_b64_tr_b16 a[4:5], v145 offset:512
ds_read_b64_tr_b16 a[6:7], v145 offset:768
ds_read_b64_tr_b16 a[8:9], v145 offset:4096
ds_read_b64_tr_b16 a[10:11], v145 offset:4352
ds_read_b64_tr_b16 a[12:13], v145 offset:4608
ds_read_b64_tr_b16 a[14:15], v145 offset:4864
ds_read_b64_tr_b16 a[16:17], v145 offset:8192
ds_read_b64_tr_b16 a[18:19], v145 offset:8448
ds_read_b64_tr_b16 a[20:21], v145 offset:8704
ds_read_b64_tr_b16 a[22:23], v145 offset:8960
ds_read_b64_tr_b16 a[24:25], v145 offset:12288
ds_read_b64_tr_b16 a[26:27], v145 offset:12544
ds_read_b64_tr_b16 a[28:29], v145 offset:12800
ds_read_b64_tr_b16 a[30:31], v145 offset:13056
ds_read_b64_tr_b16 a[32:33], v145 offset:32
ds_read_b64_tr_b16 a[34:35], v145 offset:288
ds_read_b64_tr_b16 a[36:37], v145 offset:544
ds_read_b64_tr_b16 a[38:39], v145 offset:800
ds_read_b64_tr_b16 a[40:41], v145 offset:4128
ds_read_b64_tr_b16 a[42:43], v145 offset:4384
ds_read_b64_tr_b16 a[44:45], v145 offset:4640
ds_read_b64_tr_b16 a[46:47], v145 offset:4896
ds_read_b64_tr_b16 a[48:49], v145 offset:8224
ds_read_b64_tr_b16 a[50:51], v145 offset:8480
ds_read_b64_tr_b16 a[52:53], v145 offset:8736
ds_read_b64_tr_b16 a[54:55], v145 offset:8992
ds_read_b64_tr_b16 a[56:57], v145 offset:12320
ds_read_b64_tr_b16 a[58:59], v145 offset:12576
ds_read_b64_tr_b16 a[60:61], v145 offset:12832
ds_read_b64_tr_b16 a[62:63], v145 offset:13088
s_waitcnt lgkmcnt(0)
s_barrier
.if \sf == 0
v_mov_b32 v14, 136
.else
v_mov_b32 v14, 160
.endif
s_nop 1
iw_28_\sf:
buffer_load_dwordx2 v[12:13], v14, s[32:35], 0 offen sc1
s_waitcnt vmcnt(0)
v_cmp_gt_u32 vcc, 256, v12
s_cbranch_vccz iwd_29_\sf
s_sleep 2
s_add_u32 s44, s44, 1
s_cmp_lt_u32 s44, 0x40000
s_cbranch_scc1 iw_28_\sf
iwd_29_\sf:
.if \sf == 0
v_readfirstlane_b32 s45, v13
s_cmp_lg_u32 s45, 0
s_nop 3
s_cbranch_scc1 SAFE_ENTRY
.else
.endif
s_mov_b32 s59, 0
s_mov_b32 s6, 160
s_barrier
s_mov_b32 s43, 0
r_loop_w1_\sf:
s_and_b32 s63, s43, 3
s_add_u32 s64, s43, 2
s_and_b32 s64, s64, 3
s_lshl_b32 s66, s63, 14
s_add_u32 s66, s66, s52
s_lshl_b32 s67, s63, 14
s_add_u32 s67, s67, s56
s_lshl_b32 s4, s63, 14
s_add_u32 s4, s4, s53
s_lshl_b32 s5, s64, 14
s_add_u32 s5, s5, s53
s_lshl_b32 s68, s63, 15
s_add_u32 s68, s68, s54
s_lshl_b32 s69, s64, 15
s_add_u32 s69, s69, s54
s_cmp_eq_u32 s43, 0
s_cbranch_scc1 apub_30_\sf
s_cmp_lg_u32 s43, 5
s_cbranch_scc1 nosw_31_\sf
v_mov_b32 v13, 132
s_nop 1
ch_32_\sf:
buffer_load_dword v12, v13, s[32:35], 0 offen sc1
s_waitcnt vmcnt(0)
v_readfirstlane_b32 s45, v12
s_cmp_lg_u32 s45, 0
s_cbranch_scc1 chd_33_\sf
s_add_u32 s44, s44, 1
s_cmp_lt_u32 s44, 0x40000
s_cbranch_scc1 ch_32_\sf
chd_33_\sf:
s_and_b32 s46, s45, 1
s_lshl_b32 s46, s46, 13
s_add_u32 s58, s58, s46
s_and_b32 s46, s45, 2
s_lshl_b32 s46, s46, 12
s_add_u32 s51, s51, s46
nosw_31_\sf:
s_lshl_b32 s45, s63, 14
s_add_u32 s45, s45, s58
s_add_u32 s36, s8, s45
s_addc_u32 s37, s9, 0
s_lshl_b32 s45, s63, 14
s_add_u32 s45, s45, s51
s_add_u32 s38, s8, s45
s_addc_u32 s39, s9, 0
s_sleep 7
global_load_dwordx2 v[160:161], v232, s[36:37] offset:0 sc1
global_load_dwordx2 v[162:163], v232, s[36:37] offset:1024 sc1
global_load_dwordx2 v[164:165], v232, s[36:37] offset:2048 sc1
global_load_dwordx2 v[166:167], v232, s[36:37] offset:3072 sc1
xw_35_\sf:
s_waitcnt vmcnt(0)
v_max3_u32 v12, v160, v161, v162
v_pk_add_f32 v[168:169], v[160:161], v[162:163]
v_max3_u32 v13, v163, v164, v165
v_pk_add_f32 v[170:171], v[164:165], v[166:167]
v_max3_u32 v12, v12, v166, v167
v_pk_add_f32 v[168:169], v[168:169], v[170:171]
v_max_u32 v12, v12, v13
v_cvt_pk_bf16_f32 v224, v168, v169
v_cmp_eq_u32 vcc, -1, v12
s_cbranch_vccnz xr_34_\sf
apub_30_\sf:
v_min_u32 v224, -2, v224
.if \sf == 0
buffer_store_dword v224, v233, s[8:11], s4 offen
.else
buffer_store_dword v224, v233, s[8:11], s4 offen sc1
.endif
s_barrier
buffer_load_dwordx4 v[64:67], v2, s[8:11], s66 offen offset:0 sc1
buffer_load_dwordx4 v[68:71], v2, s[8:11], s66 offen offset:1024 sc1
buffer_load_dwordx4 v[72:75], v2, s[8:11], s66 offen offset:2048 sc1
buffer_load_dwordx4 v[76:79], v2, s[8:11], s66 offen offset:3072 sc1
s_waitcnt vmcnt(3)
v_max3_u32 v12, v64, v65, v66
v_max_u32 v12, v12, v67
v_cmp_eq_u32 vcc, -1, v12
s_cbranch_vccnz ppr_36_\sf
ppo_37_\sf:
v_mfma_f32_16x16x32_bf16 v[80:83], a[0:3], v[64:67], 0
v_mfma_f32_16x16x32_bf16 v[84:87], a[4:7], v[64:67], 0
s_waitcnt vmcnt(2)
v_mfma_f32_16x16x32_bf16 v[88:91], a[32:35], v[64:67], 0
v_max3_u32 v12, v68, v69, v70
v_mfma_f32_16x16x32_bf16 v[92:95], a[36:39], v[64:67], 0
v_max_u32 v12, v12, v71
v_mfma_f32_16x16x32_bf16 v[96:99], a[64:67], v[64:67], 0
v_cmp_eq_u32 vcc, -1, v12
v_mfma_f32_16x16x32_bf16 v[100:103], a[68:71], v[64:67], 0
v_mfma_f32_16x16x32_bf16 v[104:107], a[96:99], v[64:67], 0
v_mfma_f32_16x16x32_bf16 v[108:111], a[100:103], v[64:67], 0
s_cbranch_vccnz ppr_38_\sf
ppo_39_\sf:
v_mfma_f32_16x16x32_bf16 v[80:83], a[8:11], v[68:71], v[80:83]
v_mfma_f32_16x16x32_bf16 v[84:87], a[12:15], v[68:71], v[84:87]
s_waitcnt vmcnt(1)
v_mfma_f32_16x16x32_bf16 v[88:91], a[40:43], v[68:71], v[88:91]
v_max3_u32 v12, v72, v73, v74
v_mfma_f32_16x16x32_bf16 v[92:95], a[44:47], v[68:71], v[92:95]
v_max_u32 v12, v12, v75
v_mfma_f32_16x16x32_bf16 v[96:99], a[72:75], v[68:71], v[96:99]
v_cmp_eq_u32 vcc, -1, v12
v_mfma_f32_16x16x32_bf16 v[100:103], a[76:79], v[68:71], v[100:103]
v_mfma_f32_16x16x32_bf16 v[104:107], a[104:107], v[68:71], v[104:107]
v_mfma_f32_16x16x32_bf16 v[108:111], a[108:111], v[68:71], v[108:111]
s_cbranch_vccnz ppr_40_\sf
ppo_41_\sf:
v_mfma_f32_16x16x32_bf16 v[80:83], a[16:19], v[72:75], v[80:83]
v_mfma_f32_16x16x32_bf16 v[84:87], a[20:23], v[72:75], v[84:87]
s_waitcnt vmcnt(0)
v_mfma_f32_16x16x32_bf16 v[88:91], a[48:51], v[72:75], v[88:91]
v_max3_u32 v12, v76, v77, v78
v_mfma_f32_16x16x32_bf16 v[92:95], a[52:55], v[72:75], v[92:95]
v_max_u32 v12, v12, v79
v_mfma_f32_16x16x32_bf16 v[96:99], a[80:83], v[72:75], v[96:99]
v_cmp_eq_u32 vcc, -1, v12
v_mfma_f32_16x16x32_bf16 v[100:103], a[84:87], v[72:75], v[100:103]
s_cbranch_vccnz ppr_42_\sf
ppo_43_\sf:
v_mfma_f32_16x16x32_bf16 v[80:83], a[24:27], v[76:79], v[80:83]
v_mfma_f32_16x16x32_bf16 v[84:87], a[28:31], v[76:79], v[84:87]
v_mfma_f32_16x16x32_bf16 v[88:91], a[56:59], v[76:79], v[88:91]
v_mfma_f32_16x16x32_bf16 v[92:95], a[60:63], v[76:79], v[92:95]
v_mfma_f32_16x16x32_bf16 v[104:107], a[112:115], v[72:75], v[104:107]
v_mfma_f32_16x16x32_bf16 v[108:111], a[116:119], v[72:75], v[108:111]
v_mfma_f32_16x16x32_bf16 v[96:99], a[88:91], v[76:79], v[96:99]
s_nop 2
v_add_f32_dpp v128, v84, v80 row_ror:8 row_mask:0xf bank_mask:0x3
v_add_f32_dpp v129, v85, v81 row_ror:8 row_mask:0xf bank_mask:0x3
v_mfma_f32_16x16x32_bf16 v[100:103], a[92:95], v[76:79], v[100:103]
v_add_f32_dpp v130, v86, v82 row_ror:8 row_mask:0xf bank_mask:0x3
v_add_f32_dpp v131, v87, v83 row_ror:8 row_mask:0xf bank_mask:0x3
v_mfma_f32_16x16x32_bf16 v[104:107], a[120:123], v[76:79], v[104:107]
v_add_f32_dpp v128, v88, v92 row_ror:8 row_mask:0xf bank_mask:0xc
v_add_f32_dpp v129, v89, v93 row_ror:8 row_mask:0xf bank_mask:0xc
v_mfma_f32_16x16x32_bf16 v[108:111], a[124:127], v[76:79], v[108:111]
v_add_f32_dpp v130, v90, v94 row_ror:8 row_mask:0xf bank_mask:0xc
v_add_f32_dpp v131, v91, v95 row_ror:8 row_mask:0xf bank_mask:0xc
ds_write_b128 v2, v[128:131] offset:1024
v_add_f32_dpp v132, v100, v96 row_ror:8 row_mask:0xf bank_mask:0x3
v_add_f32_dpp v133, v101, v97 row_ror:8 row_mask:0xf bank_mask:0x3
v_add_f32_dpp v134, v102, v98 row_ror:8 row_mask:0xf bank_mask:0x3
v_add_f32_dpp v135, v103, v99 row_ror:8 row_mask:0xf bank_mask:0x3
s_nop 0
v_add_f32_dpp v132, v104, v108 row_ror:8 row_mask:0xf bank_mask:0xc
v_add_f32_dpp v133, v105, v109 row_ror:8 row_mask:0xf bank_mask:0xc
v_add_f32_dpp v134, v106, v110 row_ror:8 row_mask:0xf bank_mask:0xc
v_add_f32_dpp v135, v107, v111 row_ror:8 row_mask:0xf bank_mask:0xc
s_waitcnt lgkmcnt(0)
s_barrier
ds_read_b128 v[144:147], v2 offset:4096
ds_read_b128 v[148:151], v2 offset:6144
ds_read_b128 v[152:155], v2 offset:7168
s_waitcnt lgkmcnt(2)
v_pk_add_f32 v[132:133], v[132:133], v[144:145]
v_pk_add_f32 v[134:135], v[134:135], v[146:147]
s_waitcnt lgkmcnt(0)
v_pk_add_f32 v[148:149], v[148:149], v[152:153]
v_pk_add_f32 v[150:151], v[150:151], v[154:155]
v_pk_add_f32 v[132:133], v[132:133], v[148:149]
v_pk_add_f32 v[134:135], v[134:135], v[150:151]
v_cvt_pk_bf16_f32 v132, v132, v133
v_cvt_pk_bf16_f32 v133, v134, v135
v_min_u32 v132, -2, v132
v_min_u32 v133, -2, v133
.if \sf == 0
buffer_store_dwordx2 v[132:133], v3, s[8:11], s68 offen
buffer_store_dwordx2 v[8:9], v6, s[8:11], s69 offen
.else
buffer_store_dwordx2 v[132:133], v3, s[8:11], s68 offen sc1
buffer_store_dwordx2 v[8:9], v6, s[8:11], s69 offen sc1
.endif
s_lshl_b32 s45, s43, 16
s_add_u32 s45, s45, s60
buffer_store_dwordx2 v[132:133], v3, s[8:11], s45 offen sc1
.if \sf == 0
buffer_store_dword v8, v233, s[8:11], s5 offen
.else
buffer_store_dword v8, v233, s[8:11], s5 offen sc1
.endif
v_mfma_f32_16x16x32_bf16 v[112:115], v[64:67], a[128:131], 0
v_mfma_f32_16x16x32_bf16 v[116:119], v[64:67], a[132:135], 0
v_mfma_f32_16x16x32_bf16 v[112:115], v[68:71], a[136:139], v[112:115]
v_mfma_f32_16x16x32_bf16 v[116:119], v[68:71], a[140:143], v[116:119]
v_mfma_f32_16x16x32_bf16 v[112:115], v[72:75], a[144:147], v[112:115]
v_mfma_f32_16x16x32_bf16 v[116:119], v[72:75], a[148:151], v[116:119]
v_mfma_f32_16x16x32_bf16 v[112:115], v[76:79], a[152:155], v[112:115]
v_mfma_f32_16x16x32_bf16 v[116:119], v[76:79], a[156:159], v[116:119]
v_mfma_f32_16x16x32_bf16 v[120:123], v[64:67], a[160:163], 0
v_mfma_f32_16x16x32_bf16 v[124:127], v[64:67], a[164:167], 0
v_mfma_f32_16x16x32_bf16 v[120:123], v[68:71], a[168:171], v[120:123]
v_mfma_f32_16x16x32_bf16 v[124:127], v[68:71], a[172:175], v[124:127]
v_mfma_f32_16x16x32_bf16 v[120:123], v[72:75], a[176:179], v[120:123]
v_mfma_f32_16x16x32_bf16 v[124:127], v[72:75], a[180:183], v[124:127]
v_mfma_f32_16x16x32_bf16 v[120:123], v[76:79], a[184:187], v[120:123]
v_mfma_f32_16x16x32_bf16 v[124:127], v[76:79], a[188:191], v[124:127]
s_nop 6
v_permlane32_swap_b32 v112, v120
v_permlane32_swap_b32 v116, v124
v_permlane32_swap_b32 v113, v121
v_permlane32_swap_b32 v117, v125
v_permlane32_swap_b32 v114, v122
v_permlane32_swap_b32 v118, v126
v_permlane32_swap_b32 v115, v123
v_permlane32_swap_b32 v119, v127
v_add_f32 v136, v112, v124
v_add_f32 v137, v113, v125
v_add_f32 v138, v114, v126
v_add_f32 v139, v115, v127
ds_write_b128 v2, v[136:139] offset:9216
s_waitcnt lgkmcnt(0)
s_barrier
s_cmp_eq_u32 s43, 63
s_cbranch_scc1 r_end_w1_\sf
s_barrier
buffer_load_dwordx4 v[64:67], v5, s[8:11], s67 offen offset:0 sc1
buffer_load_dwordx4 v[68:71], v5, s[8:11], s67 offen offset:1024 sc1
buffer_load_dwordx4 v[72:75], v5, s[8:11], s67 offen offset:2048 sc1
buffer_load_dwordx4 v[76:79], v5, s[8:11], s67 offen offset:3072 sc1
s_waitcnt vmcnt(3)
v_max3_u32 v12, v64, v65, v66
v_max_u32 v12, v12, v67
v_cmp_eq_u32 vcc, -1, v12
s_cbranch_vccnz ppr_44_\sf
ppo_45_\sf:
v_mfma_f32_16x16x32_bf16 v[80:83], a[192:195], v[64:67], 0
s_waitcnt vmcnt(2)
v_max3_u32 v12, v68, v69, v70
v_mfma_f32_16x16x32_bf16 v[84:87], a[196:199], v[64:67], 0
v_max_u32 v12, v12, v71
v_cmp_eq_u32 vcc, -1, v12
v_mfma_f32_16x16x32_bf16 v[88:91], a[224:227], v[64:67], 0
v_mfma_f32_16x16x32_bf16 v[92:95], a[228:231], v[64:67], 0
s_cbranch_vccnz ppr_46_\sf
ppo_47_\sf:
v_mfma_f32_16x16x32_bf16 v[80:83], a[200:203], v[68:71], v[80:83]
s_waitcnt vmcnt(1)
v_max3_u32 v12, v72, v73, v74
v_mfma_f32_16x16x32_bf16 v[84:87], a[204:207], v[68:71], v[84:87]
v_max_u32 v12, v12, v75
v_cmp_eq_u32 vcc, -1, v12
v_mfma_f32_16x16x32_bf16 v[88:91], a[232:235], v[68:71], v[88:91]
v_mfma_f32_16x16x32_bf16 v[92:95], a[236:239], v[68:71], v[92:95]
s_cbranch_vccnz ppr_48_\sf
ppo_49_\sf:
v_mfma_f32_16x16x32_bf16 v[80:83], a[208:211], v[72:75], v[80:83]
s_waitcnt vmcnt(0)
v_max3_u32 v12, v76, v77, v78
v_mfma_f32_16x16x32_bf16 v[84:87], a[212:215], v[72:75], v[84:87]
v_max_u32 v12, v12, v79
v_cmp_eq_u32 vcc, -1, v12
v_mfma_f32_16x16x32_bf16 v[88:91], a[240:243], v[72:75], v[88:91]
v_mfma_f32_16x16x32_bf16 v[92:95], a[244:247], v[72:75], v[92:95]
s_cbranch_vccnz ppr_50_\sf
ppo_51_\sf:
v_mfma_f32_16x16x32_bf16 v[80:83], a[216:219], v[76:79], v[80:83]
v_mfma_f32_16x16x32_bf16 v[84:87], a[220:223], v[76:79], v[84:87]
v_mfma_f32_16x16x32_bf16 v[88:91], a[248:251], v[76:79], v[88:91]
v_mfma_f32_16x16x32_bf16 v[92:95], a[252:255], v[76:79], v[92:95]
s_nop 5
v_add_f32_dpp v140, v84, v80 row_ror:8 row_mask:0xf bank_mask:0x3
v_add_f32_dpp v141, v85, v81 row_ror:8 row_mask:0xf bank_mask:0x3
v_add_f32_dpp v142, v86, v82 row_ror:8 row_mask:0xf bank_mask:0x3
v_add_f32_dpp v143, v87, v83 row_ror:8 row_mask:0xf bank_mask:0x3
v_add_f32_dpp v140, v88, v92 row_ror:8 row_mask:0xf bank_mask:0xc
v_add_f32_dpp v141, v89, v93 row_ror:8 row_mask:0xf bank_mask:0xc
v_add_f32_dpp v142, v90, v94 row_ror:8 row_mask:0xf bank_mask:0xc
v_add_f32_dpp v143, v91, v95 row_ror:8 row_mask:0xf bank_mask:0xc
ds_write_b128 v2, v[140:143] offset:13312
s_waitcnt lgkmcnt(0)
s_barrier
s_add_u32 s43, s43, 1
s_branch r_loop_w1_\sf
xr_34_\sf:
global_load_dwordx2 v[160:161], v232, s[36:37] offset:0 sc1
global_load_dwordx2 v[162:163], v232, s[36:37] offset:1024 sc1
global_load_dwordx2 v[164:165], v232, s[36:37] offset:2048 sc1
global_load_dwordx2 v[166:167], v232, s[36:37] offset:3072 sc1
s_add_u32 s44, s44, 1
s_cmp_lt_u32 s44, 0x40000
s_cbranch_scc1 xw_35_\sf
s_branch apub_30_\sf
ppr_36_\sf:
s_nop 7
buffer_load_dwordx4 v[64:67], v2, s[8:11], s66 offen offset:0 sc1
buffer_load_dwordx4 v[68:71], v2, s[8:11], s66 offen offset:1024 sc1
buffer_load_dwordx4 v[72:75], v2, s[8:11], s66 offen offset:2048 sc1
buffer_load_dwordx4 v[76:79], v2, s[8:11], s66 offen offset:3072 sc1
s_add_u32 s44, s44, 1
s_waitcnt vmcnt(3)
v_max3_u32 v12, v64, v65, v66
v_max_u32 v12, v12, v67
v_cmp_eq_u32 vcc, -1, v12
s_cbranch_vccz ppo_37_\sf
s_cmp_lt_u32 s44, 0x40000
s_cbranch_scc1 ppr_36_\sf
s_branch ppo_37_\sf
s_nop 0
ppr_38_\sf:
s_nop 7
buffer_load_dwordx4 v[68:71], v2, s[8:11], s66 offen offset:1024 sc1
buffer_load_dwordx4 v[72:75], v2, s[8:11], s66 offen offset:2048 sc1
buffer_load_dwordx4 v[76:79], v2, s[8:11], s66 offen offset:3072 sc1
s_add_u32 s44, s44, 1
s_waitcnt vmcnt(2)
v_max3_u32 v12, v68, v69, v70
v_max_u32 v12, v12, v71
v_cmp_eq_u32 vcc, -1, v12
s_cbranch_vccz ppo_39_\sf
s_cmp_lt_u32 s44, 0x40000
s_cbranch_scc1 ppr_38_\sf
s_branch ppo_39_\sf
s_nop 0
ppr_40_\sf:
s_nop 7
buffer_load_dwordx4 v[72:75], v2, s[8:11], s66 offen offset:2048 sc1
buffer_load_dwordx4 v[76:79], v2, s[8:11], s66 offen offset:3072 sc1
s_add_u32 s44, s44, 1
s_waitcnt vmcnt(1)
v_max3_u32 v12, v72, v73, v74
v_max_u32 v12, v12, v75
v_cmp_eq_u32 vcc, -1, v12
s_cbranch_vccz ppo_41_\sf
s_cmp_lt_u32 s44, 0x40000
s_cbranch_scc1 ppr_40_\sf
s_branch ppo_41_\sf
s_nop 0
ppr_42_\sf:
s_nop 7
buffer_load_dwordx4 v[76:79], v2, s[8:11], s66 offen offset:3072 sc1
s_add_u32 s44, s44, 1
s_waitcnt vmcnt(0)
v_max3_u32 v12, v76, v77, v78
v_max_u32 v12, v12, v79
v_cmp_eq_u32 vcc, -1, v12
s_cbranch_vccz ppo_43_\sf
s_cmp_lt_u32 s44, 0x40000
s_cbranch_scc1 ppr_42_\sf
s_branch ppo_43_\sf
s_nop 0
ppr_44_\sf:
s_nop 7
buffer_load_dwordx4 v[64:67], v5, s[8:11], s67 offen offset:0 sc1
buffer_load_dwordx4 v[68:71], v5, s[8:11], s67 offen offset:1024 sc1
buffer_load_dwordx4 v[72:75], v5, s[8:11], s67 offen offset:2048 sc1
buffer_load_dwordx4 v[76:79], v5, s[8:11], s67 offen offset:3072 sc1
s_add_u32 s44, s44, 1
s_waitcnt vmcnt(3)
v_max3_u32 v12, v64, v65, v66
v_max_u32 v12, v12, v67
v_cmp_eq_u32 vcc, -1, v12
s_cbranch_vccz ppo_45_\sf
s_cmp_lt_u32 s44, 0x40000
s_cbranch_scc1 ppr_44_\sf
s_branch ppo_45_\sf
s_nop 0
ppr_46_\sf:
s_nop 7
buffer_load_dwordx4 v[68:71], v5, s[8:11], s67 offen offset:1024 sc1
buffer_load_dwordx4 v[72:75], v5, s[8:11], s67 offen offset:2048 sc1
buffer_load_dwordx4 v[76:79], v5, s[8:11], s67 offen offset:3072 sc1
s_add_u32 s44, s44, 1
s_waitcnt vmcnt(2)
v_max3_u32 v12, v68, v69, v70
v_max_u32 v12, v12, v71
v_cmp_eq_u32 vcc, -1, v12
s_cbranch_vccz ppo_47_\sf
s_cmp_lt_u32 s44, 0x40000
s_cbranch_scc1 ppr_46_\sf
s_branch ppo_47_\sf
s_nop 0
ppr_48_\sf:
s_nop 7
buffer_load_dwordx4 v[72:75], v5, s[8:11], s67 offen offset:2048 sc1
buffer_load_dwordx4 v[76:79], v5, s[8:11], s67 offen offset:3072 sc1
s_add_u32 s44, s44, 1
s_waitcnt vmcnt(1)
v_max3_u32 v12, v72, v73, v74
v_max_u32 v12, v12, v75
v_cmp_eq_u32 vcc, -1, v12
s_cbranch_vccz ppo_49_\sf
s_cmp_lt_u32 s44, 0x40000
s_cbranch_scc1 ppr_48_\sf
s_branch ppo_49_\sf
s_nop 0
ppr_50_\sf:
s_nop 7
buffer_load_dwordx4 v[76:79], v5, s[8:11], s67 offen offset:3072 sc1
s_add_u32 s44, s44, 1
s_waitcnt vmcnt(0)
v_max3_u32 v12, v76, v77, v78
v_max_u32 v12, v12, v79
v_cmp_eq_u32 vcc, -1, v12
s_cbranch_vccz ppo_51_\sf
s_cmp_lt_u32 s44, 0x40000
s_cbranch_scc1 ppr_50_\sf
s_branch ppo_51_\sf
s_nop 0
r_end_w1_\sf:
s_waitcnt vmcnt(0)
s_barrier
s_endpgm
r_wave2_\sf:
s_lshl_b32 s45, s40, 16
.if \sf == 0
s_add_u32 s52, s45, 0x4802000
.else
s_add_u32 s52, s45, 0xc802000
.endif
s_lshl_b32 s46, s41, 9
s_add_u32 s47, s45, s46
.if \sf == 0
s_add_u32 s53, s47, 0x4800000
s_add_u32 s56, s45, 0x48c2000
s_add_u32 s57, s47, 0x48c0000
.else
s_add_u32 s53, s47, 0xc800000
s_add_u32 s56, s45, 0xc8c2000
s_add_u32 s57, s47, 0xc8c0000
.endif
s_lshl_b32 s45, s40, 17
s_lshr_b32 s46, s41, 2
s_lshl_b32 s46, s46, 12
s_add_u32 s45, s45, s46
.if \sf == 0
s_add_u32 s55, s45, 0x4840000
.else
s_add_u32 s55, s45, 0xc840000
.endif
s_lshl_b32 s46, s50, 9
s_add_u32 s54, s55, s46
s_lshl_b32 s45, s41, 16
s_add_u32 s58, s45, 0x4a00000
s_add_u32 s51, s58, 0x200000
v_add_u32 v7, 0x1000, v2
s_lshl_b32 s45, s49, 11
s_lshl_b32 s46, s50, 9
s_add_u32 s45, s45, s46
s_add_u32 s60, s45, 0x4400000
s_lshl_b32 s45, s49, 13
s_add_u32 s61, s45, 0x1000000
s_lshl_b32 s46, s50, 11
s_add_u32 s45, s45, s46
s_add_u32 s62, s45, 0x2000000
s_mov_b32 s65, 0x3e0293ee
s_mov_b32 s74, 0x7fffffff
s_mov_b32 s75, 0x7fffffff
s_mov_b32 s72, 0x7fffffff
s_mov_b32 s73, 0x7fffffff
v_add_u32 v12, 64, v1
v_lshlrev_b32 v232, 3, v12
v_add_u32 v236, 0x1000, v232
v_lshrrev_b32 v13, 1, v12
v_and_b32 v14, 7, v13
v_lshrrev_b32 v15, 4, v13
v_lshl_add_u32 v233, v15, 3, v14
v_lshlrev_b32 v233, 4, v233
v_bfe_u32 v15, v13, 3, 1
v_lshl_add_u32 v233, v15, 3, v233
v_and_b32 v15, 1, v1
v_lshl_add_u32 v233, v15, 2, v233
v_lshrrev_b32 v13, 3, v13
v_lshlrev_b32 v13, 3, v13
v_lshl_add_u32 v13, v15, 2, v13
v_lshl_add_u32 v12, v14, 11, v13
s_lshl_b32 s45, s41, 6
buffer_load_dword v224, v12, s[28:31], s45 offen
v_mov_b32 v234, 0
v_mov_b32 v235, 0
v_lshrrev_b32 v12, 2, v1
v_and_b32 v13, 3, v1
v_lshlrev_b32 v13, 4, v13
v_lshl_add_u32 v14, v12, 13, v13
v_lshl_add_u32 v15, v12, 11, v13
s_lshl_b32 s45, s40, 21
s_lshl_b32 s46, s42, 19
s_add_u32 s45, s45, s46
s_lshl_b32 s46, s41, 6
s_add_u32 s45, s45, s46
buffer_load_dwordx4 a[192:195], v15, s[24:27], s45 offen
s_add_u32 s45, s45, 0x8000
buffer_load_dwordx4 a[196:199], v15, s[24:27], s45 offen
s_add_u32 s45, s45, 0x8000
buffer_load_dwordx4 a[200:203], v15, s[24:27], s45 offen
s_add_u32 s45, s45, 0x8000
buffer_load_dwordx4 a[204:207], v15, s[24:27], s45 offen
s_add_u32 s45, s45, 0x8000
buffer_load_dwordx4 a[208:211], v15, s[24:27], s45 offen
s_add_u32 s45, s45, 0x8000
buffer_load_dwordx4 a[212:215], v15, s[24:27], s45 offen
s_add_u32 s45, s45, 0x8000
buffer_load_dwordx4 a[216:219], v15, s[24:27], s45 offen
s_add_u32 s45, s45, 0x8000
buffer_load_dwordx4 a[220:223], v15, s[24:27], s45 offen
s_add_u32 s45, s45, 0x8000
buffer_load_dwordx4 a[224:227], v15, s[24:27], s45 offen
s_add_u32 s45, s45, 0x8000
buffer_load_dwordx4 a[228:231], v15, s[24:27], s45 offen
s_add_u32 s45, s45, 0x8000
buffer_load_dwordx4 a[232:235], v15, s[24:27], s45 offen
s_add_u32 s45, s45, 0x8000
buffer_load_dwordx4 a[236:239], v15, s[24:27], s45 offen
s_add_u32 s45, s45, 0x8000
buffer_load_dwordx4 a[240:243], v15, s[24:27], s45 offen
s_add_u32 s45, s45, 0x8000
buffer_load_dwordx4 a[244:247], v15, s[24:27], s45 offen
s_add_u32 s45, s45, 0x8000
buffer_load_dwordx4 a[248:251], v15, s[24:27], s45 offen
s_add_u32 s45, s45, 0x8000
buffer_load_dwordx4 a[252:255], v15, s[24:27], s45 offen
s_lshl_b32 s47, s42, 21
s_lshl_b32 s46, s49, 8
s_add_u32 s47, s47, s46
s_lshl_b32 s46, s50, 6
s_add_u32 s47, s47, s46
s_mov_b32 s45, s47
buffer_load_dwordx4 a[64:67], v14, s[16:19], s45 offen
s_add_u32 s45, s45, 0x20000
buffer_load_dwordx4 a[68:71], v14, s[16:19], s45 offen
s_add_u32 s45, s45, 0x20000
buffer_load_dwordx4 a[72:75], v14, s[16:19], s45 offen
s_add_u32 s45, s45, 0x20000
buffer_load_dwordx4 a[76:79], v14, s[16:19], s45 offen
s_add_u32 s45, s45, 0x20000
buffer_load_dwordx4 a[80:83], v14, s[16:19], s45 offen
s_add_u32 s45, s45, 0x20000
buffer_load_dwordx4 a[84:87], v14, s[16:19], s45 offen
s_add_u32 s45, s45, 0x20000
buffer_load_dwordx4 a[88:91], v14, s[16:19], s45 offen
s_add_u32 s45, s45, 0x20000
buffer_load_dwordx4 a[92:95], v14, s[16:19], s45 offen
s_add_u32 s45, s45, 0x20000
buffer_load_dwordx4 a[96:99], v14, s[16:19], s45 offen
s_add_u32 s45, s45, 0x20000
buffer_load_dwordx4 a[100:103], v14, s[16:19], s45 offen
s_add_u32 s45, s45, 0x20000
buffer_load_dwordx4 a[104:107], v14, s[16:19], s45 offen
s_add_u32 s45, s45, 0x20000
buffer_load_dwordx4 a[108:111], v14, s[16:19], s45 offen
s_add_u32 s45, s45, 0x20000
buffer_load_dwordx4 a[112:115], v14, s[16:19], s45 offen
s_add_u32 s45, s45, 0x20000
buffer_load_dwordx4 a[116:119], v14, s[16:19], s45 offen
s_add_u32 s45, s45, 0x20000
buffer_load_dwordx4 a[120:123], v14, s[16:19], s45 offen
s_add_u32 s45, s45, 0x20000
buffer_load_dwordx4 a[124:127], v14, s[16:19], s45 offen
s_mov_b32 s45, s47
buffer_load_dwordx4 a[128:131], v14, s[20:23], s45 offen
s_add_u32 s45, s45, 0x20000
buffer_load_dwordx4 a[132:135], v14, s[20:23], s45 offen
s_add_u32 s45, s45, 0x20000
buffer_load_dwordx4 a[136:139], v14, s[20:23], s45 offen
s_add_u32 s45, s45, 0x20000
buffer_load_dwordx4 a[140:143], v14, s[20:23], s45 offen
s_add_u32 s45, s45, 0x20000
buffer_load_dwordx4 a[144:147], v14, s[20:23], s45 offen
s_add_u32 s45, s45, 0x20000
buffer_load_dwordx4 a[148:151], v14, s[20:23], s45 offen
s_add_u32 s45, s45, 0x20000
buffer_load_dwordx4 a[152:155], v14, s[20:23], s45 offen
s_add_u32 s45, s45, 0x20000
buffer_load_dwordx4 a[156:159], v14, s[20:23], s45 offen
s_add_u32 s45, s45, 0x20000
buffer_load_dwordx4 a[160:163], v14, s[20:23], s45 offen
s_add_u32 s45, s45, 0x20000
buffer_load_dwordx4 a[164:167], v14, s[20:23], s45 offen
s_add_u32 s45, s45, 0x20000
buffer_load_dwordx4 a[168:171], v14, s[20:23], s45 offen
s_add_u32 s45, s45, 0x20000
buffer_load_dwordx4 a[172:175], v14, s[20:23], s45 offen
s_add_u32 s45, s45, 0x20000
buffer_load_dwordx4 a[176:179], v14, s[20:23], s45 offen
s_add_u32 s45, s45, 0x20000
buffer_load_dwordx4 a[180:183], v14, s[20:23], s45 offen
s_add_u32 s45, s45, 0x20000
buffer_load_dwordx4 a[184:187], v14, s[20:23], s45 offen
s_add_u32 s45, s45, 0x20000
buffer_load_dwordx4 a[188:191], v14, s[20:23], s45 offen
s_mov_b32 s45, s47
buffer_load_dwordx4 a[0:3], v14, s[12:15], s45 offen
s_add_u32 s45, s45, 0x20000
buffer_load_dwordx4 a[4:7], v14, s[12:15], s45 offen
s_add_u32 s45, s45, 0x20000
buffer_load_dwordx4 a[8:11], v14, s[12:15], s45 offen
s_add_u32 s45, s45, 0x20000
buffer_load_dwordx4 a[12:15], v14, s[12:15], s45 offen
s_add_u32 s45, s45, 0x20000
buffer_load_dwordx4 a[16:19], v14, s[12:15], s45 offen
s_add_u32 s45, s45, 0x20000
buffer_load_dwordx4 a[20:23], v14, s[12:15], s45 offen
s_add_u32 s45, s45, 0x20000
buffer_load_dwordx4 a[24:27], v14, s[12:15], s45 offen
s_add_u32 s45, s45, 0x20000
buffer_load_dwordx4 a[28:31], v14, s[12:15], s45 offen
s_add_u32 s45, s45, 0x20000
buffer_load_dwordx4 a[32:35], v14, s[12:15], s45 offen
s_add_u32 s45, s45, 0x20000
buffer_load_dwordx4 a[36:39], v14, s[12:15], s45 offen
s_add_u32 s45, s45, 0x20000
buffer_load_dwordx4 a[40:43], v14, s[12:15], s45 offen
s_add_u32 s45, s45, 0x20000
buffer_load_dwordx4 a[44:47], v14, s[12:15], s45 offen
s_add_u32 s45, s45, 0x20000
buffer_load_dwordx4 a[48:51], v14, s[12:15], s45 offen
s_add_u32 s45, s45, 0x20000
buffer_load_dwordx4 a[52:55], v14, s[12:15], s45 offen
s_add_u32 s45, s45, 0x20000
buffer_load_dwordx4 a[56:59], v14, s[12:15], s45 offen
s_add_u32 s45, s45, 0x20000
buffer_load_dwordx4 a[60:63], v14, s[12:15], s45 offen
s_lshl_b32 s45, s42, 14
v_add_u32 v144, s45, v2
v_lshrrev_b32 v12, 4, v1
v_bfe_u32 v13, v1, 2, 2
v_and_b32 v14, 3, v1
v_lshl_add_u32 v15, v12, 4, v13
v_lshlrev_b32 v15, 6, v15
v_lshl_add_u32 v15, v14, 3, v15
v_add_u32 v145, s45, v15
v_lshl_add_u32 v15, v12, 2, v13
v_lshlrev_b32 v15, 6, v15
v_lshl_add_u32 v15, v14, 4, v15
v_add_u32 v146, s45, v15
s_waitcnt vmcnt(48)
ds_write_b128 v144, a[192:195] offset:0
ds_write_b128 v144, a[196:199] offset:1024
ds_write_b128 v144, a[200:203] offset:2048
ds_write_b128 v144, a[204:207] offset:3072
ds_write_b128 v144, a[208:211] offset:4096
ds_write_b128 v144, a[212:215] offset:5120
ds_write_b128 v144, a[216:219] offset:6144
ds_write_b128 v144, a[220:223] offset:7168
ds_write_b128 v144, a[224:227] offset:8192
ds_write_b128 v144, a[228:231] offset:9216
ds_write_b128 v144, a[232:235] offset:10240
ds_write_b128 v144, a[236:239] offset:11264
ds_write_b128 v144, a[240:243] offset:12288
ds_write_b128 v144, a[244:247] offset:13312
ds_write_b128 v144, a[248:251] offset:14336
ds_write_b128 v144, a[252:255] offset:15360
s_waitcnt lgkmcnt(0)
ds_read_b64_tr_b16 a[192:193], v146 offset:0
ds_read_b64_tr_b16 a[194:195], v146 offset:1024
ds_read_b64_tr_b16 a[196:197], v146 offset:2048
ds_read_b64_tr_b16 a[198:199], v146 offset:3072
ds_read_b64_tr_b16 a[200:201], v146 offset:4096
ds_read_b64_tr_b16 a[202:203], v146 offset:5120
ds_read_b64_tr_b16 a[204:205], v146 offset:6144
ds_read_b64_tr_b16 a[206:207], v146 offset:7168
ds_read_b64_tr_b16 a[208:209], v146 offset:8192
ds_read_b64_tr_b16 a[210:211], v146 offset:9216
ds_read_b64_tr_b16 a[212:213], v146 offset:10240
ds_read_b64_tr_b16 a[214:215], v146 offset:11264
ds_read_b64_tr_b16 a[216:217], v146 offset:12288
ds_read_b64_tr_b16 a[218:219], v146 offset:13312
ds_read_b64_tr_b16 a[220:221], v146 offset:14336
ds_read_b64_tr_b16 a[222:223], v146 offset:15360
ds_read_b64_tr_b16 a[224:225], v146 offset:8
ds_read_b64_tr_b16 a[226:227], v146 offset:1032
ds_read_b64_tr_b16 a[228:229], v146 offset:2056
ds_read_b64_tr_b16 a[230:231], v146 offset:3080
ds_read_b64_tr_b16 a[232:233], v146 offset:4104
ds_read_b64_tr_b16 a[234:235], v146 offset:5128
ds_read_b64_tr_b16 a[236:237], v146 offset:6152
ds_read_b64_tr_b16 a[238:239], v146 offset:7176
ds_read_b64_tr_b16 a[240:241], v146 offset:8200
ds_read_b64_tr_b16 a[242:243], v146 offset:9224
ds_read_b64_tr_b16 a[244:245], v146 offset:10248
ds_read_b64_tr_b16 a[246:247], v146 offset:11272
ds_read_b64_tr_b16 a[248:249], v146 offset:12296
ds_read_b64_tr_b16 a[250:251], v146 offset:13320
ds_read_b64_tr_b16 a[252:253], v146 offset:14344
ds_read_b64_tr_b16 a[254:255], v146 offset:15368
s_waitcnt lgkmcnt(0)
s_waitcnt vmcnt(32)
ds_write_b128 v144, a[64:67] offset:0
ds_write_b128 v144, a[68:71] offset:1024
ds_write_b128 v144, a[72:75] offset:2048
ds_write_b128 v144, a[76:79] offset:3072
ds_write_b128 v144, a[80:83] offset:4096
ds_write_b128 v144, a[84:87] offset:5120
ds_write_b128 v144, a[88:91] offset:6144
ds_write_b128 v144, a[92:95] offset:7168
ds_write_b128 v144, a[96:99] offset:8192
ds_write_b128 v144, a[100:103] offset:9216
ds_write_b128 v144, a[104:107] offset:10240
ds_write_b128 v144, a[108:111] offset:11264
ds_write_b128 v144, a[112:115] offset:12288
ds_write_b128 v144, a[116:119] offset:13312
ds_write_b128 v144, a[120:123] offset:14336
ds_write_b128 v144, a[124:127] offset:15360
s_waitcnt lgkmcnt(0)
ds_read_b64_tr_b16 a[64:65], v145 offset:0
ds_read_b64_tr_b16 a[66:67], v145 offset:256
ds_read_b64_tr_b16 a[68:69], v145 offset:512
ds_read_b64_tr_b16 a[70:71], v145 offset:768
ds_read_b64_tr_b16 a[72:73], v145 offset:4096
ds_read_b64_tr_b16 a[74:75], v145 offset:4352
ds_read_b64_tr_b16 a[76:77], v145 offset:4608
ds_read_b64_tr_b16 a[78:79], v145 offset:4864
ds_read_b64_tr_b16 a[80:81], v145 offset:8192
ds_read_b64_tr_b16 a[82:83], v145 offset:8448
ds_read_b64_tr_b16 a[84:85], v145 offset:8704
ds_read_b64_tr_b16 a[86:87], v145 offset:8960
ds_read_b64_tr_b16 a[88:89], v145 offset:12288
ds_read_b64_tr_b16 a[90:91], v145 offset:12544
ds_read_b64_tr_b16 a[92:93], v145 offset:12800
ds_read_b64_tr_b16 a[94:95], v145 offset:13056
ds_read_b64_tr_b16 a[96:97], v145 offset:32
ds_read_b64_tr_b16 a[98:99], v145 offset:288
ds_read_b64_tr_b16 a[100:101], v145 offset:544
ds_read_b64_tr_b16 a[102:103], v145 offset:800
ds_read_b64_tr_b16 a[104:105], v145 offset:4128
ds_read_b64_tr_b16 a[106:107], v145 offset:4384
ds_read_b64_tr_b16 a[108:109], v145 offset:4640
ds_read_b64_tr_b16 a[110:111], v145 offset:4896
ds_read_b64_tr_b16 a[112:113], v145 offset:8224
ds_read_b64_tr_b16 a[114:115], v145 offset:8480
ds_read_b64_tr_b16 a[116:117], v145 offset:8736
ds_read_b64_tr_b16 a[118:119], v145 offset:8992
ds_read_b64_tr_b16 a[120:121], v145 offset:12320
ds_read_b64_tr_b16 a[122:123], v145 offset:12576
ds_read_b64_tr_b16 a[124:125], v145 offset:12832
ds_read_b64_tr_b16 a[126:127], v145 offset:13088
s_waitcnt lgkmcnt(0)
s_waitcnt vmcnt(16)
ds_write_b128 v144, a[128:131] offset:0
ds_write_b128 v144, a[132:135] offset:1024
ds_write_b128 v144, a[136:139] offset:2048
ds_write_b128 v144, a[140:143] offset:3072
ds_write_b128 v144, a[144:147] offset:4096
ds_write_b128 v144, a[148:151] offset:5120
ds_write_b128 v144, a[152:155] offset:6144
ds_write_b128 v144, a[156:159] offset:7168
ds_write_b128 v144, a[160:163] offset:8192
ds_write_b128 v144, a[164:167] offset:9216
ds_write_b128 v144, a[168:171] offset:10240
ds_write_b128 v144, a[172:175] offset:11264
ds_write_b128 v144, a[176:179] offset:12288
ds_write_b128 v144, a[180:183] offset:13312
ds_write_b128 v144, a[184:187] offset:14336
ds_write_b128 v144, a[188:191] offset:15360
s_waitcnt lgkmcnt(0)
ds_read_b64_tr_b16 a[128:129], v145 offset:0
ds_read_b64_tr_b16 a[130:131], v145 offset:256
ds_read_b64_tr_b16 a[132:133], v145 offset:512
ds_read_b64_tr_b16 a[134:135], v145 offset:768
ds_read_b64_tr_b16 a[136:137], v145 offset:4096
ds_read_b64_tr_b16 a[138:139], v145 offset:4352
ds_read_b64_tr_b16 a[140:141], v145 offset:4608
ds_read_b64_tr_b16 a[142:143], v145 offset:4864
ds_read_b64_tr_b16 a[144:145], v145 offset:8192
ds_read_b64_tr_b16 a[146:147], v145 offset:8448
ds_read_b64_tr_b16 a[148:149], v145 offset:8704
ds_read_b64_tr_b16 a[150:151], v145 offset:8960
ds_read_b64_tr_b16 a[152:153], v145 offset:12288
ds_read_b64_tr_b16 a[154:155], v145 offset:12544
ds_read_b64_tr_b16 a[156:157], v145 offset:12800
ds_read_b64_tr_b16 a[158:159], v145 offset:13056
ds_read_b64_tr_b16 a[160:161], v145 offset:32
ds_read_b64_tr_b16 a[162:163], v145 offset:288
ds_read_b64_tr_b16 a[164:165], v145 offset:544
ds_read_b64_tr_b16 a[166:167], v145 offset:800
ds_read_b64_tr_b16 a[168:169], v145 offset:4128
ds_read_b64_tr_b16 a[170:171], v145 offset:4384
ds_read_b64_tr_b16 a[172:173], v145 offset:4640
ds_read_b64_tr_b16 a[174:175], v145 offset:4896
ds_read_b64_tr_b16 a[176:177], v145 offset:8224
ds_read_b64_tr_b16 a[178:179], v145 offset:8480
ds_read_b64_tr_b16 a[180:181], v145 offset:8736
ds_read_b64_tr_b16 a[182:183], v145 offset:8992
ds_read_b64_tr_b16 a[184:185], v145 offset:12320
ds_read_b64_tr_b16 a[186:187], v145 offset:12576
ds_read_b64_tr_b16 a[188:189], v145 offset:12832
ds_read_b64_tr_b16 a[190:191], v145 offset:13088
s_waitcnt lgkmcnt(0)
s_waitcnt vmcnt(0)
ds_write_b128 v144, a[0:3] offset:0
ds_write_b128 v144, a[4:7] offset:1024
ds_write_b128 v144, a[8:11] offset:2048
ds_write_b128 v144, a[12:15] offset:3072
ds_write_b128 v144, a[16:19] offset:4096
ds_write_b128 v144, a[20:23] offset:5120
ds_write_b128 v144, a[24:27] offset:6144
ds_write_b128 v144, a[28:31] offset:7168
ds_write_b128 v144, a[32:35] offset:8192
ds_write_b128 v144, a[36:39] offset:9216
ds_write_b128 v144, a[40:43] offset:10240
ds_write_b128 v144, a[44:47] offset:11264
ds_write_b128 v144, a[48:51] offset:12288
ds_write_b128 v144, a[52:55] offset:13312
ds_write_b128 v144, a[56:59] offset:14336
ds_write_b128 v144, a[60:63] offset:15360
s_waitcnt lgkmcnt(0)
ds_read_b64_tr_b16 a[0:1], v145 offset:0
ds_read_b64_tr_b16 a[2:3], v145 offset:256
ds_read_b64_tr_b16 a[4:5], v145 offset:512
ds_read_b64_tr_b16 a[6:7], v145 offset:768
ds_read_b64_tr_b16 a[8:9], v145 offset:4096
ds_read_b64_tr_b16 a[10:11], v145 offset:4352
ds_read_b64_tr_b16 a[12:13], v145 offset:4608
ds_read_b64_tr_b16 a[14:15], v145 offset:4864
ds_read_b64_tr_b16 a[16:17], v145 offset:8192
ds_read_b64_tr_b16 a[18:19], v145 offset:8448
ds_read_b64_tr_b16 a[20:21], v145 offset:8704
ds_read_b64_tr_b16 a[22:23], v145 offset:8960
ds_read_b64_tr_b16 a[24:25], v145 offset:12288
ds_read_b64_tr_b16 a[26:27], v145 offset:12544
ds_read_b64_tr_b16 a[28:29], v145 offset:12800
ds_read_b64_tr_b16 a[30:31], v145 offset:13056
ds_read_b64_tr_b16 a[32:33], v145 offset:32
ds_read_b64_tr_b16 a[34:35], v145 offset:288
ds_read_b64_tr_b16 a[36:37], v145 offset:544
ds_read_b64_tr_b16 a[38:39], v145 offset:800
ds_read_b64_tr_b16 a[40:41], v145 offset:4128
ds_read_b64_tr_b16 a[42:43], v145 offset:4384
ds_read_b64_tr_b16 a[44:45], v145 offset:4640
ds_read_b64_tr_b16 a[46:47], v145 offset:4896
ds_read_b64_tr_b16 a[48:49], v145 offset:8224
ds_read_b64_tr_b16 a[50:51], v145 offset:8480
ds_read_b64_tr_b16 a[52:53], v145 offset:8736
ds_read_b64_tr_b16 a[54:55], v145 offset:8992
ds_read_b64_tr_b16 a[56:57], v145 offset:12320
ds_read_b64_tr_b16 a[58:59], v145 offset:12576
ds_read_b64_tr_b16 a[60:61], v145 offset:12832
ds_read_b64_tr_b16 a[62:63], v145 offset:13088
s_waitcnt lgkmcnt(0)
s_barrier
.if \sf == 0
v_mov_b32 v14, 136
.else
v_mov_b32 v14, 160
.endif
s_nop 1
iw_52_\sf:
buffer_load_dwordx2 v[12:13], v14, s[32:35], 0 offen sc1
s_waitcnt vmcnt(0)
v_cmp_gt_u32 vcc, 256, v12
s_cbranch_vccz iwd_53_\sf
s_sleep 2
s_add_u32 s44, s44, 1
s_cmp_lt_u32 s44, 0x40000
s_cbranch_scc1 iw_52_\sf
iwd_53_\sf:
.if \sf == 0
v_readfirstlane_b32 s45, v13
s_cmp_lg_u32 s45, 0
s_nop 3
s_cbranch_scc1 SAFE_ENTRY
.else
.endif
s_mov_b32 s59, 0
s_mov_b32 s6, 160
s_barrier
s_mov_b32 s43, 0
r_loop_w2_\sf:
s_and_b32 s63, s43, 3
s_add_u32 s64, s43, 2
s_and_b32 s64, s64, 3
s_lshl_b32 s66, s63, 14
s_add_u32 s66, s66, s52
s_lshl_b32 s67, s63, 14
s_add_u32 s67, s67, s56
s_lshl_b32 s4, s63, 14
s_add_u32 s4, s4, s53
s_lshl_b32 s5, s64, 14
s_add_u32 s5, s5, s53
s_cmp_eq_u32 s43, 0
s_cbranch_scc1 apub_54_\sf
s_cmp_lg_u32 s43, 5
s_cbranch_scc1 nosw_55_\sf
v_mov_b32 v13, 132
s_nop 1
ch_56_\sf:
buffer_load_dword v12, v13, s[32:35], 0 offen sc1
s_waitcnt vmcnt(0)
v_readfirstlane_b32 s45, v12
s_cmp_lg_u32 s45, 0
s_cbranch_scc1 chd_57_\sf
s_add_u32 s44, s44, 1
s_cmp_lt_u32 s44, 0x40000
s_cbranch_scc1 ch_56_\sf
chd_57_\sf:
s_and_b32 s46, s45, 1
s_lshl_b32 s46, s46, 13
s_add_u32 s58, s58, s46
s_and_b32 s46, s45, 2
s_lshl_b32 s46, s46, 12
s_add_u32 s51, s51, s46
nosw_55_\sf:
s_lshl_b32 s45, s63, 14
s_add_u32 s45, s45, s58
s_add_u32 s36, s8, s45
s_addc_u32 s37, s9, 0
s_lshl_b32 s45, s63, 14
s_add_u32 s45, s45, s51
s_add_u32 s38, s8, s45
s_addc_u32 s39, s9, 0
s_sleep 7
global_load_dwordx2 v[160:161], v232, s[36:37] offset:0 sc1
global_load_dwordx2 v[162:163], v232, s[36:37] offset:1024 sc1
global_load_dwordx2 v[164:165], v232, s[36:37] offset:2048 sc1
global_load_dwordx2 v[166:167], v232, s[36:37] offset:3072 sc1
xw_59_\sf:
s_waitcnt vmcnt(0)
v_max3_u32 v12, v160, v161, v162
v_pk_add_f32 v[168:169], v[160:161], v[162:163]
v_max3_u32 v13, v163, v164, v165
v_pk_add_f32 v[170:171], v[164:165], v[166:167]
v_max3_u32 v12, v12, v166, v167
v_pk_add_f32 v[168:169], v[168:169], v[170:171]
v_max_u32 v12, v12, v13
v_cvt_pk_bf16_f32 v224, v168, v169
v_cmp_eq_u32 vcc, -1, v12
s_cbranch_vccnz xr_58_\sf
apub_54_\sf:
v_min_u32 v224, -2, v224
.if \sf == 0
buffer_store_dword v224, v233, s[8:11], s4 offen
.else
buffer_store_dword v224, v233, s[8:11], s4 offen sc1
.endif
s_barrier
buffer_load_dwordx4 v[64:67], v2, s[8:11], s66 offen offset:0 sc1
buffer_load_dwordx4 v[68:71], v2, s[8:11], s66 offen offset:1024 sc1
buffer_load_dwordx4 v[72:75], v2, s[8:11], s66 offen offset:2048 sc1
buffer_load_dwordx4 v[76:79], v2, s[8:11], s66 offen offset:3072 sc1
s_waitcnt vmcnt(3)
v_max3_u32 v12, v64, v65, v66
v_max_u32 v12, v12, v67
v_cmp_eq_u32 vcc, -1, v12
s_cbranch_vccnz ppr_60_\sf
ppo_61_\sf:
v_mfma_f32_16x16x32_bf16 v[80:83], a[0:3], v[64:67], 0
v_mfma_f32_16x16x32_bf16 v[84:87], a[4:7], v[64:67], 0
s_waitcnt vmcnt(2)
v_mfma_f32_16x16x32_bf16 v[88:91], a[32:35], v[64:67], 0
v_max3_u32 v12, v68, v69, v70
v_mfma_f32_16x16x32_bf16 v[92:95], a[36:39], v[64:67], 0
v_max_u32 v12, v12, v71
v_mfma_f32_16x16x32_bf16 v[96:99], a[64:67], v[64:67], 0
v_cmp_eq_u32 vcc, -1, v12
v_mfma_f32_16x16x32_bf16 v[100:103], a[68:71], v[64:67], 0
v_mfma_f32_16x16x32_bf16 v[104:107], a[96:99], v[64:67], 0
v_mfma_f32_16x16x32_bf16 v[108:111], a[100:103], v[64:67], 0
s_cbranch_vccnz ppr_62_\sf
ppo_63_\sf:
v_mfma_f32_16x16x32_bf16 v[80:83], a[8:11], v[68:71], v[80:83]
v_mfma_f32_16x16x32_bf16 v[84:87], a[12:15], v[68:71], v[84:87]
s_waitcnt vmcnt(1)
v_mfma_f32_16x16x32_bf16 v[88:91], a[40:43], v[68:71], v[88:91]
v_max3_u32 v12, v72, v73, v74
v_mfma_f32_16x16x32_bf16 v[92:95], a[44:47], v[68:71], v[92:95]
v_max_u32 v12, v12, v75
v_mfma_f32_16x16x32_bf16 v[96:99], a[72:75], v[68:71], v[96:99]
v_cmp_eq_u32 vcc, -1, v12
v_mfma_f32_16x16x32_bf16 v[100:103], a[76:79], v[68:71], v[100:103]
v_mfma_f32_16x16x32_bf16 v[104:107], a[104:107], v[68:71], v[104:107]
v_mfma_f32_16x16x32_bf16 v[108:111], a[108:111], v[68:71], v[108:111]
s_cbranch_vccnz ppr_64_\sf
ppo_65_\sf:
v_mfma_f32_16x16x32_bf16 v[80:83], a[16:19], v[72:75], v[80:83]
v_mfma_f32_16x16x32_bf16 v[84:87], a[20:23], v[72:75], v[84:87]
s_waitcnt vmcnt(0)
v_mfma_f32_16x16x32_bf16 v[88:91], a[48:51], v[72:75], v[88:91]
v_max3_u32 v12, v76, v77, v78
v_mfma_f32_16x16x32_bf16 v[92:95], a[52:55], v[72:75], v[92:95]
v_max_u32 v12, v12, v79
v_mfma_f32_16x16x32_bf16 v[96:99], a[80:83], v[72:75], v[96:99]
v_cmp_eq_u32 vcc, -1, v12
v_mfma_f32_16x16x32_bf16 v[100:103], a[84:87], v[72:75], v[100:103]
s_cbranch_vccnz ppr_66_\sf
ppo_67_\sf:
v_mfma_f32_16x16x32_bf16 v[80:83], a[24:27], v[76:79], v[80:83]
v_mfma_f32_16x16x32_bf16 v[84:87], a[28:31], v[76:79], v[84:87]
v_mfma_f32_16x16x32_bf16 v[88:91], a[56:59], v[76:79], v[88:91]
v_mfma_f32_16x16x32_bf16 v[92:95], a[60:63], v[76:79], v[92:95]
v_mfma_f32_16x16x32_bf16 v[104:107], a[112:115], v[72:75], v[104:107]
v_mfma_f32_16x16x32_bf16 v[108:111], a[116:119], v[72:75], v[108:111]
v_mfma_f32_16x16x32_bf16 v[96:99], a[88:91], v[76:79], v[96:99]
s_nop 2
v_add_f32_dpp v128, v84, v80 row_ror:8 row_mask:0xf bank_mask:0x3
v_add_f32_dpp v129, v85, v81 row_ror:8 row_mask:0xf bank_mask:0x3
v_mfma_f32_16x16x32_bf16 v[100:103], a[92:95], v[76:79], v[100:103]
v_add_f32_dpp v130, v86, v82 row_ror:8 row_mask:0xf bank_mask:0x3
v_add_f32_dpp v131, v87, v83 row_ror:8 row_mask:0xf bank_mask:0x3
v_mfma_f32_16x16x32_bf16 v[104:107], a[120:123], v[76:79], v[104:107]
v_add_f32_dpp v128, v88, v92 row_ror:8 row_mask:0xf bank_mask:0xc
v_add_f32_dpp v129, v89, v93 row_ror:8 row_mask:0xf bank_mask:0xc
v_mfma_f32_16x16x32_bf16 v[108:111], a[124:127], v[76:79], v[108:111]
v_add_f32_dpp v130, v90, v94 row_ror:8 row_mask:0xf bank_mask:0xc
v_add_f32_dpp v131, v91, v95 row_ror:8 row_mask:0xf bank_mask:0xc
ds_write_b128 v2, v[128:131] offset:2048
v_add_f32_dpp v132, v100, v96 row_ror:8 row_mask:0xf bank_mask:0x3
v_add_f32_dpp v133, v101, v97 row_ror:8 row_mask:0xf bank_mask:0x3
v_add_f32_dpp v134, v102, v98 row_ror:8 row_mask:0xf bank_mask:0x3
v_add_f32_dpp v135, v103, v99 row_ror:8 row_mask:0xf bank_mask:0x3
s_nop 0
v_add_f32_dpp v132, v104, v108 row_ror:8 row_mask:0xf bank_mask:0xc
v_add_f32_dpp v133, v105, v109 row_ror:8 row_mask:0xf bank_mask:0xc
v_add_f32_dpp v134, v106, v110 row_ror:8 row_mask:0xf bank_mask:0xc
v_add_f32_dpp v135, v107, v111 row_ror:8 row_mask:0xf bank_mask:0xc
ds_write_b128 v2, v[132:135] offset:6144
s_waitcnt lgkmcnt(0)
s_barrier
.if \sf == 0
buffer_store_dword v8, v233, s[8:11], s5 offen
.else
buffer_store_dword v8, v233, s[8:11], s5 offen sc1
.endif
v_mfma_f32_16x16x32_bf16 v[112:115], v[64:67], a[128:131], 0
v_mfma_f32_16x16x32_bf16 v[116:119], v[64:67], a[132:135], 0
v_mfma_f32_16x16x32_bf16 v[112:115], v[68:71], a[136:139], v[112:115]
v_mfma_f32_16x16x32_bf16 v[116:119], v[68:71], a[140:143], v[116:119]
v_mfma_f32_16x16x32_bf16 v[112:115], v[72:75], a[144:147], v[112:115]
v_mfma_f32_16x16x32_bf16 v[116:119], v[72:75], a[148:151], v[116:119]
v_mfma_f32_16x16x32_bf16 v[112:115], v[76:79], a[152:155], v[112:115]
v_mfma_f32_16x16x32_bf16 v[116:119], v[76:79], a[156:159], v[116:119]
v_mfma_f32_16x16x32_bf16 v[120:123], v[64:67], a[160:163], 0
v_mfma_f32_16x16x32_bf16 v[124:127], v[64:67], a[164:167], 0
v_mfma_f32_16x16x32_bf16 v[120:123], v[68:71], a[168:171], v[120:123]
v_mfma_f32_16x16x32_bf16 v[124:127], v[68:71], a[172:175], v[124:127]
v_mfma_f32_16x16x32_bf16 v[120:123], v[72:75], a[176:179], v[120:123]
v_mfma_f32_16x16x32_bf16 v[124:127], v[72:75], a[180:183], v[124:127]
v_mfma_f32_16x16x32_bf16 v[120:123], v[76:79], a[184:187], v[120:123]
v_mfma_f32_16x16x32_bf16 v[124:127], v[76:79], a[188:191], v[124:127]
s_nop 6
v_permlane32_swap_b32 v112, v120
v_permlane32_swap_b32 v116, v124
v_permlane32_swap_b32 v113, v121
v_permlane32_swap_b32 v117, v125
v_permlane32_swap_b32 v114, v122
v_permlane32_swap_b32 v118, v126
v_permlane32_swap_b32 v115, v123
v_permlane32_swap_b32 v119, v127
v_add_f32 v136, v112, v124
v_add_f32 v137, v113, v125
v_add_f32 v138, v114, v126
v_add_f32 v139, v115, v127
ds_write_b128 v2, v[136:139] offset:10240
s_waitcnt lgkmcnt(0)
s_barrier
ds_read_b128 v[144:147], v2 offset:8192
ds_read_b128 v[148:151], v2 offset:9216
ds_read_b128 v[152:155], v2 offset:11264
s_waitcnt lgkmcnt(2)
v_pk_add_f32 v[136:137], v[136:137], v[144:145]
v_pk_add_f32 v[138:139], v[138:139], v[146:147]
s_waitcnt lgkmcnt(0)
v_pk_add_f32 v[148:149], v[148:149], v[152:153]
v_pk_add_f32 v[150:151], v[150:151], v[154:155]
v_pk_add_f32 v[136:137], v[136:137], v[148:149]
v_pk_add_f32 v[138:139], v[138:139], v[150:151]
v_cvt_pk_bf16_f32 v136, v136, v137
v_cvt_pk_bf16_f32 v137, v138, v139
s_lshl_b32 s45, s43, 16
s_add_u32 s45, s45, s60
buffer_store_dwordx2 v[136:137], v6, s[8:11], s45 offen sc1
s_cmp_eq_u32 s43, 63
s_cbranch_scc1 r_end_w2_\sf
s_add_u32 s61, s61, 0x40000
s_add_u32 s62, s62, 0x40000
s_add_u32 s47, s43, 2
s_min_u32 s47, s47, 64
s_lshl_b32 s46, s49, 8
s_add_u32 s46, s46, 0x5502000
v_mov_b32 v12, 0
s_nop 1
gp_68_\sf:
s_cmp_ge_u32 s59, s47
s_cbranch_scc1 gpd_69_\sf
buffer_load_dwordx4 v[144:147], v12, s[8:11], s46 offen sc1
s_waitcnt vmcnt(0)
v_min3_u32 v144, v144, v145, v146
v_min_u32 v144, v144, v147
s_nop 0
v_readfirstlane_b32 s59, v144
s_add_u32 s44, s44, 1
s_cmp_lt_u32 s44, 0x40000
s_cbranch_scc1 gp_68_\sf
s_nop 1
gpd_69_\sf:
s_add_u32 s45, s61, 4096
s_mov_b32 m0, 16384
s_nop 0
buffer_load_dwordx4 v2, s[8:11], s61 offen offset:0 sc1 lds
buffer_load_dwordx4 v2, s[8:11], s61 offen offset:1024 sc1 lds
buffer_load_dwordx4 v2, s[8:11], s61 offen offset:2048 sc1 lds
buffer_load_dwordx4 v2, s[8:11], s61 offen offset:3072 sc1 lds
s_mov_b32 m0, 20480
s_nop 0
buffer_load_dwordx4 v2, s[8:11], s45 offen offset:0 sc1 lds
buffer_load_dwordx4 v2, s[8:11], s45 offen offset:1024 sc1 lds
buffer_load_dwordx4 v2, s[8:11], s45 offen offset:2048 sc1 lds
buffer_load_dwordx4 v2, s[8:11], s45 offen offset:3072 sc1 lds
s_mov_b32 m0, 24576
s_nop 0
buffer_load_dwordx4 v2, s[8:11], s62 offen offset:0 sc1 lds
buffer_load_dwordx4 v2, s[8:11], s62 offen offset:1024 sc1 lds
s_barrier
buffer_load_dwordx4 v[64:67], v5, s[8:11], s67 offen offset:0 sc1
buffer_load_dwordx4 v[68:71], v5, s[8:11], s67 offen offset:1024 sc1
buffer_load_dwordx4 v[72:75], v5, s[8:11], s67 offen offset:2048 sc1
buffer_load_dwordx4 v[76:79], v5, s[8:11], s67 offen offset:3072 sc1
s_waitcnt vmcnt(3)
v_max3_u32 v12, v64, v65, v66
v_max_u32 v12, v12, v67
v_cmp_eq_u32 vcc, -1, v12
s_cbranch_vccnz ppr_70_\sf
ppo_71_\sf:
v_mfma_f32_16x16x32_bf16 v[80:83], a[192:195], v[64:67], 0
s_waitcnt vmcnt(2)
v_max3_u32 v12, v68, v69, v70
v_mfma_f32_16x16x32_bf16 v[84:87], a[196:199], v[64:67], 0
v_max_u32 v12, v12, v71
v_cmp_eq_u32 vcc, -1, v12
v_mfma_f32_16x16x32_bf16 v[88:91], a[224:227], v[64:67], 0
v_mfma_f32_16x16x32_bf16 v[92:95], a[228:231], v[64:67], 0
s_cbranch_vccnz ppr_72_\sf
ppo_73_\sf:
v_mfma_f32_16x16x32_bf16 v[80:83], a[200:203], v[68:71], v[80:83]
s_waitcnt vmcnt(1)
v_max3_u32 v12, v72, v73, v74
v_mfma_f32_16x16x32_bf16 v[84:87], a[204:207], v[68:71], v[84:87]
v_max_u32 v12, v12, v75
v_cmp_eq_u32 vcc, -1, v12
v_mfma_f32_16x16x32_bf16 v[88:91], a[232:235], v[68:71], v[88:91]
v_mfma_f32_16x16x32_bf16 v[92:95], a[236:239], v[68:71], v[92:95]
s_cbranch_vccnz ppr_74_\sf
ppo_75_\sf:
v_mfma_f32_16x16x32_bf16 v[80:83], a[208:211], v[72:75], v[80:83]
s_waitcnt vmcnt(0)
v_max3_u32 v12, v76, v77, v78
v_mfma_f32_16x16x32_bf16 v[84:87], a[212:215], v[72:75], v[84:87]
v_max_u32 v12, v12, v79
v_cmp_eq_u32 vcc, -1, v12
v_mfma_f32_16x16x32_bf16 v[88:91], a[240:243], v[72:75], v[88:91]
v_mfma_f32_16x16x32_bf16 v[92:95], a[244:247], v[72:75], v[92:95]
s_cbranch_vccnz ppr_76_\sf
ppo_77_\sf:
v_mfma_f32_16x16x32_bf16 v[80:83], a[216:219], v[76:79], v[80:83]
v_mfma_f32_16x16x32_bf16 v[84:87], a[220:223], v[76:79], v[84:87]
v_mfma_f32_16x16x32_bf16 v[88:91], a[248:251], v[76:79], v[88:91]
v_mfma_f32_16x16x32_bf16 v[92:95], a[252:255], v[76:79], v[92:95]
s_nop 5
v_add_f32_dpp v140, v84, v80 row_ror:8 row_mask:0xf bank_mask:0x3
v_add_f32_dpp v141, v85, v81 row_ror:8 row_mask:0xf bank_mask:0x3
v_add_f32_dpp v142, v86, v82 row_ror:8 row_mask:0xf bank_mask:0x3
v_add_f32_dpp v143, v87, v83 row_ror:8 row_mask:0xf bank_mask:0x3
v_add_f32_dpp v140, v88, v92 row_ror:8 row_mask:0xf bank_mask:0xc
v_add_f32_dpp v141, v89, v93 row_ror:8 row_mask:0xf bank_mask:0xc
v_add_f32_dpp v142, v90, v94 row_ror:8 row_mask:0xf bank_mask:0xc
v_add_f32_dpp v143, v91, v95 row_ror:8 row_mask:0xf bank_mask:0xc
ds_write_b128 v2, v[140:143] offset:14336
s_waitcnt lgkmcnt(0)
s_barrier
s_add_u32 s43, s43, 1
s_branch r_loop_w2_\sf
xr_58_\sf:
global_load_dwordx2 v[160:161], v232, s[36:37] offset:0 sc1
global_load_dwordx2 v[162:163], v232, s[36:37] offset:1024 sc1
global_load_dwordx2 v[164:165], v232, s[36:37] offset:2048 sc1
global_load_dwordx2 v[166:167], v232, s[36:37] offset:3072 sc1
s_add_u32 s44, s44, 1
s_cmp_lt_u32 s44, 0x40000
s_cbranch_scc1 xw_59_\sf
s_branch apub_54_\sf
ppr_60_\sf:
s_nop 7
buffer_load_dwordx4 v[64:67], v2, s[8:11], s66 offen offset:0 sc1
buffer_load_dwordx4 v[68:71], v2, s[8:11], s66 offen offset:1024 sc1
buffer_load_dwordx4 v[72:75], v2, s[8:11], s66 offen offset:2048 sc1
buffer_load_dwordx4 v[76:79], v2, s[8:11], s66 offen offset:3072 sc1
s_add_u32 s44, s44, 1
s_waitcnt vmcnt(3)
v_max3_u32 v12, v64, v65, v66
v_max_u32 v12, v12, v67
v_cmp_eq_u32 vcc, -1, v12
s_cbranch_vccz ppo_61_\sf
s_cmp_lt_u32 s44, 0x40000
s_cbranch_scc1 ppr_60_\sf
s_branch ppo_61_\sf
s_nop 0
ppr_62_\sf:
s_nop 7
buffer_load_dwordx4 v[68:71], v2, s[8:11], s66 offen offset:1024 sc1
buffer_load_dwordx4 v[72:75], v2, s[8:11], s66 offen offset:2048 sc1
buffer_load_dwordx4 v[76:79], v2, s[8:11], s66 offen offset:3072 sc1
s_add_u32 s44, s44, 1
s_waitcnt vmcnt(2)
v_max3_u32 v12, v68, v69, v70
v_max_u32 v12, v12, v71
v_cmp_eq_u32 vcc, -1, v12
s_cbranch_vccz ppo_63_\sf
s_cmp_lt_u32 s44, 0x40000
s_cbranch_scc1 ppr_62_\sf
s_branch ppo_63_\sf
s_nop 0
ppr_64_\sf:
s_nop 7
buffer_load_dwordx4 v[72:75], v2, s[8:11], s66 offen offset:2048 sc1
buffer_load_dwordx4 v[76:79], v2, s[8:11], s66 offen offset:3072 sc1
s_add_u32 s44, s44, 1
s_waitcnt vmcnt(1)
v_max3_u32 v12, v72, v73, v74
v_max_u32 v12, v12, v75
v_cmp_eq_u32 vcc, -1, v12
s_cbranch_vccz ppo_65_\sf
s_cmp_lt_u32 s44, 0x40000
s_cbranch_scc1 ppr_64_\sf
s_branch ppo_65_\sf
s_nop 0
ppr_66_\sf:
s_nop 7
buffer_load_dwordx4 v[76:79], v2, s[8:11], s66 offen offset:3072 sc1
s_add_u32 s44, s44, 1
s_waitcnt vmcnt(0)
v_max3_u32 v12, v76, v77, v78
v_max_u32 v12, v12, v79
v_cmp_eq_u32 vcc, -1, v12
s_cbranch_vccz ppo_67_\sf
s_cmp_lt_u32 s44, 0x40000
s_cbranch_scc1 ppr_66_\sf
s_branch ppo_67_\sf
s_nop 0
ppr_70_\sf:
s_nop 7
buffer_load_dwordx4 v[64:67], v5, s[8:11], s67 offen offset:0 sc1
buffer_load_dwordx4 v[68:71], v5, s[8:11], s67 offen offset:1024 sc1
buffer_load_dwordx4 v[72:75], v5, s[8:11], s67 offen offset:2048 sc1
buffer_load_dwordx4 v[76:79], v5, s[8:11], s67 offen offset:3072 sc1
s_add_u32 s44, s44, 1
s_waitcnt vmcnt(3)
v_max3_u32 v12, v64, v65, v66
v_max_u32 v12, v12, v67
v_cmp_eq_u32 vcc, -1, v12
s_cbranch_vccz ppo_71_\sf
s_cmp_lt_u32 s44, 0x40000
s_cbranch_scc1 ppr_70_\sf
s_branch ppo_71_\sf
s_nop 0
ppr_72_\sf:
s_nop 7
buffer_load_dwordx4 v[68:71], v5, s[8:11], s67 offen offset:1024 sc1
buffer_load_dwordx4 v[72:75], v5, s[8:11], s67 offen offset:2048 sc1
buffer_load_dwordx4 v[76:79], v5, s[8:11], s67 offen offset:3072 sc1
s_add_u32 s44, s44, 1
s_waitcnt vmcnt(2)
v_max3_u32 v12, v68, v69, v70
v_max_u32 v12, v12, v71
v_cmp_eq_u32 vcc, -1, v12
s_cbranch_vccz ppo_73_\sf
s_cmp_lt_u32 s44, 0x40000
s_cbranch_scc1 ppr_72_\sf
s_branch ppo_73_\sf
s_nop 0
ppr_74_\sf:
s_nop 7
buffer_load_dwordx4 v[72:75], v5, s[8:11], s67 offen offset:2048 sc1
buffer_load_dwordx4 v[76:79], v5, s[8:11], s67 offen offset:3072 sc1
s_add_u32 s44, s44, 1
s_waitcnt vmcnt(1)
v_max3_u32 v12, v72, v73, v74
v_max_u32 v12, v12, v75
v_cmp_eq_u32 vcc, -1, v12
s_cbranch_vccz ppo_75_\sf
s_cmp_lt_u32 s44, 0x40000
s_cbranch_scc1 ppr_74_\sf
s_branch ppo_75_\sf
s_nop 0
ppr_76_\sf:
s_nop 7
buffer_load_dwordx4 v[76:79], v5, s[8:11], s67 offen offset:3072 sc1
s_add_u32 s44, s44, 1
s_waitcnt vmcnt(0)
v_max3_u32 v12, v76, v77, v78
v_max_u32 v12, v12, v79
v_cmp_eq_u32 vcc, -1, v12
s_cbranch_vccz ppo_77_\sf
s_cmp_lt_u32 s44, 0x40000
s_cbranch_scc1 ppr_76_\sf
s_branch ppo_77_\sf
s_nop 0
r_end_w2_\sf:
s_waitcnt vmcnt(0)
s_barrier
s_endpgm
r_wave3_\sf:
s_lshl_b32 s45, s40, 16
.if \sf == 0
s_add_u32 s52, s45, 0x4803000
.else
s_add_u32 s52, s45, 0xc803000
.endif
s_lshl_b32 s46, s41, 9
s_add_u32 s47, s45, s46
.if \sf == 0
s_add_u32 s53, s47, 0x4800000
s_add_u32 s56, s45, 0x48c3000
s_add_u32 s57, s47, 0x48c0000
.else
s_add_u32 s53, s47, 0xc800000
s_add_u32 s56, s45, 0xc8c3000
s_add_u32 s57, s47, 0xc8c0000
.endif
s_lshl_b32 s45, s40, 17
s_lshr_b32 s46, s41, 2
s_lshl_b32 s46, s46, 12
s_add_u32 s45, s45, s46
.if \sf == 0
s_add_u32 s55, s45, 0x4840000
.else
s_add_u32 s55, s45, 0xc840000
.endif
s_lshl_b32 s46, s50, 9
s_add_u32 s54, s55, s46
s_lshl_b32 s45, s41, 16
s_add_u32 s58, s45, 0x4a00000
s_add_u32 s51, s58, 0x200000
v_add_u32 v7, 0x1000, v2
s_lshl_b32 s45, s49, 11
s_lshl_b32 s46, s50, 9
s_add_u32 s45, s45, s46
s_add_u32 s60, s45, 0x4400000
s_lshl_b32 s45, s49, 13
s_add_u32 s61, s45, 0x1000000
s_lshl_b32 s46, s50, 11
s_add_u32 s45, s45, s46
s_add_u32 s62, s45, 0x2000000
s_mov_b32 s65, 0x3e0293ee
s_mov_b32 s74, 0x7fffffff
s_mov_b32 s75, 0x7fffffff
s_mov_b32 s72, 0x7fffffff
s_mov_b32 s73, 0x7fffffff
v_lshrrev_b32 v12, 2, v1
v_and_b32 v13, 3, v1
v_lshlrev_b32 v13, 4, v13
v_lshl_add_u32 v14, v12, 13, v13
v_lshl_add_u32 v15, v12, 11, v13
s_lshl_b32 s45, s40, 21
s_lshl_b32 s46, s42, 19
s_add_u32 s45, s45, s46
s_lshl_b32 s46, s41, 6
s_add_u32 s45, s45, s46
buffer_load_dwordx4 a[192:195], v15, s[24:27], s45 offen
s_add_u32 s45, s45, 0x8000
buffer_load_dwordx4 a[196:199], v15, s[24:27], s45 offen
s_add_u32 s45, s45, 0x8000
buffer_load_dwordx4 a[200:203], v15, s[24:27], s45 offen
s_add_u32 s45, s45, 0x8000
buffer_load_dwordx4 a[204:207], v15, s[24:27], s45 offen
s_add_u32 s45, s45, 0x8000
buffer_load_dwordx4 a[208:211], v15, s[24:27], s45 offen
s_add_u32 s45, s45, 0x8000
buffer_load_dwordx4 a[212:215], v15, s[24:27], s45 offen
s_add_u32 s45, s45, 0x8000
buffer_load_dwordx4 a[216:219], v15, s[24:27], s45 offen
s_add_u32 s45, s45, 0x8000
buffer_load_dwordx4 a[220:223], v15, s[24:27], s45 offen
s_add_u32 s45, s45, 0x8000
buffer_load_dwordx4 a[224:227], v15, s[24:27], s45 offen
s_add_u32 s45, s45, 0x8000
buffer_load_dwordx4 a[228:231], v15, s[24:27], s45 offen
s_add_u32 s45, s45, 0x8000
buffer_load_dwordx4 a[232:235], v15, s[24:27], s45 offen
s_add_u32 s45, s45, 0x8000
buffer_load_dwordx4 a[236:239], v15, s[24:27], s45 offen
s_add_u32 s45, s45, 0x8000
buffer_load_dwordx4 a[240:243], v15, s[24:27], s45 offen
s_add_u32 s45, s45, 0x8000
buffer_load_dwordx4 a[244:247], v15, s[24:27], s45 offen
s_add_u32 s45, s45, 0x8000
buffer_load_dwordx4 a[248:251], v15, s[24:27], s45 offen
s_add_u32 s45, s45, 0x8000
buffer_load_dwordx4 a[252:255], v15, s[24:27], s45 offen
s_lshl_b32 s47, s42, 21
s_lshl_b32 s46, s49, 8
s_add_u32 s47, s47, s46
s_lshl_b32 s46, s50, 6
s_add_u32 s47, s47, s46
s_mov_b32 s45, s47
buffer_load_dwordx4 a[64:67], v14, s[16:19], s45 offen
s_add_u32 s45, s45, 0x20000
buffer_load_dwordx4 a[68:71], v14, s[16:19], s45 offen
s_add_u32 s45, s45, 0x20000
buffer_load_dwordx4 a[72:75], v14, s[16:19], s45 offen
s_add_u32 s45, s45, 0x20000
buffer_load_dwordx4 a[76:79], v14, s[16:19], s45 offen
s_add_u32 s45, s45, 0x20000
buffer_load_dwordx4 a[80:83], v14, s[16:19], s45 offen
s_add_u32 s45, s45, 0x20000
buffer_load_dwordx4 a[84:87], v14, s[16:19], s45 offen
s_add_u32 s45, s45, 0x20000
buffer_load_dwordx4 a[88:91], v14, s[16:19], s45 offen
s_add_u32 s45, s45, 0x20000
buffer_load_dwordx4 a[92:95], v14, s[16:19], s45 offen
s_add_u32 s45, s45, 0x20000
buffer_load_dwordx4 a[96:99], v14, s[16:19], s45 offen
s_add_u32 s45, s45, 0x20000
buffer_load_dwordx4 a[100:103], v14, s[16:19], s45 offen
s_add_u32 s45, s45, 0x20000
buffer_load_dwordx4 a[104:107], v14, s[16:19], s45 offen
s_add_u32 s45, s45, 0x20000
buffer_load_dwordx4 a[108:111], v14, s[16:19], s45 offen
s_add_u32 s45, s45, 0x20000
buffer_load_dwordx4 a[112:115], v14, s[16:19], s45 offen
s_add_u32 s45, s45, 0x20000
buffer_load_dwordx4 a[116:119], v14, s[16:19], s45 offen
s_add_u32 s45, s45, 0x20000
buffer_load_dwordx4 a[120:123], v14, s[16:19], s45 offen
s_add_u32 s45, s45, 0x20000
buffer_load_dwordx4 a[124:127], v14, s[16:19], s45 offen
s_mov_b32 s45, s47
buffer_load_dwordx4 a[128:131], v14, s[20:23], s45 offen
s_add_u32 s45, s45, 0x20000
buffer_load_dwordx4 a[132:135], v14, s[20:23], s45 offen
s_add_u32 s45, s45, 0x20000
buffer_load_dwordx4 a[136:139], v14, s[20:23], s45 offen
s_add_u32 s45, s45, 0x20000
buffer_load_dwordx4 a[140:143], v14, s[20:23], s45 offen
s_add_u32 s45, s45, 0x20000
buffer_load_dwordx4 a[144:147], v14, s[20:23], s45 offen
s_add_u32 s45, s45, 0x20000
buffer_load_dwordx4 a[148:151], v14, s[20:23], s45 offen
s_add_u32 s45, s45, 0x20000
buffer_load_dwordx4 a[152:155], v14, s[20:23], s45 offen
s_add_u32 s45, s45, 0x20000
buffer_load_dwordx4 a[156:159], v14, s[20:23], s45 offen
s_add_u32 s45, s45, 0x20000
buffer_load_dwordx4 a[160:163], v14, s[20:23], s45 offen
s_add_u32 s45, s45, 0x20000
buffer_load_dwordx4 a[164:167], v14, s[20:23], s45 offen
s_add_u32 s45, s45, 0x20000
buffer_load_dwordx4 a[168:171], v14, s[20:23], s45 offen
s_add_u32 s45, s45, 0x20000
buffer_load_dwordx4 a[172:175], v14, s[20:23], s45 offen
s_add_u32 s45, s45, 0x20000
buffer_load_dwordx4 a[176:179], v14, s[20:23], s45 offen
s_add_u32 s45, s45, 0x20000
buffer_load_dwordx4 a[180:183], v14, s[20:23], s45 offen
s_add_u32 s45, s45, 0x20000
buffer_load_dwordx4 a[184:187], v14, s[20:23], s45 offen
s_add_u32 s45, s45, 0x20000
buffer_load_dwordx4 a[188:191], v14, s[20:23], s45 offen
s_mov_b32 s45, s47
buffer_load_dwordx4 a[0:3], v14, s[12:15], s45 offen
s_add_u32 s45, s45, 0x20000
buffer_load_dwordx4 a[4:7], v14, s[12:15], s45 offen
s_add_u32 s45, s45, 0x20000
buffer_load_dwordx4 a[8:11], v14, s[12:15], s45 offen
s_add_u32 s45, s45, 0x20000
buffer_load_dwordx4 a[12:15], v14, s[12:15], s45 offen
s_add_u32 s45, s45, 0x20000
buffer_load_dwordx4 a[16:19], v14, s[12:15], s45 offen
s_add_u32 s45, s45, 0x20000
buffer_load_dwordx4 a[20:23], v14, s[12:15], s45 offen
s_add_u32 s45, s45, 0x20000
buffer_load_dwordx4 a[24:27], v14, s[12:15], s45 offen
s_add_u32 s45, s45, 0x20000
buffer_load_dwordx4 a[28:31], v14, s[12:15], s45 offen
s_add_u32 s45, s45, 0x20000
buffer_load_dwordx4 a[32:35], v14, s[12:15], s45 offen
s_add_u32 s45, s45, 0x20000
buffer_load_dwordx4 a[36:39], v14, s[12:15], s45 offen
s_add_u32 s45, s45, 0x20000
buffer_load_dwordx4 a[40:43], v14, s[12:15], s45 offen
s_add_u32 s45, s45, 0x20000
buffer_load_dwordx4 a[44:47], v14, s[12:15], s45 offen
s_add_u32 s45, s45, 0x20000
buffer_load_dwordx4 a[48:51], v14, s[12:15], s45 offen
s_add_u32 s45, s45, 0x20000
buffer_load_dwordx4 a[52:55], v14, s[12:15], s45 offen
s_add_u32 s45, s45, 0x20000
buffer_load_dwordx4 a[56:59], v14, s[12:15], s45 offen
s_add_u32 s45, s45, 0x20000
buffer_load_dwordx4 a[60:63], v14, s[12:15], s45 offen
s_lshl_b32 s45, s42, 14
v_add_u32 v144, s45, v2
v_lshrrev_b32 v12, 4, v1
v_bfe_u32 v13, v1, 2, 2
v_and_b32 v14, 3, v1
v_lshl_add_u32 v15, v12, 4, v13
v_lshlrev_b32 v15, 6, v15
v_lshl_add_u32 v15, v14, 3, v15
v_add_u32 v145, s45, v15
v_lshl_add_u32 v15, v12, 2, v13
v_lshlrev_b32 v15, 6, v15
v_lshl_add_u32 v15, v14, 4, v15
v_add_u32 v146, s45, v15
s_waitcnt vmcnt(48)
ds_write_b128 v144, a[192:195] offset:0
ds_write_b128 v144, a[196:199] offset:1024
ds_write_b128 v144, a[200:203] offset:2048
ds_write_b128 v144, a[204:207] offset:3072
ds_write_b128 v144, a[208:211] offset:4096
ds_write_b128 v144, a[212:215] offset:5120
ds_write_b128 v144, a[216:219] offset:6144
ds_write_b128 v144, a[220:223] offset:7168
ds_write_b128 v144, a[224:227] offset:8192
ds_write_b128 v144, a[228:231] offset:9216
ds_write_b128 v144, a[232:235] offset:10240
ds_write_b128 v144, a[236:239] offset:11264
ds_write_b128 v144, a[240:243] offset:12288
ds_write_b128 v144, a[244:247] offset:13312
ds_write_b128 v144, a[248:251] offset:14336
ds_write_b128 v144, a[252:255] offset:15360
s_waitcnt lgkmcnt(0)
ds_read_b64_tr_b16 a[192:193], v146 offset:0
ds_read_b64_tr_b16 a[194:195], v146 offset:1024
ds_read_b64_tr_b16 a[196:197], v146 offset:2048
ds_read_b64_tr_b16 a[198:199], v146 offset:3072
ds_read_b64_tr_b16 a[200:201], v146 offset:4096
ds_read_b64_tr_b16 a[202:203], v146 offset:5120
ds_read_b64_tr_b16 a[204:205], v146 offset:6144
ds_read_b64_tr_b16 a[206:207], v146 offset:7168
ds_read_b64_tr_b16 a[208:209], v146 offset:8192
ds_read_b64_tr_b16 a[210:211], v146 offset:9216
ds_read_b64_tr_b16 a[212:213], v146 offset:10240
ds_read_b64_tr_b16 a[214:215], v146 offset:11264
ds_read_b64_tr_b16 a[216:217], v146 offset:12288
ds_read_b64_tr_b16 a[218:219], v146 offset:13312
ds_read_b64_tr_b16 a[220:221], v146 offset:14336
ds_read_b64_tr_b16 a[222:223], v146 offset:15360
ds_read_b64_tr_b16 a[224:225], v146 offset:8
ds_read_b64_tr_b16 a[226:227], v146 offset:1032
ds_read_b64_tr_b16 a[228:229], v146 offset:2056
ds_read_b64_tr_b16 a[230:231], v146 offset:3080
ds_read_b64_tr_b16 a[232:233], v146 offset:4104
ds_read_b64_tr_b16 a[234:235], v146 offset:5128
ds_read_b64_tr_b16 a[236:237], v146 offset:6152
ds_read_b64_tr_b16 a[238:239], v146 offset:7176
ds_read_b64_tr_b16 a[240:241], v146 offset:8200
ds_read_b64_tr_b16 a[242:243], v146 offset:9224
ds_read_b64_tr_b16 a[244:245], v146 offset:10248
ds_read_b64_tr_b16 a[246:247], v146 offset:11272
ds_read_b64_tr_b16 a[248:249], v146 offset:12296
ds_read_b64_tr_b16 a[250:251], v146 offset:13320
ds_read_b64_tr_b16 a[252:253], v146 offset:14344
ds_read_b64_tr_b16 a[254:255], v146 offset:15368
s_waitcnt lgkmcnt(0)
s_waitcnt vmcnt(32)
ds_write_b128 v144, a[64:67] offset:0
ds_write_b128 v144, a[68:71] offset:1024
ds_write_b128 v144, a[72:75] offset:2048
ds_write_b128 v144, a[76:79] offset:3072
ds_write_b128 v144, a[80:83] offset:4096
ds_write_b128 v144, a[84:87] offset:5120
ds_write_b128 v144, a[88:91] offset:6144
ds_write_b128 v144, a[92:95] offset:7168
ds_write_b128 v144, a[96:99] offset:8192
ds_write_b128 v144, a[100:103] offset:9216
ds_write_b128 v144, a[104:107] offset:10240
ds_write_b128 v144, a[108:111] offset:11264
ds_write_b128 v144, a[112:115] offset:12288
ds_write_b128 v144, a[116:119] offset:13312
ds_write_b128 v144, a[120:123] offset:14336
ds_write_b128 v144, a[124:127] offset:15360
s_waitcnt lgkmcnt(0)
ds_read_b64_tr_b16 a[64:65], v145 offset:0
ds_read_b64_tr_b16 a[66:67], v145 offset:256
ds_read_b64_tr_b16 a[68:69], v145 offset:512
ds_read_b64_tr_b16 a[70:71], v145 offset:768
ds_read_b64_tr_b16 a[72:73], v145 offset:4096
ds_read_b64_tr_b16 a[74:75], v145 offset:4352
ds_read_b64_tr_b16 a[76:77], v145 offset:4608
ds_read_b64_tr_b16 a[78:79], v145 offset:4864
ds_read_b64_tr_b16 a[80:81], v145 offset:8192
ds_read_b64_tr_b16 a[82:83], v145 offset:8448
ds_read_b64_tr_b16 a[84:85], v145 offset:8704
ds_read_b64_tr_b16 a[86:87], v145 offset:8960
ds_read_b64_tr_b16 a[88:89], v145 offset:12288
ds_read_b64_tr_b16 a[90:91], v145 offset:12544
ds_read_b64_tr_b16 a[92:93], v145 offset:12800
ds_read_b64_tr_b16 a[94:95], v145 offset:13056
ds_read_b64_tr_b16 a[96:97], v145 offset:32
ds_read_b64_tr_b16 a[98:99], v145 offset:288
ds_read_b64_tr_b16 a[100:101], v145 offset:544
ds_read_b64_tr_b16 a[102:103], v145 offset:800
ds_read_b64_tr_b16 a[104:105], v145 offset:4128
ds_read_b64_tr_b16 a[106:107], v145 offset:4384
ds_read_b64_tr_b16 a[108:109], v145 offset:4640
ds_read_b64_tr_b16 a[110:111], v145 offset:4896
ds_read_b64_tr_b16 a[112:113], v145 offset:8224
ds_read_b64_tr_b16 a[114:115], v145 offset:8480
ds_read_b64_tr_b16 a[116:117], v145 offset:8736
ds_read_b64_tr_b16 a[118:119], v145 offset:8992
ds_read_b64_tr_b16 a[120:121], v145 offset:12320
ds_read_b64_tr_b16 a[122:123], v145 offset:12576
ds_read_b64_tr_b16 a[124:125], v145 offset:12832
ds_read_b64_tr_b16 a[126:127], v145 offset:13088
s_waitcnt lgkmcnt(0)
s_waitcnt vmcnt(16)
ds_write_b128 v144, a[128:131] offset:0
ds_write_b128 v144, a[132:135] offset:1024
ds_write_b128 v144, a[136:139] offset:2048
ds_write_b128 v144, a[140:143] offset:3072
ds_write_b128 v144, a[144:147] offset:4096
ds_write_b128 v144, a[148:151] offset:5120
ds_write_b128 v144, a[152:155] offset:6144
ds_write_b128 v144, a[156:159] offset:7168
ds_write_b128 v144, a[160:163] offset:8192
ds_write_b128 v144, a[164:167] offset:9216
ds_write_b128 v144, a[168:171] offset:10240
ds_write_b128 v144, a[172:175] offset:11264
ds_write_b128 v144, a[176:179] offset:12288
ds_write_b128 v144, a[180:183] offset:13312
ds_write_b128 v144, a[184:187] offset:14336
ds_write_b128 v144, a[188:191] offset:15360
s_waitcnt lgkmcnt(0)
ds_read_b64_tr_b16 a[128:129], v145 offset:0
ds_read_b64_tr_b16 a[130:131], v145 offset:256
ds_read_b64_tr_b16 a[132:133], v145 offset:512
ds_read_b64_tr_b16 a[134:135], v145 offset:768
ds_read_b64_tr_b16 a[136:137], v145 offset:4096
ds_read_b64_tr_b16 a[138:139], v145 offset:4352
ds_read_b64_tr_b16 a[140:141], v145 offset:4608
ds_read_b64_tr_b16 a[142:143], v145 offset:4864
ds_read_b64_tr_b16 a[144:145], v145 offset:8192
ds_read_b64_tr_b16 a[146:147], v145 offset:8448
ds_read_b64_tr_b16 a[148:149], v145 offset:8704
ds_read_b64_tr_b16 a[150:151], v145 offset:8960
ds_read_b64_tr_b16 a[152:153], v145 offset:12288
ds_read_b64_tr_b16 a[154:155], v145 offset:12544
ds_read_b64_tr_b16 a[156:157], v145 offset:12800
ds_read_b64_tr_b16 a[158:159], v145 offset:13056
ds_read_b64_tr_b16 a[160:161], v145 offset:32
ds_read_b64_tr_b16 a[162:163], v145 offset:288
ds_read_b64_tr_b16 a[164:165], v145 offset:544
ds_read_b64_tr_b16 a[166:167], v145 offset:800
ds_read_b64_tr_b16 a[168:169], v145 offset:4128
ds_read_b64_tr_b16 a[170:171], v145 offset:4384
ds_read_b64_tr_b16 a[172:173], v145 offset:4640
ds_read_b64_tr_b16 a[174:175], v145 offset:4896
ds_read_b64_tr_b16 a[176:177], v145 offset:8224
ds_read_b64_tr_b16 a[178:179], v145 offset:8480
ds_read_b64_tr_b16 a[180:181], v145 offset:8736
ds_read_b64_tr_b16 a[182:183], v145 offset:8992
ds_read_b64_tr_b16 a[184:185], v145 offset:12320
ds_read_b64_tr_b16 a[186:187], v145 offset:12576
ds_read_b64_tr_b16 a[188:189], v145 offset:12832
ds_read_b64_tr_b16 a[190:191], v145 offset:13088
s_waitcnt lgkmcnt(0)
s_waitcnt vmcnt(0)
ds_write_b128 v144, a[0:3] offset:0
ds_write_b128 v144, a[4:7] offset:1024
ds_write_b128 v144, a[8:11] offset:2048
ds_write_b128 v144, a[12:15] offset:3072
ds_write_b128 v144, a[16:19] offset:4096
ds_write_b128 v144, a[20:23] offset:5120
ds_write_b128 v144, a[24:27] offset:6144
ds_write_b128 v144, a[28:31] offset:7168
ds_write_b128 v144, a[32:35] offset:8192
ds_write_b128 v144, a[36:39] offset:9216
ds_write_b128 v144, a[40:43] offset:10240
ds_write_b128 v144, a[44:47] offset:11264
ds_write_b128 v144, a[48:51] offset:12288
ds_write_b128 v144, a[52:55] offset:13312
ds_write_b128 v144, a[56:59] offset:14336
ds_write_b128 v144, a[60:63] offset:15360
s_waitcnt lgkmcnt(0)
ds_read_b64_tr_b16 a[0:1], v145 offset:0
ds_read_b64_tr_b16 a[2:3], v145 offset:256
ds_read_b64_tr_b16 a[4:5], v145 offset:512
ds_read_b64_tr_b16 a[6:7], v145 offset:768
ds_read_b64_tr_b16 a[8:9], v145 offset:4096
ds_read_b64_tr_b16 a[10:11], v145 offset:4352
ds_read_b64_tr_b16 a[12:13], v145 offset:4608
ds_read_b64_tr_b16 a[14:15], v145 offset:4864
ds_read_b64_tr_b16 a[16:17], v145 offset:8192
ds_read_b64_tr_b16 a[18:19], v145 offset:8448
ds_read_b64_tr_b16 a[20:21], v145 offset:8704
ds_read_b64_tr_b16 a[22:23], v145 offset:8960
ds_read_b64_tr_b16 a[24:25], v145 offset:12288
ds_read_b64_tr_b16 a[26:27], v145 offset:12544
ds_read_b64_tr_b16 a[28:29], v145 offset:12800
ds_read_b64_tr_b16 a[30:31], v145 offset:13056
ds_read_b64_tr_b16 a[32:33], v145 offset:32
ds_read_b64_tr_b16 a[34:35], v145 offset:288
ds_read_b64_tr_b16 a[36:37], v145 offset:544
ds_read_b64_tr_b16 a[38:39], v145 offset:800
ds_read_b64_tr_b16 a[40:41], v145 offset:4128
ds_read_b64_tr_b16 a[42:43], v145 offset:4384
ds_read_b64_tr_b16 a[44:45], v145 offset:4640
ds_read_b64_tr_b16 a[46:47], v145 offset:4896
ds_read_b64_tr_b16 a[48:49], v145 offset:8224
ds_read_b64_tr_b16 a[50:51], v145 offset:8480
ds_read_b64_tr_b16 a[52:53], v145 offset:8736
ds_read_b64_tr_b16 a[54:55], v145 offset:8992
ds_read_b64_tr_b16 a[56:57], v145 offset:12320
ds_read_b64_tr_b16 a[58:59], v145 offset:12576
ds_read_b64_tr_b16 a[60:61], v145 offset:12832
ds_read_b64_tr_b16 a[62:63], v145 offset:13088
s_waitcnt lgkmcnt(0)
s_barrier
.if \sf == 0
v_mov_b32 v14, 136
.else
v_mov_b32 v14, 160
.endif
s_nop 1
iw_78_\sf:
buffer_load_dwordx2 v[12:13], v14, s[32:35], 0 offen sc1
s_waitcnt vmcnt(0)
v_cmp_gt_u32 vcc, 256, v12
s_cbranch_vccz iwd_79_\sf
s_sleep 2
s_add_u32 s44, s44, 1
s_cmp_lt_u32 s44, 0x40000
s_cbranch_scc1 iw_78_\sf
iwd_79_\sf:
.if \sf == 0
v_readfirstlane_b32 s45, v13
s_cmp_lg_u32 s45, 0
s_nop 3
s_cbranch_scc1 SAFE_ENTRY
.else
.endif
s_mov_b32 s59, 0
s_mov_b32 s6, 160
s_barrier
s_mov_b32 s43, 0
r_loop_w3_\sf:
s_and_b32 s63, s43, 3
s_add_u32 s64, s43, 2
s_and_b32 s64, s64, 3
s_lshl_b32 s66, s63, 14
s_add_u32 s66, s66, s52
s_lshl_b32 s67, s63, 14
s_add_u32 s67, s67, s56
s_lshl_b32 s68, s63, 14
s_add_u32 s68, s68, s57
s_lshl_b32 s69, s64, 14
s_add_u32 s69, s69, s57
s_lshl_b32 s47, s63, 15
s_add_u32 s47, s47, s55
s_barrier
buffer_load_dwordx4 v[64:67], v2, s[8:11], s66 offen offset:0 sc1
buffer_load_dwordx4 v[68:71], v2, s[8:11], s66 offen offset:1024 sc1
buffer_load_dwordx4 v[72:75], v2, s[8:11], s66 offen offset:2048 sc1
buffer_load_dwordx4 v[76:79], v2, s[8:11], s66 offen offset:3072 sc1
s_waitcnt vmcnt(3)
v_max3_u32 v12, v64, v65, v66
v_max_u32 v12, v12, v67
v_cmp_eq_u32 vcc, -1, v12
s_cbranch_vccnz ppr_80_\sf
ppo_81_\sf:
v_mfma_f32_16x16x32_bf16 v[80:83], a[0:3], v[64:67], 0
v_mfma_f32_16x16x32_bf16 v[84:87], a[4:7], v[64:67], 0
s_waitcnt vmcnt(2)
v_mfma_f32_16x16x32_bf16 v[88:91], a[32:35], v[64:67], 0
v_max3_u32 v12, v68, v69, v70
v_mfma_f32_16x16x32_bf16 v[92:95], a[36:39], v[64:67], 0
v_max_u32 v12, v12, v71
v_mfma_f32_16x16x32_bf16 v[96:99], a[64:67], v[64:67], 0
v_cmp_eq_u32 vcc, -1, v12
v_mfma_f32_16x16x32_bf16 v[100:103], a[68:71], v[64:67], 0
v_mfma_f32_16x16x32_bf16 v[104:107], a[96:99], v[64:67], 0
v_mfma_f32_16x16x32_bf16 v[108:111], a[100:103], v[64:67], 0
s_cbranch_vccnz ppr_82_\sf
ppo_83_\sf:
v_mfma_f32_16x16x32_bf16 v[80:83], a[8:11], v[68:71], v[80:83]
v_mfma_f32_16x16x32_bf16 v[84:87], a[12:15], v[68:71], v[84:87]
s_waitcnt vmcnt(1)
v_mfma_f32_16x16x32_bf16 v[88:91], a[40:43], v[68:71], v[88:91]
v_max3_u32 v12, v72, v73, v74
v_mfma_f32_16x16x32_bf16 v[92:95], a[44:47], v[68:71], v[92:95]
v_max_u32 v12, v12, v75
v_mfma_f32_16x16x32_bf16 v[96:99], a[72:75], v[68:71], v[96:99]
v_cmp_eq_u32 vcc, -1, v12
v_mfma_f32_16x16x32_bf16 v[100:103], a[76:79], v[68:71], v[100:103]
v_mfma_f32_16x16x32_bf16 v[104:107], a[104:107], v[68:71], v[104:107]
v_mfma_f32_16x16x32_bf16 v[108:111], a[108:111], v[68:71], v[108:111]
s_cbranch_vccnz ppr_84_\sf
ppo_85_\sf:
v_mfma_f32_16x16x32_bf16 v[80:83], a[16:19], v[72:75], v[80:83]
v_mfma_f32_16x16x32_bf16 v[84:87], a[20:23], v[72:75], v[84:87]
s_waitcnt vmcnt(0)
v_mfma_f32_16x16x32_bf16 v[88:91], a[48:51], v[72:75], v[88:91]
v_max3_u32 v12, v76, v77, v78
v_mfma_f32_16x16x32_bf16 v[92:95], a[52:55], v[72:75], v[92:95]
v_max_u32 v12, v12, v79
v_mfma_f32_16x16x32_bf16 v[96:99], a[80:83], v[72:75], v[96:99]
v_cmp_eq_u32 vcc, -1, v12
v_mfma_f32_16x16x32_bf16 v[100:103], a[84:87], v[72:75], v[100:103]
s_cbranch_vccnz ppr_86_\sf
ppo_87_\sf:
v_mfma_f32_16x16x32_bf16 v[80:83], a[24:27], v[76:79], v[80:83]
v_mfma_f32_16x16x32_bf16 v[84:87], a[28:31], v[76:79], v[84:87]
v_mfma_f32_16x16x32_bf16 v[88:91], a[56:59], v[76:79], v[88:91]
v_mfma_f32_16x16x32_bf16 v[92:95], a[60:63], v[76:79], v[92:95]
v_mfma_f32_16x16x32_bf16 v[104:107], a[112:115], v[72:75], v[104:107]
v_mfma_f32_16x16x32_bf16 v[108:111], a[116:119], v[72:75], v[108:111]
v_mfma_f32_16x16x32_bf16 v[96:99], a[88:91], v[76:79], v[96:99]
s_nop 2
v_add_f32_dpp v128, v84, v80 row_ror:8 row_mask:0xf bank_mask:0x3
v_add_f32_dpp v129, v85, v81 row_ror:8 row_mask:0xf bank_mask:0x3
v_mfma_f32_16x16x32_bf16 v[100:103], a[92:95], v[76:79], v[100:103]
v_add_f32_dpp v130, v86, v82 row_ror:8 row_mask:0xf bank_mask:0x3
v_add_f32_dpp v131, v87, v83 row_ror:8 row_mask:0xf bank_mask:0x3
v_mfma_f32_16x16x32_bf16 v[104:107], a[120:123], v[76:79], v[104:107]
v_add_f32_dpp v128, v88, v92 row_ror:8 row_mask:0xf bank_mask:0xc
v_add_f32_dpp v129, v89, v93 row_ror:8 row_mask:0xf bank_mask:0xc
v_mfma_f32_16x16x32_bf16 v[108:111], a[124:127], v[76:79], v[108:111]
v_add_f32_dpp v130, v90, v94 row_ror:8 row_mask:0xf bank_mask:0xc
v_add_f32_dpp v131, v91, v95 row_ror:8 row_mask:0xf bank_mask:0xc
ds_write_b128 v2, v[128:131] offset:3072
v_add_f32_dpp v132, v100, v96 row_ror:8 row_mask:0xf bank_mask:0x3
v_add_f32_dpp v133, v101, v97 row_ror:8 row_mask:0xf bank_mask:0x3
v_add_f32_dpp v134, v102, v98 row_ror:8 row_mask:0xf bank_mask:0x3
v_add_f32_dpp v135, v103, v99 row_ror:8 row_mask:0xf bank_mask:0x3
s_nop 0
v_add_f32_dpp v132, v104, v108 row_ror:8 row_mask:0xf bank_mask:0xc
v_add_f32_dpp v133, v105, v109 row_ror:8 row_mask:0xf bank_mask:0xc
v_add_f32_dpp v134, v106, v110 row_ror:8 row_mask:0xf bank_mask:0xc
v_add_f32_dpp v135, v107, v111 row_ror:8 row_mask:0xf bank_mask:0xc
ds_write_b128 v2, v[132:135] offset:7168
s_waitcnt lgkmcnt(0)
s_barrier
v_mfma_f32_16x16x32_bf16 v[112:115], v[64:67], a[128:131], 0
v_mfma_f32_16x16x32_bf16 v[116:119], v[64:67], a[132:135], 0
v_mfma_f32_16x16x32_bf16 v[112:115], v[68:71], a[136:139], v[112:115]
v_mfma_f32_16x16x32_bf16 v[116:119], v[68:71], a[140:143], v[116:119]
v_mfma_f32_16x16x32_bf16 v[112:115], v[72:75], a[144:147], v[112:115]
v_mfma_f32_16x16x32_bf16 v[116:119], v[72:75], a[148:151], v[116:119]
v_mfma_f32_16x16x32_bf16 v[112:115], v[76:79], a[152:155], v[112:115]
v_mfma_f32_16x16x32_bf16 v[116:119], v[76:79], a[156:159], v[116:119]
v_mfma_f32_16x16x32_bf16 v[120:123], v[64:67], a[160:163], 0
v_mfma_f32_16x16x32_bf16 v[124:127], v[64:67], a[164:167], 0
v_mfma_f32_16x16x32_bf16 v[120:123], v[68:71], a[168:171], v[120:123]
v_mfma_f32_16x16x32_bf16 v[124:127], v[68:71], a[172:175], v[124:127]
v_mfma_f32_16x16x32_bf16 v[120:123], v[72:75], a[176:179], v[120:123]
v_mfma_f32_16x16x32_bf16 v[124:127], v[72:75], a[180:183], v[124:127]
v_mfma_f32_16x16x32_bf16 v[120:123], v[76:79], a[184:187], v[120:123]
v_mfma_f32_16x16x32_bf16 v[124:127], v[76:79], a[188:191], v[124:127]
s_nop 6
v_permlane32_swap_b32 v112, v120
v_permlane32_swap_b32 v116, v124
v_permlane32_swap_b32 v113, v121
v_permlane32_swap_b32 v117, v125
v_permlane32_swap_b32 v114, v122
v_permlane32_swap_b32 v118, v126
v_permlane32_swap_b32 v115, v123
v_permlane32_swap_b32 v119, v127
v_add_f32 v136, v112, v124
v_add_f32 v137, v113, v125
v_add_f32 v138, v114, v126
v_add_f32 v139, v115, v127
ds_write_b128 v2, v[136:139] offset:11264
s_sleep 4
s_nop 3
s_nop 3
buffer_load_dwordx4 v[16:19], v4, s[8:11], s47 offen offset:0 sc1
buffer_load_dwordx4 v[20:23], v4, s[8:11], s47 offen offset:2048 sc1
buffer_load_dwordx4 v[24:27], v4, s[8:11], s47 offen offset:512 sc1
buffer_load_dwordx4 v[28:31], v4, s[8:11], s47 offen offset:2560 sc1
buffer_load_dwordx4 v[32:35], v4, s[8:11], s47 offen offset:1024 sc1
buffer_load_dwordx4 v[36:39], v4, s[8:11], s47 offen offset:3072 sc1
buffer_load_dwordx4 v[40:43], v4, s[8:11], s47 offen offset:1536 sc1
buffer_load_dwordx4 v[44:47], v4, s[8:11], s47 offen offset:3584 sc1
s_waitcnt lgkmcnt(0)
s_barrier
ds_read_b128 v[144:147], v2 offset:8192
ds_read_b128 v[148:151], v2 offset:9216
ds_read_b128 v[152:155], v2 offset:10240
s_waitcnt lgkmcnt(2)
v_pk_add_f32 v[136:137], v[136:137], v[144:145]
v_pk_add_f32 v[138:139], v[138:139], v[146:147]
s_waitcnt lgkmcnt(0)
v_pk_add_f32 v[148:149], v[148:149], v[152:153]
v_pk_add_f32 v[150:151], v[150:151], v[154:155]
v_pk_add_f32 v[136:137], v[136:137], v[148:149]
v_pk_add_f32 v[138:139], v[138:139], v[150:151]
v_cvt_pk_bf16_f32 v222, v136, v137
v_cvt_pk_bf16_f32 v223, v138, v139
s_cmp_eq_u32 s43, 63
s_nop 0
s_cbranch_scc1 r_end_w3_\sf
s_cmp_lg_u32 s43, 0
s_cbranch_scc1 kv0_88_\sf
s_mov_b32 s74, s47
s_mov_b32 s47, 1
s_min_u32 s47, s47, 64
s_lshl_b32 s46, s49, 8
s_add_u32 s46, s46, 0x5502000
v_mov_b32 v12, 0
s_nop 1
gp_89_\sf:
s_cmp_ge_u32 s59, s47
s_cbranch_scc1 gpd_90_\sf
buffer_load_dwordx4 v[144:147], v12, s[8:11], s46 offen sc1
s_waitcnt vmcnt(0)
v_min3_u32 v144, v144, v145, v146
v_min_u32 v144, v144, v147
s_nop 0
v_readfirstlane_b32 s59, v144
s_add_u32 s44, s44, 1
s_cmp_lt_u32 s44, 0x40000
s_cbranch_scc1 gp_89_\sf
s_nop 1
gpd_90_\sf:
s_add_u32 s45, s61, 4096
buffer_load_dwordx4 v[160:163], v2, s[8:11], s61 offen offset:0 sc1
buffer_load_dwordx4 v[164:167], v2, s[8:11], s61 offen offset:1024 sc1
buffer_load_dwordx4 v[168:171], v2, s[8:11], s61 offen offset:2048 sc1
buffer_load_dwordx4 v[172:175], v2, s[8:11], s61 offen offset:3072 sc1
buffer_load_dwordx4 v[176:179], v2, s[8:11], s45 offen offset:0 sc1
buffer_load_dwordx4 v[180:183], v2, s[8:11], s45 offen offset:1024 sc1
buffer_load_dwordx4 v[184:187], v2, s[8:11], s45 offen offset:2048 sc1
buffer_load_dwordx4 v[188:191], v2, s[8:11], s45 offen offset:3072 sc1
buffer_load_dwordx4 v[192:195], v2, s[8:11], s62 offen offset:0 sc1
buffer_load_dwordx4 v[196:199], v2, s[8:11], s62 offen offset:1024 sc1
s_mov_b32 s47, s74
s_waitcnt vmcnt(0)
kv0_88_\sf:
s_waitcnt vmcnt(6)
v_max3_u32 v12, v16, v17, v18
v_max3_u32 v13, v19, v20, v21
v_max3_u32 v12, v12, v22, v23
v_max_u32 v12, v12, v13
v_cmp_eq_u32 vcc, -1, v12
s_cbranch_vccnz ppr_91_\sf
ppo_92_\sf:
v_mfma_f32_16x16x32_bf16 v[200:203], v[160:163], v[16:19], 0
s_waitcnt vmcnt(4)
v_max3_u32 v12, v24, v25, v26
v_max3_u32 v13, v27, v28, v29
v_mfma_f32_16x16x32_bf16 v[204:207], v[176:179], v[16:19], 0
v_max3_u32 v12, v12, v30, v31
v_max_u32 v12, v12, v13
v_cmp_eq_u32 vcc, -1, v12
v_mfma_f32_16x16x32_bf16 v[208:211], v[20:23], v[16:19], 0
s_cbranch_vccnz ppr_93_\sf
ppo_94_\sf:
v_mfma_f32_16x16x32_bf16 v[200:203], v[164:167], v[24:27], v[200:203]
s_waitcnt vmcnt(2)
v_max3_u32 v12, v32, v33, v34
v_max3_u32 v13, v35, v36, v37
v_mfma_f32_16x16x32_bf16 v[204:207], v[180:183], v[24:27], v[204:207]
v_max3_u32 v12, v12, v38, v39
v_max_u32 v12, v12, v13
v_cmp_eq_u32 vcc, -1, v12
v_mfma_f32_16x16x32_bf16 v[208:211], v[28:31], v[24:27], v[208:211]
s_cbranch_vccnz ppr_95_\sf
ppo_96_\sf:
v_mfma_f32_16x16x32_bf16 v[200:203], v[168:171], v[32:35], v[200:203]
s_waitcnt vmcnt(0)
v_max3_u32 v12, v40, v41, v42
v_max3_u32 v13, v43, v44, v45
v_mfma_f32_16x16x32_bf16 v[204:207], v[184:187], v[32:35], v[204:207]
v_max3_u32 v12, v12, v46, v47
v_max_u32 v12, v12, v13
v_cmp_eq_u32 vcc, -1, v12
v_mfma_f32_16x16x32_bf16 v[208:211], v[36:39], v[32:35], v[208:211]
s_cbranch_vccnz ppr_97_\sf
ppo_98_\sf:
v_mfma_f32_16x16x32_bf16 v[200:203], v[172:175], v[40:43], v[200:203]
v_mfma_f32_16x16x32_bf16 v[204:207], v[188:191], v[40:43], v[204:207]
v_mfma_f32_16x16x32_bf16 v[208:211], v[44:47], v[40:43], v[208:211]
s_nop 5
v_max3_f32 v12, v200, v201, v202
v_max3_f32 v13, v203, v204, v205
v_max3_f32 v12, v12, v206, v207
v_max3_f32 v13, v13, v208, v209
v_max3_f32 v12, v12, v210, v211
v_max_f32 v12, v12, v13
v_mov_b32 v13, v12
s_nop 1
v_permlane16_swap_b32 v12, v13
v_max_f32 v12, v12, v13
v_mov_b32 v13, v12
s_nop 1
v_permlane32_swap_b32 v12, v13
v_max_f32 v12, v12, v13
v_mul_f32 v12, s65, v12
v_fma_f32 v200, v200, s65, -v12
v_fma_f32 v201, v201, s65, -v12
v_exp_f32 v200, v200
v_fma_f32 v202, v202, s65, -v12
v_exp_f32 v201, v201
v_fma_f32 v203, v203, s65, -v12
v_exp_f32 v202, v202
v_fma_f32 v204, v204, s65, -v12
v_exp_f32 v203, v203
v_fma_f32 v205, v205, s65, -v12
v_exp_f32 v204, v204
v_fma_f32 v206, v206, s65, -v12
v_exp_f32 v205, v205
v_fma_f32 v207, v207, s65, -v12
v_exp_f32 v206, v206
v_fma_f32 v208, v208, s65, -v12
v_exp_f32 v207, v207
v_fma_f32 v209, v209, s65, -v12
v_fma_f32 v210, v210, s65, -v12
v_fma_f32 v211, v211, s65, -v12
v_cvt_pk_bf16_f32 v212, v200, v201
v_cvt_pk_bf16_f32 v213, v202, v203
v_cvt_pk_bf16_f32 v214, v204, v205
v_cvt_pk_bf16_f32 v215, v206, v207
v_exp_f32 v208, v208
v_exp_f32 v209, v209
v_mfma_f32_16x16x32_bf16 v[224:227], v[192:195], v[212:215], 0
v_exp_f32 v210, v210
v_mfma_f32_16x16x32_bf16 v[228:231], v[196:199], v[212:215], 0
v_exp_f32 v211, v211
v_cvt_pk_bf16_f32 v216, v208, v209
v_cvt_pk_bf16_f32 v217, v210, v211
v_and_b32 v218, v216, v156
v_and_b32 v219, v217, v156
v_and_b32 v220, v216, v157
v_and_b32 v221, v217, v157
v_mfma_f32_16x16x16_bf16 v[224:227], v[222:223], v[218:219], v[224:227]
v_pk_add_f32 v[208:209], v[208:209], v[210:211]
v_pk_add_f32 v[200:201], v[200:201], v[202:203]
v_mfma_f32_16x16x16_bf16 v[228:231], v[222:223], v[220:221], v[228:231]
v_pk_add_f32 v[204:205], v[204:205], v[206:207]
v_add_f32 v13, v208, v209
v_pk_add_f32 v[200:201], v[200:201], v[204:205]
v_add_f32 v12, v200, v201
v_fma_f32 v12, v13, v158, v12
v_mov_b32 v13, v12
s_nop 1
v_permlane16_swap_b32 v12, v13
v_add_f32 v12, v12, v13
v_mov_b32 v13, v12
s_nop 1
v_permlane32_swap_b32 v12, v13
v_add_f32 v12, v12, v13
v_rcp_f32 v12, v12
s_nop 0
v_mov_b32 v13, v12
v_pk_mul_f32 v[224:225], v[224:225], v[12:13]
v_pk_mul_f32 v[226:227], v[226:227], v[12:13]
v_pk_mul_f32 v[228:229], v[228:229], v[12:13]
v_pk_mul_f32 v[230:231], v[230:231], v[12:13]
v_cvt_pk_bf16_f32 v224, v224, v225
v_cvt_pk_bf16_f32 v225, v226, v227
v_cvt_pk_bf16_f32 v226, v228, v229
v_cvt_pk_bf16_f32 v227, v230, v231
v_min_u32 v224, -2, v224
v_min_u32 v225, -2, v225
v_min_u32 v226, -2, v226
v_min_u32 v227, -2, v227
.if \sf == 0
buffer_store_dwordx4 v[224:227], v4, s[8:11], s68 offen
.else
buffer_store_dwordx4 v[224:227], v4, s[8:11], s68 offen sc1
.endif
s_barrier
buffer_load_dwordx4 v[64:67], v5, s[8:11], s67 offen offset:0 sc1
buffer_load_dwordx4 v[68:71], v5, s[8:11], s67 offen offset:1024 sc1
buffer_load_dwordx4 v[72:75], v5, s[8:11], s67 offen offset:2048 sc1
buffer_load_dwordx4 v[76:79], v5, s[8:11], s67 offen offset:3072 sc1
s_waitcnt vmcnt(3)
v_max3_u32 v12, v64, v65, v66
v_max_u32 v12, v12, v67
v_cmp_eq_u32 vcc, -1, v12
s_cbranch_vccnz ppr_99_\sf
ppo_100_\sf:
v_mfma_f32_16x16x32_bf16 v[80:83], a[192:195], v[64:67], 0
s_waitcnt vmcnt(2)
v_max3_u32 v12, v68, v69, v70
v_mfma_f32_16x16x32_bf16 v[84:87], a[196:199], v[64:67], 0
v_max_u32 v12, v12, v71
v_cmp_eq_u32 vcc, -1, v12
v_mfma_f32_16x16x32_bf16 v[88:91], a[224:227], v[64:67], 0
v_mfma_f32_16x16x32_bf16 v[92:95], a[228:231], v[64:67], 0
s_cbranch_vccnz ppr_101_\sf
ppo_102_\sf:
v_mfma_f32_16x16x32_bf16 v[80:83], a[200:203], v[68:71], v[80:83]
s_waitcnt vmcnt(1)
v_max3_u32 v12, v72, v73, v74
v_mfma_f32_16x16x32_bf16 v[84:87], a[204:207], v[68:71], v[84:87]
v_max_u32 v12, v12, v75
v_cmp_eq_u32 vcc, -1, v12
v_mfma_f32_16x16x32_bf16 v[88:91], a[232:235], v[68:71], v[88:91]
v_mfma_f32_16x16x32_bf16 v[92:95], a[236:239], v[68:71], v[92:95]
s_cbranch_vccnz ppr_103_\sf
ppo_104_\sf:
v_mfma_f32_16x16x32_bf16 v[80:83], a[208:211], v[72:75], v[80:83]
s_waitcnt vmcnt(0)
v_max3_u32 v12, v76, v77, v78
v_mfma_f32_16x16x32_bf16 v[84:87], a[212:215], v[72:75], v[84:87]
v_max_u32 v12, v12, v79
v_cmp_eq_u32 vcc, -1, v12
v_mfma_f32_16x16x32_bf16 v[88:91], a[240:243], v[72:75], v[88:91]
v_mfma_f32_16x16x32_bf16 v[92:95], a[244:247], v[72:75], v[92:95]
s_cbranch_vccnz ppr_105_\sf
ppo_106_\sf:
v_mfma_f32_16x16x32_bf16 v[80:83], a[216:219], v[76:79], v[80:83]
v_mfma_f32_16x16x32_bf16 v[84:87], a[220:223], v[76:79], v[84:87]
v_mfma_f32_16x16x32_bf16 v[88:91], a[248:251], v[76:79], v[88:91]
v_mfma_f32_16x16x32_bf16 v[92:95], a[252:255], v[76:79], v[92:95]
.if \sf == 0
buffer_store_dwordx2 v[8:9], v6, s[8:11], s69 offen
.else
buffer_store_dwordx2 v[8:9], v6, s[8:11], s69 offen sc1
.endif
s_nop 4
v_add_f32_dpp v140, v84, v80 row_ror:8 row_mask:0xf bank_mask:0x3
v_add_f32_dpp v141, v85, v81 row_ror:8 row_mask:0xf bank_mask:0x3
v_add_f32_dpp v142, v86, v82 row_ror:8 row_mask:0xf bank_mask:0x3
v_add_f32_dpp v143, v87, v83 row_ror:8 row_mask:0xf bank_mask:0x3
v_add_f32_dpp v140, v88, v92 row_ror:8 row_mask:0xf bank_mask:0xc
v_add_f32_dpp v141, v89, v93 row_ror:8 row_mask:0xf bank_mask:0xc
v_add_f32_dpp v142, v90, v94 row_ror:8 row_mask:0xf bank_mask:0xc
v_add_f32_dpp v143, v91, v95 row_ror:8 row_mask:0xf bank_mask:0xc
ds_write_b128 v2, v[140:143] offset:15360
s_waitcnt lgkmcnt(0)
s_barrier
ds_read_b128 v[160:163], v2 offset:16384
ds_read_b128 v[164:167], v2 offset:17408
ds_read_b128 v[168:171], v2 offset:18432
ds_read_b128 v[172:175], v2 offset:19456
ds_read_b128 v[176:179], v2 offset:20480
ds_read_b128 v[180:183], v2 offset:21504
ds_read_b128 v[184:187], v2 offset:22528
ds_read_b128 v[188:191], v2 offset:23552
ds_read_b128 v[192:195], v2 offset:24576
ds_read_b128 v[196:199], v2 offset:25600
s_add_u32 s43, s43, 1
s_branch r_loop_w3_\sf
ppr_80_\sf:
s_nop 7
buffer_load_dwordx4 v[64:67], v2, s[8:11], s66 offen offset:0 sc1
buffer_load_dwordx4 v[68:71], v2, s[8:11], s66 offen offset:1024 sc1
buffer_load_dwordx4 v[72:75], v2, s[8:11], s66 offen offset:2048 sc1
buffer_load_dwordx4 v[76:79], v2, s[8:11], s66 offen offset:3072 sc1
s_add_u32 s44, s44, 1
s_waitcnt vmcnt(3)
v_max3_u32 v12, v64, v65, v66
v_max_u32 v12, v12, v67
v_cmp_eq_u32 vcc, -1, v12
s_cbranch_vccz ppo_81_\sf
s_cmp_lt_u32 s44, 0x40000
s_cbranch_scc1 ppr_80_\sf
s_branch ppo_81_\sf
s_nop 0
ppr_82_\sf:
s_nop 7
buffer_load_dwordx4 v[68:71], v2, s[8:11], s66 offen offset:1024 sc1
buffer_load_dwordx4 v[72:75], v2, s[8:11], s66 offen offset:2048 sc1
buffer_load_dwordx4 v[76:79], v2, s[8:11], s66 offen offset:3072 sc1
s_add_u32 s44, s44, 1
s_waitcnt vmcnt(2)
v_max3_u32 v12, v68, v69, v70
v_max_u32 v12, v12, v71
v_cmp_eq_u32 vcc, -1, v12
s_cbranch_vccz ppo_83_\sf
s_cmp_lt_u32 s44, 0x40000
s_cbranch_scc1 ppr_82_\sf
s_branch ppo_83_\sf
s_nop 0
ppr_84_\sf:
s_nop 7
buffer_load_dwordx4 v[72:75], v2, s[8:11], s66 offen offset:2048 sc1
buffer_load_dwordx4 v[76:79], v2, s[8:11], s66 offen offset:3072 sc1
s_add_u32 s44, s44, 1
s_waitcnt vmcnt(1)
v_max3_u32 v12, v72, v73, v74
v_max_u32 v12, v12, v75
v_cmp_eq_u32 vcc, -1, v12
s_cbranch_vccz ppo_85_\sf
s_cmp_lt_u32 s44, 0x40000
s_cbranch_scc1 ppr_84_\sf
s_branch ppo_85_\sf
s_nop 0
ppr_86_\sf:
s_nop 7
buffer_load_dwordx4 v[76:79], v2, s[8:11], s66 offen offset:3072 sc1
s_add_u32 s44, s44, 1
s_waitcnt vmcnt(0)
v_max3_u32 v12, v76, v77, v78
v_max_u32 v12, v12, v79
v_cmp_eq_u32 vcc, -1, v12
s_cbranch_vccz ppo_87_\sf
s_cmp_lt_u32 s44, 0x40000
s_cbranch_scc1 ppr_86_\sf
s_branch ppo_87_\sf
s_nop 0
ppr_91_\sf:
s_nop 7
buffer_load_dwordx4 v[16:19], v4, s[8:11], s47 offen offset:0 sc1
buffer_load_dwordx4 v[20:23], v4, s[8:11], s47 offen offset:2048 sc1
buffer_load_dwordx4 v[24:27], v4, s[8:11], s47 offen offset:512 sc1
buffer_load_dwordx4 v[28:31], v4, s[8:11], s47 offen offset:2560 sc1
buffer_load_dwordx4 v[32:35], v4, s[8:11], s47 offen offset:1024 sc1
buffer_load_dwordx4 v[36:39], v4, s[8:11], s47 offen offset:3072 sc1
buffer_load_dwordx4 v[40:43], v4, s[8:11], s47 offen offset:1536 sc1
buffer_load_dwordx4 v[44:47], v4, s[8:11], s47 offen offset:3584 sc1
s_add_u32 s44, s44, 1
s_waitcnt vmcnt(6)
v_max3_u32 v12, v16, v17, v18
v_max3_u32 v13, v19, v20, v21
v_max3_u32 v12, v12, v22, v23
v_max_u32 v12, v12, v13
v_cmp_eq_u32 vcc, -1, v12
s_cbranch_vccz ppo_92_\sf
s_cmp_lt_u32 s44, 0x40000
s_cbranch_scc1 ppr_91_\sf
s_branch ppo_92_\sf
s_nop 0
ppr_93_\sf:
s_nop 7
buffer_load_dwordx4 v[24:27], v4, s[8:11], s47 offen offset:512 sc1
buffer_load_dwordx4 v[28:31], v4, s[8:11], s47 offen offset:2560 sc1
buffer_load_dwordx4 v[32:35], v4, s[8:11], s47 offen offset:1024 sc1
buffer_load_dwordx4 v[36:39], v4, s[8:11], s47 offen offset:3072 sc1
buffer_load_dwordx4 v[40:43], v4, s[8:11], s47 offen offset:1536 sc1
buffer_load_dwordx4 v[44:47], v4, s[8:11], s47 offen offset:3584 sc1
s_add_u32 s44, s44, 1
s_waitcnt vmcnt(4)
v_max3_u32 v12, v24, v25, v26
v_max3_u32 v13, v27, v28, v29
v_max3_u32 v12, v12, v30, v31
v_max_u32 v12, v12, v13
v_cmp_eq_u32 vcc, -1, v12
s_cbranch_vccz ppo_94_\sf
s_cmp_lt_u32 s44, 0x40000
s_cbranch_scc1 ppr_93_\sf
s_branch ppo_94_\sf
s_nop 0
ppr_95_\sf:
s_nop 7
buffer_load_dwordx4 v[32:35], v4, s[8:11], s47 offen offset:1024 sc1
buffer_load_dwordx4 v[36:39], v4, s[8:11], s47 offen offset:3072 sc1
buffer_load_dwordx4 v[40:43], v4, s[8:11], s47 offen offset:1536 sc1
buffer_load_dwordx4 v[44:47], v4, s[8:11], s47 offen offset:3584 sc1
s_add_u32 s44, s44, 1
s_waitcnt vmcnt(2)
v_max3_u32 v12, v32, v33, v34
v_max3_u32 v13, v35, v36, v37
v_max3_u32 v12, v12, v38, v39
v_max_u32 v12, v12, v13
v_cmp_eq_u32 vcc, -1, v12
s_cbranch_vccz ppo_96_\sf
s_cmp_lt_u32 s44, 0x40000
s_cbranch_scc1 ppr_95_\sf
s_branch ppo_96_\sf
s_nop 0
ppr_97_\sf:
s_nop 7
buffer_load_dwordx4 v[40:43], v4, s[8:11], s47 offen offset:1536 sc1
buffer_load_dwordx4 v[44:47], v4, s[8:11], s47 offen offset:3584 sc1
s_add_u32 s44, s44, 1
s_waitcnt vmcnt(0)
v_max3_u32 v12, v40, v41, v42
v_max3_u32 v13, v43, v44, v45
v_max3_u32 v12, v12, v46, v47
v_max_u32 v12, v12, v13
v_cmp_eq_u32 vcc, -1, v12
s_cbranch_vccz ppo_98_\sf
s_cmp_lt_u32 s44, 0x40000
s_cbranch_scc1 ppr_97_\sf
s_branch ppo_98_\sf
s_nop 0
ppr_99_\sf:
s_nop 7
buffer_load_dwordx4 v[64:67], v5, s[8:11], s67 offen offset:0 sc1
buffer_load_dwordx4 v[68:71], v5, s[8:11], s67 offen offset:1024 sc1
buffer_load_dwordx4 v[72:75], v5, s[8:11], s67 offen offset:2048 sc1
buffer_load_dwordx4 v[76:79], v5, s[8:11], s67 offen offset:3072 sc1
s_add_u32 s44, s44, 1
s_waitcnt vmcnt(3)
v_max3_u32 v12, v64, v65, v66
v_max_u32 v12, v12, v67
v_cmp_eq_u32 vcc, -1, v12
s_cbranch_vccz ppo_100_\sf
s_cmp_lt_u32 s44, 0x40000
s_cbranch_scc1 ppr_99_\sf
s_branch ppo_100_\sf
s_nop 0
ppr_101_\sf:
s_nop 7
buffer_load_dwordx4 v[68:71], v5, s[8:11], s67 offen offset:1024 sc1
buffer_load_dwordx4 v[72:75], v5, s[8:11], s67 offen offset:2048 sc1
buffer_load_dwordx4 v[76:79], v5, s[8:11], s67 offen offset:3072 sc1
s_add_u32 s44, s44, 1
s_waitcnt vmcnt(2)
v_max3_u32 v12, v68, v69, v70
v_max_u32 v12, v12, v71
v_cmp_eq_u32 vcc, -1, v12
s_cbranch_vccz ppo_102_\sf
s_cmp_lt_u32 s44, 0x40000
s_cbranch_scc1 ppr_101_\sf
s_branch ppo_102_\sf
s_nop 0
ppr_103_\sf:
s_nop 7
buffer_load_dwordx4 v[72:75], v5, s[8:11], s67 offen offset:2048 sc1
buffer_load_dwordx4 v[76:79], v5, s[8:11], s67 offen offset:3072 sc1
s_add_u32 s44, s44, 1
s_waitcnt vmcnt(1)
v_max3_u32 v12, v72, v73, v74
v_max_u32 v12, v12, v75
v_cmp_eq_u32 vcc, -1, v12
s_cbranch_vccz ppo_104_\sf
s_cmp_lt_u32 s44, 0x40000
s_cbranch_scc1 ppr_103_\sf
s_branch ppo_104_\sf
s_nop 0
ppr_105_\sf:
s_nop 7
buffer_load_dwordx4 v[76:79], v5, s[8:11], s67 offen offset:3072 sc1
s_add_u32 s44, s44, 1
s_waitcnt vmcnt(0)
v_max3_u32 v12, v76, v77, v78
v_max_u32 v12, v12, v79
v_cmp_eq_u32 vcc, -1, v12
s_cbranch_vccz ppo_106_\sf
s_cmp_lt_u32 s44, 0x40000
s_cbranch_scc1 ppr_105_\sf
s_branch ppo_106_\sf
s_nop 0
r_end_w3_\sf:
s_waitcnt vmcnt(0)
s_barrier
s_endpgm
f_grole_\sf:
s_sub_u32 s92, s40, 4
s_mov_b32 s93, s41
s_mov_b32 s94, s42
s_lshl_b32 s95, s92, 5
s_add_u32 s95, s95, s93
s_cmp_lg_u32 s94, 0
s_cbranch_scc1 gi_107_\sf
s_lshl_b32 s45, s95, 2
s_add_u32 s47, s45, 0x5504000
s_lshr_b32 s46, s95, 2
s_lshl_b32 s46, s46, 8
s_and_b32 s48, s95, 3
s_lshl_b32 s48, s48, 2
s_add_u32 s46, s46, s48
s_add_u32 s46, s46, 0x5502000
v_mov_b32 v12, 0
s_mov_b64 exec, 1
buffer_store_dword v12, v12, s[8:11], s46 offen sc1
buffer_store_dword v12, v12, s[8:11], s47 offen sc1
s_and_b32 s45, s93, 7
s_lshl_b32 s46, s92, 3
s_add_u32 s45, s45, s46
s_lshl_b32 s45, s45, 7
s_lshr_b32 s46, s93, 3
s_lshl_b32 s46, s46, 2
s_add_u32 s45, s45, s46
s_add_u32 s45, s45, 0x5505000
buffer_store_dword v12, v12, s[8:11], s45 offen sc1
s_mov_b64 exec, -1
s_waitcnt vmcnt(0)
v_mov_b32 v12, 1
.if \sf == 0
v_mov_b32 v13, 136
.else
v_mov_b32 v13, 160
.endif
s_mov_b64 exec, 1
buffer_atomic_add v12, v13, s[32:35], 0 offen sc1
s_mov_b64 exec, -1
gi_107_\sf:
s_lshl_b32 s91, s92, 2
.if \sf == 0
s_add_u32 s91, s91, 64
.else
s_add_u32 s91, s91, 96
.endif
s_load_dwordx2 s[24:25], s[0:1], 0
s_load_dwordx2 s[28:29], s[0:1], 96
s_load_dwordx2 s[36:37], s[0:1], 64
s_waitcnt lgkmcnt(0)
s_and_b32 s25, s25, 0xffff
s_mov_b32 s26, 0x400000
s_mov_b32 s27, 0x20000
s_and_b32 s29, s29, 0xffff
s_mov_b32 s30, 0x800
s_mov_b32 s31, 0x20000
s_and_b32 s37, s37, 0xffff
s_mov_b32 s38, 0x800
s_mov_b32 s39, 0x20000
s_lshr_b32 s49, s95, 2
s_and_b32 s50, s95, 3
s_mov_b32 s42, s94
s_lshr_b32 s58, s95, 2
s_lshl_b32 s58, s58, 8
s_and_b32 s48, s95, 3
s_lshl_b32 s48, s48, 2
s_add_u32 s58, s58, s48
s_add_u32 s58, s58, 0x5502000
v_and_b32 v12, 15, v1
v_lshrrev_b32 v13, 4, v1
v_lshlrev_b32 v13, 5, v13
v_lshl_add_u32 v3, v12, 11, v13
v_add_u32 v4, 49152, v2
v_add_u32 v5, 4096, v2
v_lshrrev_b32 v12, 2, v1
v_and_b32 v13, 3, v1
v_lshlrev_b32 v13, 4, v13
v_lshl_add_u32 v239, v12, 13, v13
s_lshl_b32 s45, s93, 15
s_lshl_b32 s46, s42, 9
s_add_u32 s61, s45, s46
s_lshl_b32 s46, s42, 13
s_add_u32 s62, s45, s46
s_lshl_b32 s46, s92, 22
s_add_u32 s62, s62, s46
.if \sf == 0
s_add_u32 s62, s62, 0x6000000
.else
s_add_u32 s62, s62, 0xe000000
.endif
buffer_load_dwordx4 a[192:195], v3, s[24:27], s61 offen offset:0
buffer_load_dwordx4 a[196:199], v3, s[24:27], s61 offen offset:16
buffer_load_dwordx4 a[200:203], v3, s[24:27], s61 offen offset:128
buffer_load_dwordx4 a[204:207], v3, s[24:27], s61 offen offset:144
buffer_load_dwordx4 a[208:211], v3, s[24:27], s61 offen offset:256
buffer_load_dwordx4 a[212:215], v3, s[24:27], s61 offen offset:272
buffer_load_dwordx4 a[216:219], v3, s[24:27], s61 offen offset:384
buffer_load_dwordx4 a[220:223], v3, s[24:27], s61 offen offset:400
s_add_u32 s61, s61, 0x100000
s_lshl_b32 s63, s42, 21
s_lshl_b32 s46, s49, 8
s_add_u32 s63, s63, s46
s_lshl_b32 s46, s50, 6
s_add_u32 s63, s63, s46
s_lshl_b32 s54, s42, 9
s_mov_b32 s45, s63
buffer_load_dwordx4 a[64:67], v239, s[16:19], s45 offen
s_add_u32 s45, s45, 0x20000
buffer_load_dwordx4 a[68:71], v239, s[16:19], s45 offen
s_add_u32 s45, s45, 0x20000
buffer_load_dwordx4 a[72:75], v239, s[16:19], s45 offen
s_add_u32 s45, s45, 0x20000
buffer_load_dwordx4 a[76:79], v239, s[16:19], s45 offen
s_add_u32 s45, s45, 0x20000
buffer_load_dwordx4 a[80:83], v239, s[16:19], s45 offen
s_add_u32 s45, s45, 0x20000
buffer_load_dwordx4 a[84:87], v239, s[16:19], s45 offen
s_add_u32 s45, s45, 0x20000
buffer_load_dwordx4 a[88:91], v239, s[16:19], s45 offen
s_add_u32 s45, s45, 0x20000
buffer_load_dwordx4 a[92:95], v239, s[16:19], s45 offen
s_add_u32 s45, s45, 0x20000
s_waitcnt vmcnt(8)
.if \sf == 0
buffer_store_dwordx4 a[192:195], v2, s[8:11], s62 offen offset:0
buffer_store_dwordx4 a[196:199], v2, s[8:11], s62 offen offset:1024
buffer_store_dwordx4 a[200:203], v2, s[8:11], s62 offen offset:2048
buffer_store_dwordx4 a[204:207], v2, s[8:11], s62 offen offset:3072
buffer_store_dwordx4 a[208:211], v5, s[8:11], s62 offen offset:0
buffer_store_dwordx4 a[212:215], v5, s[8:11], s62 offen offset:1024
buffer_store_dwordx4 a[216:219], v5, s[8:11], s62 offen offset:2048
buffer_store_dwordx4 a[220:223], v5, s[8:11], s62 offen offset:3072
.else
buffer_store_dwordx4 a[192:195], v2, s[8:11], s62 offen offset:0 sc1
buffer_store_dwordx4 a[196:199], v2, s[8:11], s62 offen offset:1024 sc1
buffer_store_dwordx4 a[200:203], v2, s[8:11], s62 offen offset:2048 sc1
buffer_store_dwordx4 a[204:207], v2, s[8:11], s62 offen offset:3072 sc1
buffer_store_dwordx4 a[208:211], v5, s[8:11], s62 offen offset:0 sc1
buffer_store_dwordx4 a[212:215], v5, s[8:11], s62 offen offset:1024 sc1
buffer_store_dwordx4 a[216:219], v5, s[8:11], s62 offen offset:2048 sc1
buffer_store_dwordx4 a[220:223], v5, s[8:11], s62 offen offset:3072 sc1
.endif
s_add_u32 s62, s62, 0x100000
buffer_load_dwordx4 a[96:99], v239, s[16:19], s45 offen
s_add_u32 s45, s45, 0x20000
buffer_load_dwordx4 a[100:103], v239, s[16:19], s45 offen
s_add_u32 s45, s45, 0x20000
buffer_load_dwordx4 a[104:107], v239, s[16:19], s45 offen
s_add_u32 s45, s45, 0x20000
buffer_load_dwordx4 a[108:111], v239, s[16:19], s45 offen
s_add_u32 s45, s45, 0x20000
buffer_load_dwordx4 a[112:115], v239, s[16:19], s45 offen
s_add_u32 s45, s45, 0x20000
buffer_load_dwordx4 a[116:119], v239, s[16:19], s45 offen
s_add_u32 s45, s45, 0x20000
buffer_load_dwordx4 a[120:123], v239, s[16:19], s45 offen
s_add_u32 s45, s45, 0x20000
buffer_load_dwordx4 a[124:127], v239, s[16:19], s45 offen
s_mov_b32 s45, s63
buffer_load_dwordx4 a[128:131], v239, s[20:23], s45 offen
s_add_u32 s45, s45, 0x20000
buffer_load_dwordx4 a[132:135], v239, s[20:23], s45 offen
s_add_u32 s45, s45, 0x20000
buffer_load_dwordx4 a[136:139], v239, s[20:23], s45 offen
s_add_u32 s45, s45, 0x20000
buffer_load_dwordx4 a[140:143], v239, s[20:23], s45 offen
s_add_u32 s45, s45, 0x20000
buffer_load_dwordx4 a[144:147], v239, s[20:23], s45 offen
s_add_u32 s45, s45, 0x20000
buffer_load_dwordx4 a[148:151], v239, s[20:23], s45 offen
s_add_u32 s45, s45, 0x20000
buffer_load_dwordx4 a[152:155], v239, s[20:23], s45 offen
s_add_u32 s45, s45, 0x20000
buffer_load_dwordx4 a[156:159], v239, s[20:23], s45 offen
s_add_u32 s45, s45, 0x20000
buffer_load_dwordx4 a[160:163], v239, s[20:23], s45 offen
s_add_u32 s45, s45, 0x20000
buffer_load_dwordx4 a[164:167], v239, s[20:23], s45 offen
s_add_u32 s45, s45, 0x20000
buffer_load_dwordx4 a[168:171], v239, s[20:23], s45 offen
s_add_u32 s45, s45, 0x20000
buffer_load_dwordx4 a[172:175], v239, s[20:23], s45 offen
s_add_u32 s45, s45, 0x20000
buffer_load_dwordx4 a[176:179], v239, s[20:23], s45 offen
s_add_u32 s45, s45, 0x20000
buffer_load_dwordx4 a[180:183], v239, s[20:23], s45 offen
s_add_u32 s45, s45, 0x20000
buffer_load_dwordx4 a[184:187], v239, s[20:23], s45 offen
s_add_u32 s45, s45, 0x20000
buffer_load_dwordx4 a[188:191], v239, s[20:23], s45 offen
s_add_u32 s45, s54, 0x8000
buffer_load_dwordx4 v[16:19], v3, s[24:27], s54 offen offset:0
buffer_load_dwordx4 v[20:23], v3, s[24:27], s54 offen offset:16
buffer_load_dwordx4 v[24:27], v3, s[24:27], s54 offen offset:128
buffer_load_dwordx4 v[28:31], v3, s[24:27], s54 offen offset:144
buffer_load_dwordx4 v[32:35], v3, s[24:27], s54 offen offset:256
buffer_load_dwordx4 v[36:39], v3, s[24:27], s54 offen offset:272
buffer_load_dwordx4 v[40:43], v3, s[24:27], s54 offen offset:384
buffer_load_dwordx4 v[44:47], v3, s[24:27], s54 offen offset:400
buffer_load_dwordx4 v[48:51], v3, s[24:27], s45 offen offset:0
buffer_load_dwordx4 v[52:55], v3, s[24:27], s45 offen offset:16
buffer_load_dwordx4 v[56:59], v3, s[24:27], s45 offen offset:128
buffer_load_dwordx4 v[60:63], v3, s[24:27], s45 offen offset:144
buffer_load_dwordx4 v[64:67], v3, s[24:27], s45 offen offset:256
buffer_load_dwordx4 v[68:71], v3, s[24:27], s45 offen offset:272
buffer_load_dwordx4 v[72:75], v3, s[24:27], s45 offen offset:384
buffer_load_dwordx4 v[76:79], v3, s[24:27], s45 offen offset:400
s_add_u32 s54, s54, 0x10000
s_add_u32 s45, s54, 0x8000
buffer_load_dwordx4 v[80:83], v3, s[24:27], s54 offen offset:0
buffer_load_dwordx4 v[84:87], v3, s[24:27], s54 offen offset:16
buffer_load_dwordx4 v[88:91], v3, s[24:27], s54 offen offset:128
buffer_load_dwordx4 v[92:95], v3, s[24:27], s54 offen offset:144
buffer_load_dwordx4 v[96:99], v3, s[24:27], s54 offen offset:256
buffer_load_dwordx4 v[100:103], v3, s[24:27], s54 offen offset:272
buffer_load_dwordx4 v[104:107], v3, s[24:27], s54 offen offset:384
buffer_load_dwordx4 v[108:111], v3, s[24:27], s54 offen offset:400
buffer_load_dwordx4 v[112:115], v3, s[24:27], s45 offen offset:0
buffer_load_dwordx4 v[116:119], v3, s[24:27], s45 offen offset:16
buffer_load_dwordx4 v[120:123], v3, s[24:27], s45 offen offset:128
buffer_load_dwordx4 v[124:127], v3, s[24:27], s45 offen offset:144
buffer_load_dwordx4 v[128:131], v3, s[24:27], s45 offen offset:256
buffer_load_dwordx4 v[132:135], v3, s[24:27], s45 offen offset:272
buffer_load_dwordx4 v[136:139], v3, s[24:27], s45 offen offset:384
buffer_load_dwordx4 v[140:143], v3, s[24:27], s45 offen offset:400
s_add_u32 s54, s54, 0x10000
s_cmp_lt_u32 s42, 2
s_cselect_b32 s45, 4, 1
s_mul_i32 s45, s45, s42
s_cselect_b32 s46, 1, 4
s_add_u32 s46, s46, s45
s_lshl_b32 s45, s45, 10
s_lshl_b32 s46, s46, 10
s_add_u32 s45, s45, 65536
s_add_u32 s46, s46, 65536
v_add_u32 v240, s45, v2
v_add_u32 v241, s46, v2
s_lshl_b32 s45, s42, 13
s_add_u32 s45, s45, 65536
v_add_u32 v242, s45, v2
s_lshl_b32 s45, s49, 13
s_lshl_b32 s46, s50, 10
s_add_u32 s45, s45, s46
s_lshl_b32 s47, s42, 12
s_add_u32 s47, s47, s45
s_add_u32 s47, s47, 0x1000000
s_add_u32 s45, s45, s46
s_lshl_b32 s46, s42, 10
s_add_u32 s45, s45, s46
s_add_u32 s45, s45, 0x1fff800
s_cmp_lt_u32 s42, 2
s_cselect_b32 s64, s47, s45
s_lshl_b32 s45, s42, 14
v_add_u32 v236, s45, v2
v_lshrrev_b32 v12, 4, v1
v_bfe_u32 v13, v1, 2, 2
v_and_b32 v14, 3, v1
v_lshl_add_u32 v15, v12, 4, v13
v_lshlrev_b32 v15, 6, v15
v_lshl_add_u32 v15, v14, 3, v15
v_add_u32 v237, s45, v15
v_lshl_add_u32 v15, v12, 2, v13
v_lshlrev_b32 v15, 6, v15
v_lshl_add_u32 v15, v14, 4, v15
v_add_u32 v238, s45, v15
s_waitcnt vmcnt(48)
s_barrier
s_cmp_lg_u32 s42, 1
s_cbranch_scc1 fspa_108_\sf
v_mov_b32 v8, 1
v_mov_b32 v9, s91
s_mov_b64 exec, 1
buffer_atomic_add v8, v9, s[32:35], 0 offen sc1
s_mov_b64 exec, -1
fspa_108_\sf:
ds_write_b128 v236, a[64:67] offset:0
ds_write_b128 v236, a[68:71] offset:1024
ds_write_b128 v236, a[72:75] offset:2048
ds_write_b128 v236, a[76:79] offset:3072
ds_write_b128 v236, a[80:83] offset:4096
ds_write_b128 v236, a[84:87] offset:5120
ds_write_b128 v236, a[88:91] offset:6144
ds_write_b128 v236, a[92:95] offset:7168
ds_write_b128 v236, a[96:99] offset:8192
ds_write_b128 v236, a[100:103] offset:9216
ds_write_b128 v236, a[104:107] offset:10240
ds_write_b128 v236, a[108:111] offset:11264
ds_write_b128 v236, a[112:115] offset:12288
ds_write_b128 v236, a[116:119] offset:13312
ds_write_b128 v236, a[120:123] offset:14336
ds_write_b128 v236, a[124:127] offset:15360
s_waitcnt lgkmcnt(0)
ds_read_b64_tr_b16 a[64:65], v237 offset:0
ds_read_b64_tr_b16 a[66:67], v237 offset:256
ds_read_b64_tr_b16 a[68:69], v237 offset:512
ds_read_b64_tr_b16 a[70:71], v237 offset:768
ds_read_b64_tr_b16 a[72:73], v237 offset:4096
ds_read_b64_tr_b16 a[74:75], v237 offset:4352
ds_read_b64_tr_b16 a[76:77], v237 offset:4608
ds_read_b64_tr_b16 a[78:79], v237 offset:4864
ds_read_b64_tr_b16 a[80:81], v237 offset:8192
ds_read_b64_tr_b16 a[82:83], v237 offset:8448
ds_read_b64_tr_b16 a[84:85], v237 offset:8704
ds_read_b64_tr_b16 a[86:87], v237 offset:8960
ds_read_b64_tr_b16 a[88:89], v237 offset:12288
ds_read_b64_tr_b16 a[90:91], v237 offset:12544
ds_read_b64_tr_b16 a[92:93], v237 offset:12800
ds_read_b64_tr_b16 a[94:95], v237 offset:13056
ds_read_b64_tr_b16 a[96:97], v237 offset:32
ds_read_b64_tr_b16 a[98:99], v237 offset:288
ds_read_b64_tr_b16 a[100:101], v237 offset:544
ds_read_b64_tr_b16 a[102:103], v237 offset:800
ds_read_b64_tr_b16 a[104:105], v237 offset:4128
ds_read_b64_tr_b16 a[106:107], v237 offset:4384
ds_read_b64_tr_b16 a[108:109], v237 offset:4640
ds_read_b64_tr_b16 a[110:111], v237 offset:4896
ds_read_b64_tr_b16 a[112:113], v237 offset:8224
ds_read_b64_tr_b16 a[114:115], v237 offset:8480
ds_read_b64_tr_b16 a[116:117], v237 offset:8736
ds_read_b64_tr_b16 a[118:119], v237 offset:8992
ds_read_b64_tr_b16 a[120:121], v237 offset:12320
ds_read_b64_tr_b16 a[122:123], v237 offset:12576
ds_read_b64_tr_b16 a[124:125], v237 offset:12832
ds_read_b64_tr_b16 a[126:127], v237 offset:13088
s_waitcnt lgkmcnt(0)
s_waitcnt vmcnt(32)
ds_write_b128 v236, a[128:131] offset:0
ds_write_b128 v236, a[132:135] offset:1024
ds_write_b128 v236, a[136:139] offset:2048
ds_write_b128 v236, a[140:143] offset:3072
ds_write_b128 v236, a[144:147] offset:4096
ds_write_b128 v236, a[148:151] offset:5120
ds_write_b128 v236, a[152:155] offset:6144
ds_write_b128 v236, a[156:159] offset:7168
ds_write_b128 v236, a[160:163] offset:8192
ds_write_b128 v236, a[164:167] offset:9216
ds_write_b128 v236, a[168:171] offset:10240
ds_write_b128 v236, a[172:175] offset:11264
ds_write_b128 v236, a[176:179] offset:12288
ds_write_b128 v236, a[180:183] offset:13312
ds_write_b128 v236, a[184:187] offset:14336
ds_write_b128 v236, a[188:191] offset:15360
s_waitcnt lgkmcnt(0)
ds_read_b64_tr_b16 a[128:129], v237 offset:0
ds_read_b64_tr_b16 a[130:131], v237 offset:256
ds_read_b64_tr_b16 a[132:133], v237 offset:512
ds_read_b64_tr_b16 a[134:135], v237 offset:768
ds_read_b64_tr_b16 a[136:137], v237 offset:4096
ds_read_b64_tr_b16 a[138:139], v237 offset:4352
ds_read_b64_tr_b16 a[140:141], v237 offset:4608
ds_read_b64_tr_b16 a[142:143], v237 offset:4864
ds_read_b64_tr_b16 a[144:145], v237 offset:8192
ds_read_b64_tr_b16 a[146:147], v237 offset:8448
ds_read_b64_tr_b16 a[148:149], v237 offset:8704
ds_read_b64_tr_b16 a[150:151], v237 offset:8960
ds_read_b64_tr_b16 a[152:153], v237 offset:12288
ds_read_b64_tr_b16 a[154:155], v237 offset:12544
ds_read_b64_tr_b16 a[156:157], v237 offset:12800
ds_read_b64_tr_b16 a[158:159], v237 offset:13056
ds_read_b64_tr_b16 a[160:161], v237 offset:32
ds_read_b64_tr_b16 a[162:163], v237 offset:288
ds_read_b64_tr_b16 a[164:165], v237 offset:544
ds_read_b64_tr_b16 a[166:167], v237 offset:800
ds_read_b64_tr_b16 a[168:169], v237 offset:4128
ds_read_b64_tr_b16 a[170:171], v237 offset:4384
ds_read_b64_tr_b16 a[172:173], v237 offset:4640
ds_read_b64_tr_b16 a[174:175], v237 offset:4896
ds_read_b64_tr_b16 a[176:177], v237 offset:8224
ds_read_b64_tr_b16 a[178:179], v237 offset:8480
ds_read_b64_tr_b16 a[180:181], v237 offset:8736
ds_read_b64_tr_b16 a[182:183], v237 offset:8992
ds_read_b64_tr_b16 a[184:185], v237 offset:12320
ds_read_b64_tr_b16 a[186:187], v237 offset:12576
ds_read_b64_tr_b16 a[188:189], v237 offset:12832
ds_read_b64_tr_b16 a[190:191], v237 offset:13088
s_waitcnt lgkmcnt(0)
.if \sf == 0
v_mov_b32 v10, 136
.else
v_mov_b32 v10, 160
.endif
s_nop 1
iw_109_\sf:
buffer_load_dwordx2 v[8:9], v10, s[32:35], 0 offen sc1
s_waitcnt vmcnt(0)
v_cmp_gt_u32 vcc, 256, v8
s_cbranch_vccz iwd_110_\sf
s_sleep 2
s_add_u32 s44, s44, 1
s_cmp_lt_u32 s44, 0x40000
s_cbranch_scc1 iw_109_\sf
iwd_110_\sf:
.if \sf == 0
v_readfirstlane_b32 s45, v9
s_cmp_lg_u32 s45, 0
s_nop 3
s_cbranch_scc1 SAFE_ENTRY
.else
.endif
s_mov_b32 s59, 0
v_mfma_f32_16x16x32_bf16 v[152:155], a[64:67], v[16:19], 0
v_mfma_f32_16x16x32_bf16 v[152:155], a[68:71], v[20:23], v[152:155]
v_mfma_f32_16x16x32_bf16 v[152:155], a[72:75], v[24:27], v[152:155]
v_mfma_f32_16x16x32_bf16 v[152:155], a[76:79], v[28:31], v[152:155]
v_mfma_f32_16x16x32_bf16 v[152:155], a[80:83], v[32:35], v[152:155]
v_mfma_f32_16x16x32_bf16 v[152:155], a[84:87], v[36:39], v[152:155]
v_mfma_f32_16x16x32_bf16 v[152:155], a[88:91], v[40:43], v[152:155]
v_mfma_f32_16x16x32_bf16 v[152:155], a[92:95], v[44:47], v[152:155]
v_mfma_f32_16x16x32_bf16 v[156:159], a[96:99], v[16:19], 0
v_mfma_f32_16x16x32_bf16 v[156:159], a[100:103], v[20:23], v[156:159]
v_mfma_f32_16x16x32_bf16 v[156:159], a[104:107], v[24:27], v[156:159]
v_mfma_f32_16x16x32_bf16 v[156:159], a[108:111], v[28:31], v[156:159]
v_mfma_f32_16x16x32_bf16 v[156:159], a[112:115], v[32:35], v[156:159]
v_mfma_f32_16x16x32_bf16 v[156:159], a[116:119], v[36:39], v[156:159]
v_mfma_f32_16x16x32_bf16 v[156:159], a[120:123], v[40:43], v[156:159]
s_nop 0
ds_write_b128 v242, v[152:155] offset:0
v_mfma_f32_16x16x32_bf16 v[156:159], a[124:127], v[44:47], v[156:159]
v_mfma_f32_16x16x32_bf16 v[160:163], v[16:19], a[128:131], 0
v_mfma_f32_16x16x32_bf16 v[160:163], v[20:23], a[132:135], v[160:163]
v_mfma_f32_16x16x32_bf16 v[160:163], v[24:27], a[136:139], v[160:163]
v_mfma_f32_16x16x32_bf16 v[160:163], v[28:31], a[140:143], v[160:163]
v_mfma_f32_16x16x32_bf16 v[160:163], v[32:35], a[144:147], v[160:163]
v_mfma_f32_16x16x32_bf16 v[160:163], v[36:39], a[148:151], v[160:163]
v_mfma_f32_16x16x32_bf16 v[160:163], v[40:43], a[152:155], v[160:163]
s_nop 0
ds_write_b128 v242, v[156:159] offset:1024
v_mfma_f32_16x16x32_bf16 v[160:163], v[44:47], a[156:159], v[160:163]
v_mfma_f32_16x16x32_bf16 v[164:167], v[16:19], a[160:163], 0
v_mfma_f32_16x16x32_bf16 v[164:167], v[20:23], a[164:167], v[164:167]
v_mfma_f32_16x16x32_bf16 v[164:167], v[24:27], a[168:171], v[164:167]
v_mfma_f32_16x16x32_bf16 v[164:167], v[28:31], a[172:175], v[164:167]
v_mfma_f32_16x16x32_bf16 v[164:167], v[32:35], a[176:179], v[164:167]
v_mfma_f32_16x16x32_bf16 v[164:167], v[36:39], a[180:183], v[164:167]
v_mfma_f32_16x16x32_bf16 v[164:167], v[40:43], a[184:187], v[164:167]
s_nop 0
ds_write_b128 v242, v[160:163] offset:2048
v_mfma_f32_16x16x32_bf16 v[164:167], v[44:47], a[188:191], v[164:167]
v_mfma_f32_16x16x32_bf16 v[176:179], a[64:67], v[48:51], 0
v_mfma_f32_16x16x32_bf16 v[176:179], a[68:71], v[52:55], v[176:179]
v_mfma_f32_16x16x32_bf16 v[176:179], a[72:75], v[56:59], v[176:179]
v_mfma_f32_16x16x32_bf16 v[176:179], a[76:79], v[60:63], v[176:179]
v_mfma_f32_16x16x32_bf16 v[176:179], a[80:83], v[64:67], v[176:179]
v_mfma_f32_16x16x32_bf16 v[176:179], a[84:87], v[68:71], v[176:179]
v_mfma_f32_16x16x32_bf16 v[176:179], a[88:91], v[72:75], v[176:179]
s_nop 0
ds_write_b128 v242, v[164:167] offset:3072
v_mfma_f32_16x16x32_bf16 v[176:179], a[92:95], v[76:79], v[176:179]
v_mfma_f32_16x16x32_bf16 v[180:183], a[96:99], v[48:51], 0
v_mfma_f32_16x16x32_bf16 v[180:183], a[100:103], v[52:55], v[180:183]
v_mfma_f32_16x16x32_bf16 v[180:183], a[104:107], v[56:59], v[180:183]
v_mfma_f32_16x16x32_bf16 v[180:183], a[108:111], v[60:63], v[180:183]
v_mfma_f32_16x16x32_bf16 v[180:183], a[112:115], v[64:67], v[180:183]
v_mfma_f32_16x16x32_bf16 v[180:183], a[116:119], v[68:71], v[180:183]
v_mfma_f32_16x16x32_bf16 v[180:183], a[120:123], v[72:75], v[180:183]
s_nop 0
ds_write_b128 v242, v[176:179] offset:4096
v_mfma_f32_16x16x32_bf16 v[180:183], a[124:127], v[76:79], v[180:183]
v_mfma_f32_16x16x32_bf16 v[184:187], v[48:51], a[128:131], 0
v_mfma_f32_16x16x32_bf16 v[184:187], v[52:55], a[132:135], v[184:187]
v_mfma_f32_16x16x32_bf16 v[184:187], v[56:59], a[136:139], v[184:187]
v_mfma_f32_16x16x32_bf16 v[184:187], v[60:63], a[140:143], v[184:187]
v_mfma_f32_16x16x32_bf16 v[184:187], v[64:67], a[144:147], v[184:187]
v_mfma_f32_16x16x32_bf16 v[184:187], v[68:71], a[148:151], v[184:187]
v_mfma_f32_16x16x32_bf16 v[184:187], v[72:75], a[152:155], v[184:187]
s_nop 0
ds_write_b128 v242, v[180:183] offset:5120
v_mfma_f32_16x16x32_bf16 v[184:187], v[76:79], a[156:159], v[184:187]
v_mfma_f32_16x16x32_bf16 v[188:191], v[48:51], a[160:163], 0
v_mfma_f32_16x16x32_bf16 v[188:191], v[52:55], a[164:167], v[188:191]
v_mfma_f32_16x16x32_bf16 v[188:191], v[56:59], a[168:171], v[188:191]
v_mfma_f32_16x16x32_bf16 v[188:191], v[60:63], a[172:175], v[188:191]
v_mfma_f32_16x16x32_bf16 v[188:191], v[64:67], a[176:179], v[188:191]
v_mfma_f32_16x16x32_bf16 v[188:191], v[68:71], a[180:183], v[188:191]
v_mfma_f32_16x16x32_bf16 v[188:191], v[72:75], a[184:187], v[188:191]
s_nop 0
ds_write_b128 v242, v[184:187] offset:6144
v_mfma_f32_16x16x32_bf16 v[188:191], v[76:79], a[188:191], v[188:191]
s_nop 7
ds_write_b128 v242, v[188:191] offset:7168
s_waitcnt lgkmcnt(0)
s_barrier
ds_read_b128 v[192:195], v240 offset:0
ds_read_b128 v[196:199], v240 offset:8192
ds_read_b128 v[200:203], v240 offset:16384
ds_read_b128 v[204:207], v240 offset:24576
ds_read_b128 v[208:211], v241 offset:0
ds_read_b128 v[212:215], v241 offset:8192
ds_read_b128 v[216:219], v241 offset:16384
ds_read_b128 v[220:223], v241 offset:24576
s_waitcnt lgkmcnt(0)
v_pk_add_f32 v[192:193], v[192:193], v[196:197]
v_pk_add_f32 v[200:201], v[200:201], v[204:205]
v_pk_add_f32 v[194:195], v[194:195], v[198:199]
v_pk_add_f32 v[202:203], v[202:203], v[206:207]
v_pk_add_f32 v[192:193], v[192:193], v[200:201]
v_pk_add_f32 v[194:195], v[194:195], v[202:203]
v_cvt_pk_bf16_f32 v224, v192, v193
v_cvt_pk_bf16_f32 v225, v194, v195
v_pk_add_f32 v[208:209], v[208:209], v[212:213]
v_pk_add_f32 v[216:217], v[216:217], v[220:221]
v_pk_add_f32 v[210:211], v[210:211], v[214:215]
v_pk_add_f32 v[218:219], v[218:219], v[222:223]
v_pk_add_f32 v[208:209], v[208:209], v[216:217]
v_pk_add_f32 v[210:211], v[210:211], v[218:219]
v_cvt_pk_bf16_f32 v226, v208, v209
v_cvt_pk_bf16_f32 v227, v210, v211
buffer_store_dwordx4 v[224:227], v2, s[8:11], s64 offen sc1
s_add_u32 s64, s64, 0x40000
s_add_u32 s59, s59, 1
s_waitcnt vmcnt(0)
s_barrier
s_cmp_lg_u32 s42, 0
s_cbranch_scc1 fsp_111_\sf
s_min_u32 s46, s59, 64
v_mov_b32 v6, s46
v_mov_b32 v7, 0
s_mov_b64 exec, 1
buffer_store_dword v6, v7, s[8:11], s58 offen sc1
s_mov_b64 exec, -1
fsp_111_\sf:
v_mfma_f32_16x16x32_bf16 v[152:155], a[64:67], v[80:83], 0
v_mfma_f32_16x16x32_bf16 v[152:155], a[68:71], v[84:87], v[152:155]
v_mfma_f32_16x16x32_bf16 v[152:155], a[72:75], v[88:91], v[152:155]
v_mfma_f32_16x16x32_bf16 v[152:155], a[76:79], v[92:95], v[152:155]
v_mfma_f32_16x16x32_bf16 v[152:155], a[80:83], v[96:99], v[152:155]
v_mfma_f32_16x16x32_bf16 v[152:155], a[84:87], v[100:103], v[152:155]
v_mfma_f32_16x16x32_bf16 v[152:155], a[88:91], v[104:107], v[152:155]
v_mfma_f32_16x16x32_bf16 v[152:155], a[92:95], v[108:111], v[152:155]
v_mfma_f32_16x16x32_bf16 v[156:159], a[96:99], v[80:83], 0
v_mfma_f32_16x16x32_bf16 v[156:159], a[100:103], v[84:87], v[156:159]
v_mfma_f32_16x16x32_bf16 v[156:159], a[104:107], v[88:91], v[156:159]
v_mfma_f32_16x16x32_bf16 v[156:159], a[108:111], v[92:95], v[156:159]
v_mfma_f32_16x16x32_bf16 v[156:159], a[112:115], v[96:99], v[156:159]
v_mfma_f32_16x16x32_bf16 v[156:159], a[116:119], v[100:103], v[156:159]
v_mfma_f32_16x16x32_bf16 v[156:159], a[120:123], v[104:107], v[156:159]
s_nop 0
ds_write_b128 v242, v[152:155] offset:0
v_mfma_f32_16x16x32_bf16 v[156:159], a[124:127], v[108:111], v[156:159]
v_mfma_f32_16x16x32_bf16 v[160:163], v[80:83], a[128:131], 0
v_mfma_f32_16x16x32_bf16 v[160:163], v[84:87], a[132:135], v[160:163]
v_mfma_f32_16x16x32_bf16 v[160:163], v[88:91], a[136:139], v[160:163]
v_mfma_f32_16x16x32_bf16 v[160:163], v[92:95], a[140:143], v[160:163]
v_mfma_f32_16x16x32_bf16 v[160:163], v[96:99], a[144:147], v[160:163]
v_mfma_f32_16x16x32_bf16 v[160:163], v[100:103], a[148:151], v[160:163]
v_mfma_f32_16x16x32_bf16 v[160:163], v[104:107], a[152:155], v[160:163]
s_nop 0
ds_write_b128 v242, v[156:159] offset:1024
v_mfma_f32_16x16x32_bf16 v[160:163], v[108:111], a[156:159], v[160:163]
v_mfma_f32_16x16x32_bf16 v[164:167], v[80:83], a[160:163], 0
v_mfma_f32_16x16x32_bf16 v[164:167], v[84:87], a[164:167], v[164:167]
v_mfma_f32_16x16x32_bf16 v[164:167], v[88:91], a[168:171], v[164:167]
v_mfma_f32_16x16x32_bf16 v[164:167], v[92:95], a[172:175], v[164:167]
v_mfma_f32_16x16x32_bf16 v[164:167], v[96:99], a[176:179], v[164:167]
v_mfma_f32_16x16x32_bf16 v[164:167], v[100:103], a[180:183], v[164:167]
v_mfma_f32_16x16x32_bf16 v[164:167], v[104:107], a[184:187], v[164:167]
s_nop 0
ds_write_b128 v242, v[160:163] offset:2048
v_mfma_f32_16x16x32_bf16 v[164:167], v[108:111], a[188:191], v[164:167]
v_mfma_f32_16x16x32_bf16 v[176:179], a[64:67], v[112:115], 0
v_mfma_f32_16x16x32_bf16 v[176:179], a[68:71], v[116:119], v[176:179]
v_mfma_f32_16x16x32_bf16 v[176:179], a[72:75], v[120:123], v[176:179]
v_mfma_f32_16x16x32_bf16 v[176:179], a[76:79], v[124:127], v[176:179]
v_mfma_f32_16x16x32_bf16 v[176:179], a[80:83], v[128:131], v[176:179]
v_mfma_f32_16x16x32_bf16 v[176:179], a[84:87], v[132:135], v[176:179]
v_mfma_f32_16x16x32_bf16 v[176:179], a[88:91], v[136:139], v[176:179]
s_nop 0
ds_write_b128 v242, v[164:167] offset:3072
v_mfma_f32_16x16x32_bf16 v[176:179], a[92:95], v[140:143], v[176:179]
v_mfma_f32_16x16x32_bf16 v[180:183], a[96:99], v[112:115], 0
v_mfma_f32_16x16x32_bf16 v[180:183], a[100:103], v[116:119], v[180:183]
v_mfma_f32_16x16x32_bf16 v[180:183], a[104:107], v[120:123], v[180:183]
v_mfma_f32_16x16x32_bf16 v[180:183], a[108:111], v[124:127], v[180:183]
v_mfma_f32_16x16x32_bf16 v[180:183], a[112:115], v[128:131], v[180:183]
v_mfma_f32_16x16x32_bf16 v[180:183], a[116:119], v[132:135], v[180:183]
v_mfma_f32_16x16x32_bf16 v[180:183], a[120:123], v[136:139], v[180:183]
s_nop 0
ds_write_b128 v242, v[176:179] offset:4096
v_mfma_f32_16x16x32_bf16 v[180:183], a[124:127], v[140:143], v[180:183]
v_mfma_f32_16x16x32_bf16 v[184:187], v[112:115], a[128:131], 0
v_mfma_f32_16x16x32_bf16 v[184:187], v[116:119], a[132:135], v[184:187]
v_mfma_f32_16x16x32_bf16 v[184:187], v[120:123], a[136:139], v[184:187]
v_mfma_f32_16x16x32_bf16 v[184:187], v[124:127], a[140:143], v[184:187]
v_mfma_f32_16x16x32_bf16 v[184:187], v[128:131], a[144:147], v[184:187]
v_mfma_f32_16x16x32_bf16 v[184:187], v[132:135], a[148:151], v[184:187]
v_mfma_f32_16x16x32_bf16 v[184:187], v[136:139], a[152:155], v[184:187]
s_nop 0
ds_write_b128 v242, v[180:183] offset:5120
v_mfma_f32_16x16x32_bf16 v[184:187], v[140:143], a[156:159], v[184:187]
v_mfma_f32_16x16x32_bf16 v[188:191], v[112:115], a[160:163], 0
v_mfma_f32_16x16x32_bf16 v[188:191], v[116:119], a[164:167], v[188:191]
v_mfma_f32_16x16x32_bf16 v[188:191], v[120:123], a[168:171], v[188:191]
v_mfma_f32_16x16x32_bf16 v[188:191], v[124:127], a[172:175], v[188:191]
v_mfma_f32_16x16x32_bf16 v[188:191], v[128:131], a[176:179], v[188:191]
v_mfma_f32_16x16x32_bf16 v[188:191], v[132:135], a[180:183], v[188:191]
v_mfma_f32_16x16x32_bf16 v[188:191], v[136:139], a[184:187], v[188:191]
s_nop 0
ds_write_b128 v242, v[184:187] offset:6144
v_mfma_f32_16x16x32_bf16 v[188:191], v[140:143], a[188:191], v[188:191]
s_nop 7
ds_write_b128 v242, v[188:191] offset:7168
s_waitcnt lgkmcnt(0)
s_barrier
ds_read_b128 v[192:195], v240 offset:0
ds_read_b128 v[196:199], v240 offset:8192
ds_read_b128 v[200:203], v240 offset:16384
ds_read_b128 v[204:207], v240 offset:24576
ds_read_b128 v[208:211], v241 offset:0
ds_read_b128 v[212:215], v241 offset:8192
ds_read_b128 v[216:219], v241 offset:16384
ds_read_b128 v[220:223], v241 offset:24576
s_waitcnt lgkmcnt(0)
v_pk_add_f32 v[192:193], v[192:193], v[196:197]
v_pk_add_f32 v[200:201], v[200:201], v[204:205]
v_pk_add_f32 v[194:195], v[194:195], v[198:199]
v_pk_add_f32 v[202:203], v[202:203], v[206:207]
v_pk_add_f32 v[192:193], v[192:193], v[200:201]
v_pk_add_f32 v[194:195], v[194:195], v[202:203]
v_cvt_pk_bf16_f32 v224, v192, v193
v_cvt_pk_bf16_f32 v225, v194, v195
v_pk_add_f32 v[208:209], v[208:209], v[212:213]
v_pk_add_f32 v[216:217], v[216:217], v[220:221]
v_pk_add_f32 v[210:211], v[210:211], v[214:215]
v_pk_add_f32 v[218:219], v[218:219], v[222:223]
v_pk_add_f32 v[208:209], v[208:209], v[216:217]
v_pk_add_f32 v[210:211], v[210:211], v[218:219]
v_cvt_pk_bf16_f32 v226, v208, v209
v_cvt_pk_bf16_f32 v227, v210, v211
buffer_store_dwordx4 v[224:227], v2, s[8:11], s64 offen sc1
s_add_u32 s64, s64, 0x40000
s_add_u32 s59, s59, 1
s_waitcnt vmcnt(0)
s_barrier
s_cmp_lg_u32 s42, 0
s_cbranch_scc1 fsp_112_\sf
s_min_u32 s46, s59, 64
v_mov_b32 v6, s46
v_mov_b32 v7, 0
s_mov_b64 exec, 1
buffer_store_dword v6, v7, s[8:11], s58 offen sc1
s_mov_b64 exec, -1
fsp_112_\sf:
v_mov_b32 v9, s91
s_nop 1
dw_113_\sf:
buffer_load_dword v8, v9, s[32:35], 0 offen sc1
s_waitcnt vmcnt(0)
v_cmp_gt_u32 vcc, 32, v8
s_cbranch_vccz dwd_114_\sf
s_add_u32 s44, s44, 1
s_cmp_lt_u32 s44, 0x40000
s_cbranch_scc1 dw_113_\sf
s_nop 0
dwd_114_\sf:
s_lshl_b32 s45, s92, 22
s_lshl_b32 s46, s42, 13
s_add_u32 s54, s45, s46
.if \sf == 0
s_add_u32 s54, s54, 0x6020000
.else
s_add_u32 s54, s54, 0xe020000
.endif
s_add_u32 s45, s54, 0x8000
buffer_load_dwordx4 v[16:19], v2, s[8:11], s54 offen offset:0 sc1
buffer_load_dwordx4 v[20:23], v2, s[8:11], s54 offen offset:1024 sc1
buffer_load_dwordx4 v[24:27], v2, s[8:11], s54 offen offset:2048 sc1
buffer_load_dwordx4 v[28:31], v2, s[8:11], s54 offen offset:3072 sc1
buffer_load_dwordx4 v[32:35], v5, s[8:11], s54 offen offset:0 sc1
buffer_load_dwordx4 v[36:39], v5, s[8:11], s54 offen offset:1024 sc1
buffer_load_dwordx4 v[40:43], v5, s[8:11], s54 offen offset:2048 sc1
buffer_load_dwordx4 v[44:47], v5, s[8:11], s54 offen offset:3072 sc1
buffer_load_dwordx4 v[48:51], v2, s[8:11], s45 offen offset:0 sc1
buffer_load_dwordx4 v[52:55], v2, s[8:11], s45 offen offset:1024 sc1
buffer_load_dwordx4 v[56:59], v2, s[8:11], s45 offen offset:2048 sc1
buffer_load_dwordx4 v[60:63], v2, s[8:11], s45 offen offset:3072 sc1
buffer_load_dwordx4 v[64:67], v5, s[8:11], s45 offen offset:0 sc1
buffer_load_dwordx4 v[68:71], v5, s[8:11], s45 offen offset:1024 sc1
buffer_load_dwordx4 v[72:75], v5, s[8:11], s45 offen offset:2048 sc1
buffer_load_dwordx4 v[76:79], v5, s[8:11], s45 offen offset:3072 sc1
s_add_u32 s54, s54, 0x10000
s_add_u32 s45, s54, 0x8000
buffer_load_dwordx4 v[80:83], v2, s[8:11], s54 offen offset:0 sc1
buffer_load_dwordx4 v[84:87], v2, s[8:11], s54 offen offset:1024 sc1
buffer_load_dwordx4 v[88:91], v2, s[8:11], s54 offen offset:2048 sc1
buffer_load_dwordx4 v[92:95], v2, s[8:11], s54 offen offset:3072 sc1
buffer_load_dwordx4 v[96:99], v5, s[8:11], s54 offen offset:0 sc1
buffer_load_dwordx4 v[100:103], v5, s[8:11], s54 offen offset:1024 sc1
buffer_load_dwordx4 v[104:107], v5, s[8:11], s54 offen offset:2048 sc1
buffer_load_dwordx4 v[108:111], v5, s[8:11], s54 offen offset:3072 sc1
buffer_load_dwordx4 v[112:115], v2, s[8:11], s45 offen offset:0 sc1
buffer_load_dwordx4 v[116:119], v2, s[8:11], s45 offen offset:1024 sc1
buffer_load_dwordx4 v[120:123], v2, s[8:11], s45 offen offset:2048 sc1
buffer_load_dwordx4 v[124:127], v2, s[8:11], s45 offen offset:3072 sc1
buffer_load_dwordx4 v[128:131], v5, s[8:11], s45 offen offset:0 sc1
buffer_load_dwordx4 v[132:135], v5, s[8:11], s45 offen offset:1024 sc1
buffer_load_dwordx4 v[136:139], v5, s[8:11], s45 offen offset:2048 sc1
buffer_load_dwordx4 v[140:143], v5, s[8:11], s45 offen offset:3072 sc1
s_add_u32 s54, s54, 0x10000
buffer_load_dwordx4 a[0:3], v239, s[12:15], s63 offen
s_add_u32 s63, s63, 0x20000
buffer_load_dwordx4 a[4:7], v239, s[12:15], s63 offen
s_add_u32 s63, s63, 0x20000
buffer_load_dwordx4 a[8:11], v239, s[12:15], s63 offen
s_add_u32 s63, s63, 0x20000
buffer_load_dwordx4 a[12:15], v239, s[12:15], s63 offen
s_add_u32 s63, s63, 0x20000
buffer_load_dwordx4 a[16:19], v239, s[12:15], s63 offen
s_add_u32 s63, s63, 0x20000
buffer_load_dwordx4 a[20:23], v239, s[12:15], s63 offen
s_add_u32 s63, s63, 0x20000
buffer_load_dwordx4 a[24:27], v239, s[12:15], s63 offen
s_add_u32 s63, s63, 0x20000
buffer_load_dwordx4 a[28:31], v239, s[12:15], s63 offen
s_add_u32 s63, s63, 0x20000
s_waitcnt vmcnt(24)
v_mfma_f32_16x16x32_bf16 v[152:155], a[64:67], v[16:19], 0
v_mfma_f32_16x16x32_bf16 v[152:155], a[68:71], v[20:23], v[152:155]
v_mfma_f32_16x16x32_bf16 v[152:155], a[72:75], v[24:27], v[152:155]
v_mfma_f32_16x16x32_bf16 v[152:155], a[76:79], v[28:31], v[152:155]
v_mfma_f32_16x16x32_bf16 v[152:155], a[80:83], v[32:35], v[152:155]
v_mfma_f32_16x16x32_bf16 v[152:155], a[84:87], v[36:39], v[152:155]
v_mfma_f32_16x16x32_bf16 v[152:155], a[88:91], v[40:43], v[152:155]
v_mfma_f32_16x16x32_bf16 v[152:155], a[92:95], v[44:47], v[152:155]
v_mfma_f32_16x16x32_bf16 v[156:159], a[96:99], v[16:19], 0
v_mfma_f32_16x16x32_bf16 v[156:159], a[100:103], v[20:23], v[156:159]
v_mfma_f32_16x16x32_bf16 v[156:159], a[104:107], v[24:27], v[156:159]
v_mfma_f32_16x16x32_bf16 v[156:159], a[108:111], v[28:31], v[156:159]
v_mfma_f32_16x16x32_bf16 v[156:159], a[112:115], v[32:35], v[156:159]
v_mfma_f32_16x16x32_bf16 v[156:159], a[116:119], v[36:39], v[156:159]
v_mfma_f32_16x16x32_bf16 v[156:159], a[120:123], v[40:43], v[156:159]
s_nop 0
ds_write_b128 v242, v[152:155] offset:0
v_mfma_f32_16x16x32_bf16 v[156:159], a[124:127], v[44:47], v[156:159]
v_mfma_f32_16x16x32_bf16 v[160:163], v[16:19], a[128:131], 0
v_mfma_f32_16x16x32_bf16 v[160:163], v[20:23], a[132:135], v[160:163]
v_mfma_f32_16x16x32_bf16 v[160:163], v[24:27], a[136:139], v[160:163]
v_mfma_f32_16x16x32_bf16 v[160:163], v[28:31], a[140:143], v[160:163]
v_mfma_f32_16x16x32_bf16 v[160:163], v[32:35], a[144:147], v[160:163]
v_mfma_f32_16x16x32_bf16 v[160:163], v[36:39], a[148:151], v[160:163]
v_mfma_f32_16x16x32_bf16 v[160:163], v[40:43], a[152:155], v[160:163]
s_nop 0
ds_write_b128 v242, v[156:159] offset:1024
v_mfma_f32_16x16x32_bf16 v[160:163], v[44:47], a[156:159], v[160:163]
v_mfma_f32_16x16x32_bf16 v[164:167], v[16:19], a[160:163], 0
v_mfma_f32_16x16x32_bf16 v[164:167], v[20:23], a[164:167], v[164:167]
v_mfma_f32_16x16x32_bf16 v[164:167], v[24:27], a[168:171], v[164:167]
v_mfma_f32_16x16x32_bf16 v[164:167], v[28:31], a[172:175], v[164:167]
v_mfma_f32_16x16x32_bf16 v[164:167], v[32:35], a[176:179], v[164:167]
v_mfma_f32_16x16x32_bf16 v[164:167], v[36:39], a[180:183], v[164:167]
v_mfma_f32_16x16x32_bf16 v[164:167], v[40:43], a[184:187], v[164:167]
s_nop 0
ds_write_b128 v242, v[160:163] offset:2048
v_mfma_f32_16x16x32_bf16 v[164:167], v[44:47], a[188:191], v[164:167]
v_mfma_f32_16x16x32_bf16 v[176:179], a[64:67], v[48:51], 0
v_mfma_f32_16x16x32_bf16 v[176:179], a[68:71], v[52:55], v[176:179]
v_mfma_f32_16x16x32_bf16 v[176:179], a[72:75], v[56:59], v[176:179]
v_mfma_f32_16x16x32_bf16 v[176:179], a[76:79], v[60:63], v[176:179]
v_mfma_f32_16x16x32_bf16 v[176:179], a[80:83], v[64:67], v[176:179]
v_mfma_f32_16x16x32_bf16 v[176:179], a[84:87], v[68:71], v[176:179]
v_mfma_f32_16x16x32_bf16 v[176:179], a[88:91], v[72:75], v[176:179]
s_nop 0
ds_write_b128 v242, v[164:167] offset:3072
v_mfma_f32_16x16x32_bf16 v[176:179], a[92:95], v[76:79], v[176:179]
v_mfma_f32_16x16x32_bf16 v[180:183], a[96:99], v[48:51], 0
v_mfma_f32_16x16x32_bf16 v[180:183], a[100:103], v[52:55], v[180:183]
v_mfma_f32_16x16x32_bf16 v[180:183], a[104:107], v[56:59], v[180:183]
v_mfma_f32_16x16x32_bf16 v[180:183], a[108:111], v[60:63], v[180:183]
v_mfma_f32_16x16x32_bf16 v[180:183], a[112:115], v[64:67], v[180:183]
v_mfma_f32_16x16x32_bf16 v[180:183], a[116:119], v[68:71], v[180:183]
v_mfma_f32_16x16x32_bf16 v[180:183], a[120:123], v[72:75], v[180:183]
s_nop 0
ds_write_b128 v242, v[176:179] offset:4096
v_mfma_f32_16x16x32_bf16 v[180:183], a[124:127], v[76:79], v[180:183]
v_mfma_f32_16x16x32_bf16 v[184:187], v[48:51], a[128:131], 0
v_mfma_f32_16x16x32_bf16 v[184:187], v[52:55], a[132:135], v[184:187]
v_mfma_f32_16x16x32_bf16 v[184:187], v[56:59], a[136:139], v[184:187]
v_mfma_f32_16x16x32_bf16 v[184:187], v[60:63], a[140:143], v[184:187]
v_mfma_f32_16x16x32_bf16 v[184:187], v[64:67], a[144:147], v[184:187]
v_mfma_f32_16x16x32_bf16 v[184:187], v[68:71], a[148:151], v[184:187]
v_mfma_f32_16x16x32_bf16 v[184:187], v[72:75], a[152:155], v[184:187]
s_nop 0
ds_write_b128 v242, v[180:183] offset:5120
v_mfma_f32_16x16x32_bf16 v[184:187], v[76:79], a[156:159], v[184:187]
v_mfma_f32_16x16x32_bf16 v[188:191], v[48:51], a[160:163], 0
v_mfma_f32_16x16x32_bf16 v[188:191], v[52:55], a[164:167], v[188:191]
v_mfma_f32_16x16x32_bf16 v[188:191], v[56:59], a[168:171], v[188:191]
v_mfma_f32_16x16x32_bf16 v[188:191], v[60:63], a[172:175], v[188:191]
v_mfma_f32_16x16x32_bf16 v[188:191], v[64:67], a[176:179], v[188:191]
v_mfma_f32_16x16x32_bf16 v[188:191], v[68:71], a[180:183], v[188:191]
v_mfma_f32_16x16x32_bf16 v[188:191], v[72:75], a[184:187], v[188:191]
s_nop 0
ds_write_b128 v242, v[184:187] offset:6144
v_mfma_f32_16x16x32_bf16 v[188:191], v[76:79], a[188:191], v[188:191]
s_nop 7
ds_write_b128 v242, v[188:191] offset:7168
s_waitcnt lgkmcnt(0)
s_barrier
ds_read_b128 v[192:195], v240 offset:0
ds_read_b128 v[196:199], v240 offset:8192
ds_read_b128 v[200:203], v240 offset:16384
ds_read_b128 v[204:207], v240 offset:24576
ds_read_b128 v[208:211], v241 offset:0
ds_read_b128 v[212:215], v241 offset:8192
ds_read_b128 v[216:219], v241 offset:16384
ds_read_b128 v[220:223], v241 offset:24576
s_waitcnt lgkmcnt(0)
v_pk_add_f32 v[192:193], v[192:193], v[196:197]
v_pk_add_f32 v[200:201], v[200:201], v[204:205]
v_pk_add_f32 v[194:195], v[194:195], v[198:199]
v_pk_add_f32 v[202:203], v[202:203], v[206:207]
v_pk_add_f32 v[192:193], v[192:193], v[200:201]
v_pk_add_f32 v[194:195], v[194:195], v[202:203]
v_cvt_pk_bf16_f32 v224, v192, v193
v_cvt_pk_bf16_f32 v225, v194, v195
v_pk_add_f32 v[208:209], v[208:209], v[212:213]
v_pk_add_f32 v[216:217], v[216:217], v[220:221]
v_pk_add_f32 v[210:211], v[210:211], v[214:215]
v_pk_add_f32 v[218:219], v[218:219], v[222:223]
v_pk_add_f32 v[208:209], v[208:209], v[216:217]
v_pk_add_f32 v[210:211], v[210:211], v[218:219]
v_cvt_pk_bf16_f32 v226, v208, v209
v_cvt_pk_bf16_f32 v227, v210, v211
buffer_store_dwordx4 v[224:227], v2, s[8:11], s64 offen sc1
s_add_u32 s64, s64, 0x40000
s_add_u32 s59, s59, 1
s_waitcnt vmcnt(0)
s_barrier
s_cmp_lg_u32 s42, 0
s_cbranch_scc1 fsp_115_\sf
s_min_u32 s46, s59, 64
v_mov_b32 v6, s46
v_mov_b32 v7, 0
s_mov_b64 exec, 1
buffer_store_dword v6, v7, s[8:11], s58 offen sc1
s_mov_b64 exec, -1
fsp_115_\sf:
buffer_load_dwordx4 a[32:35], v239, s[12:15], s63 offen
s_add_u32 s63, s63, 0x20000
buffer_load_dwordx4 a[36:39], v239, s[12:15], s63 offen
s_add_u32 s63, s63, 0x20000
buffer_load_dwordx4 a[40:43], v239, s[12:15], s63 offen
s_add_u32 s63, s63, 0x20000
buffer_load_dwordx4 a[44:47], v239, s[12:15], s63 offen
s_add_u32 s63, s63, 0x20000
buffer_load_dwordx4 a[48:51], v239, s[12:15], s63 offen
s_add_u32 s63, s63, 0x20000
buffer_load_dwordx4 a[52:55], v239, s[12:15], s63 offen
s_add_u32 s63, s63, 0x20000
buffer_load_dwordx4 a[56:59], v239, s[12:15], s63 offen
s_add_u32 s63, s63, 0x20000
buffer_load_dwordx4 a[60:63], v239, s[12:15], s63 offen
s_add_u32 s63, s63, 0x20000
v_mfma_f32_16x16x32_bf16 v[152:155], a[64:67], v[80:83], 0
v_mfma_f32_16x16x32_bf16 v[152:155], a[68:71], v[84:87], v[152:155]
v_mfma_f32_16x16x32_bf16 v[152:155], a[72:75], v[88:91], v[152:155]
v_mfma_f32_16x16x32_bf16 v[152:155], a[76:79], v[92:95], v[152:155]
v_mfma_f32_16x16x32_bf16 v[152:155], a[80:83], v[96:99], v[152:155]
v_mfma_f32_16x16x32_bf16 v[152:155], a[84:87], v[100:103], v[152:155]
v_mfma_f32_16x16x32_bf16 v[152:155], a[88:91], v[104:107], v[152:155]
v_mfma_f32_16x16x32_bf16 v[152:155], a[92:95], v[108:111], v[152:155]
v_mfma_f32_16x16x32_bf16 v[156:159], a[96:99], v[80:83], 0
v_mfma_f32_16x16x32_bf16 v[156:159], a[100:103], v[84:87], v[156:159]
v_mfma_f32_16x16x32_bf16 v[156:159], a[104:107], v[88:91], v[156:159]
v_mfma_f32_16x16x32_bf16 v[156:159], a[108:111], v[92:95], v[156:159]
v_mfma_f32_16x16x32_bf16 v[156:159], a[112:115], v[96:99], v[156:159]
v_mfma_f32_16x16x32_bf16 v[156:159], a[116:119], v[100:103], v[156:159]
v_mfma_f32_16x16x32_bf16 v[156:159], a[120:123], v[104:107], v[156:159]
s_nop 0
ds_write_b128 v242, v[152:155] offset:0
v_mfma_f32_16x16x32_bf16 v[156:159], a[124:127], v[108:111], v[156:159]
v_mfma_f32_16x16x32_bf16 v[160:163], v[80:83], a[128:131], 0
v_mfma_f32_16x16x32_bf16 v[160:163], v[84:87], a[132:135], v[160:163]
v_mfma_f32_16x16x32_bf16 v[160:163], v[88:91], a[136:139], v[160:163]
v_mfma_f32_16x16x32_bf16 v[160:163], v[92:95], a[140:143], v[160:163]
v_mfma_f32_16x16x32_bf16 v[160:163], v[96:99], a[144:147], v[160:163]
v_mfma_f32_16x16x32_bf16 v[160:163], v[100:103], a[148:151], v[160:163]
v_mfma_f32_16x16x32_bf16 v[160:163], v[104:107], a[152:155], v[160:163]
s_nop 0
ds_write_b128 v242, v[156:159] offset:1024
v_mfma_f32_16x16x32_bf16 v[160:163], v[108:111], a[156:159], v[160:163]
v_mfma_f32_16x16x32_bf16 v[164:167], v[80:83], a[160:163], 0
v_mfma_f32_16x16x32_bf16 v[164:167], v[84:87], a[164:167], v[164:167]
v_mfma_f32_16x16x32_bf16 v[164:167], v[88:91], a[168:171], v[164:167]
v_mfma_f32_16x16x32_bf16 v[164:167], v[92:95], a[172:175], v[164:167]
v_mfma_f32_16x16x32_bf16 v[164:167], v[96:99], a[176:179], v[164:167]
v_mfma_f32_16x16x32_bf16 v[164:167], v[100:103], a[180:183], v[164:167]
v_mfma_f32_16x16x32_bf16 v[164:167], v[104:107], a[184:187], v[164:167]
s_nop 0
ds_write_b128 v242, v[160:163] offset:2048
v_mfma_f32_16x16x32_bf16 v[164:167], v[108:111], a[188:191], v[164:167]
v_mfma_f32_16x16x32_bf16 v[176:179], a[64:67], v[112:115], 0
v_mfma_f32_16x16x32_bf16 v[176:179], a[68:71], v[116:119], v[176:179]
v_mfma_f32_16x16x32_bf16 v[176:179], a[72:75], v[120:123], v[176:179]
v_mfma_f32_16x16x32_bf16 v[176:179], a[76:79], v[124:127], v[176:179]
v_mfma_f32_16x16x32_bf16 v[176:179], a[80:83], v[128:131], v[176:179]
v_mfma_f32_16x16x32_bf16 v[176:179], a[84:87], v[132:135], v[176:179]
v_mfma_f32_16x16x32_bf16 v[176:179], a[88:91], v[136:139], v[176:179]
s_nop 0
ds_write_b128 v242, v[164:167] offset:3072
v_mfma_f32_16x16x32_bf16 v[176:179], a[92:95], v[140:143], v[176:179]
v_mfma_f32_16x16x32_bf16 v[180:183], a[96:99], v[112:115], 0
v_mfma_f32_16x16x32_bf16 v[180:183], a[100:103], v[116:119], v[180:183]
v_mfma_f32_16x16x32_bf16 v[180:183], a[104:107], v[120:123], v[180:183]
v_mfma_f32_16x16x32_bf16 v[180:183], a[108:111], v[124:127], v[180:183]
v_mfma_f32_16x16x32_bf16 v[180:183], a[112:115], v[128:131], v[180:183]
v_mfma_f32_16x16x32_bf16 v[180:183], a[116:119], v[132:135], v[180:183]
v_mfma_f32_16x16x32_bf16 v[180:183], a[120:123], v[136:139], v[180:183]
s_nop 0
ds_write_b128 v242, v[176:179] offset:4096
v_mfma_f32_16x16x32_bf16 v[180:183], a[124:127], v[140:143], v[180:183]
v_mfma_f32_16x16x32_bf16 v[184:187], v[112:115], a[128:131], 0
v_mfma_f32_16x16x32_bf16 v[184:187], v[116:119], a[132:135], v[184:187]
v_mfma_f32_16x16x32_bf16 v[184:187], v[120:123], a[136:139], v[184:187]
v_mfma_f32_16x16x32_bf16 v[184:187], v[124:127], a[140:143], v[184:187]
v_mfma_f32_16x16x32_bf16 v[184:187], v[128:131], a[144:147], v[184:187]
v_mfma_f32_16x16x32_bf16 v[184:187], v[132:135], a[148:151], v[184:187]
v_mfma_f32_16x16x32_bf16 v[184:187], v[136:139], a[152:155], v[184:187]
s_nop 0
ds_write_b128 v242, v[180:183] offset:5120
v_mfma_f32_16x16x32_bf16 v[184:187], v[140:143], a[156:159], v[184:187]
v_mfma_f32_16x16x32_bf16 v[188:191], v[112:115], a[160:163], 0
v_mfma_f32_16x16x32_bf16 v[188:191], v[116:119], a[164:167], v[188:191]
v_mfma_f32_16x16x32_bf16 v[188:191], v[120:123], a[168:171], v[188:191]
v_mfma_f32_16x16x32_bf16 v[188:191], v[124:127], a[172:175], v[188:191]
v_mfma_f32_16x16x32_bf16 v[188:191], v[128:131], a[176:179], v[188:191]
v_mfma_f32_16x16x32_bf16 v[188:191], v[132:135], a[180:183], v[188:191]
v_mfma_f32_16x16x32_bf16 v[188:191], v[136:139], a[184:187], v[188:191]
s_nop 0
ds_write_b128 v242, v[184:187] offset:6144
v_mfma_f32_16x16x32_bf16 v[188:191], v[140:143], a[188:191], v[188:191]
s_nop 7
ds_write_b128 v242, v[188:191] offset:7168
s_waitcnt lgkmcnt(0)
s_barrier
ds_read_b128 v[192:195], v240 offset:0
ds_read_b128 v[196:199], v240 offset:8192
ds_read_b128 v[200:203], v240 offset:16384
ds_read_b128 v[204:207], v240 offset:24576
ds_read_b128 v[208:211], v241 offset:0
ds_read_b128 v[212:215], v241 offset:8192
ds_read_b128 v[216:219], v241 offset:16384
ds_read_b128 v[220:223], v241 offset:24576
s_waitcnt lgkmcnt(0)
v_pk_add_f32 v[192:193], v[192:193], v[196:197]
v_pk_add_f32 v[200:201], v[200:201], v[204:205]
v_pk_add_f32 v[194:195], v[194:195], v[198:199]
v_pk_add_f32 v[202:203], v[202:203], v[206:207]
v_pk_add_f32 v[192:193], v[192:193], v[200:201]
v_pk_add_f32 v[194:195], v[194:195], v[202:203]
v_cvt_pk_bf16_f32 v224, v192, v193
v_cvt_pk_bf16_f32 v225, v194, v195
v_pk_add_f32 v[208:209], v[208:209], v[212:213]
v_pk_add_f32 v[216:217], v[216:217], v[220:221]
v_pk_add_f32 v[210:211], v[210:211], v[214:215]
v_pk_add_f32 v[218:219], v[218:219], v[222:223]
v_pk_add_f32 v[208:209], v[208:209], v[216:217]
v_pk_add_f32 v[210:211], v[210:211], v[218:219]
v_cvt_pk_bf16_f32 v226, v208, v209
v_cvt_pk_bf16_f32 v227, v210, v211
buffer_store_dwordx4 v[224:227], v2, s[8:11], s64 offen sc1
s_add_u32 s64, s64, 0x40000
s_add_u32 s59, s59, 1
s_waitcnt vmcnt(0)
s_barrier
s_cmp_lg_u32 s42, 0
s_cbranch_scc1 fsp_116_\sf
s_min_u32 s46, s59, 64
v_mov_b32 v6, s46
v_mov_b32 v7, 0
s_mov_b64 exec, 1
buffer_store_dword v6, v7, s[8:11], s58 offen sc1
s_mov_b64 exec, -1
fsp_116_\sf:
ds_write_b128 v236, a[0:3] offset:0
ds_write_b128 v236, a[4:7] offset:1024
ds_write_b128 v236, a[8:11] offset:2048
ds_write_b128 v236, a[12:15] offset:3072
ds_write_b128 v236, a[16:19] offset:4096
ds_write_b128 v236, a[20:23] offset:5120
ds_write_b128 v236, a[24:27] offset:6144
ds_write_b128 v236, a[28:31] offset:7168
ds_write_b128 v236, a[32:35] offset:8192
ds_write_b128 v236, a[36:39] offset:9216
ds_write_b128 v236, a[40:43] offset:10240
ds_write_b128 v236, a[44:47] offset:11264
ds_write_b128 v236, a[48:51] offset:12288
ds_write_b128 v236, a[52:55] offset:13312
ds_write_b128 v236, a[56:59] offset:14336
ds_write_b128 v236, a[60:63] offset:15360
s_waitcnt lgkmcnt(0)
ds_read_b64_tr_b16 a[0:1], v237 offset:0
ds_read_b64_tr_b16 a[2:3], v237 offset:256
ds_read_b64_tr_b16 a[4:5], v237 offset:512
ds_read_b64_tr_b16 a[6:7], v237 offset:768
ds_read_b64_tr_b16 a[8:9], v237 offset:4096
ds_read_b64_tr_b16 a[10:11], v237 offset:4352
ds_read_b64_tr_b16 a[12:13], v237 offset:4608
ds_read_b64_tr_b16 a[14:15], v237 offset:4864
ds_read_b64_tr_b16 a[16:17], v237 offset:8192
ds_read_b64_tr_b16 a[18:19], v237 offset:8448
ds_read_b64_tr_b16 a[20:21], v237 offset:8704
ds_read_b64_tr_b16 a[22:23], v237 offset:8960
ds_read_b64_tr_b16 a[24:25], v237 offset:12288
ds_read_b64_tr_b16 a[26:27], v237 offset:12544
ds_read_b64_tr_b16 a[28:29], v237 offset:12800
ds_read_b64_tr_b16 a[30:31], v237 offset:13056
ds_read_b64_tr_b16 a[32:33], v237 offset:32
ds_read_b64_tr_b16 a[34:35], v237 offset:288
ds_read_b64_tr_b16 a[36:37], v237 offset:544
ds_read_b64_tr_b16 a[38:39], v237 offset:800
ds_read_b64_tr_b16 a[40:41], v237 offset:4128
ds_read_b64_tr_b16 a[42:43], v237 offset:4384
ds_read_b64_tr_b16 a[44:45], v237 offset:4640
ds_read_b64_tr_b16 a[46:47], v237 offset:4896
ds_read_b64_tr_b16 a[48:49], v237 offset:8224
ds_read_b64_tr_b16 a[50:51], v237 offset:8480
ds_read_b64_tr_b16 a[52:53], v237 offset:8736
ds_read_b64_tr_b16 a[54:55], v237 offset:8992
ds_read_b64_tr_b16 a[56:57], v237 offset:12320
ds_read_b64_tr_b16 a[58:59], v237 offset:12576
ds_read_b64_tr_b16 a[60:61], v237 offset:12832
ds_read_b64_tr_b16 a[62:63], v237 offset:13088
s_waitcnt lgkmcnt(0)
s_mov_b32 s52, 4
s_mov_b32 s53, 60
s_cmp_eq_u32 s94, 1
s_cbranch_scc1 fg1_wave1_\sf
s_cmp_eq_u32 s94, 2
s_cbranch_scc1 fg1_wave2_\sf
s_cmp_eq_u32 s94, 3
s_cbranch_scc1 fg1_wave3_\sf
fg1_wave0_\sf:
v_and_b32 v12, 15, v1
v_lshrrev_b32 v13, 4, v1
v_lshlrev_b32 v13, 5, v13
v_lshl_add_u32 v3, v12, 11, v13
v_add_u32 v4, 49152, v2
v_add_u32 v5, 4096, v2
s_lshl_b32 s54, s52, 16
s_lshl_b32 s45, s92, 22
s_add_u32 s54, s54, s45
.if \sf == 0
s_add_u32 s54, s54, 0x6000000
.else
s_add_u32 s54, s54, 0xe000000
.endif
s_lshl_b32 s45, s52, 5
s_add_u32 s45, s45, s49
s_lshl_b32 s45, s45, 13
s_lshl_b32 s46, s50, 10
s_add_u32 s47, s45, s46
s_add_u32 s55, s47, 0x0
s_add_u32 s56, s47, 0x1000000
s_add_u32 s47, s47, s46
s_add_u32 s57, s47, 0x2000000
v_mov_b32 v9, s91
s_nop 1
dw_117_\sf:
buffer_load_dword v8, v9, s[32:35], 0 offen sc1
s_waitcnt vmcnt(0)
v_cmp_gt_u32 vcc, 32, v8
s_cbranch_vccz dwd_118_\sf
s_add_u32 s44, s44, 1
s_cmp_lt_u32 s44, 0x40000
s_cbranch_scc1 dw_117_\sf
s_nop 0
dwd_118_\sf:
s_add_u32 s45, s54, 0x8000
buffer_load_dwordx4 v[16:19], v2, s[8:11], s54 offen offset:0 sc1
buffer_load_dwordx4 v[20:23], v2, s[8:11], s54 offen offset:1024 sc1
buffer_load_dwordx4 v[24:27], v2, s[8:11], s54 offen offset:2048 sc1
buffer_load_dwordx4 v[28:31], v2, s[8:11], s54 offen offset:3072 sc1
buffer_load_dwordx4 v[32:35], v5, s[8:11], s54 offen offset:0 sc1
buffer_load_dwordx4 v[36:39], v5, s[8:11], s54 offen offset:1024 sc1
buffer_load_dwordx4 v[40:43], v5, s[8:11], s54 offen offset:2048 sc1
buffer_load_dwordx4 v[44:47], v5, s[8:11], s54 offen offset:3072 sc1
buffer_load_dwordx4 v[48:51], v2, s[8:11], s45 offen offset:0 sc1
buffer_load_dwordx4 v[52:55], v2, s[8:11], s45 offen offset:1024 sc1
buffer_load_dwordx4 v[56:59], v2, s[8:11], s45 offen offset:2048 sc1
buffer_load_dwordx4 v[60:63], v2, s[8:11], s45 offen offset:3072 sc1
buffer_load_dwordx4 v[64:67], v5, s[8:11], s45 offen offset:0 sc1
buffer_load_dwordx4 v[68:71], v5, s[8:11], s45 offen offset:1024 sc1
buffer_load_dwordx4 v[72:75], v5, s[8:11], s45 offen offset:2048 sc1
buffer_load_dwordx4 v[76:79], v5, s[8:11], s45 offen offset:3072 sc1
s_mov_b32 s52, 0
s_load_dwordx2 s[12:13], s[0:1], 88
s_waitcnt lgkmcnt(0)
s_and_b32 s13, s13, 0xffff
s_mov_b32 s14, 0x700000
s_mov_b32 s15, 0x20000
s_mov_b32 s14, 0
s_mov_b32 s68, 0x30000
s_mov_b32 s69, 0
s_mov_b32 s70, 0
s_mov_b32 s71, 0
v_mov_b32 v243, 0
s_barrier
s_add_u32 s54, s54, 0x10000
s_add_u32 s45, s54, 0x8000
s_waitcnt vmcnt(0)
v_mfma_f32_16x16x32_bf16 v[144:147], a[0:3], v[16:19], 0
v_mfma_f32_16x16x32_bf16 v[148:151], a[32:35], v[16:19], 0
buffer_load_dwordx4 v[80:83], v2, s[8:11], s54 offen offset:0 sc1
v_mfma_f32_16x16x32_bf16 v[144:147], a[4:7], v[20:23], v[144:147]
buffer_load_dwordx4 a[192:195], v3, s[24:27], s61 offen offset:0
v_mfma_f32_16x16x32_bf16 v[148:151], a[36:39], v[20:23], v[148:151]
v_mfma_f32_16x16x32_bf16 v[144:147], a[8:11], v[24:27], v[144:147]
v_mfma_f32_16x16x32_bf16 v[148:151], a[40:43], v[24:27], v[148:151]
v_mfma_f32_16x16x32_bf16 v[144:147], a[12:15], v[28:31], v[144:147]
buffer_load_dwordx4 v[84:87], v2, s[8:11], s54 offen offset:1024 sc1
buffer_load_dwordx4 a[196:199], v3, s[24:27], s61 offen offset:16
v_mfma_f32_16x16x32_bf16 v[148:151], a[44:47], v[28:31], v[148:151]
v_mfma_f32_16x16x32_bf16 v[144:147], a[16:19], v[32:35], v[144:147]
v_mfma_f32_16x16x32_bf16 v[148:151], a[48:51], v[32:35], v[148:151]
v_mfma_f32_16x16x32_bf16 v[144:147], a[20:23], v[36:39], v[144:147]
buffer_load_dwordx4 a[200:203], v3, s[24:27], s61 offen offset:128
v_mfma_f32_16x16x32_bf16 v[148:151], a[52:55], v[36:39], v[148:151]
buffer_load_dwordx4 v[88:91], v2, s[8:11], s54 offen offset:2048 sc1
v_mfma_f32_16x16x32_bf16 v[144:147], a[24:27], v[40:43], v[144:147]
v_mfma_f32_16x16x32_bf16 v[148:151], a[56:59], v[40:43], v[148:151]
v_mfma_f32_16x16x32_bf16 v[144:147], a[28:31], v[44:47], v[144:147]
buffer_load_dwordx4 a[204:207], v3, s[24:27], s61 offen offset:144
v_mfma_f32_16x16x32_bf16 v[148:151], a[60:63], v[44:47], v[148:151]
v_mfma_f32_16x16x32_bf16 v[152:155], a[64:67], v[16:19], 0
buffer_load_dwordx4 v[92:95], v2, s[8:11], s54 offen offset:3072 sc1
v_mfma_f32_16x16x32_bf16 v[156:159], a[96:99], v[16:19], 0
v_mfma_f32_16x16x32_bf16 v[152:155], a[68:71], v[20:23], v[152:155]
buffer_load_dwordx4 a[208:211], v3, s[24:27], s61 offen offset:256
v_mfma_f32_16x16x32_bf16 v[156:159], a[100:103], v[20:23], v[156:159]
v_mfma_f32_16x16x32_bf16 v[152:155], a[72:75], v[24:27], v[152:155]
ds_write_b128 v2, v[144:147] offset:0
v_mfma_f32_16x16x32_bf16 v[156:159], a[104:107], v[24:27], v[156:159]
buffer_load_dwordx4 v[96:99], v5, s[8:11], s54 offen offset:0 sc1
v_mfma_f32_16x16x32_bf16 v[152:155], a[76:79], v[28:31], v[152:155]
buffer_load_dwordx4 a[212:215], v3, s[24:27], s61 offen offset:272
v_mfma_f32_16x16x32_bf16 v[156:159], a[108:111], v[28:31], v[156:159]
ds_write_b128 v2, v[148:151] offset:1024
v_mfma_f32_16x16x32_bf16 v[152:155], a[80:83], v[32:35], v[152:155]
v_mfma_f32_16x16x32_bf16 v[156:159], a[112:115], v[32:35], v[156:159]
v_mfma_f32_16x16x32_bf16 v[152:155], a[84:87], v[36:39], v[152:155]
buffer_load_dwordx4 v[100:103], v5, s[8:11], s54 offen offset:1024 sc1
buffer_load_dwordx4 a[216:219], v3, s[24:27], s61 offen offset:384
v_mfma_f32_16x16x32_bf16 v[156:159], a[116:119], v[36:39], v[156:159]
v_mfma_f32_16x16x32_bf16 v[152:155], a[88:91], v[40:43], v[152:155]
v_mfma_f32_16x16x32_bf16 v[156:159], a[120:123], v[40:43], v[156:159]
v_mfma_f32_16x16x32_bf16 v[152:155], a[92:95], v[44:47], v[152:155]
buffer_load_dwordx4 a[220:223], v3, s[24:27], s61 offen offset:400
v_mfma_f32_16x16x32_bf16 v[156:159], a[124:127], v[44:47], v[156:159]
buffer_load_dwordx4 v[104:107], v5, s[8:11], s54 offen offset:2048 sc1
v_mfma_f32_16x16x32_bf16 v[160:163], v[16:19], a[128:131], 0
v_mfma_f32_16x16x32_bf16 v[164:167], v[16:19], a[160:163], 0
v_mfma_f32_16x16x32_bf16 v[160:163], v[20:23], a[132:135], v[160:163]
v_mfma_f32_16x16x32_bf16 v[164:167], v[20:23], a[164:167], v[164:167]
v_mfma_f32_16x16x32_bf16 v[160:163], v[24:27], a[136:139], v[160:163]
buffer_load_dwordx4 v[108:111], v5, s[8:11], s54 offen offset:3072 sc1
ds_write_b128 v2, v[152:155] offset:2048
v_mfma_f32_16x16x32_bf16 v[164:167], v[24:27], a[168:171], v[164:167]
s_mov_b32 m0, s68
v_mfma_f32_16x16x32_bf16 v[160:163], v[28:31], a[140:143], v[160:163]
buffer_load_dwordx4 v243, s[12:15], s69 offen lds
v_mfma_f32_16x16x32_bf16 v[164:167], v[28:31], a[172:175], v[164:167]
s_add_u32 s68, s68, s70
s_add_u32 s69, s69, s71
ds_write_b128 v2, v[156:159] offset:3072
v_mfma_f32_16x16x32_bf16 v[160:163], v[32:35], a[144:147], v[160:163]
v_mfma_f32_16x16x32_bf16 v[164:167], v[32:35], a[176:179], v[164:167]
v_mfma_f32_16x16x32_bf16 v[160:163], v[36:39], a[148:151], v[160:163]
v_mfma_f32_16x16x32_bf16 v[164:167], v[36:39], a[180:183], v[164:167]
v_mfma_f32_16x16x32_bf16 v[160:163], v[40:43], a[152:155], v[160:163]
v_mfma_f32_16x16x32_bf16 v[164:167], v[40:43], a[184:187], v[164:167]
v_mfma_f32_16x16x32_bf16 v[160:163], v[44:47], a[156:159], v[160:163]
v_mfma_f32_16x16x32_bf16 v[164:167], v[44:47], a[188:191], v[164:167]
v_mfma_f32_16x16x32_bf16 v[168:171], a[0:3], v[48:51], 0
v_mfma_f32_16x16x32_bf16 v[172:175], a[32:35], v[48:51], 0
buffer_load_dwordx4 v[112:115], v2, s[8:11], s45 offen offset:0 sc1
v_mfma_f32_16x16x32_bf16 v[168:171], a[4:7], v[52:55], v[168:171]
v_mfma_f32_16x16x32_bf16 v[172:175], a[36:39], v[52:55], v[172:175]
v_mfma_f32_16x16x32_bf16 v[168:171], a[8:11], v[56:59], v[168:171]
s_nop 0
ds_write_b128 v2, v[160:163] offset:4096
v_mfma_f32_16x16x32_bf16 v[172:175], a[40:43], v[56:59], v[172:175]
v_mfma_f32_16x16x32_bf16 v[168:171], a[12:15], v[60:63], v[168:171]
buffer_load_dwordx4 v[116:119], v2, s[8:11], s45 offen offset:1024 sc1
v_mfma_f32_16x16x32_bf16 v[172:175], a[44:47], v[60:63], v[172:175]
ds_write_b128 v2, v[164:167] offset:5120
v_mfma_f32_16x16x32_bf16 v[168:171], a[16:19], v[64:67], v[168:171]
v_mfma_f32_16x16x32_bf16 v[172:175], a[48:51], v[64:67], v[172:175]
v_mfma_f32_16x16x32_bf16 v[168:171], a[20:23], v[68:71], v[168:171]
v_mfma_f32_16x16x32_bf16 v[172:175], a[52:55], v[68:71], v[172:175]
buffer_load_dwordx4 v[120:123], v2, s[8:11], s45 offen offset:2048 sc1
v_mfma_f32_16x16x32_bf16 v[168:171], a[24:27], v[72:75], v[168:171]
v_mfma_f32_16x16x32_bf16 v[172:175], a[56:59], v[72:75], v[172:175]
v_mfma_f32_16x16x32_bf16 v[168:171], a[28:31], v[76:79], v[168:171]
v_mfma_f32_16x16x32_bf16 v[172:175], a[60:63], v[76:79], v[172:175]
v_mfma_f32_16x16x32_bf16 v[176:179], a[64:67], v[48:51], 0
buffer_load_dwordx4 v[124:127], v2, s[8:11], s45 offen offset:3072 sc1
v_mfma_f32_16x16x32_bf16 v[180:183], a[96:99], v[48:51], 0
v_mfma_f32_16x16x32_bf16 v[176:179], a[68:71], v[52:55], v[176:179]
v_mfma_f32_16x16x32_bf16 v[180:183], a[100:103], v[52:55], v[180:183]
v_mfma_f32_16x16x32_bf16 v[176:179], a[72:75], v[56:59], v[176:179]
s_nop 0
ds_write_b128 v2, v[168:171] offset:6144
v_mfma_f32_16x16x32_bf16 v[180:183], a[104:107], v[56:59], v[180:183]
buffer_load_dwordx4 v[128:131], v5, s[8:11], s45 offen offset:0 sc1
v_mfma_f32_16x16x32_bf16 v[176:179], a[76:79], v[60:63], v[176:179]
v_mfma_f32_16x16x32_bf16 v[180:183], a[108:111], v[60:63], v[180:183]
ds_write_b128 v2, v[172:175] offset:7168
v_mfma_f32_16x16x32_bf16 v[176:179], a[80:83], v[64:67], v[176:179]
v_mfma_f32_16x16x32_bf16 v[180:183], a[112:115], v[64:67], v[180:183]
v_mfma_f32_16x16x32_bf16 v[176:179], a[84:87], v[68:71], v[176:179]
buffer_load_dwordx4 v[132:135], v5, s[8:11], s45 offen offset:1024 sc1
v_mfma_f32_16x16x32_bf16 v[180:183], a[116:119], v[68:71], v[180:183]
v_mfma_f32_16x16x32_bf16 v[176:179], a[88:91], v[72:75], v[176:179]
v_mfma_f32_16x16x32_bf16 v[180:183], a[120:123], v[72:75], v[180:183]
v_mfma_f32_16x16x32_bf16 v[176:179], a[92:95], v[76:79], v[176:179]
v_mfma_f32_16x16x32_bf16 v[180:183], a[124:127], v[76:79], v[180:183]
buffer_load_dwordx4 v[136:139], v5, s[8:11], s45 offen offset:2048 sc1
v_mfma_f32_16x16x32_bf16 v[184:187], v[48:51], a[128:131], 0
v_mfma_f32_16x16x32_bf16 v[188:191], v[48:51], a[160:163], 0
v_mfma_f32_16x16x32_bf16 v[184:187], v[52:55], a[132:135], v[184:187]
v_mfma_f32_16x16x32_bf16 v[188:191], v[52:55], a[164:167], v[188:191]
v_mfma_f32_16x16x32_bf16 v[184:187], v[56:59], a[136:139], v[184:187]
buffer_load_dwordx4 v[140:143], v5, s[8:11], s45 offen offset:3072 sc1
ds_write_b128 v2, v[176:179] offset:8192
v_mfma_f32_16x16x32_bf16 v[188:191], v[56:59], a[168:171], v[188:191]
s_mov_b32 m0, s68
v_mfma_f32_16x16x32_bf16 v[184:187], v[60:63], a[140:143], v[184:187]
buffer_load_dwordx4 v243, s[12:15], s69 offen lds
v_mfma_f32_16x16x32_bf16 v[188:191], v[60:63], a[172:175], v[188:191]
s_add_u32 s68, s68, s70
s_add_u32 s69, s69, s71
ds_write_b128 v2, v[180:183] offset:9216
v_mfma_f32_16x16x32_bf16 v[184:187], v[64:67], a[144:147], v[184:187]
v_mfma_f32_16x16x32_bf16 v[188:191], v[64:67], a[176:179], v[188:191]
v_mfma_f32_16x16x32_bf16 v[184:187], v[68:71], a[148:151], v[184:187]
v_mfma_f32_16x16x32_bf16 v[188:191], v[68:71], a[180:183], v[188:191]
v_mfma_f32_16x16x32_bf16 v[184:187], v[72:75], a[152:155], v[184:187]
v_mfma_f32_16x16x32_bf16 v[188:191], v[72:75], a[184:187], v[188:191]
v_mfma_f32_16x16x32_bf16 v[184:187], v[76:79], a[156:159], v[184:187]
v_mfma_f32_16x16x32_bf16 v[188:191], v[76:79], a[188:191], v[188:191]
s_nop 6
ds_write_b128 v2, v[184:187] offset:10240
ds_write_b128 v2, v[188:191] offset:11264
s_add_u32 s61, s61, 0x100000
s_waitcnt lgkmcnt(0)
s_barrier
s_add_u32 s54, s54, 0x10000
s_cmp_eq_u32 s52, 58
s_cselect_b32 s45, 0x400000, 0
s_sub_u32 s54, s54, s45
s_add_u32 s45, s54, 0x8000
s_waitcnt vmcnt(10)
v_mfma_f32_16x16x32_bf16 v[144:147], a[0:3], v[80:83], 0
ds_read_b128 v[192:195], v2 offset:0
v_mfma_f32_16x16x32_bf16 v[148:151], a[32:35], v[80:83], 0
buffer_load_dwordx4 v[16:19], v2, s[8:11], s54 offen offset:0 sc1
ds_read_b128 v[196:199], v2 offset:12288
v_mfma_f32_16x16x32_bf16 v[144:147], a[4:7], v[84:87], v[144:147]
buffer_load_dwordx4 a[224:227], v3, s[24:27], s61 offen offset:0
ds_read_b128 v[200:203], v2 offset:24576
v_mfma_f32_16x16x32_bf16 v[148:151], a[36:39], v[84:87], v[148:151]
ds_read_b128 v[204:207], v2 offset:36864
v_mfma_f32_16x16x32_bf16 v[144:147], a[8:11], v[88:91], v[144:147]
.if \sf == 0
buffer_store_dwordx4 a[192:195], v2, s[8:11], s62 offen offset:0
.else
buffer_store_dwordx4 a[192:195], v2, s[8:11], s62 offen offset:0 sc1
.endif
ds_read_b128 v[208:211], v2 offset:1024
v_mfma_f32_16x16x32_bf16 v[148:151], a[40:43], v[88:91], v[148:151]
ds_read_b128 v[212:215], v2 offset:13312
v_mfma_f32_16x16x32_bf16 v[144:147], a[12:15], v[92:95], v[144:147]
buffer_load_dwordx4 v[20:23], v2, s[8:11], s54 offen offset:1024 sc1
buffer_load_dwordx4 a[228:231], v3, s[24:27], s61 offen offset:16
v_mfma_f32_16x16x32_bf16 v[148:151], a[44:47], v[92:95], v[148:151]
ds_read_b128 v[216:219], v2 offset:25600
v_mfma_f32_16x16x32_bf16 v[144:147], a[16:19], v[96:99], v[144:147]
.if \sf == 0
buffer_store_dwordx4 a[196:199], v2, s[8:11], s62 offen offset:1024
.else
buffer_store_dwordx4 a[196:199], v2, s[8:11], s62 offen offset:1024 sc1
.endif
ds_read_b128 v[220:223], v2 offset:37888
v_mfma_f32_16x16x32_bf16 v[148:151], a[48:51], v[96:99], v[148:151]
v_mfma_f32_16x16x32_bf16 v[144:147], a[20:23], v[100:103], v[144:147]
buffer_load_dwordx4 a[232:235], v3, s[24:27], s61 offen offset:128
v_mfma_f32_16x16x32_bf16 v[148:151], a[52:55], v[100:103], v[148:151]
buffer_load_dwordx4 v[24:27], v2, s[8:11], s54 offen offset:2048 sc1
v_mfma_f32_16x16x32_bf16 v[144:147], a[24:27], v[104:107], v[144:147]
.if \sf == 0
buffer_store_dwordx4 a[200:203], v2, s[8:11], s62 offen offset:2048
.else
buffer_store_dwordx4 a[200:203], v2, s[8:11], s62 offen offset:2048 sc1
.endif
v_mfma_f32_16x16x32_bf16 v[148:151], a[56:59], v[104:107], v[148:151]
v_mfma_f32_16x16x32_bf16 v[144:147], a[28:31], v[108:111], v[144:147]
buffer_load_dwordx4 a[236:239], v3, s[24:27], s61 offen offset:144
s_waitcnt lgkmcnt(0)
v_mfma_f32_16x16x32_bf16 v[148:151], a[60:63], v[108:111], v[148:151]
v_add_f32 v192, v192, v196
v_add_f32 v200, v200, v204
v_mfma_f32_16x16x32_bf16 v[152:155], a[64:67], v[80:83], 0
buffer_load_dwordx4 v[28:31], v2, s[8:11], s54 offen offset:3072 sc1
.if \sf == 0
buffer_store_dwordx4 a[204:207], v2, s[8:11], s62 offen offset:3072
.else
buffer_store_dwordx4 a[204:207], v2, s[8:11], s62 offen offset:3072 sc1
.endif
v_mfma_f32_16x16x32_bf16 v[156:159], a[96:99], v[80:83], 0
v_add_f32 v193, v193, v197
v_add_f32 v201, v201, v205
v_mfma_f32_16x16x32_bf16 v[152:155], a[68:71], v[84:87], v[152:155]
buffer_load_dwordx4 a[240:243], v3, s[24:27], s61 offen offset:256
v_add_f32 v194, v194, v198
v_mfma_f32_16x16x32_bf16 v[156:159], a[100:103], v[84:87], v[156:159]
v_add_f32 v202, v202, v206
v_add_f32 v195, v195, v199
v_mfma_f32_16x16x32_bf16 v[152:155], a[72:75], v[88:91], v[152:155]
.if \sf == 0
buffer_store_dwordx4 a[208:211], v5, s[8:11], s62 offen offset:0
.else
buffer_store_dwordx4 a[208:211], v5, s[8:11], s62 offen offset:0 sc1
.endif
ds_write_b128 v2, v[144:147] offset:49152
v_mfma_f32_16x16x32_bf16 v[156:159], a[104:107], v[88:91], v[156:159]
buffer_load_dwordx4 v[32:35], v5, s[8:11], s54 offen offset:0 sc1
v_add_f32 v203, v203, v207
v_mfma_f32_16x16x32_bf16 v[152:155], a[76:79], v[92:95], v[152:155]
buffer_load_dwordx4 a[244:247], v3, s[24:27], s61 offen offset:272
v_add_f32 v192, v192, v200
v_mfma_f32_16x16x32_bf16 v[156:159], a[108:111], v[92:95], v[156:159]
ds_write_b128 v2, v[148:151] offset:50176
v_add_f32 v193, v193, v201
v_mfma_f32_16x16x32_bf16 v[152:155], a[80:83], v[96:99], v[152:155]
.if \sf == 0
buffer_store_dwordx4 a[212:215], v5, s[8:11], s62 offen offset:1024
.else
buffer_store_dwordx4 a[212:215], v5, s[8:11], s62 offen offset:1024 sc1
.endif
v_add_f32 v194, v194, v202
v_mfma_f32_16x16x32_bf16 v[156:159], a[112:115], v[96:99], v[156:159]
v_add_f32 v195, v195, v203
v_cvt_pk_bf16_f32 v224, v192, v193
v_mfma_f32_16x16x32_bf16 v[152:155], a[84:87], v[100:103], v[152:155]
buffer_load_dwordx4 v[36:39], v5, s[8:11], s54 offen offset:1024 sc1
buffer_load_dwordx4 a[248:251], v3, s[24:27], s61 offen offset:384
v_mfma_f32_16x16x32_bf16 v[156:159], a[116:119], v[100:103], v[156:159]
v_cvt_pk_bf16_f32 v225, v194, v195
v_add_f32 v208, v208, v212
v_mfma_f32_16x16x32_bf16 v[152:155], a[88:91], v[104:107], v[152:155]
.if \sf == 0
buffer_store_dwordx4 a[216:219], v5, s[8:11], s62 offen offset:2048
.else
buffer_store_dwordx4 a[216:219], v5, s[8:11], s62 offen offset:2048 sc1
.endif
v_add_f32 v216, v216, v220
v_mfma_f32_16x16x32_bf16 v[156:159], a[120:123], v[104:107], v[156:159]
v_add_f32 v209, v209, v213
v_add_f32 v217, v217, v221
v_mfma_f32_16x16x32_bf16 v[152:155], a[92:95], v[108:111], v[152:155]
buffer_load_dwordx4 a[252:255], v3, s[24:27], s61 offen offset:400
v_add_f32 v210, v210, v214
v_mfma_f32_16x16x32_bf16 v[156:159], a[124:127], v[108:111], v[156:159]
buffer_load_dwordx4 v[40:43], v5, s[8:11], s54 offen offset:2048 sc1
v_add_f32 v218, v218, v222
v_mfma_f32_16x16x32_bf16 v[160:163], v[80:83], a[128:131], 0
.if \sf == 0
buffer_store_dwordx4 a[220:223], v5, s[8:11], s62 offen offset:3072
.else
buffer_store_dwordx4 a[220:223], v5, s[8:11], s62 offen offset:3072 sc1
.endif
v_add_f32 v211, v211, v215
v_mfma_f32_16x16x32_bf16 v[164:167], v[80:83], a[160:163], 0
v_add_f32 v219, v219, v223
v_add_f32 v208, v208, v216
v_mfma_f32_16x16x32_bf16 v[160:163], v[84:87], a[132:135], v[160:163]
v_add_f32 v209, v209, v217
v_add_f32 v210, v210, v218
v_mfma_f32_16x16x32_bf16 v[164:167], v[84:87], a[164:167], v[164:167]
v_add_f32 v211, v211, v219
v_cvt_pk_bf16_f32 v226, v208, v209
v_mfma_f32_16x16x32_bf16 v[160:163], v[88:91], a[136:139], v[160:163]
buffer_load_dwordx4 v[44:47], v5, s[8:11], s54 offen offset:3072 sc1
ds_write_b128 v2, v[152:155] offset:51200
v_mfma_f32_16x16x32_bf16 v[164:167], v[88:91], a[168:171], v[164:167]
s_mov_b32 m0, s68
v_cvt_pk_bf16_f32 v227, v210, v211
v_mfma_f32_16x16x32_bf16 v[160:163], v[92:95], a[140:143], v[160:163]
buffer_load_dwordx4 v243, s[12:15], s69 offen lds
buffer_store_dwordx4 v[224:227], v2, s[8:11], s55 offen sc1
v_mfma_f32_16x16x32_bf16 v[164:167], v[92:95], a[172:175], v[164:167]
s_add_u32 s68, s68, s70
s_add_u32 s69, s69, s71
ds_write_b128 v2, v[156:159] offset:52224
v_mfma_f32_16x16x32_bf16 v[160:163], v[96:99], a[144:147], v[160:163]
ds_read_b128 v[192:195], v2 offset:6144
v_mfma_f32_16x16x32_bf16 v[164:167], v[96:99], a[176:179], v[164:167]
ds_read_b128 v[196:199], v2 offset:18432
v_mfma_f32_16x16x32_bf16 v[160:163], v[100:103], a[148:151], v[160:163]
ds_read_b128 v[200:203], v2 offset:30720
v_mfma_f32_16x16x32_bf16 v[164:167], v[100:103], a[180:183], v[164:167]
ds_read_b128 v[204:207], v2 offset:43008
v_mfma_f32_16x16x32_bf16 v[160:163], v[104:107], a[152:155], v[160:163]
ds_read_b128 v[208:211], v2 offset:7168
v_mfma_f32_16x16x32_bf16 v[164:167], v[104:107], a[184:187], v[164:167]
ds_read_b128 v[212:215], v2 offset:19456
v_mfma_f32_16x16x32_bf16 v[160:163], v[108:111], a[156:159], v[160:163]
ds_read_b128 v[216:219], v2 offset:31744
v_mfma_f32_16x16x32_bf16 v[164:167], v[108:111], a[188:191], v[164:167]
ds_read_b128 v[220:223], v2 offset:44032
s_waitcnt vmcnt(27)
v_mfma_f32_16x16x32_bf16 v[168:171], a[0:3], v[112:115], 0
v_mfma_f32_16x16x32_bf16 v[172:175], a[32:35], v[112:115], 0
buffer_load_dwordx4 v[48:51], v2, s[8:11], s45 offen offset:0 sc1
v_mfma_f32_16x16x32_bf16 v[168:171], a[4:7], v[116:119], v[168:171]
v_mfma_f32_16x16x32_bf16 v[172:175], a[36:39], v[116:119], v[172:175]
v_mfma_f32_16x16x32_bf16 v[168:171], a[8:11], v[120:123], v[168:171]
ds_write_b128 v2, v[160:163] offset:53248
v_mfma_f32_16x16x32_bf16 v[172:175], a[40:43], v[120:123], v[172:175]
s_waitcnt lgkmcnt(0)
v_add_f32 v192, v192, v196
v_mfma_f32_16x16x32_bf16 v[168:171], a[12:15], v[124:127], v[168:171]
buffer_load_dwordx4 v[52:55], v2, s[8:11], s45 offen offset:1024 sc1
v_add_f32 v200, v200, v204
v_mfma_f32_16x16x32_bf16 v[172:175], a[44:47], v[124:127], v[172:175]
ds_write_b128 v2, v[164:167] offset:54272
v_add_f32 v193, v193, v197
v_mfma_f32_16x16x32_bf16 v[168:171], a[16:19], v[128:131], v[168:171]
v_add_f32 v201, v201, v205
v_add_f32 v194, v194, v198
v_mfma_f32_16x16x32_bf16 v[172:175], a[48:51], v[128:131], v[172:175]
v_add_f32 v202, v202, v206
v_add_f32 v195, v195, v199
v_mfma_f32_16x16x32_bf16 v[168:171], a[20:23], v[132:135], v[168:171]
v_add_f32 v203, v203, v207
v_add_f32 v192, v192, v200
v_mfma_f32_16x16x32_bf16 v[172:175], a[52:55], v[132:135], v[172:175]
buffer_load_dwordx4 v[56:59], v2, s[8:11], s45 offen offset:2048 sc1
v_add_f32 v193, v193, v201
v_mfma_f32_16x16x32_bf16 v[168:171], a[24:27], v[136:139], v[168:171]
v_add_f32 v194, v194, v202
v_add_f32 v195, v195, v203
v_mfma_f32_16x16x32_bf16 v[172:175], a[56:59], v[136:139], v[172:175]
v_cvt_pk_bf16_f32 v228, v192, v193
v_cvt_pk_bf16_f32 v229, v194, v195
v_mfma_f32_16x16x32_bf16 v[168:171], a[28:31], v[140:143], v[168:171]
v_add_f32 v208, v208, v212
v_add_f32 v216, v216, v220
v_mfma_f32_16x16x32_bf16 v[172:175], a[60:63], v[140:143], v[172:175]
v_add_f32 v209, v209, v213
v_add_f32 v217, v217, v221
v_mfma_f32_16x16x32_bf16 v[176:179], a[64:67], v[112:115], 0
buffer_load_dwordx4 v[60:63], v2, s[8:11], s45 offen offset:3072 sc1
v_add_f32 v210, v210, v214
v_mfma_f32_16x16x32_bf16 v[180:183], a[96:99], v[112:115], 0
v_add_f32 v218, v218, v222
v_add_f32 v211, v211, v215
v_mfma_f32_16x16x32_bf16 v[176:179], a[68:71], v[116:119], v[176:179]
v_add_f32 v219, v219, v223
v_add_f32 v208, v208, v216
v_mfma_f32_16x16x32_bf16 v[180:183], a[100:103], v[116:119], v[180:183]
v_add_f32 v209, v209, v217
v_add_f32 v210, v210, v218
v_mfma_f32_16x16x32_bf16 v[176:179], a[72:75], v[120:123], v[176:179]
ds_write_b128 v2, v[168:171] offset:55296
v_add_f32 v211, v211, v219
v_mfma_f32_16x16x32_bf16 v[180:183], a[104:107], v[120:123], v[180:183]
buffer_load_dwordx4 v[64:67], v5, s[8:11], s45 offen offset:0 sc1
v_cvt_pk_bf16_f32 v230, v208, v209
v_mfma_f32_16x16x32_bf16 v[176:179], a[76:79], v[124:127], v[176:179]
v_cvt_pk_bf16_f32 v231, v210, v211
buffer_store_dwordx4 v[228:231], v5, s[8:11], s55 offen sc1
v_mfma_f32_16x16x32_bf16 v[180:183], a[108:111], v[124:127], v[180:183]
ds_write_b128 v2, v[172:175] offset:56320
v_mfma_f32_16x16x32_bf16 v[176:179], a[80:83], v[128:131], v[176:179]
v_mfma_f32_16x16x32_bf16 v[180:183], a[112:115], v[128:131], v[180:183]
v_mfma_f32_16x16x32_bf16 v[176:179], a[84:87], v[132:135], v[176:179]
buffer_load_dwordx4 v[68:71], v5, s[8:11], s45 offen offset:1024 sc1
v_mfma_f32_16x16x32_bf16 v[180:183], a[116:119], v[132:135], v[180:183]
v_mfma_f32_16x16x32_bf16 v[176:179], a[88:91], v[136:139], v[176:179]
v_mfma_f32_16x16x32_bf16 v[180:183], a[120:123], v[136:139], v[180:183]
v_mfma_f32_16x16x32_bf16 v[176:179], a[92:95], v[140:143], v[176:179]
v_mfma_f32_16x16x32_bf16 v[180:183], a[124:127], v[140:143], v[180:183]
buffer_load_dwordx4 v[72:75], v5, s[8:11], s45 offen offset:2048 sc1
v_mfma_f32_16x16x32_bf16 v[184:187], v[112:115], a[128:131], 0
v_mfma_f32_16x16x32_bf16 v[188:191], v[112:115], a[160:163], 0
v_mfma_f32_16x16x32_bf16 v[184:187], v[116:119], a[132:135], v[184:187]
v_mfma_f32_16x16x32_bf16 v[188:191], v[116:119], a[164:167], v[188:191]
v_mfma_f32_16x16x32_bf16 v[184:187], v[120:123], a[136:139], v[184:187]
buffer_load_dwordx4 v[76:79], v5, s[8:11], s45 offen offset:3072 sc1
ds_write_b128 v2, v[176:179] offset:57344
v_mfma_f32_16x16x32_bf16 v[188:191], v[120:123], a[168:171], v[188:191]
s_mov_b32 m0, s68
v_mfma_f32_16x16x32_bf16 v[184:187], v[124:127], a[140:143], v[184:187]
buffer_load_dwordx4 v243, s[12:15], s69 offen lds
v_mfma_f32_16x16x32_bf16 v[188:191], v[124:127], a[172:175], v[188:191]
s_add_u32 s68, s68, s70
s_add_u32 s69, s69, s71
ds_write_b128 v2, v[180:183] offset:58368
v_mfma_f32_16x16x32_bf16 v[184:187], v[128:131], a[144:147], v[184:187]
v_mfma_f32_16x16x32_bf16 v[188:191], v[128:131], a[176:179], v[188:191]
v_mfma_f32_16x16x32_bf16 v[184:187], v[132:135], a[148:151], v[184:187]
v_mfma_f32_16x16x32_bf16 v[188:191], v[132:135], a[180:183], v[188:191]
v_mfma_f32_16x16x32_bf16 v[184:187], v[136:139], a[152:155], v[184:187]
v_mfma_f32_16x16x32_bf16 v[188:191], v[136:139], a[184:187], v[188:191]
v_mfma_f32_16x16x32_bf16 v[184:187], v[140:143], a[156:159], v[184:187]
v_mfma_f32_16x16x32_bf16 v[188:191], v[140:143], a[188:191], v[188:191]
s_nop 6
ds_write_b128 v2, v[184:187] offset:59392
ds_write_b128 v2, v[188:191] offset:60416
s_add_u32 s55, s55, 0x40000
s_add_u32 s56, s56, 0x40000
s_add_u32 s57, s57, 0x40000
s_add_u32 s61, s61, 0x100000
s_add_u32 s62, s62, 0x100000
s_waitcnt vmcnt(4) lgkmcnt(0)
s_barrier
s_add_u32 s59, s59, 1
s_min_u32 s46, s59, 64
v_mov_b32 v6, s46
v_mov_b32 v7, 0
s_mov_b64 exec, 1
buffer_store_dword v6, v7, s[8:11], s58 offen sc1
s_mov_b64 exec, -1
s_add_u32 s54, s54, 0x10000
s_add_u32 s45, s54, 0x8000
s_waitcnt vmcnt(12)
v_mfma_f32_16x16x32_bf16 v[144:147], a[0:3], v[16:19], 0
ds_read_b128 v[192:195], v2 offset:49152
v_mfma_f32_16x16x32_bf16 v[148:151], a[32:35], v[16:19], 0
buffer_load_dwordx4 v[80:83], v2, s[8:11], s54 offen offset:0 sc1
ds_read_b128 v[196:199], v2 offset:61440
v_mfma_f32_16x16x32_bf16 v[144:147], a[4:7], v[20:23], v[144:147]
buffer_load_dwordx4 a[192:195], v3, s[24:27], s61 offen offset:0
ds_read_b128 v[200:203], v4 offset:24576
v_mfma_f32_16x16x32_bf16 v[148:151], a[36:39], v[20:23], v[148:151]
ds_read_b128 v[204:207], v4 offset:36864
v_mfma_f32_16x16x32_bf16 v[144:147], a[8:11], v[24:27], v[144:147]
.if \sf == 0
buffer_store_dwordx4 a[224:227], v2, s[8:11], s62 offen offset:0
.else
buffer_store_dwordx4 a[224:227], v2, s[8:11], s62 offen offset:0 sc1
.endif
ds_read_b128 v[208:211], v2 offset:50176
v_mfma_f32_16x16x32_bf16 v[148:151], a[40:43], v[24:27], v[148:151]
ds_read_b128 v[212:215], v2 offset:62464
v_mfma_f32_16x16x32_bf16 v[144:147], a[12:15], v[28:31], v[144:147]
buffer_load_dwordx4 v[84:87], v2, s[8:11], s54 offen offset:1024 sc1
buffer_load_dwordx4 a[196:199], v3, s[24:27], s61 offen offset:16
v_mfma_f32_16x16x32_bf16 v[148:151], a[44:47], v[28:31], v[148:151]
ds_read_b128 v[216:219], v4 offset:25600
v_mfma_f32_16x16x32_bf16 v[144:147], a[16:19], v[32:35], v[144:147]
.if \sf == 0
buffer_store_dwordx4 a[228:231], v2, s[8:11], s62 offen offset:1024
.else
buffer_store_dwordx4 a[228:231], v2, s[8:11], s62 offen offset:1024 sc1
.endif
ds_read_b128 v[220:223], v4 offset:37888
v_mfma_f32_16x16x32_bf16 v[148:151], a[48:51], v[32:35], v[148:151]
v_mfma_f32_16x16x32_bf16 v[144:147], a[20:23], v[36:39], v[144:147]
buffer_load_dwordx4 a[200:203], v3, s[24:27], s61 offen offset:128
v_mfma_f32_16x16x32_bf16 v[148:151], a[52:55], v[36:39], v[148:151]
buffer_load_dwordx4 v[88:91], v2, s[8:11], s54 offen offset:2048 sc1
v_mfma_f32_16x16x32_bf16 v[144:147], a[24:27], v[40:43], v[144:147]
.if \sf == 0
buffer_store_dwordx4 a[232:235], v2, s[8:11], s62 offen offset:2048
.else
buffer_store_dwordx4 a[232:235], v2, s[8:11], s62 offen offset:2048 sc1
.endif
v_mfma_f32_16x16x32_bf16 v[148:151], a[56:59], v[40:43], v[148:151]
v_mfma_f32_16x16x32_bf16 v[144:147], a[28:31], v[44:47], v[144:147]
buffer_load_dwordx4 a[204:207], v3, s[24:27], s61 offen offset:144
s_waitcnt lgkmcnt(0)
v_mfma_f32_16x16x32_bf16 v[148:151], a[60:63], v[44:47], v[148:151]
v_add_f32 v192, v192, v196
v_add_f32 v200, v200, v204
v_mfma_f32_16x16x32_bf16 v[152:155], a[64:67], v[16:19], 0
buffer_load_dwordx4 v[92:95], v2, s[8:11], s54 offen offset:3072 sc1
.if \sf == 0
buffer_store_dwordx4 a[236:239], v2, s[8:11], s62 offen offset:3072
.else
buffer_store_dwordx4 a[236:239], v2, s[8:11], s62 offen offset:3072 sc1
.endif
v_mfma_f32_16x16x32_bf16 v[156:159], a[96:99], v[16:19], 0
v_add_f32 v193, v193, v197
v_add_f32 v201, v201, v205
v_mfma_f32_16x16x32_bf16 v[152:155], a[68:71], v[20:23], v[152:155]
buffer_load_dwordx4 a[208:211], v3, s[24:27], s61 offen offset:256
v_add_f32 v194, v194, v198
v_mfma_f32_16x16x32_bf16 v[156:159], a[100:103], v[20:23], v[156:159]
v_add_f32 v202, v202, v206
v_add_f32 v195, v195, v199
v_mfma_f32_16x16x32_bf16 v[152:155], a[72:75], v[24:27], v[152:155]
.if \sf == 0
buffer_store_dwordx4 a[240:243], v5, s[8:11], s62 offen offset:0
.else
buffer_store_dwordx4 a[240:243], v5, s[8:11], s62 offen offset:0 sc1
.endif
ds_write_b128 v2, v[144:147] offset:0
v_mfma_f32_16x16x32_bf16 v[156:159], a[104:107], v[24:27], v[156:159]
buffer_load_dwordx4 v[96:99], v5, s[8:11], s54 offen offset:0 sc1
v_add_f32 v203, v203, v207
v_mfma_f32_16x16x32_bf16 v[152:155], a[76:79], v[28:31], v[152:155]
buffer_load_dwordx4 a[212:215], v3, s[24:27], s61 offen offset:272
v_add_f32 v192, v192, v200
v_mfma_f32_16x16x32_bf16 v[156:159], a[108:111], v[28:31], v[156:159]
ds_write_b128 v2, v[148:151] offset:1024
v_add_f32 v193, v193, v201
v_mfma_f32_16x16x32_bf16 v[152:155], a[80:83], v[32:35], v[152:155]
.if \sf == 0
buffer_store_dwordx4 a[244:247], v5, s[8:11], s62 offen offset:1024
.else
buffer_store_dwordx4 a[244:247], v5, s[8:11], s62 offen offset:1024 sc1
.endif
v_add_f32 v194, v194, v202
v_mfma_f32_16x16x32_bf16 v[156:159], a[112:115], v[32:35], v[156:159]
v_add_f32 v195, v195, v203
v_cvt_pk_bf16_f32 v224, v192, v193
v_mfma_f32_16x16x32_bf16 v[152:155], a[84:87], v[36:39], v[152:155]
buffer_load_dwordx4 v[100:103], v5, s[8:11], s54 offen offset:1024 sc1
buffer_load_dwordx4 a[216:219], v3, s[24:27], s61 offen offset:384
v_mfma_f32_16x16x32_bf16 v[156:159], a[116:119], v[36:39], v[156:159]
v_cvt_pk_bf16_f32 v225, v194, v195
v_add_f32 v208, v208, v212
v_mfma_f32_16x16x32_bf16 v[152:155], a[88:91], v[40:43], v[152:155]
.if \sf == 0
buffer_store_dwordx4 a[248:251], v5, s[8:11], s62 offen offset:2048
.else
buffer_store_dwordx4 a[248:251], v5, s[8:11], s62 offen offset:2048 sc1
.endif
v_add_f32 v216, v216, v220
v_mfma_f32_16x16x32_bf16 v[156:159], a[120:123], v[40:43], v[156:159]
v_add_f32 v209, v209, v213
v_add_f32 v217, v217, v221
v_mfma_f32_16x16x32_bf16 v[152:155], a[92:95], v[44:47], v[152:155]
buffer_load_dwordx4 a[220:223], v3, s[24:27], s61 offen offset:400
v_add_f32 v210, v210, v214
v_mfma_f32_16x16x32_bf16 v[156:159], a[124:127], v[44:47], v[156:159]
buffer_load_dwordx4 v[104:107], v5, s[8:11], s54 offen offset:2048 sc1
v_add_f32 v218, v218, v222
v_mfma_f32_16x16x32_bf16 v[160:163], v[16:19], a[128:131], 0
.if \sf == 0
buffer_store_dwordx4 a[252:255], v5, s[8:11], s62 offen offset:3072
.else
buffer_store_dwordx4 a[252:255], v5, s[8:11], s62 offen offset:3072 sc1
.endif
v_add_f32 v211, v211, v215
v_mfma_f32_16x16x32_bf16 v[164:167], v[16:19], a[160:163], 0
v_add_f32 v219, v219, v223
v_add_f32 v208, v208, v216
v_mfma_f32_16x16x32_bf16 v[160:163], v[20:23], a[132:135], v[160:163]
v_add_f32 v209, v209, v217
v_add_f32 v210, v210, v218
v_mfma_f32_16x16x32_bf16 v[164:167], v[20:23], a[164:167], v[164:167]
v_add_f32 v211, v211, v219
v_cvt_pk_bf16_f32 v226, v208, v209
v_mfma_f32_16x16x32_bf16 v[160:163], v[24:27], a[136:139], v[160:163]
buffer_load_dwordx4 v[108:111], v5, s[8:11], s54 offen offset:3072 sc1
ds_write_b128 v2, v[152:155] offset:2048
v_mfma_f32_16x16x32_bf16 v[164:167], v[24:27], a[168:171], v[164:167]
s_mov_b32 m0, s68
v_cvt_pk_bf16_f32 v227, v210, v211
v_mfma_f32_16x16x32_bf16 v[160:163], v[28:31], a[140:143], v[160:163]
buffer_load_dwordx4 v243, s[12:15], s69 offen lds
buffer_store_dwordx4 v[224:227], v2, s[8:11], s55 offen sc1
v_mfma_f32_16x16x32_bf16 v[164:167], v[28:31], a[172:175], v[164:167]
s_add_u32 s68, s68, s70
s_add_u32 s69, s69, s71
ds_write_b128 v2, v[156:159] offset:3072
v_mfma_f32_16x16x32_bf16 v[160:163], v[32:35], a[144:147], v[160:163]
v_mfma_f32_16x16x32_bf16 v[164:167], v[32:35], a[176:179], v[164:167]
v_mfma_f32_16x16x32_bf16 v[160:163], v[36:39], a[148:151], v[160:163]
v_mfma_f32_16x16x32_bf16 v[164:167], v[36:39], a[180:183], v[164:167]
v_mfma_f32_16x16x32_bf16 v[160:163], v[40:43], a[152:155], v[160:163]
v_mfma_f32_16x16x32_bf16 v[164:167], v[40:43], a[184:187], v[164:167]
v_mfma_f32_16x16x32_bf16 v[160:163], v[44:47], a[156:159], v[160:163]
v_mfma_f32_16x16x32_bf16 v[164:167], v[44:47], a[188:191], v[164:167]
s_waitcnt vmcnt(27)
v_mfma_f32_16x16x32_bf16 v[168:171], a[0:3], v[48:51], 0
v_mfma_f32_16x16x32_bf16 v[172:175], a[32:35], v[48:51], 0
buffer_load_dwordx4 v[112:115], v2, s[8:11], s45 offen offset:0 sc1
v_mfma_f32_16x16x32_bf16 v[168:171], a[4:7], v[52:55], v[168:171]
v_mfma_f32_16x16x32_bf16 v[172:175], a[36:39], v[52:55], v[172:175]
v_mfma_f32_16x16x32_bf16 v[168:171], a[8:11], v[56:59], v[168:171]
ds_write_b128 v2, v[160:163] offset:4096
v_mfma_f32_16x16x32_bf16 v[172:175], a[40:43], v[56:59], v[172:175]
v_mfma_f32_16x16x32_bf16 v[168:171], a[12:15], v[60:63], v[168:171]
buffer_load_dwordx4 v[116:119], v2, s[8:11], s45 offen offset:1024 sc1
v_mfma_f32_16x16x32_bf16 v[172:175], a[44:47], v[60:63], v[172:175]
ds_write_b128 v2, v[164:167] offset:5120
v_mfma_f32_16x16x32_bf16 v[168:171], a[16:19], v[64:67], v[168:171]
v_mfma_f32_16x16x32_bf16 v[172:175], a[48:51], v[64:67], v[172:175]
v_mfma_f32_16x16x32_bf16 v[168:171], a[20:23], v[68:71], v[168:171]
v_mfma_f32_16x16x32_bf16 v[172:175], a[52:55], v[68:71], v[172:175]
buffer_load_dwordx4 v[120:123], v2, s[8:11], s45 offen offset:2048 sc1
v_mfma_f32_16x16x32_bf16 v[168:171], a[24:27], v[72:75], v[168:171]
v_mfma_f32_16x16x32_bf16 v[172:175], a[56:59], v[72:75], v[172:175]
v_mfma_f32_16x16x32_bf16 v[168:171], a[28:31], v[76:79], v[168:171]
v_mfma_f32_16x16x32_bf16 v[172:175], a[60:63], v[76:79], v[172:175]
v_mfma_f32_16x16x32_bf16 v[176:179], a[64:67], v[48:51], 0
buffer_load_dwordx4 v[124:127], v2, s[8:11], s45 offen offset:3072 sc1
v_mfma_f32_16x16x32_bf16 v[180:183], a[96:99], v[48:51], 0
v_mfma_f32_16x16x32_bf16 v[176:179], a[68:71], v[52:55], v[176:179]
v_mfma_f32_16x16x32_bf16 v[180:183], a[100:103], v[52:55], v[180:183]
v_mfma_f32_16x16x32_bf16 v[176:179], a[72:75], v[56:59], v[176:179]
s_nop 0
ds_write_b128 v2, v[168:171] offset:6144
v_mfma_f32_16x16x32_bf16 v[180:183], a[104:107], v[56:59], v[180:183]
buffer_load_dwordx4 v[128:131], v5, s[8:11], s45 offen offset:0 sc1
v_mfma_f32_16x16x32_bf16 v[176:179], a[76:79], v[60:63], v[176:179]
v_mfma_f32_16x16x32_bf16 v[180:183], a[108:111], v[60:63], v[180:183]
ds_write_b128 v2, v[172:175] offset:7168
v_mfma_f32_16x16x32_bf16 v[176:179], a[80:83], v[64:67], v[176:179]
v_mfma_f32_16x16x32_bf16 v[180:183], a[112:115], v[64:67], v[180:183]
v_mfma_f32_16x16x32_bf16 v[176:179], a[84:87], v[68:71], v[176:179]
buffer_load_dwordx4 v[132:135], v5, s[8:11], s45 offen offset:1024 sc1
v_mfma_f32_16x16x32_bf16 v[180:183], a[116:119], v[68:71], v[180:183]
v_mfma_f32_16x16x32_bf16 v[176:179], a[88:91], v[72:75], v[176:179]
v_mfma_f32_16x16x32_bf16 v[180:183], a[120:123], v[72:75], v[180:183]
v_mfma_f32_16x16x32_bf16 v[176:179], a[92:95], v[76:79], v[176:179]
v_mfma_f32_16x16x32_bf16 v[180:183], a[124:127], v[76:79], v[180:183]
buffer_load_dwordx4 v[136:139], v5, s[8:11], s45 offen offset:2048 sc1
v_mfma_f32_16x16x32_bf16 v[184:187], v[48:51], a[128:131], 0
v_mfma_f32_16x16x32_bf16 v[188:191], v[48:51], a[160:163], 0
v_mfma_f32_16x16x32_bf16 v[184:187], v[52:55], a[132:135], v[184:187]
v_mfma_f32_16x16x32_bf16 v[188:191], v[52:55], a[164:167], v[188:191]
v_mfma_f32_16x16x32_bf16 v[184:187], v[56:59], a[136:139], v[184:187]
buffer_load_dwordx4 v[140:143], v5, s[8:11], s45 offen offset:3072 sc1
ds_write_b128 v2, v[176:179] offset:8192
v_mfma_f32_16x16x32_bf16 v[188:191], v[56:59], a[168:171], v[188:191]
s_mov_b32 m0, s68
v_mfma_f32_16x16x32_bf16 v[184:187], v[60:63], a[140:143], v[184:187]
buffer_load_dwordx4 v243, s[12:15], s69 offen lds
v_mfma_f32_16x16x32_bf16 v[188:191], v[60:63], a[172:175], v[188:191]
s_add_u32 s68, s68, s70
s_add_u32 s69, s69, s71
ds_write_b128 v2, v[180:183] offset:9216
v_mfma_f32_16x16x32_bf16 v[184:187], v[64:67], a[144:147], v[184:187]
v_mfma_f32_16x16x32_bf16 v[188:191], v[64:67], a[176:179], v[188:191]
v_mfma_f32_16x16x32_bf16 v[184:187], v[68:71], a[148:151], v[184:187]
v_mfma_f32_16x16x32_bf16 v[188:191], v[68:71], a[180:183], v[188:191]
v_mfma_f32_16x16x32_bf16 v[184:187], v[72:75], a[152:155], v[184:187]
v_mfma_f32_16x16x32_bf16 v[188:191], v[72:75], a[184:187], v[188:191]
v_mfma_f32_16x16x32_bf16 v[184:187], v[76:79], a[156:159], v[184:187]
v_mfma_f32_16x16x32_bf16 v[188:191], v[76:79], a[188:191], v[188:191]
s_nop 6
ds_write_b128 v2, v[184:187] offset:10240
ds_write_b128 v2, v[188:191] offset:11264
s_add_u32 s55, s55, 0x40000
s_add_u32 s56, s56, 0x40000
s_add_u32 s57, s57, 0x40000
s_cmp_eq_u32 s52, 60
s_cselect_b32 s45, 0x1000000, 0
s_sub_u32 s55, s55, s45
s_sub_u32 s56, s56, s45
s_sub_u32 s57, s57, s45
s_add_u32 s61, s61, 0x100000
s_add_u32 s62, s62, 0x100000
s_waitcnt vmcnt(9) lgkmcnt(0)
s_barrier
s_add_u32 s59, s59, 1
s_min_u32 s46, s59, 64
v_mov_b32 v6, s46
v_mov_b32 v7, 0
s_mov_b64 exec, 1
buffer_store_dword v6, v7, s[8:11], s58 offen sc1
s_mov_b64 exec, -1
s_add_u32 s54, s54, 0x10000
s_cmp_eq_u32 s52, 58
s_cselect_b32 s45, 0x400000, 0
s_sub_u32 s54, s54, s45
s_add_u32 s45, s54, 0x8000
s_waitcnt vmcnt(11)
v_mfma_f32_16x16x32_bf16 v[144:147], a[0:3], v[80:83], 0
ds_read_b128 v[192:195], v2 offset:0
v_mfma_f32_16x16x32_bf16 v[148:151], a[32:35], v[80:83], 0
buffer_load_dwordx4 v[16:19], v2, s[8:11], s54 offen offset:0 sc1
ds_read_b128 v[196:199], v2 offset:12288
v_mfma_f32_16x16x32_bf16 v[144:147], a[4:7], v[84:87], v[144:147]
ds_read_b128 v[200:203], v2 offset:24576
v_mfma_f32_16x16x32_bf16 v[148:151], a[36:39], v[84:87], v[148:151]
ds_read_b128 v[204:207], v2 offset:36864
v_mfma_f32_16x16x32_bf16 v[144:147], a[8:11], v[88:91], v[144:147]
.if \sf == 0
buffer_store_dwordx4 a[192:195], v2, s[8:11], s62 offen offset:0
.else
buffer_store_dwordx4 a[192:195], v2, s[8:11], s62 offen offset:0 sc1
.endif
ds_read_b128 v[208:211], v2 offset:1024
v_mfma_f32_16x16x32_bf16 v[148:151], a[40:43], v[88:91], v[148:151]
ds_read_b128 v[212:215], v2 offset:13312
v_mfma_f32_16x16x32_bf16 v[144:147], a[12:15], v[92:95], v[144:147]
buffer_load_dwordx4 v[20:23], v2, s[8:11], s54 offen offset:1024 sc1
ds_read_b128 v[216:219], v2 offset:25600
v_mfma_f32_16x16x32_bf16 v[148:151], a[44:47], v[92:95], v[148:151]
ds_read_b128 v[220:223], v2 offset:37888
v_mfma_f32_16x16x32_bf16 v[144:147], a[16:19], v[96:99], v[144:147]
.if \sf == 0
buffer_store_dwordx4 a[196:199], v2, s[8:11], s62 offen offset:1024
.else
buffer_store_dwordx4 a[196:199], v2, s[8:11], s62 offen offset:1024 sc1
.endif
v_mfma_f32_16x16x32_bf16 v[148:151], a[48:51], v[96:99], v[148:151]
v_mfma_f32_16x16x32_bf16 v[144:147], a[20:23], v[100:103], v[144:147]
v_mfma_f32_16x16x32_bf16 v[148:151], a[52:55], v[100:103], v[148:151]
buffer_load_dwordx4 v[24:27], v2, s[8:11], s54 offen offset:2048 sc1
v_mfma_f32_16x16x32_bf16 v[144:147], a[24:27], v[104:107], v[144:147]
.if \sf == 0
buffer_store_dwordx4 a[200:203], v2, s[8:11], s62 offen offset:2048
.else
buffer_store_dwordx4 a[200:203], v2, s[8:11], s62 offen offset:2048 sc1
.endif
v_mfma_f32_16x16x32_bf16 v[148:151], a[56:59], v[104:107], v[148:151]
s_waitcnt lgkmcnt(0)
v_add_f32 v192, v192, v196
v_mfma_f32_16x16x32_bf16 v[144:147], a[28:31], v[108:111], v[144:147]
v_add_f32 v200, v200, v204
v_add_f32 v193, v193, v197
v_mfma_f32_16x16x32_bf16 v[148:151], a[60:63], v[108:111], v[148:151]
v_add_f32 v201, v201, v205
v_add_f32 v194, v194, v198
v_mfma_f32_16x16x32_bf16 v[152:155], a[64:67], v[80:83], 0
buffer_load_dwordx4 v[28:31], v2, s[8:11], s54 offen offset:3072 sc1
.if \sf == 0
buffer_store_dwordx4 a[204:207], v2, s[8:11], s62 offen offset:3072
.else
buffer_store_dwordx4 a[204:207], v2, s[8:11], s62 offen offset:3072 sc1
.endif
v_mfma_f32_16x16x32_bf16 v[156:159], a[96:99], v[80:83], 0
v_add_f32 v202, v202, v206
v_add_f32 v195, v195, v199
v_mfma_f32_16x16x32_bf16 v[152:155], a[68:71], v[84:87], v[152:155]
v_add_f32 v203, v203, v207
v_add_f32 v192, v192, v200
v_mfma_f32_16x16x32_bf16 v[156:159], a[100:103], v[84:87], v[156:159]
v_add_f32 v193, v193, v201
v_add_f32 v194, v194, v202
v_mfma_f32_16x16x32_bf16 v[152:155], a[72:75], v[88:91], v[152:155]
.if \sf == 0
buffer_store_dwordx4 a[208:211], v5, s[8:11], s62 offen offset:0
.else
buffer_store_dwordx4 a[208:211], v5, s[8:11], s62 offen offset:0 sc1
.endif
ds_write_b128 v2, v[144:147] offset:49152
v_mfma_f32_16x16x32_bf16 v[156:159], a[104:107], v[88:91], v[156:159]
buffer_load_dwordx4 v[32:35], v5, s[8:11], s54 offen offset:0 sc1
v_add_f32 v195, v195, v203
v_mfma_f32_16x16x32_bf16 v[152:155], a[76:79], v[92:95], v[152:155]
v_cvt_pk_bf16_f32 v224, v192, v193
v_cvt_pk_bf16_f32 v225, v194, v195
v_mfma_f32_16x16x32_bf16 v[156:159], a[108:111], v[92:95], v[156:159]
ds_write_b128 v2, v[148:151] offset:50176
v_add_f32 v208, v208, v212
v_mfma_f32_16x16x32_bf16 v[152:155], a[80:83], v[96:99], v[152:155]
.if \sf == 0
buffer_store_dwordx4 a[212:215], v5, s[8:11], s62 offen offset:1024
.else
buffer_store_dwordx4 a[212:215], v5, s[8:11], s62 offen offset:1024 sc1
.endif
v_add_f32 v216, v216, v220
v_mfma_f32_16x16x32_bf16 v[156:159], a[112:115], v[96:99], v[156:159]
v_add_f32 v209, v209, v213
v_add_f32 v217, v217, v221
v_mfma_f32_16x16x32_bf16 v[152:155], a[84:87], v[100:103], v[152:155]
buffer_load_dwordx4 v[36:39], v5, s[8:11], s54 offen offset:1024 sc1
v_add_f32 v210, v210, v214
v_mfma_f32_16x16x32_bf16 v[156:159], a[116:119], v[100:103], v[156:159]
v_add_f32 v218, v218, v222
v_add_f32 v211, v211, v215
v_mfma_f32_16x16x32_bf16 v[152:155], a[88:91], v[104:107], v[152:155]
.if \sf == 0
buffer_store_dwordx4 a[216:219], v5, s[8:11], s62 offen offset:2048
.else
buffer_store_dwordx4 a[216:219], v5, s[8:11], s62 offen offset:2048 sc1
.endif
v_add_f32 v219, v219, v223
v_mfma_f32_16x16x32_bf16 v[156:159], a[120:123], v[104:107], v[156:159]
v_add_f32 v208, v208, v216
v_add_f32 v209, v209, v217
v_mfma_f32_16x16x32_bf16 v[152:155], a[92:95], v[108:111], v[152:155]
v_add_f32 v210, v210, v218
v_add_f32 v211, v211, v219
v_mfma_f32_16x16x32_bf16 v[156:159], a[124:127], v[108:111], v[156:159]
buffer_load_dwordx4 v[40:43], v5, s[8:11], s54 offen offset:2048 sc1
v_cvt_pk_bf16_f32 v226, v208, v209
v_mfma_f32_16x16x32_bf16 v[160:163], v[80:83], a[128:131], 0
.if \sf == 0
buffer_store_dwordx4 a[220:223], v5, s[8:11], s62 offen offset:3072
.else
buffer_store_dwordx4 a[220:223], v5, s[8:11], s62 offen offset:3072 sc1
.endif
v_cvt_pk_bf16_f32 v227, v210, v211
v_mfma_f32_16x16x32_bf16 v[164:167], v[80:83], a[160:163], 0
buffer_store_dwordx4 v[224:227], v2, s[8:11], s55 offen sc1
v_mfma_f32_16x16x32_bf16 v[160:163], v[84:87], a[132:135], v[160:163]
ds_read_b128 v[192:195], v2 offset:6144
v_mfma_f32_16x16x32_bf16 v[164:167], v[84:87], a[164:167], v[164:167]
ds_read_b128 v[196:199], v2 offset:18432
v_mfma_f32_16x16x32_bf16 v[160:163], v[88:91], a[136:139], v[160:163]
buffer_load_dwordx4 v[44:47], v5, s[8:11], s54 offen offset:3072 sc1
ds_write_b128 v2, v[152:155] offset:51200
v_mfma_f32_16x16x32_bf16 v[164:167], v[88:91], a[168:171], v[164:167]
s_mov_b32 m0, s68
ds_read_b128 v[200:203], v2 offset:30720
v_mfma_f32_16x16x32_bf16 v[160:163], v[92:95], a[140:143], v[160:163]
buffer_load_dwordx4 v243, s[12:15], s69 offen lds
ds_read_b128 v[204:207], v2 offset:43008
v_mfma_f32_16x16x32_bf16 v[164:167], v[92:95], a[172:175], v[164:167]
s_add_u32 s68, s68, s70
s_add_u32 s69, s69, s71
ds_write_b128 v2, v[156:159] offset:52224
v_mfma_f32_16x16x32_bf16 v[160:163], v[96:99], a[144:147], v[160:163]
ds_read_b128 v[208:211], v2 offset:7168
v_mfma_f32_16x16x32_bf16 v[164:167], v[96:99], a[176:179], v[164:167]
ds_read_b128 v[212:215], v2 offset:19456
v_mfma_f32_16x16x32_bf16 v[160:163], v[100:103], a[148:151], v[160:163]
ds_read_b128 v[216:219], v2 offset:31744
v_mfma_f32_16x16x32_bf16 v[164:167], v[100:103], a[180:183], v[164:167]
ds_read_b128 v[220:223], v2 offset:44032
v_mfma_f32_16x16x32_bf16 v[160:163], v[104:107], a[152:155], v[160:163]
v_mfma_f32_16x16x32_bf16 v[164:167], v[104:107], a[184:187], v[164:167]
v_mfma_f32_16x16x32_bf16 v[160:163], v[108:111], a[156:159], v[160:163]
v_mfma_f32_16x16x32_bf16 v[164:167], v[108:111], a[188:191], v[164:167]
s_waitcnt vmcnt(19)
v_mfma_f32_16x16x32_bf16 v[168:171], a[0:3], v[112:115], 0
v_mfma_f32_16x16x32_bf16 v[172:175], a[32:35], v[112:115], 0
buffer_load_dwordx4 v[48:51], v2, s[8:11], s45 offen offset:0 sc1
s_waitcnt lgkmcnt(0)
v_mfma_f32_16x16x32_bf16 v[168:171], a[4:7], v[116:119], v[168:171]
v_add_f32 v192, v192, v196
v_add_f32 v200, v200, v204
v_mfma_f32_16x16x32_bf16 v[172:175], a[36:39], v[116:119], v[172:175]
v_add_f32 v193, v193, v197
v_add_f32 v201, v201, v205
v_mfma_f32_16x16x32_bf16 v[168:171], a[8:11], v[120:123], v[168:171]
ds_write_b128 v2, v[160:163] offset:53248
v_add_f32 v194, v194, v198
v_mfma_f32_16x16x32_bf16 v[172:175], a[40:43], v[120:123], v[172:175]
v_add_f32 v202, v202, v206
v_add_f32 v195, v195, v199
v_mfma_f32_16x16x32_bf16 v[168:171], a[12:15], v[124:127], v[168:171]
buffer_load_dwordx4 v[52:55], v2, s[8:11], s45 offen offset:1024 sc1
v_add_f32 v203, v203, v207
v_mfma_f32_16x16x32_bf16 v[172:175], a[44:47], v[124:127], v[172:175]
ds_write_b128 v2, v[164:167] offset:54272
v_add_f32 v192, v192, v200
v_mfma_f32_16x16x32_bf16 v[168:171], a[16:19], v[128:131], v[168:171]
v_add_f32 v193, v193, v201
v_add_f32 v194, v194, v202
v_mfma_f32_16x16x32_bf16 v[172:175], a[48:51], v[128:131], v[172:175]
v_add_f32 v195, v195, v203
v_cvt_pk_bf16_f32 v228, v192, v193
v_mfma_f32_16x16x32_bf16 v[168:171], a[20:23], v[132:135], v[168:171]
v_cvt_pk_bf16_f32 v229, v194, v195
v_add_f32 v208, v208, v212
v_mfma_f32_16x16x32_bf16 v[172:175], a[52:55], v[132:135], v[172:175]
buffer_load_dwordx4 v[56:59], v2, s[8:11], s45 offen offset:2048 sc1
v_add_f32 v216, v216, v220
v_mfma_f32_16x16x32_bf16 v[168:171], a[24:27], v[136:139], v[168:171]
v_add_f32 v209, v209, v213
v_add_f32 v217, v217, v221
v_mfma_f32_16x16x32_bf16 v[172:175], a[56:59], v[136:139], v[172:175]
v_add_f32 v210, v210, v214
v_add_f32 v218, v218, v222
v_mfma_f32_16x16x32_bf16 v[168:171], a[28:31], v[140:143], v[168:171]
v_add_f32 v211, v211, v215
v_add_f32 v219, v219, v223
v_mfma_f32_16x16x32_bf16 v[172:175], a[60:63], v[140:143], v[172:175]
v_add_f32 v208, v208, v216
v_add_f32 v209, v209, v217
v_mfma_f32_16x16x32_bf16 v[176:179], a[64:67], v[112:115], 0
buffer_load_dwordx4 v[60:63], v2, s[8:11], s45 offen offset:3072 sc1
v_add_f32 v210, v210, v218
v_mfma_f32_16x16x32_bf16 v[180:183], a[96:99], v[112:115], 0
v_add_f32 v211, v211, v219
v_cvt_pk_bf16_f32 v230, v208, v209
v_mfma_f32_16x16x32_bf16 v[176:179], a[68:71], v[116:119], v[176:179]
v_cvt_pk_bf16_f32 v231, v210, v211
buffer_store_dwordx4 v[228:231], v5, s[8:11], s55 offen sc1
v_mfma_f32_16x16x32_bf16 v[180:183], a[100:103], v[116:119], v[180:183]
v_mfma_f32_16x16x32_bf16 v[176:179], a[72:75], v[120:123], v[176:179]
ds_write_b128 v2, v[168:171] offset:55296
v_mfma_f32_16x16x32_bf16 v[180:183], a[104:107], v[120:123], v[180:183]
buffer_load_dwordx4 v[64:67], v5, s[8:11], s45 offen offset:0 sc1
v_mfma_f32_16x16x32_bf16 v[176:179], a[76:79], v[124:127], v[176:179]
v_mfma_f32_16x16x32_bf16 v[180:183], a[108:111], v[124:127], v[180:183]
ds_write_b128 v2, v[172:175] offset:56320
v_mfma_f32_16x16x32_bf16 v[176:179], a[80:83], v[128:131], v[176:179]
v_mfma_f32_16x16x32_bf16 v[180:183], a[112:115], v[128:131], v[180:183]
v_mfma_f32_16x16x32_bf16 v[176:179], a[84:87], v[132:135], v[176:179]
buffer_load_dwordx4 v[68:71], v5, s[8:11], s45 offen offset:1024 sc1
v_mfma_f32_16x16x32_bf16 v[180:183], a[116:119], v[132:135], v[180:183]
v_mfma_f32_16x16x32_bf16 v[176:179], a[88:91], v[136:139], v[176:179]
v_mfma_f32_16x16x32_bf16 v[180:183], a[120:123], v[136:139], v[180:183]
v_mfma_f32_16x16x32_bf16 v[176:179], a[92:95], v[140:143], v[176:179]
v_mfma_f32_16x16x32_bf16 v[180:183], a[124:127], v[140:143], v[180:183]
buffer_load_dwordx4 v[72:75], v5, s[8:11], s45 offen offset:2048 sc1
v_mfma_f32_16x16x32_bf16 v[184:187], v[112:115], a[128:131], 0
v_mfma_f32_16x16x32_bf16 v[188:191], v[112:115], a[160:163], 0
v_mfma_f32_16x16x32_bf16 v[184:187], v[116:119], a[132:135], v[184:187]
v_mfma_f32_16x16x32_bf16 v[188:191], v[116:119], a[164:167], v[188:191]
v_mfma_f32_16x16x32_bf16 v[184:187], v[120:123], a[136:139], v[184:187]
buffer_load_dwordx4 v[76:79], v5, s[8:11], s45 offen offset:3072 sc1
ds_write_b128 v2, v[176:179] offset:57344
v_mfma_f32_16x16x32_bf16 v[188:191], v[120:123], a[168:171], v[188:191]
s_mov_b32 m0, s68
v_mfma_f32_16x16x32_bf16 v[184:187], v[124:127], a[140:143], v[184:187]
buffer_load_dwordx4 v243, s[12:15], s69 offen lds
v_mfma_f32_16x16x32_bf16 v[188:191], v[124:127], a[172:175], v[188:191]
s_add_u32 s68, s68, s70
s_add_u32 s69, s69, s71
ds_write_b128 v2, v[180:183] offset:58368
v_mfma_f32_16x16x32_bf16 v[184:187], v[128:131], a[144:147], v[184:187]
v_mfma_f32_16x16x32_bf16 v[188:191], v[128:131], a[176:179], v[188:191]
v_mfma_f32_16x16x32_bf16 v[184:187], v[132:135], a[148:151], v[184:187]
v_mfma_f32_16x16x32_bf16 v[188:191], v[132:135], a[180:183], v[188:191]
v_mfma_f32_16x16x32_bf16 v[184:187], v[136:139], a[152:155], v[184:187]
v_mfma_f32_16x16x32_bf16 v[188:191], v[136:139], a[184:187], v[188:191]
v_mfma_f32_16x16x32_bf16 v[184:187], v[140:143], a[156:159], v[184:187]
v_mfma_f32_16x16x32_bf16 v[188:191], v[140:143], a[188:191], v[188:191]
s_nop 6
ds_write_b128 v2, v[184:187] offset:59392
ds_write_b128 v2, v[188:191] offset:60416
s_add_u32 s55, s55, 0x40000
s_add_u32 s56, s56, 0x40000
s_add_u32 s57, s57, 0x40000
s_add_u32 s62, s62, 0x100000
s_waitcnt vmcnt(5) lgkmcnt(0)
s_barrier
s_add_u32 s59, s59, 1
s_min_u32 s46, s59, 64
v_mov_b32 v6, s46
v_mov_b32 v7, 0
s_mov_b64 exec, 1
buffer_store_dword v6, v7, s[8:11], s58 offen sc1
s_mov_b64 exec, -1
s_add_u32 s54, s54, 0x10000
s_add_u32 s45, s54, 0x8000
s_waitcnt vmcnt(11)
v_mfma_f32_16x16x32_bf16 v[144:147], a[0:3], v[16:19], 0
ds_read_b128 v[192:195], v2 offset:49152
v_mfma_f32_16x16x32_bf16 v[148:151], a[32:35], v[16:19], 0
buffer_load_dwordx4 v[80:83], v2, s[8:11], s54 offen offset:0 sc1
v_mfma_f32_16x16x32_bf16 v[144:147], a[4:7], v[20:23], v[144:147]
ds_read_b128 v[196:199], v2 offset:61440
v_mfma_f32_16x16x32_bf16 v[148:151], a[36:39], v[20:23], v[148:151]
ds_read_b128 v[200:203], v4 offset:24576
v_mfma_f32_16x16x32_bf16 v[144:147], a[8:11], v[24:27], v[144:147]
ds_read_b128 v[204:207], v4 offset:36864
v_mfma_f32_16x16x32_bf16 v[148:151], a[40:43], v[24:27], v[148:151]
ds_read_b128 v[208:211], v2 offset:50176
v_mfma_f32_16x16x32_bf16 v[144:147], a[12:15], v[28:31], v[144:147]
buffer_load_dwordx4 v[84:87], v2, s[8:11], s54 offen offset:1024 sc1
v_mfma_f32_16x16x32_bf16 v[148:151], a[44:47], v[28:31], v[148:151]
ds_read_b128 v[212:215], v2 offset:62464
v_mfma_f32_16x16x32_bf16 v[144:147], a[16:19], v[32:35], v[144:147]
ds_read_b128 v[216:219], v4 offset:25600
v_mfma_f32_16x16x32_bf16 v[148:151], a[48:51], v[32:35], v[148:151]
ds_read_b128 v[220:223], v4 offset:37888
v_mfma_f32_16x16x32_bf16 v[144:147], a[20:23], v[36:39], v[144:147]
v_mfma_f32_16x16x32_bf16 v[148:151], a[52:55], v[36:39], v[148:151]
buffer_load_dwordx4 v[88:91], v2, s[8:11], s54 offen offset:2048 sc1
v_mfma_f32_16x16x32_bf16 v[144:147], a[24:27], v[40:43], v[144:147]
v_mfma_f32_16x16x32_bf16 v[148:151], a[56:59], v[40:43], v[148:151]
v_mfma_f32_16x16x32_bf16 v[144:147], a[28:31], v[44:47], v[144:147]
v_mfma_f32_16x16x32_bf16 v[148:151], a[60:63], v[44:47], v[148:151]
s_waitcnt lgkmcnt(0)
v_add_f32 v192, v192, v196
v_mfma_f32_16x16x32_bf16 v[152:155], a[64:67], v[16:19], 0
buffer_load_dwordx4 v[92:95], v2, s[8:11], s54 offen offset:3072 sc1
v_add_f32 v200, v200, v204
v_mfma_f32_16x16x32_bf16 v[156:159], a[96:99], v[16:19], 0
v_add_f32 v193, v193, v197
v_add_f32 v201, v201, v205
v_mfma_f32_16x16x32_bf16 v[152:155], a[68:71], v[20:23], v[152:155]
v_add_f32 v194, v194, v198
v_add_f32 v202, v202, v206
v_mfma_f32_16x16x32_bf16 v[156:159], a[100:103], v[20:23], v[156:159]
v_add_f32 v195, v195, v199
v_add_f32 v203, v203, v207
v_mfma_f32_16x16x32_bf16 v[152:155], a[72:75], v[24:27], v[152:155]
ds_write_b128 v2, v[144:147] offset:0
v_add_f32 v192, v192, v200
v_mfma_f32_16x16x32_bf16 v[156:159], a[104:107], v[24:27], v[156:159]
buffer_load_dwordx4 v[96:99], v5, s[8:11], s54 offen offset:0 sc1
v_add_f32 v193, v193, v201
v_mfma_f32_16x16x32_bf16 v[152:155], a[76:79], v[28:31], v[152:155]
v_add_f32 v194, v194, v202
v_add_f32 v195, v195, v203
v_mfma_f32_16x16x32_bf16 v[156:159], a[108:111], v[28:31], v[156:159]
ds_write_b128 v2, v[148:151] offset:1024
v_cvt_pk_bf16_f32 v224, v192, v193
v_mfma_f32_16x16x32_bf16 v[152:155], a[80:83], v[32:35], v[152:155]
v_cvt_pk_bf16_f32 v225, v194, v195
v_add_f32 v208, v208, v212
v_mfma_f32_16x16x32_bf16 v[156:159], a[112:115], v[32:35], v[156:159]
v_add_f32 v216, v216, v220
v_add_f32 v209, v209, v213
v_mfma_f32_16x16x32_bf16 v[152:155], a[84:87], v[36:39], v[152:155]
buffer_load_dwordx4 v[100:103], v5, s[8:11], s54 offen offset:1024 sc1
v_add_f32 v217, v217, v221
v_mfma_f32_16x16x32_bf16 v[156:159], a[116:119], v[36:39], v[156:159]
v_add_f32 v210, v210, v214
v_add_f32 v218, v218, v222
v_mfma_f32_16x16x32_bf16 v[152:155], a[88:91], v[40:43], v[152:155]
v_add_f32 v211, v211, v215
v_add_f32 v219, v219, v223
v_mfma_f32_16x16x32_bf16 v[156:159], a[120:123], v[40:43], v[156:159]
v_add_f32 v208, v208, v216
v_add_f32 v209, v209, v217
v_mfma_f32_16x16x32_bf16 v[152:155], a[92:95], v[44:47], v[152:155]
v_add_f32 v210, v210, v218
v_add_f32 v211, v211, v219
v_mfma_f32_16x16x32_bf16 v[156:159], a[124:127], v[44:47], v[156:159]
buffer_load_dwordx4 v[104:107], v5, s[8:11], s54 offen offset:2048 sc1
v_cvt_pk_bf16_f32 v226, v208, v209
v_mfma_f32_16x16x32_bf16 v[160:163], v[16:19], a[128:131], 0
v_cvt_pk_bf16_f32 v227, v210, v211
buffer_store_dwordx4 v[224:227], v2, s[8:11], s55 offen sc1
v_mfma_f32_16x16x32_bf16 v[164:167], v[16:19], a[160:163], 0
v_mfma_f32_16x16x32_bf16 v[160:163], v[20:23], a[132:135], v[160:163]
v_mfma_f32_16x16x32_bf16 v[164:167], v[20:23], a[164:167], v[164:167]
v_mfma_f32_16x16x32_bf16 v[160:163], v[24:27], a[136:139], v[160:163]
buffer_load_dwordx4 v[108:111], v5, s[8:11], s54 offen offset:3072 sc1
ds_write_b128 v2, v[152:155] offset:2048
v_mfma_f32_16x16x32_bf16 v[164:167], v[24:27], a[168:171], v[164:167]
s_mov_b32 m0, s68
v_mfma_f32_16x16x32_bf16 v[160:163], v[28:31], a[140:143], v[160:163]
buffer_load_dwordx4 v243, s[12:15], s69 offen lds
v_mfma_f32_16x16x32_bf16 v[164:167], v[28:31], a[172:175], v[164:167]
s_add_u32 s68, s68, s70
s_add_u32 s69, s69, s71
ds_write_b128 v2, v[156:159] offset:3072
v_mfma_f32_16x16x32_bf16 v[160:163], v[32:35], a[144:147], v[160:163]
v_mfma_f32_16x16x32_bf16 v[164:167], v[32:35], a[176:179], v[164:167]
v_mfma_f32_16x16x32_bf16 v[160:163], v[36:39], a[148:151], v[160:163]
v_mfma_f32_16x16x32_bf16 v[164:167], v[36:39], a[180:183], v[164:167]
v_mfma_f32_16x16x32_bf16 v[160:163], v[40:43], a[152:155], v[160:163]
v_mfma_f32_16x16x32_bf16 v[164:167], v[40:43], a[184:187], v[164:167]
v_mfma_f32_16x16x32_bf16 v[160:163], v[44:47], a[156:159], v[160:163]
v_mfma_f32_16x16x32_bf16 v[164:167], v[44:47], a[188:191], v[164:167]
s_waitcnt vmcnt(11)
v_mfma_f32_16x16x32_bf16 v[168:171], a[0:3], v[48:51], 0
v_mfma_f32_16x16x32_bf16 v[172:175], a[32:35], v[48:51], 0
buffer_load_dwordx4 v[112:115], v2, s[8:11], s45 offen offset:0 sc1
v_mfma_f32_16x16x32_bf16 v[168:171], a[4:7], v[52:55], v[168:171]
v_mfma_f32_16x16x32_bf16 v[172:175], a[36:39], v[52:55], v[172:175]
v_mfma_f32_16x16x32_bf16 v[168:171], a[8:11], v[56:59], v[168:171]
ds_write_b128 v2, v[160:163] offset:4096
v_mfma_f32_16x16x32_bf16 v[172:175], a[40:43], v[56:59], v[172:175]
v_mfma_f32_16x16x32_bf16 v[168:171], a[12:15], v[60:63], v[168:171]
buffer_load_dwordx4 v[116:119], v2, s[8:11], s45 offen offset:1024 sc1
v_mfma_f32_16x16x32_bf16 v[172:175], a[44:47], v[60:63], v[172:175]
ds_write_b128 v2, v[164:167] offset:5120
v_mfma_f32_16x16x32_bf16 v[168:171], a[16:19], v[64:67], v[168:171]
v_mfma_f32_16x16x32_bf16 v[172:175], a[48:51], v[64:67], v[172:175]
v_mfma_f32_16x16x32_bf16 v[168:171], a[20:23], v[68:71], v[168:171]
v_mfma_f32_16x16x32_bf16 v[172:175], a[52:55], v[68:71], v[172:175]
buffer_load_dwordx4 v[120:123], v2, s[8:11], s45 offen offset:2048 sc1
v_mfma_f32_16x16x32_bf16 v[168:171], a[24:27], v[72:75], v[168:171]
v_mfma_f32_16x16x32_bf16 v[172:175], a[56:59], v[72:75], v[172:175]
v_mfma_f32_16x16x32_bf16 v[168:171], a[28:31], v[76:79], v[168:171]
v_mfma_f32_16x16x32_bf16 v[172:175], a[60:63], v[76:79], v[172:175]
v_mfma_f32_16x16x32_bf16 v[176:179], a[64:67], v[48:51], 0
buffer_load_dwordx4 v[124:127], v2, s[8:11], s45 offen offset:3072 sc1
v_mfma_f32_16x16x32_bf16 v[180:183], a[96:99], v[48:51], 0
v_mfma_f32_16x16x32_bf16 v[176:179], a[68:71], v[52:55], v[176:179]
v_mfma_f32_16x16x32_bf16 v[180:183], a[100:103], v[52:55], v[180:183]
v_mfma_f32_16x16x32_bf16 v[176:179], a[72:75], v[56:59], v[176:179]
s_nop 0
ds_write_b128 v2, v[168:171] offset:6144
v_mfma_f32_16x16x32_bf16 v[180:183], a[104:107], v[56:59], v[180:183]
buffer_load_dwordx4 v[128:131], v5, s[8:11], s45 offen offset:0 sc1
v_mfma_f32_16x16x32_bf16 v[176:179], a[76:79], v[60:63], v[176:179]
v_mfma_f32_16x16x32_bf16 v[180:183], a[108:111], v[60:63], v[180:183]
ds_write_b128 v2, v[172:175] offset:7168
v_mfma_f32_16x16x32_bf16 v[176:179], a[80:83], v[64:67], v[176:179]
v_mfma_f32_16x16x32_bf16 v[180:183], a[112:115], v[64:67], v[180:183]
v_mfma_f32_16x16x32_bf16 v[176:179], a[84:87], v[68:71], v[176:179]
buffer_load_dwordx4 v[132:135], v5, s[8:11], s45 offen offset:1024 sc1
v_mfma_f32_16x16x32_bf16 v[180:183], a[116:119], v[68:71], v[180:183]
v_mfma_f32_16x16x32_bf16 v[176:179], a[88:91], v[72:75], v[176:179]
v_mfma_f32_16x16x32_bf16 v[180:183], a[120:123], v[72:75], v[180:183]
v_mfma_f32_16x16x32_bf16 v[176:179], a[92:95], v[76:79], v[176:179]
v_mfma_f32_16x16x32_bf16 v[180:183], a[124:127], v[76:79], v[180:183]
buffer_load_dwordx4 v[136:139], v5, s[8:11], s45 offen offset:2048 sc1
v_mfma_f32_16x16x32_bf16 v[184:187], v[48:51], a[128:131], 0
v_mfma_f32_16x16x32_bf16 v[188:191], v[48:51], a[160:163], 0
v_mfma_f32_16x16x32_bf16 v[184:187], v[52:55], a[132:135], v[184:187]
v_mfma_f32_16x16x32_bf16 v[188:191], v[52:55], a[164:167], v[188:191]
v_mfma_f32_16x16x32_bf16 v[184:187], v[56:59], a[136:139], v[184:187]
buffer_load_dwordx4 v[140:143], v5, s[8:11], s45 offen offset:3072 sc1
ds_write_b128 v2, v[176:179] offset:8192
v_mfma_f32_16x16x32_bf16 v[188:191], v[56:59], a[168:171], v[188:191]
s_mov_b32 m0, s68
v_mfma_f32_16x16x32_bf16 v[184:187], v[60:63], a[140:143], v[184:187]
buffer_load_dwordx4 v243, s[12:15], s69 offen lds
v_mfma_f32_16x16x32_bf16 v[188:191], v[60:63], a[172:175], v[188:191]
s_add_u32 s68, s68, s70
s_add_u32 s69, s69, s71
ds_write_b128 v2, v[180:183] offset:9216
v_mfma_f32_16x16x32_bf16 v[184:187], v[64:67], a[144:147], v[184:187]
v_mfma_f32_16x16x32_bf16 v[188:191], v[64:67], a[176:179], v[188:191]
v_mfma_f32_16x16x32_bf16 v[184:187], v[68:71], a[148:151], v[184:187]
v_mfma_f32_16x16x32_bf16 v[188:191], v[68:71], a[180:183], v[188:191]
v_mfma_f32_16x16x32_bf16 v[184:187], v[72:75], a[152:155], v[184:187]
v_mfma_f32_16x16x32_bf16 v[188:191], v[72:75], a[184:187], v[188:191]
v_mfma_f32_16x16x32_bf16 v[184:187], v[76:79], a[156:159], v[184:187]
v_mfma_f32_16x16x32_bf16 v[188:191], v[76:79], a[188:191], v[188:191]
s_nop 6
ds_write_b128 v2, v[184:187] offset:10240
ds_write_b128 v2, v[188:191] offset:11264
s_add_u32 s55, s55, 0x40000
s_add_u32 s56, s56, 0x40000
s_add_u32 s57, s57, 0x40000
s_cmp_eq_u32 s52, 60
s_cselect_b32 s45, 0x1000000, 0
s_sub_u32 s55, s55, s45
s_sub_u32 s56, s56, s45
s_sub_u32 s57, s57, s45
s_waitcnt vmcnt(19) lgkmcnt(0)
s_barrier
s_min_u32 s46, s59, 64
v_mov_b32 v6, s46
v_mov_b32 v7, 0
s_mov_b64 exec, 1
buffer_store_dword v6, v7, s[8:11], s58 offen sc1
s_mov_b64 exec, -1
s_add_u32 s59, s59, 1
s_add_u32 s52, s52, 4
fg1_loop_w0_\sf:
s_and_b32 s45, s52, 3
s_cmp_lg_u32 s45, 0
s_cbranch_scc1 nocv_119_\sf
s_mov_b32 s90, 0
s_branch g1_side_\sf
g1_back_w0_\sf:
nocv_119_\sf:
s_add_u32 s54, s54, 0x10000
s_cmp_eq_u32 s52, 58
s_cselect_b32 s45, 0x400000, 0
s_sub_u32 s54, s54, s45
s_add_u32 s45, s54, 0x8000
s_waitcnt vmcnt(10)
v_mfma_f32_16x16x32_bf16 v[144:147], a[0:3], v[80:83], 0
ds_read_b128 v[192:195], v2 offset:0
v_mfma_f32_16x16x32_bf16 v[148:151], a[32:35], v[80:83], 0
buffer_load_dwordx4 v[16:19], v2, s[8:11], s54 offen offset:0 sc1
v_mfma_f32_16x16x32_bf16 v[144:147], a[4:7], v[84:87], v[144:147]
ds_read_b128 v[196:199], v2 offset:12288
v_mfma_f32_16x16x32_bf16 v[148:151], a[36:39], v[84:87], v[148:151]
ds_read_b128 v[200:203], v2 offset:24576
v_mfma_f32_16x16x32_bf16 v[144:147], a[8:11], v[88:91], v[144:147]
ds_read_b128 v[204:207], v2 offset:36864
v_mfma_f32_16x16x32_bf16 v[148:151], a[40:43], v[88:91], v[148:151]
ds_read_b128 v[208:211], v2 offset:1024
v_mfma_f32_16x16x32_bf16 v[144:147], a[12:15], v[92:95], v[144:147]
buffer_load_dwordx4 v[20:23], v2, s[8:11], s54 offen offset:1024 sc1
v_mfma_f32_16x16x32_bf16 v[148:151], a[44:47], v[92:95], v[148:151]
ds_read_b128 v[212:215], v2 offset:13312
v_mfma_f32_16x16x32_bf16 v[144:147], a[16:19], v[96:99], v[144:147]
ds_read_b128 v[216:219], v2 offset:25600
v_mfma_f32_16x16x32_bf16 v[148:151], a[48:51], v[96:99], v[148:151]
ds_read_b128 v[220:223], v2 offset:37888
v_mfma_f32_16x16x32_bf16 v[144:147], a[20:23], v[100:103], v[144:147]
v_mfma_f32_16x16x32_bf16 v[148:151], a[52:55], v[100:103], v[148:151]
buffer_load_dwordx4 v[24:27], v2, s[8:11], s54 offen offset:2048 sc1
v_mfma_f32_16x16x32_bf16 v[144:147], a[24:27], v[104:107], v[144:147]
v_mfma_f32_16x16x32_bf16 v[148:151], a[56:59], v[104:107], v[148:151]
v_mfma_f32_16x16x32_bf16 v[144:147], a[28:31], v[108:111], v[144:147]
v_mfma_f32_16x16x32_bf16 v[148:151], a[60:63], v[108:111], v[148:151]
s_waitcnt lgkmcnt(0)
v_add_f32 v192, v192, v196
v_mfma_f32_16x16x32_bf16 v[152:155], a[64:67], v[80:83], 0
buffer_load_dwordx4 v[28:31], v2, s[8:11], s54 offen offset:3072 sc1
v_add_f32 v200, v200, v204
v_mfma_f32_16x16x32_bf16 v[156:159], a[96:99], v[80:83], 0
v_add_f32 v193, v193, v197
v_add_f32 v201, v201, v205
v_mfma_f32_16x16x32_bf16 v[152:155], a[68:71], v[84:87], v[152:155]
v_add_f32 v194, v194, v198
v_add_f32 v202, v202, v206
v_mfma_f32_16x16x32_bf16 v[156:159], a[100:103], v[84:87], v[156:159]
v_add_f32 v195, v195, v199
v_add_f32 v203, v203, v207
v_mfma_f32_16x16x32_bf16 v[152:155], a[72:75], v[88:91], v[152:155]
ds_write_b128 v2, v[144:147] offset:49152
v_add_f32 v192, v192, v200
v_mfma_f32_16x16x32_bf16 v[156:159], a[104:107], v[88:91], v[156:159]
buffer_load_dwordx4 v[32:35], v5, s[8:11], s54 offen offset:0 sc1
v_add_f32 v193, v193, v201
v_mfma_f32_16x16x32_bf16 v[152:155], a[76:79], v[92:95], v[152:155]
v_add_f32 v194, v194, v202
v_add_f32 v195, v195, v203
v_mfma_f32_16x16x32_bf16 v[156:159], a[108:111], v[92:95], v[156:159]
ds_write_b128 v2, v[148:151] offset:50176
v_cvt_pk_bf16_f32 v224, v192, v193
v_mfma_f32_16x16x32_bf16 v[152:155], a[80:83], v[96:99], v[152:155]
v_cvt_pk_bf16_f32 v225, v194, v195
v_add_f32 v208, v208, v212
v_mfma_f32_16x16x32_bf16 v[156:159], a[112:115], v[96:99], v[156:159]
v_add_f32 v216, v216, v220
v_add_f32 v209, v209, v213
v_mfma_f32_16x16x32_bf16 v[152:155], a[84:87], v[100:103], v[152:155]
buffer_load_dwordx4 v[36:39], v5, s[8:11], s54 offen offset:1024 sc1
v_add_f32 v217, v217, v221
v_mfma_f32_16x16x32_bf16 v[156:159], a[116:119], v[100:103], v[156:159]
v_add_f32 v210, v210, v214
v_add_f32 v218, v218, v222
v_mfma_f32_16x16x32_bf16 v[152:155], a[88:91], v[104:107], v[152:155]
v_add_f32 v211, v211, v215
v_add_f32 v219, v219, v223
v_mfma_f32_16x16x32_bf16 v[156:159], a[120:123], v[104:107], v[156:159]
v_add_f32 v208, v208, v216
v_add_f32 v209, v209, v217
v_mfma_f32_16x16x32_bf16 v[152:155], a[92:95], v[108:111], v[152:155]
v_add_f32 v210, v210, v218
v_add_f32 v211, v211, v219
v_mfma_f32_16x16x32_bf16 v[156:159], a[124:127], v[108:111], v[156:159]
buffer_load_dwordx4 v[40:43], v5, s[8:11], s54 offen offset:2048 sc1
v_cvt_pk_bf16_f32 v226, v208, v209
v_mfma_f32_16x16x32_bf16 v[160:163], v[80:83], a[128:131], 0
v_cvt_pk_bf16_f32 v227, v210, v211
buffer_store_dwordx4 v[224:227], v2, s[8:11], s55 offen sc1
v_mfma_f32_16x16x32_bf16 v[164:167], v[80:83], a[160:163], 0
ds_read_b128 v[192:195], v2 offset:6144
v_mfma_f32_16x16x32_bf16 v[160:163], v[84:87], a[132:135], v[160:163]
ds_read_b128 v[196:199], v2 offset:18432
v_mfma_f32_16x16x32_bf16 v[164:167], v[84:87], a[164:167], v[164:167]
ds_read_b128 v[200:203], v2 offset:30720
v_mfma_f32_16x16x32_bf16 v[160:163], v[88:91], a[136:139], v[160:163]
buffer_load_dwordx4 v[44:47], v5, s[8:11], s54 offen offset:3072 sc1
ds_write_b128 v2, v[152:155] offset:51200
v_mfma_f32_16x16x32_bf16 v[164:167], v[88:91], a[168:171], v[164:167]
s_mov_b32 m0, s68
v_mfma_f32_16x16x32_bf16 v[160:163], v[92:95], a[140:143], v[160:163]
buffer_load_dwordx4 v243, s[12:15], s69 offen lds
v_mfma_f32_16x16x32_bf16 v[164:167], v[92:95], a[172:175], v[164:167]
s_add_u32 s68, s68, s70
s_add_u32 s69, s69, s71
ds_write_b128 v2, v[156:159] offset:52224
v_mfma_f32_16x16x32_bf16 v[160:163], v[96:99], a[144:147], v[160:163]
ds_read_b128 v[204:207], v2 offset:43008
v_mfma_f32_16x16x32_bf16 v[164:167], v[96:99], a[176:179], v[164:167]
ds_read_b128 v[208:211], v2 offset:7168
v_mfma_f32_16x16x32_bf16 v[160:163], v[100:103], a[148:151], v[160:163]
ds_read_b128 v[212:215], v2 offset:19456
v_mfma_f32_16x16x32_bf16 v[164:167], v[100:103], a[180:183], v[164:167]
ds_read_b128 v[216:219], v2 offset:31744
v_mfma_f32_16x16x32_bf16 v[160:163], v[104:107], a[152:155], v[160:163]
ds_read_b128 v[220:223], v2 offset:44032
v_mfma_f32_16x16x32_bf16 v[164:167], v[104:107], a[184:187], v[164:167]
v_mfma_f32_16x16x32_bf16 v[160:163], v[108:111], a[156:159], v[160:163]
v_mfma_f32_16x16x32_bf16 v[164:167], v[108:111], a[188:191], v[164:167]
s_waitcnt vmcnt(11)
v_mfma_f32_16x16x32_bf16 v[168:171], a[0:3], v[112:115], 0
v_mfma_f32_16x16x32_bf16 v[172:175], a[32:35], v[112:115], 0
buffer_load_dwordx4 v[48:51], v2, s[8:11], s45 offen offset:0 sc1
v_mfma_f32_16x16x32_bf16 v[168:171], a[4:7], v[116:119], v[168:171]
s_waitcnt lgkmcnt(0)
v_add_f32 v192, v192, v196
v_mfma_f32_16x16x32_bf16 v[172:175], a[36:39], v[116:119], v[172:175]
v_add_f32 v200, v200, v204
v_add_f32 v193, v193, v197
v_mfma_f32_16x16x32_bf16 v[168:171], a[8:11], v[120:123], v[168:171]
ds_write_b128 v2, v[160:163] offset:53248
v_add_f32 v201, v201, v205
v_mfma_f32_16x16x32_bf16 v[172:175], a[40:43], v[120:123], v[172:175]
v_add_f32 v194, v194, v198
v_add_f32 v202, v202, v206
v_mfma_f32_16x16x32_bf16 v[168:171], a[12:15], v[124:127], v[168:171]
buffer_load_dwordx4 v[52:55], v2, s[8:11], s45 offen offset:1024 sc1
v_add_f32 v195, v195, v199
v_mfma_f32_16x16x32_bf16 v[172:175], a[44:47], v[124:127], v[172:175]
ds_write_b128 v2, v[164:167] offset:54272
v_add_f32 v203, v203, v207
v_mfma_f32_16x16x32_bf16 v[168:171], a[16:19], v[128:131], v[168:171]
v_add_f32 v192, v192, v200
v_add_f32 v193, v193, v201
v_mfma_f32_16x16x32_bf16 v[172:175], a[48:51], v[128:131], v[172:175]
v_add_f32 v194, v194, v202
v_add_f32 v195, v195, v203
v_mfma_f32_16x16x32_bf16 v[168:171], a[20:23], v[132:135], v[168:171]
v_cvt_pk_bf16_f32 v228, v192, v193
v_cvt_pk_bf16_f32 v229, v194, v195
v_mfma_f32_16x16x32_bf16 v[172:175], a[52:55], v[132:135], v[172:175]
buffer_load_dwordx4 v[56:59], v2, s[8:11], s45 offen offset:2048 sc1
v_add_f32 v208, v208, v212
v_mfma_f32_16x16x32_bf16 v[168:171], a[24:27], v[136:139], v[168:171]
v_add_f32 v216, v216, v220
v_add_f32 v209, v209, v213
v_mfma_f32_16x16x32_bf16 v[172:175], a[56:59], v[136:139], v[172:175]
v_add_f32 v217, v217, v221
v_add_f32 v210, v210, v214
v_mfma_f32_16x16x32_bf16 v[168:171], a[28:31], v[140:143], v[168:171]
v_add_f32 v218, v218, v222
v_add_f32 v211, v211, v215
v_mfma_f32_16x16x32_bf16 v[172:175], a[60:63], v[140:143], v[172:175]
v_add_f32 v219, v219, v223
v_add_f32 v208, v208, v216
v_mfma_f32_16x16x32_bf16 v[176:179], a[64:67], v[112:115], 0
buffer_load_dwordx4 v[60:63], v2, s[8:11], s45 offen offset:3072 sc1
v_add_f32 v209, v209, v217
v_mfma_f32_16x16x32_bf16 v[180:183], a[96:99], v[112:115], 0
v_add_f32 v210, v210, v218
v_add_f32 v211, v211, v219
v_mfma_f32_16x16x32_bf16 v[176:179], a[68:71], v[116:119], v[176:179]
v_cvt_pk_bf16_f32 v230, v208, v209
v_cvt_pk_bf16_f32 v231, v210, v211
v_mfma_f32_16x16x32_bf16 v[180:183], a[100:103], v[116:119], v[180:183]
buffer_store_dwordx4 v[228:231], v5, s[8:11], s55 offen sc1
v_mfma_f32_16x16x32_bf16 v[176:179], a[72:75], v[120:123], v[176:179]
ds_write_b128 v2, v[168:171] offset:55296
v_mfma_f32_16x16x32_bf16 v[180:183], a[104:107], v[120:123], v[180:183]
buffer_load_dwordx4 v[64:67], v5, s[8:11], s45 offen offset:0 sc1
v_mfma_f32_16x16x32_bf16 v[176:179], a[76:79], v[124:127], v[176:179]
v_mfma_f32_16x16x32_bf16 v[180:183], a[108:111], v[124:127], v[180:183]
ds_write_b128 v2, v[172:175] offset:56320
v_mfma_f32_16x16x32_bf16 v[176:179], a[80:83], v[128:131], v[176:179]
v_mfma_f32_16x16x32_bf16 v[180:183], a[112:115], v[128:131], v[180:183]
v_mfma_f32_16x16x32_bf16 v[176:179], a[84:87], v[132:135], v[176:179]
buffer_load_dwordx4 v[68:71], v5, s[8:11], s45 offen offset:1024 sc1
v_mfma_f32_16x16x32_bf16 v[180:183], a[116:119], v[132:135], v[180:183]
v_mfma_f32_16x16x32_bf16 v[176:179], a[88:91], v[136:139], v[176:179]
v_mfma_f32_16x16x32_bf16 v[180:183], a[120:123], v[136:139], v[180:183]
v_mfma_f32_16x16x32_bf16 v[176:179], a[92:95], v[140:143], v[176:179]
v_mfma_f32_16x16x32_bf16 v[180:183], a[124:127], v[140:143], v[180:183]
buffer_load_dwordx4 v[72:75], v5, s[8:11], s45 offen offset:2048 sc1
v_mfma_f32_16x16x32_bf16 v[184:187], v[112:115], a[128:131], 0
v_mfma_f32_16x16x32_bf16 v[188:191], v[112:115], a[160:163], 0
v_mfma_f32_16x16x32_bf16 v[184:187], v[116:119], a[132:135], v[184:187]
v_mfma_f32_16x16x32_bf16 v[188:191], v[116:119], a[164:167], v[188:191]
v_mfma_f32_16x16x32_bf16 v[184:187], v[120:123], a[136:139], v[184:187]
buffer_load_dwordx4 v[76:79], v5, s[8:11], s45 offen offset:3072 sc1
ds_write_b128 v2, v[176:179] offset:57344
v_mfma_f32_16x16x32_bf16 v[188:191], v[120:123], a[168:171], v[188:191]
s_mov_b32 m0, s68
v_mfma_f32_16x16x32_bf16 v[184:187], v[124:127], a[140:143], v[184:187]
buffer_load_dwordx4 v243, s[12:15], s69 offen lds
v_mfma_f32_16x16x32_bf16 v[188:191], v[124:127], a[172:175], v[188:191]
s_add_u32 s68, s68, s70
s_add_u32 s69, s69, s71
ds_write_b128 v2, v[180:183] offset:58368
v_mfma_f32_16x16x32_bf16 v[184:187], v[128:131], a[144:147], v[184:187]
v_mfma_f32_16x16x32_bf16 v[188:191], v[128:131], a[176:179], v[188:191]
v_mfma_f32_16x16x32_bf16 v[184:187], v[132:135], a[148:151], v[184:187]
v_mfma_f32_16x16x32_bf16 v[188:191], v[132:135], a[180:183], v[188:191]
v_mfma_f32_16x16x32_bf16 v[184:187], v[136:139], a[152:155], v[184:187]
v_mfma_f32_16x16x32_bf16 v[188:191], v[136:139], a[184:187], v[188:191]
v_mfma_f32_16x16x32_bf16 v[184:187], v[140:143], a[156:159], v[184:187]
v_mfma_f32_16x16x32_bf16 v[188:191], v[140:143], a[188:191], v[188:191]
s_nop 6
ds_write_b128 v2, v[184:187] offset:59392
ds_write_b128 v2, v[188:191] offset:60416
s_add_u32 s55, s55, 0x40000
s_add_u32 s56, s56, 0x40000
s_add_u32 s57, s57, 0x40000
s_waitcnt vmcnt(20) lgkmcnt(0)
s_barrier
s_min_u32 s46, s59, 64
v_mov_b32 v6, s46
v_mov_b32 v7, 0
s_mov_b64 exec, 1
buffer_store_dword v6, v7, s[8:11], s58 offen sc1
s_mov_b64 exec, -1
s_add_u32 s59, s59, 1
s_add_u32 s52, s52, 2
s_cmp_ge_u32 s52, s53
s_cbranch_scc1 fg1_done_w0_\sf
s_add_u32 s54, s54, 0x10000
s_add_u32 s45, s54, 0x8000
s_waitcnt vmcnt(11)
v_mfma_f32_16x16x32_bf16 v[144:147], a[0:3], v[16:19], 0
ds_read_b128 v[192:195], v2 offset:49152
v_mfma_f32_16x16x32_bf16 v[148:151], a[32:35], v[16:19], 0
buffer_load_dwordx4 v[80:83], v2, s[8:11], s54 offen offset:0 sc1
v_mfma_f32_16x16x32_bf16 v[144:147], a[4:7], v[20:23], v[144:147]
ds_read_b128 v[196:199], v2 offset:61440
v_mfma_f32_16x16x32_bf16 v[148:151], a[36:39], v[20:23], v[148:151]
ds_read_b128 v[200:203], v4 offset:24576
v_mfma_f32_16x16x32_bf16 v[144:147], a[8:11], v[24:27], v[144:147]
ds_read_b128 v[204:207], v4 offset:36864
v_mfma_f32_16x16x32_bf16 v[148:151], a[40:43], v[24:27], v[148:151]
ds_read_b128 v[208:211], v2 offset:50176
v_mfma_f32_16x16x32_bf16 v[144:147], a[12:15], v[28:31], v[144:147]
buffer_load_dwordx4 v[84:87], v2, s[8:11], s54 offen offset:1024 sc1
v_mfma_f32_16x16x32_bf16 v[148:151], a[44:47], v[28:31], v[148:151]
ds_read_b128 v[212:215], v2 offset:62464
v_mfma_f32_16x16x32_bf16 v[144:147], a[16:19], v[32:35], v[144:147]
ds_read_b128 v[216:219], v4 offset:25600
v_mfma_f32_16x16x32_bf16 v[148:151], a[48:51], v[32:35], v[148:151]
ds_read_b128 v[220:223], v4 offset:37888
v_mfma_f32_16x16x32_bf16 v[144:147], a[20:23], v[36:39], v[144:147]
v_mfma_f32_16x16x32_bf16 v[148:151], a[52:55], v[36:39], v[148:151]
buffer_load_dwordx4 v[88:91], v2, s[8:11], s54 offen offset:2048 sc1
v_mfma_f32_16x16x32_bf16 v[144:147], a[24:27], v[40:43], v[144:147]
v_mfma_f32_16x16x32_bf16 v[148:151], a[56:59], v[40:43], v[148:151]
v_mfma_f32_16x16x32_bf16 v[144:147], a[28:31], v[44:47], v[144:147]
v_mfma_f32_16x16x32_bf16 v[148:151], a[60:63], v[44:47], v[148:151]
s_waitcnt lgkmcnt(0)
v_add_f32 v192, v192, v196
v_mfma_f32_16x16x32_bf16 v[152:155], a[64:67], v[16:19], 0
buffer_load_dwordx4 v[92:95], v2, s[8:11], s54 offen offset:3072 sc1
v_add_f32 v200, v200, v204
v_mfma_f32_16x16x32_bf16 v[156:159], a[96:99], v[16:19], 0
v_add_f32 v193, v193, v197
v_add_f32 v201, v201, v205
v_mfma_f32_16x16x32_bf16 v[152:155], a[68:71], v[20:23], v[152:155]
v_add_f32 v194, v194, v198
v_add_f32 v202, v202, v206
v_mfma_f32_16x16x32_bf16 v[156:159], a[100:103], v[20:23], v[156:159]
v_add_f32 v195, v195, v199
v_add_f32 v203, v203, v207
v_mfma_f32_16x16x32_bf16 v[152:155], a[72:75], v[24:27], v[152:155]
ds_write_b128 v2, v[144:147] offset:0
v_add_f32 v192, v192, v200
v_mfma_f32_16x16x32_bf16 v[156:159], a[104:107], v[24:27], v[156:159]
buffer_load_dwordx4 v[96:99], v5, s[8:11], s54 offen offset:0 sc1
v_add_f32 v193, v193, v201
v_mfma_f32_16x16x32_bf16 v[152:155], a[76:79], v[28:31], v[152:155]
v_add_f32 v194, v194, v202
v_add_f32 v195, v195, v203
v_mfma_f32_16x16x32_bf16 v[156:159], a[108:111], v[28:31], v[156:159]
ds_write_b128 v2, v[148:151] offset:1024
v_cvt_pk_bf16_f32 v224, v192, v193
v_mfma_f32_16x16x32_bf16 v[152:155], a[80:83], v[32:35], v[152:155]
v_cvt_pk_bf16_f32 v225, v194, v195
v_add_f32 v208, v208, v212
v_mfma_f32_16x16x32_bf16 v[156:159], a[112:115], v[32:35], v[156:159]
v_add_f32 v216, v216, v220
v_add_f32 v209, v209, v213
v_mfma_f32_16x16x32_bf16 v[152:155], a[84:87], v[36:39], v[152:155]
buffer_load_dwordx4 v[100:103], v5, s[8:11], s54 offen offset:1024 sc1
v_add_f32 v217, v217, v221
v_mfma_f32_16x16x32_bf16 v[156:159], a[116:119], v[36:39], v[156:159]
v_add_f32 v210, v210, v214
v_add_f32 v218, v218, v222
v_mfma_f32_16x16x32_bf16 v[152:155], a[88:91], v[40:43], v[152:155]
v_add_f32 v211, v211, v215
v_add_f32 v219, v219, v223
v_mfma_f32_16x16x32_bf16 v[156:159], a[120:123], v[40:43], v[156:159]
v_add_f32 v208, v208, v216
v_add_f32 v209, v209, v217
v_mfma_f32_16x16x32_bf16 v[152:155], a[92:95], v[44:47], v[152:155]
v_add_f32 v210, v210, v218
v_add_f32 v211, v211, v219
v_mfma_f32_16x16x32_bf16 v[156:159], a[124:127], v[44:47], v[156:159]
buffer_load_dwordx4 v[104:107], v5, s[8:11], s54 offen offset:2048 sc1
v_cvt_pk_bf16_f32 v226, v208, v209
v_mfma_f32_16x16x32_bf16 v[160:163], v[16:19], a[128:131], 0
v_cvt_pk_bf16_f32 v227, v210, v211
buffer_store_dwordx4 v[224:227], v2, s[8:11], s55 offen sc1
v_mfma_f32_16x16x32_bf16 v[164:167], v[16:19], a[160:163], 0
v_mfma_f32_16x16x32_bf16 v[160:163], v[20:23], a[132:135], v[160:163]
v_mfma_f32_16x16x32_bf16 v[164:167], v[20:23], a[164:167], v[164:167]
v_mfma_f32_16x16x32_bf16 v[160:163], v[24:27], a[136:139], v[160:163]
buffer_load_dwordx4 v[108:111], v5, s[8:11], s54 offen offset:3072 sc1
ds_write_b128 v2, v[152:155] offset:2048
v_mfma_f32_16x16x32_bf16 v[164:167], v[24:27], a[168:171], v[164:167]
s_mov_b32 m0, s68
v_mfma_f32_16x16x32_bf16 v[160:163], v[28:31], a[140:143], v[160:163]
buffer_load_dwordx4 v243, s[12:15], s69 offen lds
v_mfma_f32_16x16x32_bf16 v[164:167], v[28:31], a[172:175], v[164:167]
s_add_u32 s68, s68, s70
s_add_u32 s69, s69, s71
ds_write_b128 v2, v[156:159] offset:3072
v_mfma_f32_16x16x32_bf16 v[160:163], v[32:35], a[144:147], v[160:163]
v_mfma_f32_16x16x32_bf16 v[164:167], v[32:35], a[176:179], v[164:167]
v_mfma_f32_16x16x32_bf16 v[160:163], v[36:39], a[148:151], v[160:163]
v_mfma_f32_16x16x32_bf16 v[164:167], v[36:39], a[180:183], v[164:167]
v_mfma_f32_16x16x32_bf16 v[160:163], v[40:43], a[152:155], v[160:163]
v_mfma_f32_16x16x32_bf16 v[164:167], v[40:43], a[184:187], v[164:167]
v_mfma_f32_16x16x32_bf16 v[160:163], v[44:47], a[156:159], v[160:163]
v_mfma_f32_16x16x32_bf16 v[164:167], v[44:47], a[188:191], v[164:167]
s_waitcnt vmcnt(11)
v_mfma_f32_16x16x32_bf16 v[168:171], a[0:3], v[48:51], 0
v_mfma_f32_16x16x32_bf16 v[172:175], a[32:35], v[48:51], 0
buffer_load_dwordx4 v[112:115], v2, s[8:11], s45 offen offset:0 sc1
v_mfma_f32_16x16x32_bf16 v[168:171], a[4:7], v[52:55], v[168:171]
v_mfma_f32_16x16x32_bf16 v[172:175], a[36:39], v[52:55], v[172:175]
v_mfma_f32_16x16x32_bf16 v[168:171], a[8:11], v[56:59], v[168:171]
ds_write_b128 v2, v[160:163] offset:4096
v_mfma_f32_16x16x32_bf16 v[172:175], a[40:43], v[56:59], v[172:175]
v_mfma_f32_16x16x32_bf16 v[168:171], a[12:15], v[60:63], v[168:171]
buffer_load_dwordx4 v[116:119], v2, s[8:11], s45 offen offset:1024 sc1
v_mfma_f32_16x16x32_bf16 v[172:175], a[44:47], v[60:63], v[172:175]
ds_write_b128 v2, v[164:167] offset:5120
v_mfma_f32_16x16x32_bf16 v[168:171], a[16:19], v[64:67], v[168:171]
v_mfma_f32_16x16x32_bf16 v[172:175], a[48:51], v[64:67], v[172:175]
v_mfma_f32_16x16x32_bf16 v[168:171], a[20:23], v[68:71], v[168:171]
v_mfma_f32_16x16x32_bf16 v[172:175], a[52:55], v[68:71], v[172:175]
buffer_load_dwordx4 v[120:123], v2, s[8:11], s45 offen offset:2048 sc1
v_mfma_f32_16x16x32_bf16 v[168:171], a[24:27], v[72:75], v[168:171]
v_mfma_f32_16x16x32_bf16 v[172:175], a[56:59], v[72:75], v[172:175]
v_mfma_f32_16x16x32_bf16 v[168:171], a[28:31], v[76:79], v[168:171]
v_mfma_f32_16x16x32_bf16 v[172:175], a[60:63], v[76:79], v[172:175]
v_mfma_f32_16x16x32_bf16 v[176:179], a[64:67], v[48:51], 0
buffer_load_dwordx4 v[124:127], v2, s[8:11], s45 offen offset:3072 sc1
v_mfma_f32_16x16x32_bf16 v[180:183], a[96:99], v[48:51], 0
v_mfma_f32_16x16x32_bf16 v[176:179], a[68:71], v[52:55], v[176:179]
v_mfma_f32_16x16x32_bf16 v[180:183], a[100:103], v[52:55], v[180:183]
v_mfma_f32_16x16x32_bf16 v[176:179], a[72:75], v[56:59], v[176:179]
s_nop 0
ds_write_b128 v2, v[168:171] offset:6144
v_mfma_f32_16x16x32_bf16 v[180:183], a[104:107], v[56:59], v[180:183]
buffer_load_dwordx4 v[128:131], v5, s[8:11], s45 offen offset:0 sc1
v_mfma_f32_16x16x32_bf16 v[176:179], a[76:79], v[60:63], v[176:179]
v_mfma_f32_16x16x32_bf16 v[180:183], a[108:111], v[60:63], v[180:183]
ds_write_b128 v2, v[172:175] offset:7168
v_mfma_f32_16x16x32_bf16 v[176:179], a[80:83], v[64:67], v[176:179]
v_mfma_f32_16x16x32_bf16 v[180:183], a[112:115], v[64:67], v[180:183]
v_mfma_f32_16x16x32_bf16 v[176:179], a[84:87], v[68:71], v[176:179]
buffer_load_dwordx4 v[132:135], v5, s[8:11], s45 offen offset:1024 sc1
v_mfma_f32_16x16x32_bf16 v[180:183], a[116:119], v[68:71], v[180:183]
v_mfma_f32_16x16x32_bf16 v[176:179], a[88:91], v[72:75], v[176:179]
v_mfma_f32_16x16x32_bf16 v[180:183], a[120:123], v[72:75], v[180:183]
v_mfma_f32_16x16x32_bf16 v[176:179], a[92:95], v[76:79], v[176:179]
v_mfma_f32_16x16x32_bf16 v[180:183], a[124:127], v[76:79], v[180:183]
buffer_load_dwordx4 v[136:139], v5, s[8:11], s45 offen offset:2048 sc1
v_mfma_f32_16x16x32_bf16 v[184:187], v[48:51], a[128:131], 0
v_mfma_f32_16x16x32_bf16 v[188:191], v[48:51], a[160:163], 0
v_mfma_f32_16x16x32_bf16 v[184:187], v[52:55], a[132:135], v[184:187]
v_mfma_f32_16x16x32_bf16 v[188:191], v[52:55], a[164:167], v[188:191]
v_mfma_f32_16x16x32_bf16 v[184:187], v[56:59], a[136:139], v[184:187]
buffer_load_dwordx4 v[140:143], v5, s[8:11], s45 offen offset:3072 sc1
ds_write_b128 v2, v[176:179] offset:8192
v_mfma_f32_16x16x32_bf16 v[188:191], v[56:59], a[168:171], v[188:191]
s_mov_b32 m0, s68
v_mfma_f32_16x16x32_bf16 v[184:187], v[60:63], a[140:143], v[184:187]
buffer_load_dwordx4 v243, s[12:15], s69 offen lds
v_mfma_f32_16x16x32_bf16 v[188:191], v[60:63], a[172:175], v[188:191]
s_add_u32 s68, s68, s70
s_add_u32 s69, s69, s71
ds_write_b128 v2, v[180:183] offset:9216
v_mfma_f32_16x16x32_bf16 v[184:187], v[64:67], a[144:147], v[184:187]
v_mfma_f32_16x16x32_bf16 v[188:191], v[64:67], a[176:179], v[188:191]
v_mfma_f32_16x16x32_bf16 v[184:187], v[68:71], a[148:151], v[184:187]
v_mfma_f32_16x16x32_bf16 v[188:191], v[68:71], a[180:183], v[188:191]
v_mfma_f32_16x16x32_bf16 v[184:187], v[72:75], a[152:155], v[184:187]
v_mfma_f32_16x16x32_bf16 v[188:191], v[72:75], a[184:187], v[188:191]
v_mfma_f32_16x16x32_bf16 v[184:187], v[76:79], a[156:159], v[184:187]
v_mfma_f32_16x16x32_bf16 v[188:191], v[76:79], a[188:191], v[188:191]
s_nop 6
ds_write_b128 v2, v[184:187] offset:10240
ds_write_b128 v2, v[188:191] offset:11264
s_add_u32 s55, s55, 0x40000
s_add_u32 s56, s56, 0x40000
s_add_u32 s57, s57, 0x40000
s_cmp_eq_u32 s52, 60
s_cselect_b32 s45, 0x1000000, 0
s_sub_u32 s55, s55, s45
s_sub_u32 s56, s56, s45
s_sub_u32 s57, s57, s45
s_waitcnt vmcnt(19) lgkmcnt(0)
s_barrier
s_min_u32 s46, s59, 64
v_mov_b32 v6, s46
v_mov_b32 v7, 0
s_mov_b64 exec, 1
buffer_store_dword v6, v7, s[8:11], s58 offen sc1
s_mov_b64 exec, -1
s_add_u32 s59, s59, 1
s_branch fg1_loop_w0_\sf
fg1_done_w0_\sf:
ds_read_b128 v[192:195], v2 offset:49152
ds_read_b128 v[196:199], v2 offset:61440
ds_read_b128 v[200:203], v4 offset:24576
ds_read_b128 v[204:207], v4 offset:36864
ds_read_b128 v[208:211], v2 offset:50176
ds_read_b128 v[212:215], v2 offset:62464
ds_read_b128 v[216:219], v4 offset:25600
ds_read_b128 v[220:223], v4 offset:37888
s_waitcnt lgkmcnt(0)
v_add_f32 v192, v192, v196
v_add_f32 v200, v200, v204
v_add_f32 v193, v193, v197
v_add_f32 v201, v201, v205
v_add_f32 v194, v194, v198
v_add_f32 v202, v202, v206
v_add_f32 v195, v195, v199
v_add_f32 v203, v203, v207
v_add_f32 v192, v192, v200
v_add_f32 v193, v193, v201
v_add_f32 v194, v194, v202
v_add_f32 v195, v195, v203
v_cvt_pk_bf16_f32 v224, v192, v193
v_cvt_pk_bf16_f32 v225, v194, v195
v_add_f32 v208, v208, v212
v_add_f32 v216, v216, v220
v_add_f32 v209, v209, v213
v_add_f32 v217, v217, v221
v_add_f32 v210, v210, v214
v_add_f32 v218, v218, v222
v_add_f32 v211, v211, v215
v_add_f32 v219, v219, v223
v_add_f32 v208, v208, v216
v_add_f32 v209, v209, v217
v_add_f32 v210, v210, v218
v_add_f32 v211, v211, v219
v_cvt_pk_bf16_f32 v226, v208, v209
v_cvt_pk_bf16_f32 v227, v210, v211
buffer_store_dwordx4 v[224:227], v2, s[8:11], s55 offen sc1
s_nop 1
s_branch fg1_join_\sf
fg1_wave1_\sf:
v_and_b32 v12, 15, v1
v_lshrrev_b32 v13, 4, v1
v_lshlrev_b32 v13, 5, v13
v_lshl_add_u32 v3, v12, 11, v13
v_add_u32 v4, 49152, v2
v_add_u32 v5, 4096, v2
s_lshl_b32 s54, s52, 16
s_lshl_b32 s45, s92, 22
s_add_u32 s54, s54, s45
.if \sf == 0
s_add_u32 s54, s54, 0x6002000
.else
s_add_u32 s54, s54, 0xe002000
.endif
s_lshl_b32 s45, s52, 5
s_add_u32 s45, s45, s49
s_lshl_b32 s45, s45, 13
s_lshl_b32 s46, s50, 10
s_add_u32 s47, s45, s46
s_add_u32 s55, s47, 0x0
s_add_u32 s56, s47, 0x1000000
s_add_u32 s47, s47, s46
s_add_u32 s57, s47, 0x2000000
v_mov_b32 v9, s91
s_nop 1
dw_120_\sf:
buffer_load_dword v8, v9, s[32:35], 0 offen sc1
s_waitcnt vmcnt(0)
v_cmp_gt_u32 vcc, 32, v8
s_cbranch_vccz dwd_121_\sf
s_add_u32 s44, s44, 1
s_cmp_lt_u32 s44, 0x40000
s_cbranch_scc1 dw_120_\sf
s_nop 0
dwd_121_\sf:
s_add_u32 s45, s54, 0x8000
buffer_load_dwordx4 v[16:19], v2, s[8:11], s54 offen offset:0 sc1
buffer_load_dwordx4 v[20:23], v2, s[8:11], s54 offen offset:1024 sc1
buffer_load_dwordx4 v[24:27], v2, s[8:11], s54 offen offset:2048 sc1
buffer_load_dwordx4 v[28:31], v2, s[8:11], s54 offen offset:3072 sc1
buffer_load_dwordx4 v[32:35], v5, s[8:11], s54 offen offset:0 sc1
buffer_load_dwordx4 v[36:39], v5, s[8:11], s54 offen offset:1024 sc1
buffer_load_dwordx4 v[40:43], v5, s[8:11], s54 offen offset:2048 sc1
buffer_load_dwordx4 v[44:47], v5, s[8:11], s54 offen offset:3072 sc1
buffer_load_dwordx4 v[48:51], v2, s[8:11], s45 offen offset:0 sc1
buffer_load_dwordx4 v[52:55], v2, s[8:11], s45 offen offset:1024 sc1
buffer_load_dwordx4 v[56:59], v2, s[8:11], s45 offen offset:2048 sc1
buffer_load_dwordx4 v[60:63], v2, s[8:11], s45 offen offset:3072 sc1
buffer_load_dwordx4 v[64:67], v5, s[8:11], s45 offen offset:0 sc1
buffer_load_dwordx4 v[68:71], v5, s[8:11], s45 offen offset:1024 sc1
buffer_load_dwordx4 v[72:75], v5, s[8:11], s45 offen offset:2048 sc1
buffer_load_dwordx4 v[76:79], v5, s[8:11], s45 offen offset:3072 sc1
s_mov_b32 s52, 0
s_load_dwordx2 s[12:13], s[0:1], 88
s_waitcnt lgkmcnt(0)
s_and_b32 s13, s13, 0xffff
s_mov_b32 s14, 0x700000
s_mov_b32 s15, 0x20000
s_mov_b32 s14, 0
s_mov_b32 s68, 0x30000
s_mov_b32 s69, 0
s_mov_b32 s70, 0
s_mov_b32 s71, 0
v_mov_b32 v243, 0
s_barrier
s_add_u32 s54, s54, 0x10000
s_add_u32 s45, s54, 0x8000
s_waitcnt vmcnt(0)
v_mfma_f32_16x16x32_bf16 v[144:147], a[0:3], v[16:19], 0
v_mfma_f32_16x16x32_bf16 v[148:151], a[32:35], v[16:19], 0
buffer_load_dwordx4 v[80:83], v2, s[8:11], s54 offen offset:0 sc1
v_mfma_f32_16x16x32_bf16 v[144:147], a[4:7], v[20:23], v[144:147]
buffer_load_dwordx4 a[192:195], v3, s[24:27], s61 offen offset:0
v_mfma_f32_16x16x32_bf16 v[148:151], a[36:39], v[20:23], v[148:151]
v_mfma_f32_16x16x32_bf16 v[144:147], a[8:11], v[24:27], v[144:147]
v_mfma_f32_16x16x32_bf16 v[148:151], a[40:43], v[24:27], v[148:151]
v_mfma_f32_16x16x32_bf16 v[144:147], a[12:15], v[28:31], v[144:147]
buffer_load_dwordx4 v[84:87], v2, s[8:11], s54 offen offset:1024 sc1
buffer_load_dwordx4 a[196:199], v3, s[24:27], s61 offen offset:16
v_mfma_f32_16x16x32_bf16 v[148:151], a[44:47], v[28:31], v[148:151]
v_mfma_f32_16x16x32_bf16 v[144:147], a[16:19], v[32:35], v[144:147]
v_mfma_f32_16x16x32_bf16 v[148:151], a[48:51], v[32:35], v[148:151]
v_mfma_f32_16x16x32_bf16 v[144:147], a[20:23], v[36:39], v[144:147]
buffer_load_dwordx4 a[200:203], v3, s[24:27], s61 offen offset:128
v_mfma_f32_16x16x32_bf16 v[148:151], a[52:55], v[36:39], v[148:151]
buffer_load_dwordx4 v[88:91], v2, s[8:11], s54 offen offset:2048 sc1
v_mfma_f32_16x16x32_bf16 v[144:147], a[24:27], v[40:43], v[144:147]
v_mfma_f32_16x16x32_bf16 v[148:151], a[56:59], v[40:43], v[148:151]
v_mfma_f32_16x16x32_bf16 v[144:147], a[28:31], v[44:47], v[144:147]
buffer_load_dwordx4 a[204:207], v3, s[24:27], s61 offen offset:144
v_mfma_f32_16x16x32_bf16 v[148:151], a[60:63], v[44:47], v[148:151]
v_mfma_f32_16x16x32_bf16 v[152:155], a[64:67], v[16:19], 0
buffer_load_dwordx4 v[92:95], v2, s[8:11], s54 offen offset:3072 sc1
v_mfma_f32_16x16x32_bf16 v[156:159], a[96:99], v[16:19], 0
v_mfma_f32_16x16x32_bf16 v[152:155], a[68:71], v[20:23], v[152:155]
buffer_load_dwordx4 a[208:211], v3, s[24:27], s61 offen offset:256
v_mfma_f32_16x16x32_bf16 v[156:159], a[100:103], v[20:23], v[156:159]
v_mfma_f32_16x16x32_bf16 v[152:155], a[72:75], v[24:27], v[152:155]
ds_write_b128 v2, v[144:147] offset:12288
v_mfma_f32_16x16x32_bf16 v[156:159], a[104:107], v[24:27], v[156:159]
buffer_load_dwordx4 v[96:99], v5, s[8:11], s54 offen offset:0 sc1
v_mfma_f32_16x16x32_bf16 v[152:155], a[76:79], v[28:31], v[152:155]
buffer_load_dwordx4 a[212:215], v3, s[24:27], s61 offen offset:272
v_mfma_f32_16x16x32_bf16 v[156:159], a[108:111], v[28:31], v[156:159]
ds_write_b128 v2, v[148:151] offset:13312
v_mfma_f32_16x16x32_bf16 v[152:155], a[80:83], v[32:35], v[152:155]
v_mfma_f32_16x16x32_bf16 v[156:159], a[112:115], v[32:35], v[156:159]
v_mfma_f32_16x16x32_bf16 v[152:155], a[84:87], v[36:39], v[152:155]
buffer_load_dwordx4 v[100:103], v5, s[8:11], s54 offen offset:1024 sc1
buffer_load_dwordx4 a[216:219], v3, s[24:27], s61 offen offset:384
v_mfma_f32_16x16x32_bf16 v[156:159], a[116:119], v[36:39], v[156:159]
v_mfma_f32_16x16x32_bf16 v[152:155], a[88:91], v[40:43], v[152:155]
v_mfma_f32_16x16x32_bf16 v[156:159], a[120:123], v[40:43], v[156:159]
v_mfma_f32_16x16x32_bf16 v[152:155], a[92:95], v[44:47], v[152:155]
buffer_load_dwordx4 a[220:223], v3, s[24:27], s61 offen offset:400
v_mfma_f32_16x16x32_bf16 v[156:159], a[124:127], v[44:47], v[156:159]
buffer_load_dwordx4 v[104:107], v5, s[8:11], s54 offen offset:2048 sc1
v_mfma_f32_16x16x32_bf16 v[160:163], v[16:19], a[128:131], 0
v_mfma_f32_16x16x32_bf16 v[164:167], v[16:19], a[160:163], 0
v_mfma_f32_16x16x32_bf16 v[160:163], v[20:23], a[132:135], v[160:163]
v_mfma_f32_16x16x32_bf16 v[164:167], v[20:23], a[164:167], v[164:167]
v_mfma_f32_16x16x32_bf16 v[160:163], v[24:27], a[136:139], v[160:163]
buffer_load_dwordx4 v[108:111], v5, s[8:11], s54 offen offset:3072 sc1
ds_write_b128 v2, v[152:155] offset:14336
v_mfma_f32_16x16x32_bf16 v[164:167], v[24:27], a[168:171], v[164:167]
s_mov_b32 m0, s68
v_mfma_f32_16x16x32_bf16 v[160:163], v[28:31], a[140:143], v[160:163]
buffer_load_dwordx4 v243, s[12:15], s69 offen lds
v_mfma_f32_16x16x32_bf16 v[164:167], v[28:31], a[172:175], v[164:167]
s_add_u32 s68, s68, s70
s_add_u32 s69, s69, s71
ds_write_b128 v2, v[156:159] offset:15360
v_mfma_f32_16x16x32_bf16 v[160:163], v[32:35], a[144:147], v[160:163]
v_mfma_f32_16x16x32_bf16 v[164:167], v[32:35], a[176:179], v[164:167]
v_mfma_f32_16x16x32_bf16 v[160:163], v[36:39], a[148:151], v[160:163]
v_mfma_f32_16x16x32_bf16 v[164:167], v[36:39], a[180:183], v[164:167]
v_mfma_f32_16x16x32_bf16 v[160:163], v[40:43], a[152:155], v[160:163]
v_mfma_f32_16x16x32_bf16 v[164:167], v[40:43], a[184:187], v[164:167]
v_mfma_f32_16x16x32_bf16 v[160:163], v[44:47], a[156:159], v[160:163]
v_mfma_f32_16x16x32_bf16 v[164:167], v[44:47], a[188:191], v[164:167]
v_mfma_f32_16x16x32_bf16 v[168:171], a[0:3], v[48:51], 0
v_mfma_f32_16x16x32_bf16 v[172:175], a[32:35], v[48:51], 0
buffer_load_dwordx4 v[112:115], v2, s[8:11], s45 offen offset:0 sc1
v_mfma_f32_16x16x32_bf16 v[168:171], a[4:7], v[52:55], v[168:171]
v_mfma_f32_16x16x32_bf16 v[172:175], a[36:39], v[52:55], v[172:175]
v_mfma_f32_16x16x32_bf16 v[168:171], a[8:11], v[56:59], v[168:171]
s_nop 0
ds_write_b128 v2, v[160:163] offset:16384
v_mfma_f32_16x16x32_bf16 v[172:175], a[40:43], v[56:59], v[172:175]
v_mfma_f32_16x16x32_bf16 v[168:171], a[12:15], v[60:63], v[168:171]
buffer_load_dwordx4 v[116:119], v2, s[8:11], s45 offen offset:1024 sc1
v_mfma_f32_16x16x32_bf16 v[172:175], a[44:47], v[60:63], v[172:175]
ds_write_b128 v2, v[164:167] offset:17408
v_mfma_f32_16x16x32_bf16 v[168:171], a[16:19], v[64:67], v[168:171]
v_mfma_f32_16x16x32_bf16 v[172:175], a[48:51], v[64:67], v[172:175]
v_mfma_f32_16x16x32_bf16 v[168:171], a[20:23], v[68:71], v[168:171]
v_mfma_f32_16x16x32_bf16 v[172:175], a[52:55], v[68:71], v[172:175]
buffer_load_dwordx4 v[120:123], v2, s[8:11], s45 offen offset:2048 sc1
v_mfma_f32_16x16x32_bf16 v[168:171], a[24:27], v[72:75], v[168:171]
v_mfma_f32_16x16x32_bf16 v[172:175], a[56:59], v[72:75], v[172:175]
v_mfma_f32_16x16x32_bf16 v[168:171], a[28:31], v[76:79], v[168:171]
v_mfma_f32_16x16x32_bf16 v[172:175], a[60:63], v[76:79], v[172:175]
v_mfma_f32_16x16x32_bf16 v[176:179], a[64:67], v[48:51], 0
buffer_load_dwordx4 v[124:127], v2, s[8:11], s45 offen offset:3072 sc1
v_mfma_f32_16x16x32_bf16 v[180:183], a[96:99], v[48:51], 0
v_mfma_f32_16x16x32_bf16 v[176:179], a[68:71], v[52:55], v[176:179]
v_mfma_f32_16x16x32_bf16 v[180:183], a[100:103], v[52:55], v[180:183]
v_mfma_f32_16x16x32_bf16 v[176:179], a[72:75], v[56:59], v[176:179]
s_nop 0
ds_write_b128 v2, v[168:171] offset:18432
v_mfma_f32_16x16x32_bf16 v[180:183], a[104:107], v[56:59], v[180:183]
buffer_load_dwordx4 v[128:131], v5, s[8:11], s45 offen offset:0 sc1
v_mfma_f32_16x16x32_bf16 v[176:179], a[76:79], v[60:63], v[176:179]
v_mfma_f32_16x16x32_bf16 v[180:183], a[108:111], v[60:63], v[180:183]
ds_write_b128 v2, v[172:175] offset:19456
v_mfma_f32_16x16x32_bf16 v[176:179], a[80:83], v[64:67], v[176:179]
v_mfma_f32_16x16x32_bf16 v[180:183], a[112:115], v[64:67], v[180:183]
v_mfma_f32_16x16x32_bf16 v[176:179], a[84:87], v[68:71], v[176:179]
buffer_load_dwordx4 v[132:135], v5, s[8:11], s45 offen offset:1024 sc1
v_mfma_f32_16x16x32_bf16 v[180:183], a[116:119], v[68:71], v[180:183]
v_mfma_f32_16x16x32_bf16 v[176:179], a[88:91], v[72:75], v[176:179]
v_mfma_f32_16x16x32_bf16 v[180:183], a[120:123], v[72:75], v[180:183]
v_mfma_f32_16x16x32_bf16 v[176:179], a[92:95], v[76:79], v[176:179]
v_mfma_f32_16x16x32_bf16 v[180:183], a[124:127], v[76:79], v[180:183]
buffer_load_dwordx4 v[136:139], v5, s[8:11], s45 offen offset:2048 sc1
v_mfma_f32_16x16x32_bf16 v[184:187], v[48:51], a[128:131], 0
v_mfma_f32_16x16x32_bf16 v[188:191], v[48:51], a[160:163], 0
v_mfma_f32_16x16x32_bf16 v[184:187], v[52:55], a[132:135], v[184:187]
v_mfma_f32_16x16x32_bf16 v[188:191], v[52:55], a[164:167], v[188:191]
v_mfma_f32_16x16x32_bf16 v[184:187], v[56:59], a[136:139], v[184:187]
buffer_load_dwordx4 v[140:143], v5, s[8:11], s45 offen offset:3072 sc1
ds_write_b128 v2, v[176:179] offset:20480
v_mfma_f32_16x16x32_bf16 v[188:191], v[56:59], a[168:171], v[188:191]
s_mov_b32 m0, s68
v_mfma_f32_16x16x32_bf16 v[184:187], v[60:63], a[140:143], v[184:187]
buffer_load_dwordx4 v243, s[12:15], s69 offen lds
v_mfma_f32_16x16x32_bf16 v[188:191], v[60:63], a[172:175], v[188:191]
s_add_u32 s68, s68, s70
s_add_u32 s69, s69, s71
ds_write_b128 v2, v[180:183] offset:21504
v_mfma_f32_16x16x32_bf16 v[184:187], v[64:67], a[144:147], v[184:187]
v_mfma_f32_16x16x32_bf16 v[188:191], v[64:67], a[176:179], v[188:191]
v_mfma_f32_16x16x32_bf16 v[184:187], v[68:71], a[148:151], v[184:187]
v_mfma_f32_16x16x32_bf16 v[188:191], v[68:71], a[180:183], v[188:191]
v_mfma_f32_16x16x32_bf16 v[184:187], v[72:75], a[152:155], v[184:187]
v_mfma_f32_16x16x32_bf16 v[188:191], v[72:75], a[184:187], v[188:191]
v_mfma_f32_16x16x32_bf16 v[184:187], v[76:79], a[156:159], v[184:187]
v_mfma_f32_16x16x32_bf16 v[188:191], v[76:79], a[188:191], v[188:191]
s_nop 6
ds_write_b128 v2, v[184:187] offset:22528
ds_write_b128 v2, v[188:191] offset:23552
s_add_u32 s61, s61, 0x100000
s_waitcnt lgkmcnt(0)
s_barrier
s_add_u32 s54, s54, 0x10000
s_cmp_eq_u32 s52, 58
s_cselect_b32 s45, 0x400000, 0
s_sub_u32 s54, s54, s45
s_add_u32 s45, s54, 0x8000
s_waitcnt vmcnt(10)
v_mfma_f32_16x16x32_bf16 v[144:147], a[0:3], v[80:83], 0
ds_read_b128 v[192:195], v2 offset:2048
v_mfma_f32_16x16x32_bf16 v[148:151], a[32:35], v[80:83], 0
buffer_load_dwordx4 v[16:19], v2, s[8:11], s54 offen offset:0 sc1
ds_read_b128 v[196:199], v2 offset:14336
v_mfma_f32_16x16x32_bf16 v[144:147], a[4:7], v[84:87], v[144:147]
buffer_load_dwordx4 a[224:227], v3, s[24:27], s61 offen offset:0
ds_read_b128 v[200:203], v2 offset:26624
v_mfma_f32_16x16x32_bf16 v[148:151], a[36:39], v[84:87], v[148:151]
ds_read_b128 v[204:207], v2 offset:38912
v_mfma_f32_16x16x32_bf16 v[144:147], a[8:11], v[88:91], v[144:147]
.if \sf == 0
buffer_store_dwordx4 a[192:195], v2, s[8:11], s62 offen offset:0
.else
buffer_store_dwordx4 a[192:195], v2, s[8:11], s62 offen offset:0 sc1
.endif
ds_read_b128 v[208:211], v2 offset:3072
v_mfma_f32_16x16x32_bf16 v[148:151], a[40:43], v[88:91], v[148:151]
ds_read_b128 v[212:215], v2 offset:15360
v_mfma_f32_16x16x32_bf16 v[144:147], a[12:15], v[92:95], v[144:147]
buffer_load_dwordx4 v[20:23], v2, s[8:11], s54 offen offset:1024 sc1
buffer_load_dwordx4 a[228:231], v3, s[24:27], s61 offen offset:16
v_mfma_f32_16x16x32_bf16 v[148:151], a[44:47], v[92:95], v[148:151]
ds_read_b128 v[216:219], v2 offset:27648
v_mfma_f32_16x16x32_bf16 v[144:147], a[16:19], v[96:99], v[144:147]
.if \sf == 0
buffer_store_dwordx4 a[196:199], v2, s[8:11], s62 offen offset:1024
.else
buffer_store_dwordx4 a[196:199], v2, s[8:11], s62 offen offset:1024 sc1
.endif
ds_read_b128 v[220:223], v2 offset:39936
v_mfma_f32_16x16x32_bf16 v[148:151], a[48:51], v[96:99], v[148:151]
v_mfma_f32_16x16x32_bf16 v[144:147], a[20:23], v[100:103], v[144:147]
buffer_load_dwordx4 a[232:235], v3, s[24:27], s61 offen offset:128
v_mfma_f32_16x16x32_bf16 v[148:151], a[52:55], v[100:103], v[148:151]
buffer_load_dwordx4 v[24:27], v2, s[8:11], s54 offen offset:2048 sc1
v_mfma_f32_16x16x32_bf16 v[144:147], a[24:27], v[104:107], v[144:147]
.if \sf == 0
buffer_store_dwordx4 a[200:203], v2, s[8:11], s62 offen offset:2048
.else
buffer_store_dwordx4 a[200:203], v2, s[8:11], s62 offen offset:2048 sc1
.endif
v_mfma_f32_16x16x32_bf16 v[148:151], a[56:59], v[104:107], v[148:151]
v_mfma_f32_16x16x32_bf16 v[144:147], a[28:31], v[108:111], v[144:147]
buffer_load_dwordx4 a[236:239], v3, s[24:27], s61 offen offset:144
s_waitcnt lgkmcnt(0)
v_mfma_f32_16x16x32_bf16 v[148:151], a[60:63], v[108:111], v[148:151]
v_add_f32 v192, v192, v196
v_add_f32 v200, v200, v204
v_mfma_f32_16x16x32_bf16 v[152:155], a[64:67], v[80:83], 0
buffer_load_dwordx4 v[28:31], v2, s[8:11], s54 offen offset:3072 sc1
.if \sf == 0
buffer_store_dwordx4 a[204:207], v2, s[8:11], s62 offen offset:3072
.else
buffer_store_dwordx4 a[204:207], v2, s[8:11], s62 offen offset:3072 sc1
.endif
v_mfma_f32_16x16x32_bf16 v[156:159], a[96:99], v[80:83], 0
v_add_f32 v193, v193, v197
v_add_f32 v201, v201, v205
v_mfma_f32_16x16x32_bf16 v[152:155], a[68:71], v[84:87], v[152:155]
buffer_load_dwordx4 a[240:243], v3, s[24:27], s61 offen offset:256
v_add_f32 v194, v194, v198
v_mfma_f32_16x16x32_bf16 v[156:159], a[100:103], v[84:87], v[156:159]
v_add_f32 v202, v202, v206
v_add_f32 v195, v195, v199
v_mfma_f32_16x16x32_bf16 v[152:155], a[72:75], v[88:91], v[152:155]
.if \sf == 0
buffer_store_dwordx4 a[208:211], v5, s[8:11], s62 offen offset:0
.else
buffer_store_dwordx4 a[208:211], v5, s[8:11], s62 offen offset:0 sc1
.endif
ds_write_b128 v2, v[144:147] offset:61440
v_mfma_f32_16x16x32_bf16 v[156:159], a[104:107], v[88:91], v[156:159]
buffer_load_dwordx4 v[32:35], v5, s[8:11], s54 offen offset:0 sc1
v_add_f32 v203, v203, v207
v_mfma_f32_16x16x32_bf16 v[152:155], a[76:79], v[92:95], v[152:155]
buffer_load_dwordx4 a[244:247], v3, s[24:27], s61 offen offset:272
v_add_f32 v192, v192, v200
v_mfma_f32_16x16x32_bf16 v[156:159], a[108:111], v[92:95], v[156:159]
ds_write_b128 v2, v[148:151] offset:62464
v_add_f32 v193, v193, v201
v_mfma_f32_16x16x32_bf16 v[152:155], a[80:83], v[96:99], v[152:155]
.if \sf == 0
buffer_store_dwordx4 a[212:215], v5, s[8:11], s62 offen offset:1024
.else
buffer_store_dwordx4 a[212:215], v5, s[8:11], s62 offen offset:1024 sc1
.endif
v_add_f32 v194, v194, v202
v_mfma_f32_16x16x32_bf16 v[156:159], a[112:115], v[96:99], v[156:159]
v_add_f32 v195, v195, v203
v_cvt_pk_bf16_f32 v224, v192, v193
v_mfma_f32_16x16x32_bf16 v[152:155], a[84:87], v[100:103], v[152:155]
buffer_load_dwordx4 v[36:39], v5, s[8:11], s54 offen offset:1024 sc1
buffer_load_dwordx4 a[248:251], v3, s[24:27], s61 offen offset:384
v_mfma_f32_16x16x32_bf16 v[156:159], a[116:119], v[100:103], v[156:159]
v_cvt_pk_bf16_f32 v225, v194, v195
v_add_f32 v208, v208, v212
v_mfma_f32_16x16x32_bf16 v[152:155], a[88:91], v[104:107], v[152:155]
.if \sf == 0
buffer_store_dwordx4 a[216:219], v5, s[8:11], s62 offen offset:2048
.else
buffer_store_dwordx4 a[216:219], v5, s[8:11], s62 offen offset:2048 sc1
.endif
v_add_f32 v216, v216, v220
v_mfma_f32_16x16x32_bf16 v[156:159], a[120:123], v[104:107], v[156:159]
v_add_f32 v209, v209, v213
v_add_f32 v217, v217, v221
v_mfma_f32_16x16x32_bf16 v[152:155], a[92:95], v[108:111], v[152:155]
buffer_load_dwordx4 a[252:255], v3, s[24:27], s61 offen offset:400
v_add_f32 v210, v210, v214
v_mfma_f32_16x16x32_bf16 v[156:159], a[124:127], v[108:111], v[156:159]
buffer_load_dwordx4 v[40:43], v5, s[8:11], s54 offen offset:2048 sc1
v_add_f32 v218, v218, v222
v_mfma_f32_16x16x32_bf16 v[160:163], v[80:83], a[128:131], 0
.if \sf == 0
buffer_store_dwordx4 a[220:223], v5, s[8:11], s62 offen offset:3072
.else
buffer_store_dwordx4 a[220:223], v5, s[8:11], s62 offen offset:3072 sc1
.endif
v_add_f32 v211, v211, v215
v_mfma_f32_16x16x32_bf16 v[164:167], v[80:83], a[160:163], 0
v_add_f32 v219, v219, v223
v_add_f32 v208, v208, v216
v_mfma_f32_16x16x32_bf16 v[160:163], v[84:87], a[132:135], v[160:163]
v_add_f32 v209, v209, v217
v_add_f32 v210, v210, v218
v_mfma_f32_16x16x32_bf16 v[164:167], v[84:87], a[164:167], v[164:167]
v_add_f32 v211, v211, v219
v_cvt_pk_bf16_f32 v226, v208, v209
v_mfma_f32_16x16x32_bf16 v[160:163], v[88:91], a[136:139], v[160:163]
buffer_load_dwordx4 v[44:47], v5, s[8:11], s54 offen offset:3072 sc1
ds_write_b128 v2, v[152:155] offset:63488
v_mfma_f32_16x16x32_bf16 v[164:167], v[88:91], a[168:171], v[164:167]
s_mov_b32 m0, s68
v_cvt_pk_bf16_f32 v227, v210, v211
v_mfma_f32_16x16x32_bf16 v[160:163], v[92:95], a[140:143], v[160:163]
buffer_load_dwordx4 v243, s[12:15], s69 offen lds
buffer_store_dwordx4 v[224:227], v2, s[8:11], s56 offen sc1
v_mfma_f32_16x16x32_bf16 v[164:167], v[92:95], a[172:175], v[164:167]
s_add_u32 s68, s68, s70
s_add_u32 s69, s69, s71
ds_write_b128 v2, v[156:159] offset:64512
v_mfma_f32_16x16x32_bf16 v[160:163], v[96:99], a[144:147], v[160:163]
ds_read_b128 v[192:195], v2 offset:8192
v_mfma_f32_16x16x32_bf16 v[164:167], v[96:99], a[176:179], v[164:167]
ds_read_b128 v[196:199], v2 offset:20480
v_mfma_f32_16x16x32_bf16 v[160:163], v[100:103], a[148:151], v[160:163]
ds_read_b128 v[200:203], v2 offset:32768
v_mfma_f32_16x16x32_bf16 v[164:167], v[100:103], a[180:183], v[164:167]
ds_read_b128 v[204:207], v2 offset:45056
v_mfma_f32_16x16x32_bf16 v[160:163], v[104:107], a[152:155], v[160:163]
ds_read_b128 v[208:211], v2 offset:9216
v_mfma_f32_16x16x32_bf16 v[164:167], v[104:107], a[184:187], v[164:167]
ds_read_b128 v[212:215], v2 offset:21504
v_mfma_f32_16x16x32_bf16 v[160:163], v[108:111], a[156:159], v[160:163]
ds_read_b128 v[216:219], v2 offset:33792
v_mfma_f32_16x16x32_bf16 v[164:167], v[108:111], a[188:191], v[164:167]
ds_read_b128 v[220:223], v2 offset:46080
s_waitcnt vmcnt(27)
v_mfma_f32_16x16x32_bf16 v[168:171], a[0:3], v[112:115], 0
v_mfma_f32_16x16x32_bf16 v[172:175], a[32:35], v[112:115], 0
buffer_load_dwordx4 v[48:51], v2, s[8:11], s45 offen offset:0 sc1
v_mfma_f32_16x16x32_bf16 v[168:171], a[4:7], v[116:119], v[168:171]
v_mfma_f32_16x16x32_bf16 v[172:175], a[36:39], v[116:119], v[172:175]
v_mfma_f32_16x16x32_bf16 v[168:171], a[8:11], v[120:123], v[168:171]
ds_write_b128 v4, v[160:163] offset:16384
v_mfma_f32_16x16x32_bf16 v[172:175], a[40:43], v[120:123], v[172:175]
s_waitcnt lgkmcnt(0)
v_add_f32 v192, v192, v196
v_mfma_f32_16x16x32_bf16 v[168:171], a[12:15], v[124:127], v[168:171]
buffer_load_dwordx4 v[52:55], v2, s[8:11], s45 offen offset:1024 sc1
v_add_f32 v200, v200, v204
v_mfma_f32_16x16x32_bf16 v[172:175], a[44:47], v[124:127], v[172:175]
ds_write_b128 v4, v[164:167] offset:17408
v_add_f32 v193, v193, v197
v_mfma_f32_16x16x32_bf16 v[168:171], a[16:19], v[128:131], v[168:171]
v_add_f32 v201, v201, v205
v_add_f32 v194, v194, v198
v_mfma_f32_16x16x32_bf16 v[172:175], a[48:51], v[128:131], v[172:175]
v_add_f32 v202, v202, v206
v_add_f32 v195, v195, v199
v_mfma_f32_16x16x32_bf16 v[168:171], a[20:23], v[132:135], v[168:171]
v_add_f32 v203, v203, v207
v_add_f32 v192, v192, v200
v_mfma_f32_16x16x32_bf16 v[172:175], a[52:55], v[132:135], v[172:175]
buffer_load_dwordx4 v[56:59], v2, s[8:11], s45 offen offset:2048 sc1
v_add_f32 v193, v193, v201
v_mfma_f32_16x16x32_bf16 v[168:171], a[24:27], v[136:139], v[168:171]
v_add_f32 v194, v194, v202
v_add_f32 v195, v195, v203
v_mfma_f32_16x16x32_bf16 v[172:175], a[56:59], v[136:139], v[172:175]
v_cvt_pk_bf16_f32 v228, v192, v193
v_cvt_pk_bf16_f32 v229, v194, v195
v_mfma_f32_16x16x32_bf16 v[168:171], a[28:31], v[140:143], v[168:171]
v_add_f32 v208, v208, v212
v_add_f32 v216, v216, v220
v_mfma_f32_16x16x32_bf16 v[172:175], a[60:63], v[140:143], v[172:175]
v_add_f32 v209, v209, v213
v_add_f32 v217, v217, v221
v_mfma_f32_16x16x32_bf16 v[176:179], a[64:67], v[112:115], 0
buffer_load_dwordx4 v[60:63], v2, s[8:11], s45 offen offset:3072 sc1
v_add_f32 v210, v210, v214
v_mfma_f32_16x16x32_bf16 v[180:183], a[96:99], v[112:115], 0
v_add_f32 v218, v218, v222
v_add_f32 v211, v211, v215
v_mfma_f32_16x16x32_bf16 v[176:179], a[68:71], v[116:119], v[176:179]
v_add_f32 v219, v219, v223
v_add_f32 v208, v208, v216
v_mfma_f32_16x16x32_bf16 v[180:183], a[100:103], v[116:119], v[180:183]
v_add_f32 v209, v209, v217
v_add_f32 v210, v210, v218
v_mfma_f32_16x16x32_bf16 v[176:179], a[72:75], v[120:123], v[176:179]
ds_write_b128 v4, v[168:171] offset:18432
v_add_f32 v211, v211, v219
v_mfma_f32_16x16x32_bf16 v[180:183], a[104:107], v[120:123], v[180:183]
buffer_load_dwordx4 v[64:67], v5, s[8:11], s45 offen offset:0 sc1
v_cvt_pk_bf16_f32 v230, v208, v209
v_mfma_f32_16x16x32_bf16 v[176:179], a[76:79], v[124:127], v[176:179]
v_cvt_pk_bf16_f32 v231, v210, v211
buffer_store_dwordx4 v[228:231], v5, s[8:11], s56 offen sc1
v_mfma_f32_16x16x32_bf16 v[180:183], a[108:111], v[124:127], v[180:183]
ds_write_b128 v4, v[172:175] offset:19456
v_mfma_f32_16x16x32_bf16 v[176:179], a[80:83], v[128:131], v[176:179]
v_mfma_f32_16x16x32_bf16 v[180:183], a[112:115], v[128:131], v[180:183]
v_mfma_f32_16x16x32_bf16 v[176:179], a[84:87], v[132:135], v[176:179]
buffer_load_dwordx4 v[68:71], v5, s[8:11], s45 offen offset:1024 sc1
v_mfma_f32_16x16x32_bf16 v[180:183], a[116:119], v[132:135], v[180:183]
v_mfma_f32_16x16x32_bf16 v[176:179], a[88:91], v[136:139], v[176:179]
v_mfma_f32_16x16x32_bf16 v[180:183], a[120:123], v[136:139], v[180:183]
v_mfma_f32_16x16x32_bf16 v[176:179], a[92:95], v[140:143], v[176:179]
v_mfma_f32_16x16x32_bf16 v[180:183], a[124:127], v[140:143], v[180:183]
buffer_load_dwordx4 v[72:75], v5, s[8:11], s45 offen offset:2048 sc1
v_mfma_f32_16x16x32_bf16 v[184:187], v[112:115], a[128:131], 0
v_mfma_f32_16x16x32_bf16 v[188:191], v[112:115], a[160:163], 0
v_mfma_f32_16x16x32_bf16 v[184:187], v[116:119], a[132:135], v[184:187]
v_mfma_f32_16x16x32_bf16 v[188:191], v[116:119], a[164:167], v[188:191]
v_mfma_f32_16x16x32_bf16 v[184:187], v[120:123], a[136:139], v[184:187]
buffer_load_dwordx4 v[76:79], v5, s[8:11], s45 offen offset:3072 sc1
ds_write_b128 v4, v[176:179] offset:20480
v_mfma_f32_16x16x32_bf16 v[188:191], v[120:123], a[168:171], v[188:191]
s_mov_b32 m0, s68
v_mfma_f32_16x16x32_bf16 v[184:187], v[124:127], a[140:143], v[184:187]
buffer_load_dwordx4 v243, s[12:15], s69 offen lds
v_mfma_f32_16x16x32_bf16 v[188:191], v[124:127], a[172:175], v[188:191]
s_add_u32 s68, s68, s70
s_add_u32 s69, s69, s71
ds_write_b128 v4, v[180:183] offset:21504
v_mfma_f32_16x16x32_bf16 v[184:187], v[128:131], a[144:147], v[184:187]
v_mfma_f32_16x16x32_bf16 v[188:191], v[128:131], a[176:179], v[188:191]
v_mfma_f32_16x16x32_bf16 v[184:187], v[132:135], a[148:151], v[184:187]
v_mfma_f32_16x16x32_bf16 v[188:191], v[132:135], a[180:183], v[188:191]
v_mfma_f32_16x16x32_bf16 v[184:187], v[136:139], a[152:155], v[184:187]
v_mfma_f32_16x16x32_bf16 v[188:191], v[136:139], a[184:187], v[188:191]
v_mfma_f32_16x16x32_bf16 v[184:187], v[140:143], a[156:159], v[184:187]
v_mfma_f32_16x16x32_bf16 v[188:191], v[140:143], a[188:191], v[188:191]
s_nop 6
ds_write_b128 v4, v[184:187] offset:22528
ds_write_b128 v4, v[188:191] offset:23552
s_add_u32 s55, s55, 0x40000
s_add_u32 s56, s56, 0x40000
s_add_u32 s57, s57, 0x40000
s_add_u32 s61, s61, 0x100000
s_add_u32 s62, s62, 0x100000
s_waitcnt vmcnt(4) lgkmcnt(0)
s_barrier
s_add_u32 s59, s59, 1
s_add_u32 s54, s54, 0x10000
s_add_u32 s45, s54, 0x8000
s_waitcnt vmcnt(12)
v_mfma_f32_16x16x32_bf16 v[144:147], a[0:3], v[16:19], 0
ds_read_b128 v[192:195], v2 offset:55296
v_mfma_f32_16x16x32_bf16 v[148:151], a[32:35], v[16:19], 0
buffer_load_dwordx4 v[80:83], v2, s[8:11], s54 offen offset:0 sc1
ds_read_b128 v[196:199], v4 offset:18432
v_mfma_f32_16x16x32_bf16 v[144:147], a[4:7], v[20:23], v[144:147]
buffer_load_dwordx4 a[192:195], v3, s[24:27], s61 offen offset:0
ds_read_b128 v[200:203], v4 offset:30720
v_mfma_f32_16x16x32_bf16 v[148:151], a[36:39], v[20:23], v[148:151]
ds_read_b128 v[204:207], v4 offset:43008
v_mfma_f32_16x16x32_bf16 v[144:147], a[8:11], v[24:27], v[144:147]
.if \sf == 0
buffer_store_dwordx4 a[224:227], v2, s[8:11], s62 offen offset:0
.else
buffer_store_dwordx4 a[224:227], v2, s[8:11], s62 offen offset:0 sc1
.endif
ds_read_b128 v[208:211], v2 offset:56320
v_mfma_f32_16x16x32_bf16 v[148:151], a[40:43], v[24:27], v[148:151]
ds_read_b128 v[212:215], v4 offset:19456
v_mfma_f32_16x16x32_bf16 v[144:147], a[12:15], v[28:31], v[144:147]
buffer_load_dwordx4 v[84:87], v2, s[8:11], s54 offen offset:1024 sc1
buffer_load_dwordx4 a[196:199], v3, s[24:27], s61 offen offset:16
v_mfma_f32_16x16x32_bf16 v[148:151], a[44:47], v[28:31], v[148:151]
ds_read_b128 v[216:219], v4 offset:31744
v_mfma_f32_16x16x32_bf16 v[144:147], a[16:19], v[32:35], v[144:147]
.if \sf == 0
buffer_store_dwordx4 a[228:231], v2, s[8:11], s62 offen offset:1024
.else
buffer_store_dwordx4 a[228:231], v2, s[8:11], s62 offen offset:1024 sc1
.endif
ds_read_b128 v[220:223], v4 offset:44032
v_mfma_f32_16x16x32_bf16 v[148:151], a[48:51], v[32:35], v[148:151]
v_mfma_f32_16x16x32_bf16 v[144:147], a[20:23], v[36:39], v[144:147]
buffer_load_dwordx4 a[200:203], v3, s[24:27], s61 offen offset:128
v_mfma_f32_16x16x32_bf16 v[148:151], a[52:55], v[36:39], v[148:151]
buffer_load_dwordx4 v[88:91], v2, s[8:11], s54 offen offset:2048 sc1
v_mfma_f32_16x16x32_bf16 v[144:147], a[24:27], v[40:43], v[144:147]
.if \sf == 0
buffer_store_dwordx4 a[232:235], v2, s[8:11], s62 offen offset:2048
.else
buffer_store_dwordx4 a[232:235], v2, s[8:11], s62 offen offset:2048 sc1
.endif
v_mfma_f32_16x16x32_bf16 v[148:151], a[56:59], v[40:43], v[148:151]
v_mfma_f32_16x16x32_bf16 v[144:147], a[28:31], v[44:47], v[144:147]
buffer_load_dwordx4 a[204:207], v3, s[24:27], s61 offen offset:144
s_waitcnt lgkmcnt(0)
v_mfma_f32_16x16x32_bf16 v[148:151], a[60:63], v[44:47], v[148:151]
v_add_f32 v192, v192, v196
v_add_f32 v200, v200, v204
v_mfma_f32_16x16x32_bf16 v[152:155], a[64:67], v[16:19], 0
buffer_load_dwordx4 v[92:95], v2, s[8:11], s54 offen offset:3072 sc1
.if \sf == 0
buffer_store_dwordx4 a[236:239], v2, s[8:11], s62 offen offset:3072
.else
buffer_store_dwordx4 a[236:239], v2, s[8:11], s62 offen offset:3072 sc1
.endif
v_mfma_f32_16x16x32_bf16 v[156:159], a[96:99], v[16:19], 0
v_add_f32 v193, v193, v197
v_add_f32 v201, v201, v205
v_mfma_f32_16x16x32_bf16 v[152:155], a[68:71], v[20:23], v[152:155]
buffer_load_dwordx4 a[208:211], v3, s[24:27], s61 offen offset:256
v_add_f32 v194, v194, v198
v_mfma_f32_16x16x32_bf16 v[156:159], a[100:103], v[20:23], v[156:159]
v_add_f32 v202, v202, v206
v_add_f32 v195, v195, v199
v_mfma_f32_16x16x32_bf16 v[152:155], a[72:75], v[24:27], v[152:155]
.if \sf == 0
buffer_store_dwordx4 a[240:243], v5, s[8:11], s62 offen offset:0
.else
buffer_store_dwordx4 a[240:243], v5, s[8:11], s62 offen offset:0 sc1
.endif
ds_write_b128 v2, v[144:147] offset:12288
v_mfma_f32_16x16x32_bf16 v[156:159], a[104:107], v[24:27], v[156:159]
buffer_load_dwordx4 v[96:99], v5, s[8:11], s54 offen offset:0 sc1
v_add_f32 v203, v203, v207
v_mfma_f32_16x16x32_bf16 v[152:155], a[76:79], v[28:31], v[152:155]
buffer_load_dwordx4 a[212:215], v3, s[24:27], s61 offen offset:272
v_add_f32 v192, v192, v200
v_mfma_f32_16x16x32_bf16 v[156:159], a[108:111], v[28:31], v[156:159]
ds_write_b128 v2, v[148:151] offset:13312
v_add_f32 v193, v193, v201
v_mfma_f32_16x16x32_bf16 v[152:155], a[80:83], v[32:35], v[152:155]
.if \sf == 0
buffer_store_dwordx4 a[244:247], v5, s[8:11], s62 offen offset:1024
.else
buffer_store_dwordx4 a[244:247], v5, s[8:11], s62 offen offset:1024 sc1
.endif
v_add_f32 v194, v194, v202
v_mfma_f32_16x16x32_bf16 v[156:159], a[112:115], v[32:35], v[156:159]
v_add_f32 v195, v195, v203
v_cvt_pk_bf16_f32 v224, v192, v193
v_mfma_f32_16x16x32_bf16 v[152:155], a[84:87], v[36:39], v[152:155]
buffer_load_dwordx4 v[100:103], v5, s[8:11], s54 offen offset:1024 sc1
buffer_load_dwordx4 a[216:219], v3, s[24:27], s61 offen offset:384
v_mfma_f32_16x16x32_bf16 v[156:159], a[116:119], v[36:39], v[156:159]
v_cvt_pk_bf16_f32 v225, v194, v195
v_add_f32 v208, v208, v212
v_mfma_f32_16x16x32_bf16 v[152:155], a[88:91], v[40:43], v[152:155]
.if \sf == 0
buffer_store_dwordx4 a[248:251], v5, s[8:11], s62 offen offset:2048
.else
buffer_store_dwordx4 a[248:251], v5, s[8:11], s62 offen offset:2048 sc1
.endif
v_add_f32 v216, v216, v220
v_mfma_f32_16x16x32_bf16 v[156:159], a[120:123], v[40:43], v[156:159]
v_add_f32 v209, v209, v213
v_add_f32 v217, v217, v221
v_mfma_f32_16x16x32_bf16 v[152:155], a[92:95], v[44:47], v[152:155]
buffer_load_dwordx4 a[220:223], v3, s[24:27], s61 offen offset:400
v_add_f32 v210, v210, v214
v_mfma_f32_16x16x32_bf16 v[156:159], a[124:127], v[44:47], v[156:159]
buffer_load_dwordx4 v[104:107], v5, s[8:11], s54 offen offset:2048 sc1
v_add_f32 v218, v218, v222
v_mfma_f32_16x16x32_bf16 v[160:163], v[16:19], a[128:131], 0
.if \sf == 0
buffer_store_dwordx4 a[252:255], v5, s[8:11], s62 offen offset:3072
.else
buffer_store_dwordx4 a[252:255], v5, s[8:11], s62 offen offset:3072 sc1
.endif
v_add_f32 v211, v211, v215
v_mfma_f32_16x16x32_bf16 v[164:167], v[16:19], a[160:163], 0
v_add_f32 v219, v219, v223
v_add_f32 v208, v208, v216
v_mfma_f32_16x16x32_bf16 v[160:163], v[20:23], a[132:135], v[160:163]
v_add_f32 v209, v209, v217
v_add_f32 v210, v210, v218
v_mfma_f32_16x16x32_bf16 v[164:167], v[20:23], a[164:167], v[164:167]
v_add_f32 v211, v211, v219
v_cvt_pk_bf16_f32 v226, v208, v209
v_mfma_f32_16x16x32_bf16 v[160:163], v[24:27], a[136:139], v[160:163]
buffer_load_dwordx4 v[108:111], v5, s[8:11], s54 offen offset:3072 sc1
ds_write_b128 v2, v[152:155] offset:14336
v_mfma_f32_16x16x32_bf16 v[164:167], v[24:27], a[168:171], v[164:167]
s_mov_b32 m0, s68
v_cvt_pk_bf16_f32 v227, v210, v211
v_mfma_f32_16x16x32_bf16 v[160:163], v[28:31], a[140:143], v[160:163]
buffer_load_dwordx4 v243, s[12:15], s69 offen lds
buffer_store_dwordx4 v[224:227], v5, s[8:11], s55 offen sc1
v_mfma_f32_16x16x32_bf16 v[164:167], v[28:31], a[172:175], v[164:167]
s_add_u32 s68, s68, s70
s_add_u32 s69, s69, s71
ds_write_b128 v2, v[156:159] offset:15360
v_mfma_f32_16x16x32_bf16 v[160:163], v[32:35], a[144:147], v[160:163]
v_mfma_f32_16x16x32_bf16 v[164:167], v[32:35], a[176:179], v[164:167]
v_mfma_f32_16x16x32_bf16 v[160:163], v[36:39], a[148:151], v[160:163]
v_mfma_f32_16x16x32_bf16 v[164:167], v[36:39], a[180:183], v[164:167]
v_mfma_f32_16x16x32_bf16 v[160:163], v[40:43], a[152:155], v[160:163]
v_mfma_f32_16x16x32_bf16 v[164:167], v[40:43], a[184:187], v[164:167]
v_mfma_f32_16x16x32_bf16 v[160:163], v[44:47], a[156:159], v[160:163]
v_mfma_f32_16x16x32_bf16 v[164:167], v[44:47], a[188:191], v[164:167]
s_waitcnt vmcnt(27)
v_mfma_f32_16x16x32_bf16 v[168:171], a[0:3], v[48:51], 0
v_mfma_f32_16x16x32_bf16 v[172:175], a[32:35], v[48:51], 0
buffer_load_dwordx4 v[112:115], v2, s[8:11], s45 offen offset:0 sc1
v_mfma_f32_16x16x32_bf16 v[168:171], a[4:7], v[52:55], v[168:171]
v_mfma_f32_16x16x32_bf16 v[172:175], a[36:39], v[52:55], v[172:175]
v_mfma_f32_16x16x32_bf16 v[168:171], a[8:11], v[56:59], v[168:171]
ds_write_b128 v2, v[160:163] offset:16384
v_mfma_f32_16x16x32_bf16 v[172:175], a[40:43], v[56:59], v[172:175]
v_mfma_f32_16x16x32_bf16 v[168:171], a[12:15], v[60:63], v[168:171]
buffer_load_dwordx4 v[116:119], v2, s[8:11], s45 offen offset:1024 sc1
v_mfma_f32_16x16x32_bf16 v[172:175], a[44:47], v[60:63], v[172:175]
ds_write_b128 v2, v[164:167] offset:17408
v_mfma_f32_16x16x32_bf16 v[168:171], a[16:19], v[64:67], v[168:171]
v_mfma_f32_16x16x32_bf16 v[172:175], a[48:51], v[64:67], v[172:175]
v_mfma_f32_16x16x32_bf16 v[168:171], a[20:23], v[68:71], v[168:171]
v_mfma_f32_16x16x32_bf16 v[172:175], a[52:55], v[68:71], v[172:175]
buffer_load_dwordx4 v[120:123], v2, s[8:11], s45 offen offset:2048 sc1
v_mfma_f32_16x16x32_bf16 v[168:171], a[24:27], v[72:75], v[168:171]
v_mfma_f32_16x16x32_bf16 v[172:175], a[56:59], v[72:75], v[172:175]
v_mfma_f32_16x16x32_bf16 v[168:171], a[28:31], v[76:79], v[168:171]
v_mfma_f32_16x16x32_bf16 v[172:175], a[60:63], v[76:79], v[172:175]
v_mfma_f32_16x16x32_bf16 v[176:179], a[64:67], v[48:51], 0
buffer_load_dwordx4 v[124:127], v2, s[8:11], s45 offen offset:3072 sc1
v_mfma_f32_16x16x32_bf16 v[180:183], a[96:99], v[48:51], 0
v_mfma_f32_16x16x32_bf16 v[176:179], a[68:71], v[52:55], v[176:179]
v_mfma_f32_16x16x32_bf16 v[180:183], a[100:103], v[52:55], v[180:183]
v_mfma_f32_16x16x32_bf16 v[176:179], a[72:75], v[56:59], v[176:179]
s_nop 0
ds_write_b128 v2, v[168:171] offset:18432
v_mfma_f32_16x16x32_bf16 v[180:183], a[104:107], v[56:59], v[180:183]
buffer_load_dwordx4 v[128:131], v5, s[8:11], s45 offen offset:0 sc1
v_mfma_f32_16x16x32_bf16 v[176:179], a[76:79], v[60:63], v[176:179]
v_mfma_f32_16x16x32_bf16 v[180:183], a[108:111], v[60:63], v[180:183]
ds_write_b128 v2, v[172:175] offset:19456
v_mfma_f32_16x16x32_bf16 v[176:179], a[80:83], v[64:67], v[176:179]
v_mfma_f32_16x16x32_bf16 v[180:183], a[112:115], v[64:67], v[180:183]
v_mfma_f32_16x16x32_bf16 v[176:179], a[84:87], v[68:71], v[176:179]
buffer_load_dwordx4 v[132:135], v5, s[8:11], s45 offen offset:1024 sc1
v_mfma_f32_16x16x32_bf16 v[180:183], a[116:119], v[68:71], v[180:183]
v_mfma_f32_16x16x32_bf16 v[176:179], a[88:91], v[72:75], v[176:179]
v_mfma_f32_16x16x32_bf16 v[180:183], a[120:123], v[72:75], v[180:183]
v_mfma_f32_16x16x32_bf16 v[176:179], a[92:95], v[76:79], v[176:179]
v_mfma_f32_16x16x32_bf16 v[180:183], a[124:127], v[76:79], v[180:183]
buffer_load_dwordx4 v[136:139], v5, s[8:11], s45 offen offset:2048 sc1
v_mfma_f32_16x16x32_bf16 v[184:187], v[48:51], a[128:131], 0
v_mfma_f32_16x16x32_bf16 v[188:191], v[48:51], a[160:163], 0
v_mfma_f32_16x16x32_bf16 v[184:187], v[52:55], a[132:135], v[184:187]
v_mfma_f32_16x16x32_bf16 v[188:191], v[52:55], a[164:167], v[188:191]
v_mfma_f32_16x16x32_bf16 v[184:187], v[56:59], a[136:139], v[184:187]
buffer_load_dwordx4 v[140:143], v5, s[8:11], s45 offen offset:3072 sc1
ds_write_b128 v2, v[176:179] offset:20480
v_mfma_f32_16x16x32_bf16 v[188:191], v[56:59], a[168:171], v[188:191]
s_mov_b32 m0, s68
v_mfma_f32_16x16x32_bf16 v[184:187], v[60:63], a[140:143], v[184:187]
buffer_load_dwordx4 v243, s[12:15], s69 offen lds
v_mfma_f32_16x16x32_bf16 v[188:191], v[60:63], a[172:175], v[188:191]
s_add_u32 s68, s68, s70
s_add_u32 s69, s69, s71
ds_write_b128 v2, v[180:183] offset:21504
v_mfma_f32_16x16x32_bf16 v[184:187], v[64:67], a[144:147], v[184:187]
v_mfma_f32_16x16x32_bf16 v[188:191], v[64:67], a[176:179], v[188:191]
v_mfma_f32_16x16x32_bf16 v[184:187], v[68:71], a[148:151], v[184:187]
v_mfma_f32_16x16x32_bf16 v[188:191], v[68:71], a[180:183], v[188:191]
v_mfma_f32_16x16x32_bf16 v[184:187], v[72:75], a[152:155], v[184:187]
v_mfma_f32_16x16x32_bf16 v[188:191], v[72:75], a[184:187], v[188:191]
v_mfma_f32_16x16x32_bf16 v[184:187], v[76:79], a[156:159], v[184:187]
v_mfma_f32_16x16x32_bf16 v[188:191], v[76:79], a[188:191], v[188:191]
s_nop 6
ds_write_b128 v2, v[184:187] offset:22528
ds_write_b128 v2, v[188:191] offset:23552
s_add_u32 s55, s55, 0x40000
s_add_u32 s56, s56, 0x40000
s_add_u32 s57, s57, 0x40000
s_cmp_eq_u32 s52, 60
s_cselect_b32 s45, 0x1000000, 0
s_sub_u32 s55, s55, s45
s_sub_u32 s56, s56, s45
s_sub_u32 s57, s57, s45
s_add_u32 s61, s61, 0x100000
s_add_u32 s62, s62, 0x100000
s_waitcnt vmcnt(9) lgkmcnt(0)
s_barrier
s_add_u32 s59, s59, 1
s_add_u32 s54, s54, 0x10000
s_cmp_eq_u32 s52, 58
s_cselect_b32 s45, 0x400000, 0
s_sub_u32 s54, s54, s45
s_add_u32 s45, s54, 0x8000
s_waitcnt vmcnt(11)
v_mfma_f32_16x16x32_bf16 v[144:147], a[0:3], v[80:83], 0
ds_read_b128 v[192:195], v2 offset:2048
v_mfma_f32_16x16x32_bf16 v[148:151], a[32:35], v[80:83], 0
buffer_load_dwordx4 v[16:19], v2, s[8:11], s54 offen offset:0 sc1
ds_read_b128 v[196:199], v2 offset:14336
v_mfma_f32_16x16x32_bf16 v[144:147], a[4:7], v[84:87], v[144:147]
ds_read_b128 v[200:203], v2 offset:26624
v_mfma_f32_16x16x32_bf16 v[148:151], a[36:39], v[84:87], v[148:151]
ds_read_b128 v[204:207], v2 offset:38912
v_mfma_f32_16x16x32_bf16 v[144:147], a[8:11], v[88:91], v[144:147]
.if \sf == 0
buffer_store_dwordx4 a[192:195], v2, s[8:11], s62 offen offset:0
.else
buffer_store_dwordx4 a[192:195], v2, s[8:11], s62 offen offset:0 sc1
.endif
ds_read_b128 v[208:211], v2 offset:3072
v_mfma_f32_16x16x32_bf16 v[148:151], a[40:43], v[88:91], v[148:151]
ds_read_b128 v[212:215], v2 offset:15360
v_mfma_f32_16x16x32_bf16 v[144:147], a[12:15], v[92:95], v[144:147]
buffer_load_dwordx4 v[20:23], v2, s[8:11], s54 offen offset:1024 sc1
ds_read_b128 v[216:219], v2 offset:27648
v_mfma_f32_16x16x32_bf16 v[148:151], a[44:47], v[92:95], v[148:151]
ds_read_b128 v[220:223], v2 offset:39936
v_mfma_f32_16x16x32_bf16 v[144:147], a[16:19], v[96:99], v[144:147]
.if \sf == 0
buffer_store_dwordx4 a[196:199], v2, s[8:11], s62 offen offset:1024
.else
buffer_store_dwordx4 a[196:199], v2, s[8:11], s62 offen offset:1024 sc1
.endif
v_mfma_f32_16x16x32_bf16 v[148:151], a[48:51], v[96:99], v[148:151]
v_mfma_f32_16x16x32_bf16 v[144:147], a[20:23], v[100:103], v[144:147]
v_mfma_f32_16x16x32_bf16 v[148:151], a[52:55], v[100:103], v[148:151]
buffer_load_dwordx4 v[24:27], v2, s[8:11], s54 offen offset:2048 sc1
v_mfma_f32_16x16x32_bf16 v[144:147], a[24:27], v[104:107], v[144:147]
.if \sf == 0
buffer_store_dwordx4 a[200:203], v2, s[8:11], s62 offen offset:2048
.else
buffer_store_dwordx4 a[200:203], v2, s[8:11], s62 offen offset:2048 sc1
.endif
v_mfma_f32_16x16x32_bf16 v[148:151], a[56:59], v[104:107], v[148:151]
s_waitcnt lgkmcnt(0)
v_add_f32 v192, v192, v196
v_mfma_f32_16x16x32_bf16 v[144:147], a[28:31], v[108:111], v[144:147]
v_add_f32 v200, v200, v204
v_add_f32 v193, v193, v197
v_mfma_f32_16x16x32_bf16 v[148:151], a[60:63], v[108:111], v[148:151]
v_add_f32 v201, v201, v205
v_add_f32 v194, v194, v198
v_mfma_f32_16x16x32_bf16 v[152:155], a[64:67], v[80:83], 0
buffer_load_dwordx4 v[28:31], v2, s[8:11], s54 offen offset:3072 sc1
.if \sf == 0
buffer_store_dwordx4 a[204:207], v2, s[8:11], s62 offen offset:3072
.else
buffer_store_dwordx4 a[204:207], v2, s[8:11], s62 offen offset:3072 sc1
.endif
v_mfma_f32_16x16x32_bf16 v[156:159], a[96:99], v[80:83], 0
v_add_f32 v202, v202, v206
v_add_f32 v195, v195, v199
v_mfma_f32_16x16x32_bf16 v[152:155], a[68:71], v[84:87], v[152:155]
v_add_f32 v203, v203, v207
v_add_f32 v192, v192, v200
v_mfma_f32_16x16x32_bf16 v[156:159], a[100:103], v[84:87], v[156:159]
v_add_f32 v193, v193, v201
v_add_f32 v194, v194, v202
v_mfma_f32_16x16x32_bf16 v[152:155], a[72:75], v[88:91], v[152:155]
.if \sf == 0
buffer_store_dwordx4 a[208:211], v5, s[8:11], s62 offen offset:0
.else
buffer_store_dwordx4 a[208:211], v5, s[8:11], s62 offen offset:0 sc1
.endif
ds_write_b128 v2, v[144:147] offset:61440
v_mfma_f32_16x16x32_bf16 v[156:159], a[104:107], v[88:91], v[156:159]
buffer_load_dwordx4 v[32:35], v5, s[8:11], s54 offen offset:0 sc1
v_add_f32 v195, v195, v203
v_mfma_f32_16x16x32_bf16 v[152:155], a[76:79], v[92:95], v[152:155]
v_cvt_pk_bf16_f32 v224, v192, v193
v_cvt_pk_bf16_f32 v225, v194, v195
v_mfma_f32_16x16x32_bf16 v[156:159], a[108:111], v[92:95], v[156:159]
ds_write_b128 v2, v[148:151] offset:62464
v_add_f32 v208, v208, v212
v_mfma_f32_16x16x32_bf16 v[152:155], a[80:83], v[96:99], v[152:155]
.if \sf == 0
buffer_store_dwordx4 a[212:215], v5, s[8:11], s62 offen offset:1024
.else
buffer_store_dwordx4 a[212:215], v5, s[8:11], s62 offen offset:1024 sc1
.endif
v_add_f32 v216, v216, v220
v_mfma_f32_16x16x32_bf16 v[156:159], a[112:115], v[96:99], v[156:159]
v_add_f32 v209, v209, v213
v_add_f32 v217, v217, v221
v_mfma_f32_16x16x32_bf16 v[152:155], a[84:87], v[100:103], v[152:155]
buffer_load_dwordx4 v[36:39], v5, s[8:11], s54 offen offset:1024 sc1
v_add_f32 v210, v210, v214
v_mfma_f32_16x16x32_bf16 v[156:159], a[116:119], v[100:103], v[156:159]
v_add_f32 v218, v218, v222
v_add_f32 v211, v211, v215
v_mfma_f32_16x16x32_bf16 v[152:155], a[88:91], v[104:107], v[152:155]
.if \sf == 0
buffer_store_dwordx4 a[216:219], v5, s[8:11], s62 offen offset:2048
.else
buffer_store_dwordx4 a[216:219], v5, s[8:11], s62 offen offset:2048 sc1
.endif
v_add_f32 v219, v219, v223
v_mfma_f32_16x16x32_bf16 v[156:159], a[120:123], v[104:107], v[156:159]
v_add_f32 v208, v208, v216
v_add_f32 v209, v209, v217
v_mfma_f32_16x16x32_bf16 v[152:155], a[92:95], v[108:111], v[152:155]
v_add_f32 v210, v210, v218
v_add_f32 v211, v211, v219
v_mfma_f32_16x16x32_bf16 v[156:159], a[124:127], v[108:111], v[156:159]
buffer_load_dwordx4 v[40:43], v5, s[8:11], s54 offen offset:2048 sc1
v_cvt_pk_bf16_f32 v226, v208, v209
v_mfma_f32_16x16x32_bf16 v[160:163], v[80:83], a[128:131], 0
.if \sf == 0
buffer_store_dwordx4 a[220:223], v5, s[8:11], s62 offen offset:3072
.else
buffer_store_dwordx4 a[220:223], v5, s[8:11], s62 offen offset:3072 sc1
.endif
v_cvt_pk_bf16_f32 v227, v210, v211
v_mfma_f32_16x16x32_bf16 v[164:167], v[80:83], a[160:163], 0
buffer_store_dwordx4 v[224:227], v2, s[8:11], s56 offen sc1
v_mfma_f32_16x16x32_bf16 v[160:163], v[84:87], a[132:135], v[160:163]
ds_read_b128 v[192:195], v2 offset:8192
v_mfma_f32_16x16x32_bf16 v[164:167], v[84:87], a[164:167], v[164:167]
ds_read_b128 v[196:199], v2 offset:20480
v_mfma_f32_16x16x32_bf16 v[160:163], v[88:91], a[136:139], v[160:163]
buffer_load_dwordx4 v[44:47], v5, s[8:11], s54 offen offset:3072 sc1
ds_write_b128 v2, v[152:155] offset:63488
v_mfma_f32_16x16x32_bf16 v[164:167], v[88:91], a[168:171], v[164:167]
s_mov_b32 m0, s68
ds_read_b128 v[200:203], v2 offset:32768
v_mfma_f32_16x16x32_bf16 v[160:163], v[92:95], a[140:143], v[160:163]
buffer_load_dwordx4 v243, s[12:15], s69 offen lds
ds_read_b128 v[204:207], v2 offset:45056
v_mfma_f32_16x16x32_bf16 v[164:167], v[92:95], a[172:175], v[164:167]
s_add_u32 s68, s68, s70
s_add_u32 s69, s69, s71
ds_write_b128 v2, v[156:159] offset:64512
v_mfma_f32_16x16x32_bf16 v[160:163], v[96:99], a[144:147], v[160:163]
ds_read_b128 v[208:211], v2 offset:9216
v_mfma_f32_16x16x32_bf16 v[164:167], v[96:99], a[176:179], v[164:167]
ds_read_b128 v[212:215], v2 offset:21504
v_mfma_f32_16x16x32_bf16 v[160:163], v[100:103], a[148:151], v[160:163]
ds_read_b128 v[216:219], v2 offset:33792
v_mfma_f32_16x16x32_bf16 v[164:167], v[100:103], a[180:183], v[164:167]
ds_read_b128 v[220:223], v2 offset:46080
v_mfma_f32_16x16x32_bf16 v[160:163], v[104:107], a[152:155], v[160:163]
v_mfma_f32_16x16x32_bf16 v[164:167], v[104:107], a[184:187], v[164:167]
v_mfma_f32_16x16x32_bf16 v[160:163], v[108:111], a[156:159], v[160:163]
v_mfma_f32_16x16x32_bf16 v[164:167], v[108:111], a[188:191], v[164:167]
s_waitcnt vmcnt(19)
v_mfma_f32_16x16x32_bf16 v[168:171], a[0:3], v[112:115], 0
v_mfma_f32_16x16x32_bf16 v[172:175], a[32:35], v[112:115], 0
buffer_load_dwordx4 v[48:51], v2, s[8:11], s45 offen offset:0 sc1
s_waitcnt lgkmcnt(0)
v_mfma_f32_16x16x32_bf16 v[168:171], a[4:7], v[116:119], v[168:171]
v_add_f32 v192, v192, v196
v_add_f32 v200, v200, v204
v_mfma_f32_16x16x32_bf16 v[172:175], a[36:39], v[116:119], v[172:175]
v_add_f32 v193, v193, v197
v_add_f32 v201, v201, v205
v_mfma_f32_16x16x32_bf16 v[168:171], a[8:11], v[120:123], v[168:171]
ds_write_b128 v4, v[160:163] offset:16384
v_add_f32 v194, v194, v198
v_mfma_f32_16x16x32_bf16 v[172:175], a[40:43], v[120:123], v[172:175]
v_add_f32 v202, v202, v206
v_add_f32 v195, v195, v199
v_mfma_f32_16x16x32_bf16 v[168:171], a[12:15], v[124:127], v[168:171]
buffer_load_dwordx4 v[52:55], v2, s[8:11], s45 offen offset:1024 sc1
v_add_f32 v203, v203, v207
v_mfma_f32_16x16x32_bf16 v[172:175], a[44:47], v[124:127], v[172:175]
ds_write_b128 v4, v[164:167] offset:17408
v_add_f32 v192, v192, v200
v_mfma_f32_16x16x32_bf16 v[168:171], a[16:19], v[128:131], v[168:171]
v_add_f32 v193, v193, v201
v_add_f32 v194, v194, v202
v_mfma_f32_16x16x32_bf16 v[172:175], a[48:51], v[128:131], v[172:175]
v_add_f32 v195, v195, v203
v_cvt_pk_bf16_f32 v228, v192, v193
v_mfma_f32_16x16x32_bf16 v[168:171], a[20:23], v[132:135], v[168:171]
v_cvt_pk_bf16_f32 v229, v194, v195
v_add_f32 v208, v208, v212
v_mfma_f32_16x16x32_bf16 v[172:175], a[52:55], v[132:135], v[172:175]
buffer_load_dwordx4 v[56:59], v2, s[8:11], s45 offen offset:2048 sc1
v_add_f32 v216, v216, v220
v_mfma_f32_16x16x32_bf16 v[168:171], a[24:27], v[136:139], v[168:171]
v_add_f32 v209, v209, v213
v_add_f32 v217, v217, v221
v_mfma_f32_16x16x32_bf16 v[172:175], a[56:59], v[136:139], v[172:175]
v_add_f32 v210, v210, v214
v_add_f32 v218, v218, v222
v_mfma_f32_16x16x32_bf16 v[168:171], a[28:31], v[140:143], v[168:171]
v_add_f32 v211, v211, v215
v_add_f32 v219, v219, v223
v_mfma_f32_16x16x32_bf16 v[172:175], a[60:63], v[140:143], v[172:175]
v_add_f32 v208, v208, v216
v_add_f32 v209, v209, v217
v_mfma_f32_16x16x32_bf16 v[176:179], a[64:67], v[112:115], 0
buffer_load_dwordx4 v[60:63], v2, s[8:11], s45 offen offset:3072 sc1
v_add_f32 v210, v210, v218
v_mfma_f32_16x16x32_bf16 v[180:183], a[96:99], v[112:115], 0
v_add_f32 v211, v211, v219
v_cvt_pk_bf16_f32 v230, v208, v209
v_mfma_f32_16x16x32_bf16 v[176:179], a[68:71], v[116:119], v[176:179]
v_cvt_pk_bf16_f32 v231, v210, v211
buffer_store_dwordx4 v[228:231], v5, s[8:11], s56 offen sc1
v_mfma_f32_16x16x32_bf16 v[180:183], a[100:103], v[116:119], v[180:183]
v_mfma_f32_16x16x32_bf16 v[176:179], a[72:75], v[120:123], v[176:179]
ds_write_b128 v4, v[168:171] offset:18432
v_mfma_f32_16x16x32_bf16 v[180:183], a[104:107], v[120:123], v[180:183]
buffer_load_dwordx4 v[64:67], v5, s[8:11], s45 offen offset:0 sc1
v_mfma_f32_16x16x32_bf16 v[176:179], a[76:79], v[124:127], v[176:179]
v_mfma_f32_16x16x32_bf16 v[180:183], a[108:111], v[124:127], v[180:183]
ds_write_b128 v4, v[172:175] offset:19456
v_mfma_f32_16x16x32_bf16 v[176:179], a[80:83], v[128:131], v[176:179]
v_mfma_f32_16x16x32_bf16 v[180:183], a[112:115], v[128:131], v[180:183]
v_mfma_f32_16x16x32_bf16 v[176:179], a[84:87], v[132:135], v[176:179]
buffer_load_dwordx4 v[68:71], v5, s[8:11], s45 offen offset:1024 sc1
v_mfma_f32_16x16x32_bf16 v[180:183], a[116:119], v[132:135], v[180:183]
v_mfma_f32_16x16x32_bf16 v[176:179], a[88:91], v[136:139], v[176:179]
v_mfma_f32_16x16x32_bf16 v[180:183], a[120:123], v[136:139], v[180:183]
v_mfma_f32_16x16x32_bf16 v[176:179], a[92:95], v[140:143], v[176:179]
v_mfma_f32_16x16x32_bf16 v[180:183], a[124:127], v[140:143], v[180:183]
buffer_load_dwordx4 v[72:75], v5, s[8:11], s45 offen offset:2048 sc1
v_mfma_f32_16x16x32_bf16 v[184:187], v[112:115], a[128:131], 0
v_mfma_f32_16x16x32_bf16 v[188:191], v[112:115], a[160:163], 0
v_mfma_f32_16x16x32_bf16 v[184:187], v[116:119], a[132:135], v[184:187]
v_mfma_f32_16x16x32_bf16 v[188:191], v[116:119], a[164:167], v[188:191]
v_mfma_f32_16x16x32_bf16 v[184:187], v[120:123], a[136:139], v[184:187]
buffer_load_dwordx4 v[76:79], v5, s[8:11], s45 offen offset:3072 sc1
ds_write_b128 v4, v[176:179] offset:20480
v_mfma_f32_16x16x32_bf16 v[188:191], v[120:123], a[168:171], v[188:191]
s_mov_b32 m0, s68
v_mfma_f32_16x16x32_bf16 v[184:187], v[124:127], a[140:143], v[184:187]
buffer_load_dwordx4 v243, s[12:15], s69 offen lds
v_mfma_f32_16x16x32_bf16 v[188:191], v[124:127], a[172:175], v[188:191]
s_add_u32 s68, s68, s70
s_add_u32 s69, s69, s71
ds_write_b128 v4, v[180:183] offset:21504
v_mfma_f32_16x16x32_bf16 v[184:187], v[128:131], a[144:147], v[184:187]
v_mfma_f32_16x16x32_bf16 v[188:191], v[128:131], a[176:179], v[188:191]
v_mfma_f32_16x16x32_bf16 v[184:187], v[132:135], a[148:151], v[184:187]
v_mfma_f32_16x16x32_bf16 v[188:191], v[132:135], a[180:183], v[188:191]
v_mfma_f32_16x16x32_bf16 v[184:187], v[136:139], a[152:155], v[184:187]
v_mfma_f32_16x16x32_bf16 v[188:191], v[136:139], a[184:187], v[188:191]
v_mfma_f32_16x16x32_bf16 v[184:187], v[140:143], a[156:159], v[184:187]
v_mfma_f32_16x16x32_bf16 v[188:191], v[140:143], a[188:191], v[188:191]
s_nop 6
ds_write_b128 v4, v[184:187] offset:22528
ds_write_b128 v4, v[188:191] offset:23552
s_add_u32 s55, s55, 0x40000
s_add_u32 s56, s56, 0x40000
s_add_u32 s57, s57, 0x40000
s_add_u32 s62, s62, 0x100000
s_waitcnt vmcnt(5) lgkmcnt(0)
s_barrier
s_add_u32 s59, s59, 1
s_add_u32 s54, s54, 0x10000
s_add_u32 s45, s54, 0x8000
s_waitcnt vmcnt(11)
v_mfma_f32_16x16x32_bf16 v[144:147], a[0:3], v[16:19], 0
ds_read_b128 v[192:195], v2 offset:55296
v_mfma_f32_16x16x32_bf16 v[148:151], a[32:35], v[16:19], 0
buffer_load_dwordx4 v[80:83], v2, s[8:11], s54 offen offset:0 sc1
v_mfma_f32_16x16x32_bf16 v[144:147], a[4:7], v[20:23], v[144:147]
ds_read_b128 v[196:199], v4 offset:18432
v_mfma_f32_16x16x32_bf16 v[148:151], a[36:39], v[20:23], v[148:151]
ds_read_b128 v[200:203], v4 offset:30720
v_mfma_f32_16x16x32_bf16 v[144:147], a[8:11], v[24:27], v[144:147]
ds_read_b128 v[204:207], v4 offset:43008
v_mfma_f32_16x16x32_bf16 v[148:151], a[40:43], v[24:27], v[148:151]
ds_read_b128 v[208:211], v2 offset:56320
v_mfma_f32_16x16x32_bf16 v[144:147], a[12:15], v[28:31], v[144:147]
buffer_load_dwordx4 v[84:87], v2, s[8:11], s54 offen offset:1024 sc1
v_mfma_f32_16x16x32_bf16 v[148:151], a[44:47], v[28:31], v[148:151]
ds_read_b128 v[212:215], v4 offset:19456
v_mfma_f32_16x16x32_bf16 v[144:147], a[16:19], v[32:35], v[144:147]
ds_read_b128 v[216:219], v4 offset:31744
v_mfma_f32_16x16x32_bf16 v[148:151], a[48:51], v[32:35], v[148:151]
ds_read_b128 v[220:223], v4 offset:44032
v_mfma_f32_16x16x32_bf16 v[144:147], a[20:23], v[36:39], v[144:147]
v_mfma_f32_16x16x32_bf16 v[148:151], a[52:55], v[36:39], v[148:151]
buffer_load_dwordx4 v[88:91], v2, s[8:11], s54 offen offset:2048 sc1
v_mfma_f32_16x16x32_bf16 v[144:147], a[24:27], v[40:43], v[144:147]
v_mfma_f32_16x16x32_bf16 v[148:151], a[56:59], v[40:43], v[148:151]
v_mfma_f32_16x16x32_bf16 v[144:147], a[28:31], v[44:47], v[144:147]
v_mfma_f32_16x16x32_bf16 v[148:151], a[60:63], v[44:47], v[148:151]
s_waitcnt lgkmcnt(0)
v_add_f32 v192, v192, v196
v_mfma_f32_16x16x32_bf16 v[152:155], a[64:67], v[16:19], 0
buffer_load_dwordx4 v[92:95], v2, s[8:11], s54 offen offset:3072 sc1
v_add_f32 v200, v200, v204
v_mfma_f32_16x16x32_bf16 v[156:159], a[96:99], v[16:19], 0
v_add_f32 v193, v193, v197
v_add_f32 v201, v201, v205
v_mfma_f32_16x16x32_bf16 v[152:155], a[68:71], v[20:23], v[152:155]
v_add_f32 v194, v194, v198
v_add_f32 v202, v202, v206
v_mfma_f32_16x16x32_bf16 v[156:159], a[100:103], v[20:23], v[156:159]
v_add_f32 v195, v195, v199
v_add_f32 v203, v203, v207
v_mfma_f32_16x16x32_bf16 v[152:155], a[72:75], v[24:27], v[152:155]
ds_write_b128 v2, v[144:147] offset:12288
v_add_f32 v192, v192, v200
v_mfma_f32_16x16x32_bf16 v[156:159], a[104:107], v[24:27], v[156:159]
buffer_load_dwordx4 v[96:99], v5, s[8:11], s54 offen offset:0 sc1
v_add_f32 v193, v193, v201
v_mfma_f32_16x16x32_bf16 v[152:155], a[76:79], v[28:31], v[152:155]
v_add_f32 v194, v194, v202
v_add_f32 v195, v195, v203
v_mfma_f32_16x16x32_bf16 v[156:159], a[108:111], v[28:31], v[156:159]
ds_write_b128 v2, v[148:151] offset:13312
v_cvt_pk_bf16_f32 v224, v192, v193
v_mfma_f32_16x16x32_bf16 v[152:155], a[80:83], v[32:35], v[152:155]
v_cvt_pk_bf16_f32 v225, v194, v195
v_add_f32 v208, v208, v212
v_mfma_f32_16x16x32_bf16 v[156:159], a[112:115], v[32:35], v[156:159]
v_add_f32 v216, v216, v220
v_add_f32 v209, v209, v213
v_mfma_f32_16x16x32_bf16 v[152:155], a[84:87], v[36:39], v[152:155]
buffer_load_dwordx4 v[100:103], v5, s[8:11], s54 offen offset:1024 sc1
v_add_f32 v217, v217, v221
v_mfma_f32_16x16x32_bf16 v[156:159], a[116:119], v[36:39], v[156:159]
v_add_f32 v210, v210, v214
v_add_f32 v218, v218, v222
v_mfma_f32_16x16x32_bf16 v[152:155], a[88:91], v[40:43], v[152:155]
v_add_f32 v211, v211, v215
v_add_f32 v219, v219, v223
v_mfma_f32_16x16x32_bf16 v[156:159], a[120:123], v[40:43], v[156:159]
v_add_f32 v208, v208, v216
v_add_f32 v209, v209, v217
v_mfma_f32_16x16x32_bf16 v[152:155], a[92:95], v[44:47], v[152:155]
v_add_f32 v210, v210, v218
v_add_f32 v211, v211, v219
v_mfma_f32_16x16x32_bf16 v[156:159], a[124:127], v[44:47], v[156:159]
buffer_load_dwordx4 v[104:107], v5, s[8:11], s54 offen offset:2048 sc1
v_cvt_pk_bf16_f32 v226, v208, v209
v_mfma_f32_16x16x32_bf16 v[160:163], v[16:19], a[128:131], 0
v_cvt_pk_bf16_f32 v227, v210, v211
buffer_store_dwordx4 v[224:227], v5, s[8:11], s55 offen sc1
v_mfma_f32_16x16x32_bf16 v[164:167], v[16:19], a[160:163], 0
v_mfma_f32_16x16x32_bf16 v[160:163], v[20:23], a[132:135], v[160:163]
v_mfma_f32_16x16x32_bf16 v[164:167], v[20:23], a[164:167], v[164:167]
v_mfma_f32_16x16x32_bf16 v[160:163], v[24:27], a[136:139], v[160:163]
buffer_load_dwordx4 v[108:111], v5, s[8:11], s54 offen offset:3072 sc1
ds_write_b128 v2, v[152:155] offset:14336
v_mfma_f32_16x16x32_bf16 v[164:167], v[24:27], a[168:171], v[164:167]
s_mov_b32 m0, s68
v_mfma_f32_16x16x32_bf16 v[160:163], v[28:31], a[140:143], v[160:163]
buffer_load_dwordx4 v243, s[12:15], s69 offen lds
v_mfma_f32_16x16x32_bf16 v[164:167], v[28:31], a[172:175], v[164:167]
s_add_u32 s68, s68, s70
s_add_u32 s69, s69, s71
ds_write_b128 v2, v[156:159] offset:15360
v_mfma_f32_16x16x32_bf16 v[160:163], v[32:35], a[144:147], v[160:163]
v_mfma_f32_16x16x32_bf16 v[164:167], v[32:35], a[176:179], v[164:167]
v_mfma_f32_16x16x32_bf16 v[160:163], v[36:39], a[148:151], v[160:163]
v_mfma_f32_16x16x32_bf16 v[164:167], v[36:39], a[180:183], v[164:167]
v_mfma_f32_16x16x32_bf16 v[160:163], v[40:43], a[152:155], v[160:163]
v_mfma_f32_16x16x32_bf16 v[164:167], v[40:43], a[184:187], v[164:167]
v_mfma_f32_16x16x32_bf16 v[160:163], v[44:47], a[156:159], v[160:163]
v_mfma_f32_16x16x32_bf16 v[164:167], v[44:47], a[188:191], v[164:167]
s_waitcnt vmcnt(11)
v_mfma_f32_16x16x32_bf16 v[168:171], a[0:3], v[48:51], 0
v_mfma_f32_16x16x32_bf16 v[172:175], a[32:35], v[48:51], 0
buffer_load_dwordx4 v[112:115], v2, s[8:11], s45 offen offset:0 sc1
v_mfma_f32_16x16x32_bf16 v[168:171], a[4:7], v[52:55], v[168:171]
v_mfma_f32_16x16x32_bf16 v[172:175], a[36:39], v[52:55], v[172:175]
v_mfma_f32_16x16x32_bf16 v[168:171], a[8:11], v[56:59], v[168:171]
ds_write_b128 v2, v[160:163] offset:16384
v_mfma_f32_16x16x32_bf16 v[172:175], a[40:43], v[56:59], v[172:175]
v_mfma_f32_16x16x32_bf16 v[168:171], a[12:15], v[60:63], v[168:171]
buffer_load_dwordx4 v[116:119], v2, s[8:11], s45 offen offset:1024 sc1
v_mfma_f32_16x16x32_bf16 v[172:175], a[44:47], v[60:63], v[172:175]
ds_write_b128 v2, v[164:167] offset:17408
v_mfma_f32_16x16x32_bf16 v[168:171], a[16:19], v[64:67], v[168:171]
v_mfma_f32_16x16x32_bf16 v[172:175], a[48:51], v[64:67], v[172:175]
v_mfma_f32_16x16x32_bf16 v[168:171], a[20:23], v[68:71], v[168:171]
v_mfma_f32_16x16x32_bf16 v[172:175], a[52:55], v[68:71], v[172:175]
buffer_load_dwordx4 v[120:123], v2, s[8:11], s45 offen offset:2048 sc1
v_mfma_f32_16x16x32_bf16 v[168:171], a[24:27], v[72:75], v[168:171]
v_mfma_f32_16x16x32_bf16 v[172:175], a[56:59], v[72:75], v[172:175]
v_mfma_f32_16x16x32_bf16 v[168:171], a[28:31], v[76:79], v[168:171]
v_mfma_f32_16x16x32_bf16 v[172:175], a[60:63], v[76:79], v[172:175]
v_mfma_f32_16x16x32_bf16 v[176:179], a[64:67], v[48:51], 0
buffer_load_dwordx4 v[124:127], v2, s[8:11], s45 offen offset:3072 sc1
v_mfma_f32_16x16x32_bf16 v[180:183], a[96:99], v[48:51], 0
v_mfma_f32_16x16x32_bf16 v[176:179], a[68:71], v[52:55], v[176:179]
v_mfma_f32_16x16x32_bf16 v[180:183], a[100:103], v[52:55], v[180:183]
v_mfma_f32_16x16x32_bf16 v[176:179], a[72:75], v[56:59], v[176:179]
s_nop 0
ds_write_b128 v2, v[168:171] offset:18432
v_mfma_f32_16x16x32_bf16 v[180:183], a[104:107], v[56:59], v[180:183]
buffer_load_dwordx4 v[128:131], v5, s[8:11], s45 offen offset:0 sc1
v_mfma_f32_16x16x32_bf16 v[176:179], a[76:79], v[60:63], v[176:179]
v_mfma_f32_16x16x32_bf16 v[180:183], a[108:111], v[60:63], v[180:183]
ds_write_b128 v2, v[172:175] offset:19456
v_mfma_f32_16x16x32_bf16 v[176:179], a[80:83], v[64:67], v[176:179]
v_mfma_f32_16x16x32_bf16 v[180:183], a[112:115], v[64:67], v[180:183]
v_mfma_f32_16x16x32_bf16 v[176:179], a[84:87], v[68:71], v[176:179]
buffer_load_dwordx4 v[132:135], v5, s[8:11], s45 offen offset:1024 sc1
v_mfma_f32_16x16x32_bf16 v[180:183], a[116:119], v[68:71], v[180:183]
v_mfma_f32_16x16x32_bf16 v[176:179], a[88:91], v[72:75], v[176:179]
v_mfma_f32_16x16x32_bf16 v[180:183], a[120:123], v[72:75], v[180:183]
v_mfma_f32_16x16x32_bf16 v[176:179], a[92:95], v[76:79], v[176:179]
v_mfma_f32_16x16x32_bf16 v[180:183], a[124:127], v[76:79], v[180:183]
buffer_load_dwordx4 v[136:139], v5, s[8:11], s45 offen offset:2048 sc1
v_mfma_f32_16x16x32_bf16 v[184:187], v[48:51], a[128:131], 0
v_mfma_f32_16x16x32_bf16 v[188:191], v[48:51], a[160:163], 0
v_mfma_f32_16x16x32_bf16 v[184:187], v[52:55], a[132:135], v[184:187]
v_mfma_f32_16x16x32_bf16 v[188:191], v[52:55], a[164:167], v[188:191]
v_mfma_f32_16x16x32_bf16 v[184:187], v[56:59], a[136:139], v[184:187]
buffer_load_dwordx4 v[140:143], v5, s[8:11], s45 offen offset:3072 sc1
ds_write_b128 v2, v[176:179] offset:20480
v_mfma_f32_16x16x32_bf16 v[188:191], v[56:59], a[168:171], v[188:191]
s_mov_b32 m0, s68
v_mfma_f32_16x16x32_bf16 v[184:187], v[60:63], a[140:143], v[184:187]
buffer_load_dwordx4 v243, s[12:15], s69 offen lds
v_mfma_f32_16x16x32_bf16 v[188:191], v[60:63], a[172:175], v[188:191]
s_add_u32 s68, s68, s70
s_add_u32 s69, s69, s71
ds_write_b128 v2, v[180:183] offset:21504
v_mfma_f32_16x16x32_bf16 v[184:187], v[64:67], a[144:147], v[184:187]
v_mfma_f32_16x16x32_bf16 v[188:191], v[64:67], a[176:179], v[188:191]
v_mfma_f32_16x16x32_bf16 v[184:187], v[68:71], a[148:151], v[184:187]
v_mfma_f32_16x16x32_bf16 v[188:191], v[68:71], a[180:183], v[188:191]
v_mfma_f32_16x16x32_bf16 v[184:187], v[72:75], a[152:155], v[184:187]
v_mfma_f32_16x16x32_bf16 v[188:191], v[72:75], a[184:187], v[188:191]
v_mfma_f32_16x16x32_bf16 v[184:187], v[76:79], a[156:159], v[184:187]
v_mfma_f32_16x16x32_bf16 v[188:191], v[76:79], a[188:191], v[188:191]
s_nop 6
ds_write_b128 v2, v[184:187] offset:22528
ds_write_b128 v2, v[188:191] offset:23552
s_add_u32 s55, s55, 0x40000
s_add_u32 s56, s56, 0x40000
s_add_u32 s57, s57, 0x40000
s_cmp_eq_u32 s52, 60
s_cselect_b32 s45, 0x1000000, 0
s_sub_u32 s55, s55, s45
s_sub_u32 s56, s56, s45
s_sub_u32 s57, s57, s45
s_waitcnt vmcnt(19) lgkmcnt(0)
s_barrier
s_add_u32 s59, s59, 1
v_mov_b32 v8, 1
v_mov_b32 v9, s91
s_mov_b64 exec, 1
buffer_atomic_add v8, v9, s[32:35], 0 offen sc1
s_mov_b64 exec, -1
s_add_u32 s52, s52, 4
fg1_loop_w1_\sf:
s_and_b32 s45, s52, 3
s_cmp_lg_u32 s45, 0
s_cbranch_scc1 nocv_122_\sf
s_mov_b32 s90, 1
s_branch g1_side_\sf
g1_back_w1_\sf:
nocv_122_\sf:
s_add_u32 s54, s54, 0x10000
s_cmp_eq_u32 s52, 58
s_cselect_b32 s45, 0x400000, 0
s_sub_u32 s54, s54, s45
s_add_u32 s45, s54, 0x8000
s_waitcnt vmcnt(10)
v_mfma_f32_16x16x32_bf16 v[144:147], a[0:3], v[80:83], 0
ds_read_b128 v[192:195], v2 offset:2048
v_mfma_f32_16x16x32_bf16 v[148:151], a[32:35], v[80:83], 0
buffer_load_dwordx4 v[16:19], v2, s[8:11], s54 offen offset:0 sc1
v_mfma_f32_16x16x32_bf16 v[144:147], a[4:7], v[84:87], v[144:147]
ds_read_b128 v[196:199], v2 offset:14336
v_mfma_f32_16x16x32_bf16 v[148:151], a[36:39], v[84:87], v[148:151]
ds_read_b128 v[200:203], v2 offset:26624
v_mfma_f32_16x16x32_bf16 v[144:147], a[8:11], v[88:91], v[144:147]
ds_read_b128 v[204:207], v2 offset:38912
v_mfma_f32_16x16x32_bf16 v[148:151], a[40:43], v[88:91], v[148:151]
ds_read_b128 v[208:211], v2 offset:3072
v_mfma_f32_16x16x32_bf16 v[144:147], a[12:15], v[92:95], v[144:147]
buffer_load_dwordx4 v[20:23], v2, s[8:11], s54 offen offset:1024 sc1
v_mfma_f32_16x16x32_bf16 v[148:151], a[44:47], v[92:95], v[148:151]
ds_read_b128 v[212:215], v2 offset:15360
v_mfma_f32_16x16x32_bf16 v[144:147], a[16:19], v[96:99], v[144:147]
ds_read_b128 v[216:219], v2 offset:27648
v_mfma_f32_16x16x32_bf16 v[148:151], a[48:51], v[96:99], v[148:151]
ds_read_b128 v[220:223], v2 offset:39936
v_mfma_f32_16x16x32_bf16 v[144:147], a[20:23], v[100:103], v[144:147]
v_mfma_f32_16x16x32_bf16 v[148:151], a[52:55], v[100:103], v[148:151]
buffer_load_dwordx4 v[24:27], v2, s[8:11], s54 offen offset:2048 sc1
v_mfma_f32_16x16x32_bf16 v[144:147], a[24:27], v[104:107], v[144:147]
v_mfma_f32_16x16x32_bf16 v[148:151], a[56:59], v[104:107], v[148:151]
v_mfma_f32_16x16x32_bf16 v[144:147], a[28:31], v[108:111], v[144:147]
v_mfma_f32_16x16x32_bf16 v[148:151], a[60:63], v[108:111], v[148:151]
s_waitcnt lgkmcnt(0)
v_add_f32 v192, v192, v196
v_mfma_f32_16x16x32_bf16 v[152:155], a[64:67], v[80:83], 0
buffer_load_dwordx4 v[28:31], v2, s[8:11], s54 offen offset:3072 sc1
v_add_f32 v200, v200, v204
v_mfma_f32_16x16x32_bf16 v[156:159], a[96:99], v[80:83], 0
v_add_f32 v193, v193, v197
v_add_f32 v201, v201, v205
v_mfma_f32_16x16x32_bf16 v[152:155], a[68:71], v[84:87], v[152:155]
v_add_f32 v194, v194, v198
v_add_f32 v202, v202, v206
v_mfma_f32_16x16x32_bf16 v[156:159], a[100:103], v[84:87], v[156:159]
v_add_f32 v195, v195, v199
v_add_f32 v203, v203, v207
v_mfma_f32_16x16x32_bf16 v[152:155], a[72:75], v[88:91], v[152:155]
ds_write_b128 v2, v[144:147] offset:61440
v_add_f32 v192, v192, v200
v_mfma_f32_16x16x32_bf16 v[156:159], a[104:107], v[88:91], v[156:159]
buffer_load_dwordx4 v[32:35], v5, s[8:11], s54 offen offset:0 sc1
v_add_f32 v193, v193, v201
v_mfma_f32_16x16x32_bf16 v[152:155], a[76:79], v[92:95], v[152:155]
v_add_f32 v194, v194, v202
v_add_f32 v195, v195, v203
v_mfma_f32_16x16x32_bf16 v[156:159], a[108:111], v[92:95], v[156:159]
ds_write_b128 v2, v[148:151] offset:62464
v_cvt_pk_bf16_f32 v224, v192, v193
v_mfma_f32_16x16x32_bf16 v[152:155], a[80:83], v[96:99], v[152:155]
v_cvt_pk_bf16_f32 v225, v194, v195
v_add_f32 v208, v208, v212
v_mfma_f32_16x16x32_bf16 v[156:159], a[112:115], v[96:99], v[156:159]
v_add_f32 v216, v216, v220
v_add_f32 v209, v209, v213
v_mfma_f32_16x16x32_bf16 v[152:155], a[84:87], v[100:103], v[152:155]
buffer_load_dwordx4 v[36:39], v5, s[8:11], s54 offen offset:1024 sc1
v_add_f32 v217, v217, v221
v_mfma_f32_16x16x32_bf16 v[156:159], a[116:119], v[100:103], v[156:159]
v_add_f32 v210, v210, v214
v_add_f32 v218, v218, v222
v_mfma_f32_16x16x32_bf16 v[152:155], a[88:91], v[104:107], v[152:155]
v_add_f32 v211, v211, v215
v_add_f32 v219, v219, v223
v_mfma_f32_16x16x32_bf16 v[156:159], a[120:123], v[104:107], v[156:159]
v_add_f32 v208, v208, v216
v_add_f32 v209, v209, v217
v_mfma_f32_16x16x32_bf16 v[152:155], a[92:95], v[108:111], v[152:155]
v_add_f32 v210, v210, v218
v_add_f32 v211, v211, v219
v_mfma_f32_16x16x32_bf16 v[156:159], a[124:127], v[108:111], v[156:159]
buffer_load_dwordx4 v[40:43], v5, s[8:11], s54 offen offset:2048 sc1
v_cvt_pk_bf16_f32 v226, v208, v209
v_mfma_f32_16x16x32_bf16 v[160:163], v[80:83], a[128:131], 0
v_cvt_pk_bf16_f32 v227, v210, v211
buffer_store_dwordx4 v[224:227], v2, s[8:11], s56 offen sc1
v_mfma_f32_16x16x32_bf16 v[164:167], v[80:83], a[160:163], 0
ds_read_b128 v[192:195], v2 offset:8192
v_mfma_f32_16x16x32_bf16 v[160:163], v[84:87], a[132:135], v[160:163]
ds_read_b128 v[196:199], v2 offset:20480
v_mfma_f32_16x16x32_bf16 v[164:167], v[84:87], a[164:167], v[164:167]
ds_read_b128 v[200:203], v2 offset:32768
v_mfma_f32_16x16x32_bf16 v[160:163], v[88:91], a[136:139], v[160:163]
buffer_load_dwordx4 v[44:47], v5, s[8:11], s54 offen offset:3072 sc1
ds_write_b128 v2, v[152:155] offset:63488
v_mfma_f32_16x16x32_bf16 v[164:167], v[88:91], a[168:171], v[164:167]
s_mov_b32 m0, s68
v_mfma_f32_16x16x32_bf16 v[160:163], v[92:95], a[140:143], v[160:163]
buffer_load_dwordx4 v243, s[12:15], s69 offen lds
v_mfma_f32_16x16x32_bf16 v[164:167], v[92:95], a[172:175], v[164:167]
s_add_u32 s68, s68, s70
s_add_u32 s69, s69, s71
ds_write_b128 v2, v[156:159] offset:64512
v_mfma_f32_16x16x32_bf16 v[160:163], v[96:99], a[144:147], v[160:163]
ds_read_b128 v[204:207], v2 offset:45056
v_mfma_f32_16x16x32_bf16 v[164:167], v[96:99], a[176:179], v[164:167]
ds_read_b128 v[208:211], v2 offset:9216
v_mfma_f32_16x16x32_bf16 v[160:163], v[100:103], a[148:151], v[160:163]
ds_read_b128 v[212:215], v2 offset:21504
v_mfma_f32_16x16x32_bf16 v[164:167], v[100:103], a[180:183], v[164:167]
ds_read_b128 v[216:219], v2 offset:33792
v_mfma_f32_16x16x32_bf16 v[160:163], v[104:107], a[152:155], v[160:163]
ds_read_b128 v[220:223], v2 offset:46080
v_mfma_f32_16x16x32_bf16 v[164:167], v[104:107], a[184:187], v[164:167]
v_mfma_f32_16x16x32_bf16 v[160:163], v[108:111], a[156:159], v[160:163]
v_mfma_f32_16x16x32_bf16 v[164:167], v[108:111], a[188:191], v[164:167]
s_waitcnt vmcnt(11)
v_mfma_f32_16x16x32_bf16 v[168:171], a[0:3], v[112:115], 0
v_mfma_f32_16x16x32_bf16 v[172:175], a[32:35], v[112:115], 0
buffer_load_dwordx4 v[48:51], v2, s[8:11], s45 offen offset:0 sc1
v_mfma_f32_16x16x32_bf16 v[168:171], a[4:7], v[116:119], v[168:171]
s_waitcnt lgkmcnt(0)
v_add_f32 v192, v192, v196
v_mfma_f32_16x16x32_bf16 v[172:175], a[36:39], v[116:119], v[172:175]
v_add_f32 v200, v200, v204
v_add_f32 v193, v193, v197
v_mfma_f32_16x16x32_bf16 v[168:171], a[8:11], v[120:123], v[168:171]
ds_write_b128 v4, v[160:163] offset:16384
v_add_f32 v201, v201, v205
v_mfma_f32_16x16x32_bf16 v[172:175], a[40:43], v[120:123], v[172:175]
v_add_f32 v194, v194, v198
v_add_f32 v202, v202, v206
v_mfma_f32_16x16x32_bf16 v[168:171], a[12:15], v[124:127], v[168:171]
buffer_load_dwordx4 v[52:55], v2, s[8:11], s45 offen offset:1024 sc1
v_add_f32 v195, v195, v199
v_mfma_f32_16x16x32_bf16 v[172:175], a[44:47], v[124:127], v[172:175]
ds_write_b128 v4, v[164:167] offset:17408
v_add_f32 v203, v203, v207
v_mfma_f32_16x16x32_bf16 v[168:171], a[16:19], v[128:131], v[168:171]
v_add_f32 v192, v192, v200
v_add_f32 v193, v193, v201
v_mfma_f32_16x16x32_bf16 v[172:175], a[48:51], v[128:131], v[172:175]
v_add_f32 v194, v194, v202
v_add_f32 v195, v195, v203
v_mfma_f32_16x16x32_bf16 v[168:171], a[20:23], v[132:135], v[168:171]
v_cvt_pk_bf16_f32 v228, v192, v193
v_cvt_pk_bf16_f32 v229, v194, v195
v_mfma_f32_16x16x32_bf16 v[172:175], a[52:55], v[132:135], v[172:175]
buffer_load_dwordx4 v[56:59], v2, s[8:11], s45 offen offset:2048 sc1
v_add_f32 v208, v208, v212
v_mfma_f32_16x16x32_bf16 v[168:171], a[24:27], v[136:139], v[168:171]
v_add_f32 v216, v216, v220
v_add_f32 v209, v209, v213
v_mfma_f32_16x16x32_bf16 v[172:175], a[56:59], v[136:139], v[172:175]
v_add_f32 v217, v217, v221
v_add_f32 v210, v210, v214
v_mfma_f32_16x16x32_bf16 v[168:171], a[28:31], v[140:143], v[168:171]
v_add_f32 v218, v218, v222
v_add_f32 v211, v211, v215
v_mfma_f32_16x16x32_bf16 v[172:175], a[60:63], v[140:143], v[172:175]
v_add_f32 v219, v219, v223
v_add_f32 v208, v208, v216
v_mfma_f32_16x16x32_bf16 v[176:179], a[64:67], v[112:115], 0
buffer_load_dwordx4 v[60:63], v2, s[8:11], s45 offen offset:3072 sc1
v_add_f32 v209, v209, v217
v_mfma_f32_16x16x32_bf16 v[180:183], a[96:99], v[112:115], 0
v_add_f32 v210, v210, v218
v_add_f32 v211, v211, v219
v_mfma_f32_16x16x32_bf16 v[176:179], a[68:71], v[116:119], v[176:179]
v_cvt_pk_bf16_f32 v230, v208, v209
v_cvt_pk_bf16_f32 v231, v210, v211
v_mfma_f32_16x16x32_bf16 v[180:183], a[100:103], v[116:119], v[180:183]
buffer_store_dwordx4 v[228:231], v5, s[8:11], s56 offen sc1
v_mfma_f32_16x16x32_bf16 v[176:179], a[72:75], v[120:123], v[176:179]
ds_write_b128 v4, v[168:171] offset:18432
v_mfma_f32_16x16x32_bf16 v[180:183], a[104:107], v[120:123], v[180:183]
buffer_load_dwordx4 v[64:67], v5, s[8:11], s45 offen offset:0 sc1
v_mfma_f32_16x16x32_bf16 v[176:179], a[76:79], v[124:127], v[176:179]
v_mfma_f32_16x16x32_bf16 v[180:183], a[108:111], v[124:127], v[180:183]
ds_write_b128 v4, v[172:175] offset:19456
v_mfma_f32_16x16x32_bf16 v[176:179], a[80:83], v[128:131], v[176:179]
v_mfma_f32_16x16x32_bf16 v[180:183], a[112:115], v[128:131], v[180:183]
v_mfma_f32_16x16x32_bf16 v[176:179], a[84:87], v[132:135], v[176:179]
buffer_load_dwordx4 v[68:71], v5, s[8:11], s45 offen offset:1024 sc1
v_mfma_f32_16x16x32_bf16 v[180:183], a[116:119], v[132:135], v[180:183]
v_mfma_f32_16x16x32_bf16 v[176:179], a[88:91], v[136:139], v[176:179]
v_mfma_f32_16x16x32_bf16 v[180:183], a[120:123], v[136:139], v[180:183]
v_mfma_f32_16x16x32_bf16 v[176:179], a[92:95], v[140:143], v[176:179]
v_mfma_f32_16x16x32_bf16 v[180:183], a[124:127], v[140:143], v[180:183]
buffer_load_dwordx4 v[72:75], v5, s[8:11], s45 offen offset:2048 sc1
v_mfma_f32_16x16x32_bf16 v[184:187], v[112:115], a[128:131], 0
v_mfma_f32_16x16x32_bf16 v[188:191], v[112:115], a[160:163], 0
v_mfma_f32_16x16x32_bf16 v[184:187], v[116:119], a[132:135], v[184:187]
v_mfma_f32_16x16x32_bf16 v[188:191], v[116:119], a[164:167], v[188:191]
v_mfma_f32_16x16x32_bf16 v[184:187], v[120:123], a[136:139], v[184:187]
buffer_load_dwordx4 v[76:79], v5, s[8:11], s45 offen offset:3072 sc1
ds_write_b128 v4, v[176:179] offset:20480
v_mfma_f32_16x16x32_bf16 v[188:191], v[120:123], a[168:171], v[188:191]
s_mov_b32 m0, s68
v_mfma_f32_16x16x32_bf16 v[184:187], v[124:127], a[140:143], v[184:187]
buffer_load_dwordx4 v243, s[12:15], s69 offen lds
v_mfma_f32_16x16x32_bf16 v[188:191], v[124:127], a[172:175], v[188:191]
s_add_u32 s68, s68, s70
s_add_u32 s69, s69, s71
ds_write_b128 v4, v[180:183] offset:21504
v_mfma_f32_16x16x32_bf16 v[184:187], v[128:131], a[144:147], v[184:187]
v_mfma_f32_16x16x32_bf16 v[188:191], v[128:131], a[176:179], v[188:191]
v_mfma_f32_16x16x32_bf16 v[184:187], v[132:135], a[148:151], v[184:187]
v_mfma_f32_16x16x32_bf16 v[188:191], v[132:135], a[180:183], v[188:191]
v_mfma_f32_16x16x32_bf16 v[184:187], v[136:139], a[152:155], v[184:187]
v_mfma_f32_16x16x32_bf16 v[188:191], v[136:139], a[184:187], v[188:191]
v_mfma_f32_16x16x32_bf16 v[184:187], v[140:143], a[156:159], v[184:187]
v_mfma_f32_16x16x32_bf16 v[188:191], v[140:143], a[188:191], v[188:191]
s_nop 6
ds_write_b128 v4, v[184:187] offset:22528
ds_write_b128 v4, v[188:191] offset:23552
s_add_u32 s55, s55, 0x40000
s_add_u32 s56, s56, 0x40000
s_add_u32 s57, s57, 0x40000
s_waitcnt vmcnt(20) lgkmcnt(0)
s_barrier
s_add_u32 s59, s59, 1
s_add_u32 s52, s52, 2
s_cmp_ge_u32 s52, s53
s_cbranch_scc1 fg1_done_w1_\sf
s_add_u32 s54, s54, 0x10000
s_add_u32 s45, s54, 0x8000
s_waitcnt vmcnt(11)
v_mfma_f32_16x16x32_bf16 v[144:147], a[0:3], v[16:19], 0
ds_read_b128 v[192:195], v2 offset:55296
v_mfma_f32_16x16x32_bf16 v[148:151], a[32:35], v[16:19], 0
buffer_load_dwordx4 v[80:83], v2, s[8:11], s54 offen offset:0 sc1
v_mfma_f32_16x16x32_bf16 v[144:147], a[4:7], v[20:23], v[144:147]
ds_read_b128 v[196:199], v4 offset:18432
v_mfma_f32_16x16x32_bf16 v[148:151], a[36:39], v[20:23], v[148:151]
ds_read_b128 v[200:203], v4 offset:30720
v_mfma_f32_16x16x32_bf16 v[144:147], a[8:11], v[24:27], v[144:147]
ds_read_b128 v[204:207], v4 offset:43008
v_mfma_f32_16x16x32_bf16 v[148:151], a[40:43], v[24:27], v[148:151]
ds_read_b128 v[208:211], v2 offset:56320
v_mfma_f32_16x16x32_bf16 v[144:147], a[12:15], v[28:31], v[144:147]
buffer_load_dwordx4 v[84:87], v2, s[8:11], s54 offen offset:1024 sc1
v_mfma_f32_16x16x32_bf16 v[148:151], a[44:47], v[28:31], v[148:151]
ds_read_b128 v[212:215], v4 offset:19456
v_mfma_f32_16x16x32_bf16 v[144:147], a[16:19], v[32:35], v[144:147]
ds_read_b128 v[216:219], v4 offset:31744
v_mfma_f32_16x16x32_bf16 v[148:151], a[48:51], v[32:35], v[148:151]
ds_read_b128 v[220:223], v4 offset:44032
v_mfma_f32_16x16x32_bf16 v[144:147], a[20:23], v[36:39], v[144:147]
v_mfma_f32_16x16x32_bf16 v[148:151], a[52:55], v[36:39], v[148:151]
buffer_load_dwordx4 v[88:91], v2, s[8:11], s54 offen offset:2048 sc1
v_mfma_f32_16x16x32_bf16 v[144:147], a[24:27], v[40:43], v[144:147]
v_mfma_f32_16x16x32_bf16 v[148:151], a[56:59], v[40:43], v[148:151]
v_mfma_f32_16x16x32_bf16 v[144:147], a[28:31], v[44:47], v[144:147]
v_mfma_f32_16x16x32_bf16 v[148:151], a[60:63], v[44:47], v[148:151]
s_waitcnt lgkmcnt(0)
v_add_f32 v192, v192, v196
v_mfma_f32_16x16x32_bf16 v[152:155], a[64:67], v[16:19], 0
buffer_load_dwordx4 v[92:95], v2, s[8:11], s54 offen offset:3072 sc1
v_add_f32 v200, v200, v204
v_mfma_f32_16x16x32_bf16 v[156:159], a[96:99], v[16:19], 0
v_add_f32 v193, v193, v197
v_add_f32 v201, v201, v205
v_mfma_f32_16x16x32_bf16 v[152:155], a[68:71], v[20:23], v[152:155]
v_add_f32 v194, v194, v198
v_add_f32 v202, v202, v206
v_mfma_f32_16x16x32_bf16 v[156:159], a[100:103], v[20:23], v[156:159]
v_add_f32 v195, v195, v199
v_add_f32 v203, v203, v207
v_mfma_f32_16x16x32_bf16 v[152:155], a[72:75], v[24:27], v[152:155]
ds_write_b128 v2, v[144:147] offset:12288
v_add_f32 v192, v192, v200
v_mfma_f32_16x16x32_bf16 v[156:159], a[104:107], v[24:27], v[156:159]
buffer_load_dwordx4 v[96:99], v5, s[8:11], s54 offen offset:0 sc1
v_add_f32 v193, v193, v201
v_mfma_f32_16x16x32_bf16 v[152:155], a[76:79], v[28:31], v[152:155]
v_add_f32 v194, v194, v202
v_add_f32 v195, v195, v203
v_mfma_f32_16x16x32_bf16 v[156:159], a[108:111], v[28:31], v[156:159]
ds_write_b128 v2, v[148:151] offset:13312
v_cvt_pk_bf16_f32 v224, v192, v193
v_mfma_f32_16x16x32_bf16 v[152:155], a[80:83], v[32:35], v[152:155]
v_cvt_pk_bf16_f32 v225, v194, v195
v_add_f32 v208, v208, v212
v_mfma_f32_16x16x32_bf16 v[156:159], a[112:115], v[32:35], v[156:159]
v_add_f32 v216, v216, v220
v_add_f32 v209, v209, v213
v_mfma_f32_16x16x32_bf16 v[152:155], a[84:87], v[36:39], v[152:155]
buffer_load_dwordx4 v[100:103], v5, s[8:11], s54 offen offset:1024 sc1
v_add_f32 v217, v217, v221
v_mfma_f32_16x16x32_bf16 v[156:159], a[116:119], v[36:39], v[156:159]
v_add_f32 v210, v210, v214
v_add_f32 v218, v218, v222
v_mfma_f32_16x16x32_bf16 v[152:155], a[88:91], v[40:43], v[152:155]
v_add_f32 v211, v211, v215
v_add_f32 v219, v219, v223
v_mfma_f32_16x16x32_bf16 v[156:159], a[120:123], v[40:43], v[156:159]
v_add_f32 v208, v208, v216
v_add_f32 v209, v209, v217
v_mfma_f32_16x16x32_bf16 v[152:155], a[92:95], v[44:47], v[152:155]
v_add_f32 v210, v210, v218
v_add_f32 v211, v211, v219
v_mfma_f32_16x16x32_bf16 v[156:159], a[124:127], v[44:47], v[156:159]
buffer_load_dwordx4 v[104:107], v5, s[8:11], s54 offen offset:2048 sc1
v_cvt_pk_bf16_f32 v226, v208, v209
v_mfma_f32_16x16x32_bf16 v[160:163], v[16:19], a[128:131], 0
v_cvt_pk_bf16_f32 v227, v210, v211
buffer_store_dwordx4 v[224:227], v5, s[8:11], s55 offen sc1
v_mfma_f32_16x16x32_bf16 v[164:167], v[16:19], a[160:163], 0
v_mfma_f32_16x16x32_bf16 v[160:163], v[20:23], a[132:135], v[160:163]
v_mfma_f32_16x16x32_bf16 v[164:167], v[20:23], a[164:167], v[164:167]
v_mfma_f32_16x16x32_bf16 v[160:163], v[24:27], a[136:139], v[160:163]
buffer_load_dwordx4 v[108:111], v5, s[8:11], s54 offen offset:3072 sc1
ds_write_b128 v2, v[152:155] offset:14336
v_mfma_f32_16x16x32_bf16 v[164:167], v[24:27], a[168:171], v[164:167]
s_mov_b32 m0, s68
v_mfma_f32_16x16x32_bf16 v[160:163], v[28:31], a[140:143], v[160:163]
buffer_load_dwordx4 v243, s[12:15], s69 offen lds
v_mfma_f32_16x16x32_bf16 v[164:167], v[28:31], a[172:175], v[164:167]
s_add_u32 s68, s68, s70
s_add_u32 s69, s69, s71
ds_write_b128 v2, v[156:159] offset:15360
v_mfma_f32_16x16x32_bf16 v[160:163], v[32:35], a[144:147], v[160:163]
v_mfma_f32_16x16x32_bf16 v[164:167], v[32:35], a[176:179], v[164:167]
v_mfma_f32_16x16x32_bf16 v[160:163], v[36:39], a[148:151], v[160:163]
v_mfma_f32_16x16x32_bf16 v[164:167], v[36:39], a[180:183], v[164:167]
v_mfma_f32_16x16x32_bf16 v[160:163], v[40:43], a[152:155], v[160:163]
v_mfma_f32_16x16x32_bf16 v[164:167], v[40:43], a[184:187], v[164:167]
v_mfma_f32_16x16x32_bf16 v[160:163], v[44:47], a[156:159], v[160:163]
v_mfma_f32_16x16x32_bf16 v[164:167], v[44:47], a[188:191], v[164:167]
s_waitcnt vmcnt(11)
v_mfma_f32_16x16x32_bf16 v[168:171], a[0:3], v[48:51], 0
v_mfma_f32_16x16x32_bf16 v[172:175], a[32:35], v[48:51], 0
buffer_load_dwordx4 v[112:115], v2, s[8:11], s45 offen offset:0 sc1
v_mfma_f32_16x16x32_bf16 v[168:171], a[4:7], v[52:55], v[168:171]
v_mfma_f32_16x16x32_bf16 v[172:175], a[36:39], v[52:55], v[172:175]
v_mfma_f32_16x16x32_bf16 v[168:171], a[8:11], v[56:59], v[168:171]
ds_write_b128 v2, v[160:163] offset:16384
v_mfma_f32_16x16x32_bf16 v[172:175], a[40:43], v[56:59], v[172:175]
v_mfma_f32_16x16x32_bf16 v[168:171], a[12:15], v[60:63], v[168:171]
buffer_load_dwordx4 v[116:119], v2, s[8:11], s45 offen offset:1024 sc1
v_mfma_f32_16x16x32_bf16 v[172:175], a[44:47], v[60:63], v[172:175]
ds_write_b128 v2, v[164:167] offset:17408
v_mfma_f32_16x16x32_bf16 v[168:171], a[16:19], v[64:67], v[168:171]
v_mfma_f32_16x16x32_bf16 v[172:175], a[48:51], v[64:67], v[172:175]
v_mfma_f32_16x16x32_bf16 v[168:171], a[20:23], v[68:71], v[168:171]
v_mfma_f32_16x16x32_bf16 v[172:175], a[52:55], v[68:71], v[172:175]
buffer_load_dwordx4 v[120:123], v2, s[8:11], s45 offen offset:2048 sc1
v_mfma_f32_16x16x32_bf16 v[168:171], a[24:27], v[72:75], v[168:171]
v_mfma_f32_16x16x32_bf16 v[172:175], a[56:59], v[72:75], v[172:175]
v_mfma_f32_16x16x32_bf16 v[168:171], a[28:31], v[76:79], v[168:171]
v_mfma_f32_16x16x32_bf16 v[172:175], a[60:63], v[76:79], v[172:175]
v_mfma_f32_16x16x32_bf16 v[176:179], a[64:67], v[48:51], 0
buffer_load_dwordx4 v[124:127], v2, s[8:11], s45 offen offset:3072 sc1
v_mfma_f32_16x16x32_bf16 v[180:183], a[96:99], v[48:51], 0
v_mfma_f32_16x16x32_bf16 v[176:179], a[68:71], v[52:55], v[176:179]
v_mfma_f32_16x16x32_bf16 v[180:183], a[100:103], v[52:55], v[180:183]
v_mfma_f32_16x16x32_bf16 v[176:179], a[72:75], v[56:59], v[176:179]
s_nop 0
ds_write_b128 v2, v[168:171] offset:18432
v_mfma_f32_16x16x32_bf16 v[180:183], a[104:107], v[56:59], v[180:183]
buffer_load_dwordx4 v[128:131], v5, s[8:11], s45 offen offset:0 sc1
v_mfma_f32_16x16x32_bf16 v[176:179], a[76:79], v[60:63], v[176:179]
v_mfma_f32_16x16x32_bf16 v[180:183], a[108:111], v[60:63], v[180:183]
ds_write_b128 v2, v[172:175] offset:19456
v_mfma_f32_16x16x32_bf16 v[176:179], a[80:83], v[64:67], v[176:179]
v_mfma_f32_16x16x32_bf16 v[180:183], a[112:115], v[64:67], v[180:183]
v_mfma_f32_16x16x32_bf16 v[176:179], a[84:87], v[68:71], v[176:179]
buffer_load_dwordx4 v[132:135], v5, s[8:11], s45 offen offset:1024 sc1
v_mfma_f32_16x16x32_bf16 v[180:183], a[116:119], v[68:71], v[180:183]
v_mfma_f32_16x16x32_bf16 v[176:179], a[88:91], v[72:75], v[176:179]
v_mfma_f32_16x16x32_bf16 v[180:183], a[120:123], v[72:75], v[180:183]
v_mfma_f32_16x16x32_bf16 v[176:179], a[92:95], v[76:79], v[176:179]
v_mfma_f32_16x16x32_bf16 v[180:183], a[124:127], v[76:79], v[180:183]
buffer_load_dwordx4 v[136:139], v5, s[8:11], s45 offen offset:2048 sc1
v_mfma_f32_16x16x32_bf16 v[184:187], v[48:51], a[128:131], 0
v_mfma_f32_16x16x32_bf16 v[188:191], v[48:51], a[160:163], 0
v_mfma_f32_16x16x32_bf16 v[184:187], v[52:55], a[132:135], v[184:187]
v_mfma_f32_16x16x32_bf16 v[188:191], v[52:55], a[164:167], v[188:191]
v_mfma_f32_16x16x32_bf16 v[184:187], v[56:59], a[136:139], v[184:187]
buffer_load_dwordx4 v[140:143], v5, s[8:11], s45 offen offset:3072 sc1
ds_write_b128 v2, v[176:179] offset:20480
v_mfma_f32_16x16x32_bf16 v[188:191], v[56:59], a[168:171], v[188:191]
s_mov_b32 m0, s68
v_mfma_f32_16x16x32_bf16 v[184:187], v[60:63], a[140:143], v[184:187]
buffer_load_dwordx4 v243, s[12:15], s69 offen lds
v_mfma_f32_16x16x32_bf16 v[188:191], v[60:63], a[172:175], v[188:191]
s_add_u32 s68, s68, s70
s_add_u32 s69, s69, s71
ds_write_b128 v2, v[180:183] offset:21504
v_mfma_f32_16x16x32_bf16 v[184:187], v[64:67], a[144:147], v[184:187]
v_mfma_f32_16x16x32_bf16 v[188:191], v[64:67], a[176:179], v[188:191]
v_mfma_f32_16x16x32_bf16 v[184:187], v[68:71], a[148:151], v[184:187]
v_mfma_f32_16x16x32_bf16 v[188:191], v[68:71], a[180:183], v[188:191]
v_mfma_f32_16x16x32_bf16 v[184:187], v[72:75], a[152:155], v[184:187]
v_mfma_f32_16x16x32_bf16 v[188:191], v[72:75], a[184:187], v[188:191]
v_mfma_f32_16x16x32_bf16 v[184:187], v[76:79], a[156:159], v[184:187]
v_mfma_f32_16x16x32_bf16 v[188:191], v[76:79], a[188:191], v[188:191]
s_nop 6
ds_write_b128 v2, v[184:187] offset:22528
ds_write_b128 v2, v[188:191] offset:23552
s_add_u32 s55, s55, 0x40000
s_add_u32 s56, s56, 0x40000
s_add_u32 s57, s57, 0x40000
s_cmp_eq_u32 s52, 60
s_cselect_b32 s45, 0x1000000, 0
s_sub_u32 s55, s55, s45
s_sub_u32 s56, s56, s45
s_sub_u32 s57, s57, s45
s_waitcnt vmcnt(19) lgkmcnt(0)
s_barrier
s_add_u32 s59, s59, 1
s_branch fg1_loop_w1_\sf
fg1_done_w1_\sf:
ds_read_b128 v[192:195], v2 offset:55296
ds_read_b128 v[196:199], v4 offset:18432
ds_read_b128 v[200:203], v4 offset:30720
ds_read_b128 v[204:207], v4 offset:43008
ds_read_b128 v[208:211], v2 offset:56320
ds_read_b128 v[212:215], v4 offset:19456
ds_read_b128 v[216:219], v4 offset:31744
ds_read_b128 v[220:223], v4 offset:44032
s_waitcnt lgkmcnt(0)
v_add_f32 v192, v192, v196
v_add_f32 v200, v200, v204
v_add_f32 v193, v193, v197
v_add_f32 v201, v201, v205
v_add_f32 v194, v194, v198
v_add_f32 v202, v202, v206
v_add_f32 v195, v195, v199
v_add_f32 v203, v203, v207
v_add_f32 v192, v192, v200
v_add_f32 v193, v193, v201
v_add_f32 v194, v194, v202
v_add_f32 v195, v195, v203
v_cvt_pk_bf16_f32 v224, v192, v193
v_cvt_pk_bf16_f32 v225, v194, v195
v_add_f32 v208, v208, v212
v_add_f32 v216, v216, v220
v_add_f32 v209, v209, v213
v_add_f32 v217, v217, v221
v_add_f32 v210, v210, v214
v_add_f32 v218, v218, v222
v_add_f32 v211, v211, v215
v_add_f32 v219, v219, v223
v_add_f32 v208, v208, v216
v_add_f32 v209, v209, v217
v_add_f32 v210, v210, v218
v_add_f32 v211, v211, v219
v_cvt_pk_bf16_f32 v226, v208, v209
v_cvt_pk_bf16_f32 v227, v210, v211
buffer_store_dwordx4 v[224:227], v5, s[8:11], s55 offen sc1
s_nop 1
s_branch fg1_join_\sf
fg1_wave2_\sf:
v_and_b32 v12, 15, v1
v_lshrrev_b32 v13, 4, v1
v_lshlrev_b32 v13, 5, v13
v_lshl_add_u32 v3, v12, 11, v13
v_add_u32 v4, 49152, v2
v_add_u32 v5, 4096, v2
s_lshl_b32 s54, s52, 16
s_lshl_b32 s45, s92, 22
s_add_u32 s54, s54, s45
.if \sf == 0
s_add_u32 s54, s54, 0x6004000
.else
s_add_u32 s54, s54, 0xe004000
.endif
s_lshl_b32 s45, s52, 5
s_add_u32 s45, s45, s49
s_lshl_b32 s45, s45, 13
s_lshl_b32 s46, s50, 10
s_add_u32 s47, s45, s46
s_add_u32 s55, s47, 0x0
s_add_u32 s56, s47, 0x1000000
s_add_u32 s47, s47, s46
s_add_u32 s57, s47, 0x2000000
v_mov_b32 v9, s91
s_nop 1
dw_123_\sf:
buffer_load_dword v8, v9, s[32:35], 0 offen sc1
s_waitcnt vmcnt(0)
v_cmp_gt_u32 vcc, 32, v8
s_cbranch_vccz dwd_124_\sf
s_add_u32 s44, s44, 1
s_cmp_lt_u32 s44, 0x40000
s_cbranch_scc1 dw_123_\sf
s_nop 0
dwd_124_\sf:
s_add_u32 s45, s54, 0x8000
buffer_load_dwordx4 v[16:19], v2, s[8:11], s54 offen offset:0 sc1
buffer_load_dwordx4 v[20:23], v2, s[8:11], s54 offen offset:1024 sc1
buffer_load_dwordx4 v[24:27], v2, s[8:11], s54 offen offset:2048 sc1
buffer_load_dwordx4 v[28:31], v2, s[8:11], s54 offen offset:3072 sc1
buffer_load_dwordx4 v[32:35], v5, s[8:11], s54 offen offset:0 sc1
buffer_load_dwordx4 v[36:39], v5, s[8:11], s54 offen offset:1024 sc1
buffer_load_dwordx4 v[40:43], v5, s[8:11], s54 offen offset:2048 sc1
buffer_load_dwordx4 v[44:47], v5, s[8:11], s54 offen offset:3072 sc1
buffer_load_dwordx4 v[48:51], v2, s[8:11], s45 offen offset:0 sc1
buffer_load_dwordx4 v[52:55], v2, s[8:11], s45 offen offset:1024 sc1
buffer_load_dwordx4 v[56:59], v2, s[8:11], s45 offen offset:2048 sc1
buffer_load_dwordx4 v[60:63], v2, s[8:11], s45 offen offset:3072 sc1
buffer_load_dwordx4 v[64:67], v5, s[8:11], s45 offen offset:0 sc1
buffer_load_dwordx4 v[68:71], v5, s[8:11], s45 offen offset:1024 sc1
buffer_load_dwordx4 v[72:75], v5, s[8:11], s45 offen offset:2048 sc1
buffer_load_dwordx4 v[76:79], v5, s[8:11], s45 offen offset:3072 sc1
s_mov_b32 s52, 0
s_load_dwordx2 s[12:13], s[0:1], 88
s_waitcnt lgkmcnt(0)
s_and_b32 s13, s13, 0xffff
s_mov_b32 s14, 0x700000
s_mov_b32 s15, 0x20000
s_mov_b32 s14, 0
s_mov_b32 s68, 0x30000
s_mov_b32 s69, 0
s_mov_b32 s70, 0
s_mov_b32 s71, 0
v_mov_b32 v243, 0
s_barrier
s_add_u32 s54, s54, 0x10000
s_add_u32 s45, s54, 0x8000
s_waitcnt vmcnt(0)
v_mfma_f32_16x16x32_bf16 v[144:147], a[0:3], v[16:19], 0
v_mfma_f32_16x16x32_bf16 v[148:151], a[32:35], v[16:19], 0
buffer_load_dwordx4 v[80:83], v2, s[8:11], s54 offen offset:0 sc1
v_mfma_f32_16x16x32_bf16 v[144:147], a[4:7], v[20:23], v[144:147]
buffer_load_dwordx4 a[192:195], v3, s[24:27], s61 offen offset:0
v_mfma_f32_16x16x32_bf16 v[148:151], a[36:39], v[20:23], v[148:151]
v_mfma_f32_16x16x32_bf16 v[144:147], a[8:11], v[24:27], v[144:147]
v_mfma_f32_16x16x32_bf16 v[148:151], a[40:43], v[24:27], v[148:151]
v_mfma_f32_16x16x32_bf16 v[144:147], a[12:15], v[28:31], v[144:147]
buffer_load_dwordx4 v[84:87], v2, s[8:11], s54 offen offset:1024 sc1
buffer_load_dwordx4 a[196:199], v3, s[24:27], s61 offen offset:16
v_mfma_f32_16x16x32_bf16 v[148:151], a[44:47], v[28:31], v[148:151]
v_mfma_f32_16x16x32_bf16 v[144:147], a[16:19], v[32:35], v[144:147]
v_mfma_f32_16x16x32_bf16 v[148:151], a[48:51], v[32:35], v[148:151]
v_mfma_f32_16x16x32_bf16 v[144:147], a[20:23], v[36:39], v[144:147]
buffer_load_dwordx4 a[200:203], v3, s[24:27], s61 offen offset:128
v_mfma_f32_16x16x32_bf16 v[148:151], a[52:55], v[36:39], v[148:151]
buffer_load_dwordx4 v[88:91], v2, s[8:11], s54 offen offset:2048 sc1
v_mfma_f32_16x16x32_bf16 v[144:147], a[24:27], v[40:43], v[144:147]
v_mfma_f32_16x16x32_bf16 v[148:151], a[56:59], v[40:43], v[148:151]
v_mfma_f32_16x16x32_bf16 v[144:147], a[28:31], v[44:47], v[144:147]
buffer_load_dwordx4 a[204:207], v3, s[24:27], s61 offen offset:144
v_mfma_f32_16x16x32_bf16 v[148:151], a[60:63], v[44:47], v[148:151]
v_mfma_f32_16x16x32_bf16 v[152:155], a[64:67], v[16:19], 0
buffer_load_dwordx4 v[92:95], v2, s[8:11], s54 offen offset:3072 sc1
v_mfma_f32_16x16x32_bf16 v[156:159], a[96:99], v[16:19], 0
v_mfma_f32_16x16x32_bf16 v[152:155], a[68:71], v[20:23], v[152:155]
buffer_load_dwordx4 a[208:211], v3, s[24:27], s61 offen offset:256
v_mfma_f32_16x16x32_bf16 v[156:159], a[100:103], v[20:23], v[156:159]
v_mfma_f32_16x16x32_bf16 v[152:155], a[72:75], v[24:27], v[152:155]
ds_write_b128 v2, v[144:147] offset:24576
v_mfma_f32_16x16x32_bf16 v[156:159], a[104:107], v[24:27], v[156:159]
buffer_load_dwordx4 v[96:99], v5, s[8:11], s54 offen offset:0 sc1
v_mfma_f32_16x16x32_bf16 v[152:155], a[76:79], v[28:31], v[152:155]
buffer_load_dwordx4 a[212:215], v3, s[24:27], s61 offen offset:272
v_mfma_f32_16x16x32_bf16 v[156:159], a[108:111], v[28:31], v[156:159]
ds_write_b128 v2, v[148:151] offset:25600
v_mfma_f32_16x16x32_bf16 v[152:155], a[80:83], v[32:35], v[152:155]
v_mfma_f32_16x16x32_bf16 v[156:159], a[112:115], v[32:35], v[156:159]
v_mfma_f32_16x16x32_bf16 v[152:155], a[84:87], v[36:39], v[152:155]
buffer_load_dwordx4 v[100:103], v5, s[8:11], s54 offen offset:1024 sc1
buffer_load_dwordx4 a[216:219], v3, s[24:27], s61 offen offset:384
v_mfma_f32_16x16x32_bf16 v[156:159], a[116:119], v[36:39], v[156:159]
v_mfma_f32_16x16x32_bf16 v[152:155], a[88:91], v[40:43], v[152:155]
v_mfma_f32_16x16x32_bf16 v[156:159], a[120:123], v[40:43], v[156:159]
v_mfma_f32_16x16x32_bf16 v[152:155], a[92:95], v[44:47], v[152:155]
buffer_load_dwordx4 a[220:223], v3, s[24:27], s61 offen offset:400
v_mfma_f32_16x16x32_bf16 v[156:159], a[124:127], v[44:47], v[156:159]
buffer_load_dwordx4 v[104:107], v5, s[8:11], s54 offen offset:2048 sc1
v_mfma_f32_16x16x32_bf16 v[160:163], v[16:19], a[128:131], 0
v_mfma_f32_16x16x32_bf16 v[164:167], v[16:19], a[160:163], 0
v_mfma_f32_16x16x32_bf16 v[160:163], v[20:23], a[132:135], v[160:163]
v_mfma_f32_16x16x32_bf16 v[164:167], v[20:23], a[164:167], v[164:167]
v_mfma_f32_16x16x32_bf16 v[160:163], v[24:27], a[136:139], v[160:163]
buffer_load_dwordx4 v[108:111], v5, s[8:11], s54 offen offset:3072 sc1
ds_write_b128 v2, v[152:155] offset:26624
v_mfma_f32_16x16x32_bf16 v[164:167], v[24:27], a[168:171], v[164:167]
s_mov_b32 m0, s68
v_mfma_f32_16x16x32_bf16 v[160:163], v[28:31], a[140:143], v[160:163]
buffer_load_dwordx4 v243, s[12:15], s69 offen lds
v_mfma_f32_16x16x32_bf16 v[164:167], v[28:31], a[172:175], v[164:167]
s_add_u32 s68, s68, s70
s_add_u32 s69, s69, s71
ds_write_b128 v2, v[156:159] offset:27648
v_mfma_f32_16x16x32_bf16 v[160:163], v[32:35], a[144:147], v[160:163]
v_mfma_f32_16x16x32_bf16 v[164:167], v[32:35], a[176:179], v[164:167]
v_mfma_f32_16x16x32_bf16 v[160:163], v[36:39], a[148:151], v[160:163]
v_mfma_f32_16x16x32_bf16 v[164:167], v[36:39], a[180:183], v[164:167]
v_mfma_f32_16x16x32_bf16 v[160:163], v[40:43], a[152:155], v[160:163]
v_mfma_f32_16x16x32_bf16 v[164:167], v[40:43], a[184:187], v[164:167]
v_mfma_f32_16x16x32_bf16 v[160:163], v[44:47], a[156:159], v[160:163]
v_mfma_f32_16x16x32_bf16 v[164:167], v[44:47], a[188:191], v[164:167]
v_mfma_f32_16x16x32_bf16 v[168:171], a[0:3], v[48:51], 0
v_mfma_f32_16x16x32_bf16 v[172:175], a[32:35], v[48:51], 0
buffer_load_dwordx4 v[112:115], v2, s[8:11], s45 offen offset:0 sc1
v_mfma_f32_16x16x32_bf16 v[168:171], a[4:7], v[52:55], v[168:171]
v_mfma_f32_16x16x32_bf16 v[172:175], a[36:39], v[52:55], v[172:175]
v_mfma_f32_16x16x32_bf16 v[168:171], a[8:11], v[56:59], v[168:171]
s_nop 0
ds_write_b128 v2, v[160:163] offset:28672
v_mfma_f32_16x16x32_bf16 v[172:175], a[40:43], v[56:59], v[172:175]
v_mfma_f32_16x16x32_bf16 v[168:171], a[12:15], v[60:63], v[168:171]
buffer_load_dwordx4 v[116:119], v2, s[8:11], s45 offen offset:1024 sc1
v_mfma_f32_16x16x32_bf16 v[172:175], a[44:47], v[60:63], v[172:175]
ds_write_b128 v2, v[164:167] offset:29696
v_mfma_f32_16x16x32_bf16 v[168:171], a[16:19], v[64:67], v[168:171]
v_mfma_f32_16x16x32_bf16 v[172:175], a[48:51], v[64:67], v[172:175]
v_mfma_f32_16x16x32_bf16 v[168:171], a[20:23], v[68:71], v[168:171]
v_mfma_f32_16x16x32_bf16 v[172:175], a[52:55], v[68:71], v[172:175]
buffer_load_dwordx4 v[120:123], v2, s[8:11], s45 offen offset:2048 sc1
v_mfma_f32_16x16x32_bf16 v[168:171], a[24:27], v[72:75], v[168:171]
v_mfma_f32_16x16x32_bf16 v[172:175], a[56:59], v[72:75], v[172:175]
v_mfma_f32_16x16x32_bf16 v[168:171], a[28:31], v[76:79], v[168:171]
v_mfma_f32_16x16x32_bf16 v[172:175], a[60:63], v[76:79], v[172:175]
v_mfma_f32_16x16x32_bf16 v[176:179], a[64:67], v[48:51], 0
buffer_load_dwordx4 v[124:127], v2, s[8:11], s45 offen offset:3072 sc1
v_mfma_f32_16x16x32_bf16 v[180:183], a[96:99], v[48:51], 0
v_mfma_f32_16x16x32_bf16 v[176:179], a[68:71], v[52:55], v[176:179]
v_mfma_f32_16x16x32_bf16 v[180:183], a[100:103], v[52:55], v[180:183]
v_mfma_f32_16x16x32_bf16 v[176:179], a[72:75], v[56:59], v[176:179]
s_nop 0
ds_write_b128 v2, v[168:171] offset:30720
v_mfma_f32_16x16x32_bf16 v[180:183], a[104:107], v[56:59], v[180:183]
buffer_load_dwordx4 v[128:131], v5, s[8:11], s45 offen offset:0 sc1
v_mfma_f32_16x16x32_bf16 v[176:179], a[76:79], v[60:63], v[176:179]
v_mfma_f32_16x16x32_bf16 v[180:183], a[108:111], v[60:63], v[180:183]
ds_write_b128 v2, v[172:175] offset:31744
v_mfma_f32_16x16x32_bf16 v[176:179], a[80:83], v[64:67], v[176:179]
v_mfma_f32_16x16x32_bf16 v[180:183], a[112:115], v[64:67], v[180:183]
v_mfma_f32_16x16x32_bf16 v[176:179], a[84:87], v[68:71], v[176:179]
buffer_load_dwordx4 v[132:135], v5, s[8:11], s45 offen offset:1024 sc1
v_mfma_f32_16x16x32_bf16 v[180:183], a[116:119], v[68:71], v[180:183]
v_mfma_f32_16x16x32_bf16 v[176:179], a[88:91], v[72:75], v[176:179]
v_mfma_f32_16x16x32_bf16 v[180:183], a[120:123], v[72:75], v[180:183]
v_mfma_f32_16x16x32_bf16 v[176:179], a[92:95], v[76:79], v[176:179]
v_mfma_f32_16x16x32_bf16 v[180:183], a[124:127], v[76:79], v[180:183]
buffer_load_dwordx4 v[136:139], v5, s[8:11], s45 offen offset:2048 sc1
v_mfma_f32_16x16x32_bf16 v[184:187], v[48:51], a[128:131], 0
v_mfma_f32_16x16x32_bf16 v[188:191], v[48:51], a[160:163], 0
v_mfma_f32_16x16x32_bf16 v[184:187], v[52:55], a[132:135], v[184:187]
v_mfma_f32_16x16x32_bf16 v[188:191], v[52:55], a[164:167], v[188:191]
v_mfma_f32_16x16x32_bf16 v[184:187], v[56:59], a[136:139], v[184:187]
buffer_load_dwordx4 v[140:143], v5, s[8:11], s45 offen offset:3072 sc1
ds_write_b128 v2, v[176:179] offset:32768
v_mfma_f32_16x16x32_bf16 v[188:191], v[56:59], a[168:171], v[188:191]
s_mov_b32 m0, s68
v_mfma_f32_16x16x32_bf16 v[184:187], v[60:63], a[140:143], v[184:187]
buffer_load_dwordx4 v243, s[12:15], s69 offen lds
v_mfma_f32_16x16x32_bf16 v[188:191], v[60:63], a[172:175], v[188:191]
s_add_u32 s68, s68, s70
s_add_u32 s69, s69, s71
ds_write_b128 v2, v[180:183] offset:33792
v_mfma_f32_16x16x32_bf16 v[184:187], v[64:67], a[144:147], v[184:187]
v_mfma_f32_16x16x32_bf16 v[188:191], v[64:67], a[176:179], v[188:191]
v_mfma_f32_16x16x32_bf16 v[184:187], v[68:71], a[148:151], v[184:187]
v_mfma_f32_16x16x32_bf16 v[188:191], v[68:71], a[180:183], v[188:191]
v_mfma_f32_16x16x32_bf16 v[184:187], v[72:75], a[152:155], v[184:187]
v_mfma_f32_16x16x32_bf16 v[188:191], v[72:75], a[184:187], v[188:191]
v_mfma_f32_16x16x32_bf16 v[184:187], v[76:79], a[156:159], v[184:187]
v_mfma_f32_16x16x32_bf16 v[188:191], v[76:79], a[188:191], v[188:191]
s_nop 6
ds_write_b128 v2, v[184:187] offset:34816
ds_write_b128 v2, v[188:191] offset:35840
s_add_u32 s61, s61, 0x100000
s_waitcnt lgkmcnt(0)
s_barrier
s_add_u32 s54, s54, 0x10000
s_cmp_eq_u32 s52, 58
s_cselect_b32 s45, 0x400000, 0
s_sub_u32 s54, s54, s45
s_add_u32 s45, s54, 0x8000
s_waitcnt vmcnt(10)
v_mfma_f32_16x16x32_bf16 v[144:147], a[0:3], v[80:83], 0
ds_read_b128 v[192:195], v2 offset:4096
v_mfma_f32_16x16x32_bf16 v[148:151], a[32:35], v[80:83], 0
buffer_load_dwordx4 v[16:19], v2, s[8:11], s54 offen offset:0 sc1
ds_read_b128 v[196:199], v2 offset:16384
v_mfma_f32_16x16x32_bf16 v[144:147], a[4:7], v[84:87], v[144:147]
buffer_load_dwordx4 a[224:227], v3, s[24:27], s61 offen offset:0
ds_read_b128 v[200:203], v2 offset:28672
v_mfma_f32_16x16x32_bf16 v[148:151], a[36:39], v[84:87], v[148:151]
ds_read_b128 v[204:207], v2 offset:40960
v_mfma_f32_16x16x32_bf16 v[144:147], a[8:11], v[88:91], v[144:147]
.if \sf == 0
buffer_store_dwordx4 a[192:195], v2, s[8:11], s62 offen offset:0
.else
buffer_store_dwordx4 a[192:195], v2, s[8:11], s62 offen offset:0 sc1
.endif
ds_read_b128 v[208:211], v2 offset:10240
v_mfma_f32_16x16x32_bf16 v[148:151], a[40:43], v[88:91], v[148:151]
ds_read_b128 v[212:215], v2 offset:22528
v_mfma_f32_16x16x32_bf16 v[144:147], a[12:15], v[92:95], v[144:147]
buffer_load_dwordx4 v[20:23], v2, s[8:11], s54 offen offset:1024 sc1
buffer_load_dwordx4 a[228:231], v3, s[24:27], s61 offen offset:16
v_mfma_f32_16x16x32_bf16 v[148:151], a[44:47], v[92:95], v[148:151]
ds_read_b128 v[216:219], v2 offset:34816
v_mfma_f32_16x16x32_bf16 v[144:147], a[16:19], v[96:99], v[144:147]
.if \sf == 0
buffer_store_dwordx4 a[196:199], v2, s[8:11], s62 offen offset:1024
.else
buffer_store_dwordx4 a[196:199], v2, s[8:11], s62 offen offset:1024 sc1
.endif
ds_read_b128 v[220:223], v2 offset:47104
v_mfma_f32_16x16x32_bf16 v[148:151], a[48:51], v[96:99], v[148:151]
v_mfma_f32_16x16x32_bf16 v[144:147], a[20:23], v[100:103], v[144:147]
buffer_load_dwordx4 a[232:235], v3, s[24:27], s61 offen offset:128
v_mfma_f32_16x16x32_bf16 v[148:151], a[52:55], v[100:103], v[148:151]
buffer_load_dwordx4 v[24:27], v2, s[8:11], s54 offen offset:2048 sc1
v_mfma_f32_16x16x32_bf16 v[144:147], a[24:27], v[104:107], v[144:147]
.if \sf == 0
buffer_store_dwordx4 a[200:203], v2, s[8:11], s62 offen offset:2048
.else
buffer_store_dwordx4 a[200:203], v2, s[8:11], s62 offen offset:2048 sc1
.endif
v_mfma_f32_16x16x32_bf16 v[148:151], a[56:59], v[104:107], v[148:151]
v_mfma_f32_16x16x32_bf16 v[144:147], a[28:31], v[108:111], v[144:147]
buffer_load_dwordx4 a[236:239], v3, s[24:27], s61 offen offset:144
s_waitcnt lgkmcnt(0)
v_mfma_f32_16x16x32_bf16 v[148:151], a[60:63], v[108:111], v[148:151]
v_add_f32 v192, v192, v196
v_add_f32 v200, v200, v204
v_mfma_f32_16x16x32_bf16 v[152:155], a[64:67], v[80:83], 0
buffer_load_dwordx4 v[28:31], v2, s[8:11], s54 offen offset:3072 sc1
.if \sf == 0
buffer_store_dwordx4 a[204:207], v2, s[8:11], s62 offen offset:3072
.else
buffer_store_dwordx4 a[204:207], v2, s[8:11], s62 offen offset:3072 sc1
.endif
v_mfma_f32_16x16x32_bf16 v[156:159], a[96:99], v[80:83], 0
v_add_f32 v193, v193, v197
v_add_f32 v201, v201, v205
v_mfma_f32_16x16x32_bf16 v[152:155], a[68:71], v[84:87], v[152:155]
buffer_load_dwordx4 a[240:243], v3, s[24:27], s61 offen offset:256
v_add_f32 v194, v194, v198
v_mfma_f32_16x16x32_bf16 v[156:159], a[100:103], v[84:87], v[156:159]
v_add_f32 v202, v202, v206
v_add_f32 v195, v195, v199
v_mfma_f32_16x16x32_bf16 v[152:155], a[72:75], v[88:91], v[152:155]
.if \sf == 0
buffer_store_dwordx4 a[208:211], v5, s[8:11], s62 offen offset:0
.else
buffer_store_dwordx4 a[208:211], v5, s[8:11], s62 offen offset:0 sc1
.endif
ds_write_b128 v4, v[144:147] offset:24576
v_mfma_f32_16x16x32_bf16 v[156:159], a[104:107], v[88:91], v[156:159]
buffer_load_dwordx4 v[32:35], v5, s[8:11], s54 offen offset:0 sc1
v_add_f32 v203, v203, v207
v_mfma_f32_16x16x32_bf16 v[152:155], a[76:79], v[92:95], v[152:155]
buffer_load_dwordx4 a[244:247], v3, s[24:27], s61 offen offset:272
v_add_f32 v192, v192, v200
v_mfma_f32_16x16x32_bf16 v[156:159], a[108:111], v[92:95], v[156:159]
ds_write_b128 v4, v[148:151] offset:25600
v_add_f32 v193, v193, v201
v_mfma_f32_16x16x32_bf16 v[152:155], a[80:83], v[96:99], v[152:155]
.if \sf == 0
buffer_store_dwordx4 a[212:215], v5, s[8:11], s62 offen offset:1024
.else
buffer_store_dwordx4 a[212:215], v5, s[8:11], s62 offen offset:1024 sc1
.endif
v_add_f32 v194, v194, v202
v_mfma_f32_16x16x32_bf16 v[156:159], a[112:115], v[96:99], v[156:159]
v_add_f32 v195, v195, v203
v_cvt_pk_bf16_f32 v224, v192, v193
v_mfma_f32_16x16x32_bf16 v[152:155], a[84:87], v[100:103], v[152:155]
buffer_load_dwordx4 v[36:39], v5, s[8:11], s54 offen offset:1024 sc1
buffer_load_dwordx4 a[248:251], v3, s[24:27], s61 offen offset:384
v_mfma_f32_16x16x32_bf16 v[156:159], a[116:119], v[100:103], v[156:159]
v_cvt_pk_bf16_f32 v225, v194, v195
v_add_f32 v208, v208, v212
v_mfma_f32_16x16x32_bf16 v[152:155], a[88:91], v[104:107], v[152:155]
.if \sf == 0
buffer_store_dwordx4 a[216:219], v5, s[8:11], s62 offen offset:2048
.else
buffer_store_dwordx4 a[216:219], v5, s[8:11], s62 offen offset:2048 sc1
.endif
v_add_f32 v216, v216, v220
v_mfma_f32_16x16x32_bf16 v[156:159], a[120:123], v[104:107], v[156:159]
v_add_f32 v209, v209, v213
v_add_f32 v217, v217, v221
v_mfma_f32_16x16x32_bf16 v[152:155], a[92:95], v[108:111], v[152:155]
buffer_load_dwordx4 a[252:255], v3, s[24:27], s61 offen offset:400
v_add_f32 v210, v210, v214
v_mfma_f32_16x16x32_bf16 v[156:159], a[124:127], v[108:111], v[156:159]
buffer_load_dwordx4 v[40:43], v5, s[8:11], s54 offen offset:2048 sc1
v_add_f32 v218, v218, v222
v_mfma_f32_16x16x32_bf16 v[160:163], v[80:83], a[128:131], 0
.if \sf == 0
buffer_store_dwordx4 a[220:223], v5, s[8:11], s62 offen offset:3072
.else
buffer_store_dwordx4 a[220:223], v5, s[8:11], s62 offen offset:3072 sc1
.endif
v_add_f32 v211, v211, v215
v_mfma_f32_16x16x32_bf16 v[164:167], v[80:83], a[160:163], 0
v_add_f32 v219, v219, v223
v_add_f32 v208, v208, v216
v_mfma_f32_16x16x32_bf16 v[160:163], v[84:87], a[132:135], v[160:163]
v_add_f32 v209, v209, v217
v_add_f32 v210, v210, v218
v_mfma_f32_16x16x32_bf16 v[164:167], v[84:87], a[164:167], v[164:167]
v_add_f32 v211, v211, v219
v_cvt_pk_bf16_f32 v226, v208, v209
v_mfma_f32_16x16x32_bf16 v[160:163], v[88:91], a[136:139], v[160:163]
buffer_load_dwordx4 v[44:47], v5, s[8:11], s54 offen offset:3072 sc1
ds_write_b128 v4, v[152:155] offset:26624
v_mfma_f32_16x16x32_bf16 v[164:167], v[88:91], a[168:171], v[164:167]
s_mov_b32 m0, s68
v_cvt_pk_bf16_f32 v227, v210, v211
v_mfma_f32_16x16x32_bf16 v[160:163], v[92:95], a[140:143], v[160:163]
buffer_load_dwordx4 v243, s[12:15], s69 offen lds
buffer_store_dwordx4 v[224:227], v2, s[8:11], s57 offen offset:0 sc1
v_mfma_f32_16x16x32_bf16 v[164:167], v[92:95], a[172:175], v[164:167]
s_add_u32 s68, s68, s70
s_add_u32 s69, s69, s71
ds_write_b128 v4, v[156:159] offset:27648
v_mfma_f32_16x16x32_bf16 v[160:163], v[96:99], a[144:147], v[160:163]
v_mfma_f32_16x16x32_bf16 v[164:167], v[96:99], a[176:179], v[164:167]
v_mfma_f32_16x16x32_bf16 v[160:163], v[100:103], a[148:151], v[160:163]
v_mfma_f32_16x16x32_bf16 v[164:167], v[100:103], a[180:183], v[164:167]
v_mfma_f32_16x16x32_bf16 v[160:163], v[104:107], a[152:155], v[160:163]
v_mfma_f32_16x16x32_bf16 v[164:167], v[104:107], a[184:187], v[164:167]
v_mfma_f32_16x16x32_bf16 v[160:163], v[108:111], a[156:159], v[160:163]
v_mfma_f32_16x16x32_bf16 v[164:167], v[108:111], a[188:191], v[164:167]
s_waitcnt vmcnt(27)
v_mfma_f32_16x16x32_bf16 v[168:171], a[0:3], v[112:115], 0
v_mfma_f32_16x16x32_bf16 v[172:175], a[32:35], v[112:115], 0
buffer_load_dwordx4 v[48:51], v2, s[8:11], s45 offen offset:0 sc1
v_mfma_f32_16x16x32_bf16 v[168:171], a[4:7], v[116:119], v[168:171]
v_mfma_f32_16x16x32_bf16 v[172:175], a[36:39], v[116:119], v[172:175]
v_mfma_f32_16x16x32_bf16 v[168:171], a[8:11], v[120:123], v[168:171]
ds_write_b128 v4, v[160:163] offset:28672
v_mfma_f32_16x16x32_bf16 v[172:175], a[40:43], v[120:123], v[172:175]
v_mfma_f32_16x16x32_bf16 v[168:171], a[12:15], v[124:127], v[168:171]
buffer_load_dwordx4 v[52:55], v2, s[8:11], s45 offen offset:1024 sc1
v_mfma_f32_16x16x32_bf16 v[172:175], a[44:47], v[124:127], v[172:175]
ds_write_b128 v4, v[164:167] offset:29696
v_mfma_f32_16x16x32_bf16 v[168:171], a[16:19], v[128:131], v[168:171]
v_mfma_f32_16x16x32_bf16 v[172:175], a[48:51], v[128:131], v[172:175]
v_mfma_f32_16x16x32_bf16 v[168:171], a[20:23], v[132:135], v[168:171]
v_mfma_f32_16x16x32_bf16 v[172:175], a[52:55], v[132:135], v[172:175]
buffer_load_dwordx4 v[56:59], v2, s[8:11], s45 offen offset:2048 sc1
v_mfma_f32_16x16x32_bf16 v[168:171], a[24:27], v[136:139], v[168:171]
v_mfma_f32_16x16x32_bf16 v[172:175], a[56:59], v[136:139], v[172:175]
v_mfma_f32_16x16x32_bf16 v[168:171], a[28:31], v[140:143], v[168:171]
v_mfma_f32_16x16x32_bf16 v[172:175], a[60:63], v[140:143], v[172:175]
v_mfma_f32_16x16x32_bf16 v[176:179], a[64:67], v[112:115], 0
buffer_load_dwordx4 v[60:63], v2, s[8:11], s45 offen offset:3072 sc1
v_mfma_f32_16x16x32_bf16 v[180:183], a[96:99], v[112:115], 0
v_mfma_f32_16x16x32_bf16 v[176:179], a[68:71], v[116:119], v[176:179]
v_mfma_f32_16x16x32_bf16 v[180:183], a[100:103], v[116:119], v[180:183]
v_mfma_f32_16x16x32_bf16 v[176:179], a[72:75], v[120:123], v[176:179]
s_nop 0
ds_write_b128 v4, v[168:171] offset:30720
v_mfma_f32_16x16x32_bf16 v[180:183], a[104:107], v[120:123], v[180:183]
buffer_load_dwordx4 v[64:67], v5, s[8:11], s45 offen offset:0 sc1
v_mfma_f32_16x16x32_bf16 v[176:179], a[76:79], v[124:127], v[176:179]
v_mfma_f32_16x16x32_bf16 v[180:183], a[108:111], v[124:127], v[180:183]
ds_write_b128 v4, v[172:175] offset:31744
v_mfma_f32_16x16x32_bf16 v[176:179], a[80:83], v[128:131], v[176:179]
v_mfma_f32_16x16x32_bf16 v[180:183], a[112:115], v[128:131], v[180:183]
v_mfma_f32_16x16x32_bf16 v[176:179], a[84:87], v[132:135], v[176:179]
buffer_load_dwordx4 v[68:71], v5, s[8:11], s45 offen offset:1024 sc1
v_mfma_f32_16x16x32_bf16 v[180:183], a[116:119], v[132:135], v[180:183]
v_mfma_f32_16x16x32_bf16 v[176:179], a[88:91], v[136:139], v[176:179]
v_mfma_f32_16x16x32_bf16 v[180:183], a[120:123], v[136:139], v[180:183]
v_mfma_f32_16x16x32_bf16 v[176:179], a[92:95], v[140:143], v[176:179]
v_mfma_f32_16x16x32_bf16 v[180:183], a[124:127], v[140:143], v[180:183]
buffer_load_dwordx4 v[72:75], v5, s[8:11], s45 offen offset:2048 sc1
v_mfma_f32_16x16x32_bf16 v[184:187], v[112:115], a[128:131], 0
v_mfma_f32_16x16x32_bf16 v[188:191], v[112:115], a[160:163], 0
v_mfma_f32_16x16x32_bf16 v[184:187], v[116:119], a[132:135], v[184:187]
v_mfma_f32_16x16x32_bf16 v[188:191], v[116:119], a[164:167], v[188:191]
v_mfma_f32_16x16x32_bf16 v[184:187], v[120:123], a[136:139], v[184:187]
buffer_load_dwordx4 v[76:79], v5, s[8:11], s45 offen offset:3072 sc1
ds_write_b128 v4, v[176:179] offset:32768
v_mfma_f32_16x16x32_bf16 v[188:191], v[120:123], a[168:171], v[188:191]
s_mov_b32 m0, s68
v_mfma_f32_16x16x32_bf16 v[184:187], v[124:127], a[140:143], v[184:187]
buffer_load_dwordx4 v243, s[12:15], s69 offen lds
v_mfma_f32_16x16x32_bf16 v[188:191], v[124:127], a[172:175], v[188:191]
s_add_u32 s68, s68, s70
s_add_u32 s69, s69, s71
ds_write_b128 v4, v[180:183] offset:33792
v_mfma_f32_16x16x32_bf16 v[184:187], v[128:131], a[144:147], v[184:187]
v_mfma_f32_16x16x32_bf16 v[188:191], v[128:131], a[176:179], v[188:191]
v_mfma_f32_16x16x32_bf16 v[184:187], v[132:135], a[148:151], v[184:187]
v_mfma_f32_16x16x32_bf16 v[188:191], v[132:135], a[180:183], v[188:191]
v_mfma_f32_16x16x32_bf16 v[184:187], v[136:139], a[152:155], v[184:187]
v_mfma_f32_16x16x32_bf16 v[188:191], v[136:139], a[184:187], v[188:191]
v_mfma_f32_16x16x32_bf16 v[184:187], v[140:143], a[156:159], v[184:187]
v_mfma_f32_16x16x32_bf16 v[188:191], v[140:143], a[188:191], v[188:191]
s_nop 6
ds_write_b128 v4, v[184:187] offset:34816
ds_write_b128 v4, v[188:191] offset:35840
s_add_u32 s55, s55, 0x40000
s_add_u32 s56, s56, 0x40000
s_add_u32 s57, s57, 0x40000
s_add_u32 s61, s61, 0x100000
s_add_u32 s62, s62, 0x100000
s_waitcnt vmcnt(9) lgkmcnt(0)
s_barrier
s_add_u32 s59, s59, 1
s_add_u32 s54, s54, 0x10000
s_add_u32 s45, s54, 0x8000
s_waitcnt vmcnt(11)
v_mfma_f32_16x16x32_bf16 v[144:147], a[0:3], v[16:19], 0
ds_read_b128 v[192:195], v2 offset:51200
v_mfma_f32_16x16x32_bf16 v[148:151], a[32:35], v[16:19], 0
buffer_load_dwordx4 v[80:83], v2, s[8:11], s54 offen offset:0 sc1
ds_read_b128 v[196:199], v2 offset:63488
v_mfma_f32_16x16x32_bf16 v[144:147], a[4:7], v[20:23], v[144:147]
buffer_load_dwordx4 a[192:195], v3, s[24:27], s61 offen offset:0
ds_read_b128 v[200:203], v4 offset:26624
v_mfma_f32_16x16x32_bf16 v[148:151], a[36:39], v[20:23], v[148:151]
ds_read_b128 v[204:207], v4 offset:38912
v_mfma_f32_16x16x32_bf16 v[144:147], a[8:11], v[24:27], v[144:147]
.if \sf == 0
buffer_store_dwordx4 a[224:227], v2, s[8:11], s62 offen offset:0
.else
buffer_store_dwordx4 a[224:227], v2, s[8:11], s62 offen offset:0 sc1
.endif
ds_read_b128 v[208:211], v2 offset:52224
v_mfma_f32_16x16x32_bf16 v[148:151], a[40:43], v[24:27], v[148:151]
ds_read_b128 v[212:215], v2 offset:64512
v_mfma_f32_16x16x32_bf16 v[144:147], a[12:15], v[28:31], v[144:147]
buffer_load_dwordx4 v[84:87], v2, s[8:11], s54 offen offset:1024 sc1
buffer_load_dwordx4 a[196:199], v3, s[24:27], s61 offen offset:16
v_mfma_f32_16x16x32_bf16 v[148:151], a[44:47], v[28:31], v[148:151]
ds_read_b128 v[216:219], v4 offset:27648
v_mfma_f32_16x16x32_bf16 v[144:147], a[16:19], v[32:35], v[144:147]
.if \sf == 0
buffer_store_dwordx4 a[228:231], v2, s[8:11], s62 offen offset:1024
.else
buffer_store_dwordx4 a[228:231], v2, s[8:11], s62 offen offset:1024 sc1
.endif
ds_read_b128 v[220:223], v4 offset:39936
v_mfma_f32_16x16x32_bf16 v[148:151], a[48:51], v[32:35], v[148:151]
v_mfma_f32_16x16x32_bf16 v[144:147], a[20:23], v[36:39], v[144:147]
buffer_load_dwordx4 a[200:203], v3, s[24:27], s61 offen offset:128
v_mfma_f32_16x16x32_bf16 v[148:151], a[52:55], v[36:39], v[148:151]
buffer_load_dwordx4 v[88:91], v2, s[8:11], s54 offen offset:2048 sc1
v_mfma_f32_16x16x32_bf16 v[144:147], a[24:27], v[40:43], v[144:147]
.if \sf == 0
buffer_store_dwordx4 a[232:235], v2, s[8:11], s62 offen offset:2048
.else
buffer_store_dwordx4 a[232:235], v2, s[8:11], s62 offen offset:2048 sc1
.endif
v_mfma_f32_16x16x32_bf16 v[148:151], a[56:59], v[40:43], v[148:151]
v_mfma_f32_16x16x32_bf16 v[144:147], a[28:31], v[44:47], v[144:147]
buffer_load_dwordx4 a[204:207], v3, s[24:27], s61 offen offset:144
s_waitcnt lgkmcnt(0)
v_mfma_f32_16x16x32_bf16 v[148:151], a[60:63], v[44:47], v[148:151]
v_add_f32 v192, v192, v196
v_add_f32 v200, v200, v204
v_mfma_f32_16x16x32_bf16 v[152:155], a[64:67], v[16:19], 0
buffer_load_dwordx4 v[92:95], v2, s[8:11], s54 offen offset:3072 sc1
.if \sf == 0
buffer_store_dwordx4 a[236:239], v2, s[8:11], s62 offen offset:3072
.else
buffer_store_dwordx4 a[236:239], v2, s[8:11], s62 offen offset:3072 sc1
.endif
v_mfma_f32_16x16x32_bf16 v[156:159], a[96:99], v[16:19], 0
v_add_f32 v193, v193, v197
v_add_f32 v201, v201, v205
v_mfma_f32_16x16x32_bf16 v[152:155], a[68:71], v[20:23], v[152:155]
buffer_load_dwordx4 a[208:211], v3, s[24:27], s61 offen offset:256
v_add_f32 v194, v194, v198
v_mfma_f32_16x16x32_bf16 v[156:159], a[100:103], v[20:23], v[156:159]
v_add_f32 v202, v202, v206
v_add_f32 v195, v195, v199
v_mfma_f32_16x16x32_bf16 v[152:155], a[72:75], v[24:27], v[152:155]
.if \sf == 0
buffer_store_dwordx4 a[240:243], v5, s[8:11], s62 offen offset:0
.else
buffer_store_dwordx4 a[240:243], v5, s[8:11], s62 offen offset:0 sc1
.endif
ds_write_b128 v2, v[144:147] offset:24576
v_mfma_f32_16x16x32_bf16 v[156:159], a[104:107], v[24:27], v[156:159]
buffer_load_dwordx4 v[96:99], v5, s[8:11], s54 offen offset:0 sc1
v_add_f32 v203, v203, v207
v_mfma_f32_16x16x32_bf16 v[152:155], a[76:79], v[28:31], v[152:155]
buffer_load_dwordx4 a[212:215], v3, s[24:27], s61 offen offset:272
v_add_f32 v192, v192, v200
v_mfma_f32_16x16x32_bf16 v[156:159], a[108:111], v[28:31], v[156:159]
ds_write_b128 v2, v[148:151] offset:25600
v_add_f32 v193, v193, v201
v_mfma_f32_16x16x32_bf16 v[152:155], a[80:83], v[32:35], v[152:155]
.if \sf == 0
buffer_store_dwordx4 a[244:247], v5, s[8:11], s62 offen offset:1024
.else
buffer_store_dwordx4 a[244:247], v5, s[8:11], s62 offen offset:1024 sc1
.endif
v_add_f32 v194, v194, v202
v_mfma_f32_16x16x32_bf16 v[156:159], a[112:115], v[32:35], v[156:159]
v_add_f32 v195, v195, v203
v_cvt_pk_bf16_f32 v224, v192, v193
v_mfma_f32_16x16x32_bf16 v[152:155], a[84:87], v[36:39], v[152:155]
buffer_load_dwordx4 v[100:103], v5, s[8:11], s54 offen offset:1024 sc1
buffer_load_dwordx4 a[216:219], v3, s[24:27], s61 offen offset:384
v_mfma_f32_16x16x32_bf16 v[156:159], a[116:119], v[36:39], v[156:159]
v_cvt_pk_bf16_f32 v225, v194, v195
v_add_f32 v208, v208, v212
v_mfma_f32_16x16x32_bf16 v[152:155], a[88:91], v[40:43], v[152:155]
.if \sf == 0
buffer_store_dwordx4 a[248:251], v5, s[8:11], s62 offen offset:2048
.else
buffer_store_dwordx4 a[248:251], v5, s[8:11], s62 offen offset:2048 sc1
.endif
v_add_f32 v216, v216, v220
v_mfma_f32_16x16x32_bf16 v[156:159], a[120:123], v[40:43], v[156:159]
v_add_f32 v209, v209, v213
v_add_f32 v217, v217, v221
v_mfma_f32_16x16x32_bf16 v[152:155], a[92:95], v[44:47], v[152:155]
buffer_load_dwordx4 a[220:223], v3, s[24:27], s61 offen offset:400
v_add_f32 v210, v210, v214
v_mfma_f32_16x16x32_bf16 v[156:159], a[124:127], v[44:47], v[156:159]
buffer_load_dwordx4 v[104:107], v5, s[8:11], s54 offen offset:2048 sc1
v_add_f32 v218, v218, v222
v_mfma_f32_16x16x32_bf16 v[160:163], v[16:19], a[128:131], 0
.if \sf == 0
buffer_store_dwordx4 a[252:255], v5, s[8:11], s62 offen offset:3072
.else
buffer_store_dwordx4 a[252:255], v5, s[8:11], s62 offen offset:3072 sc1
.endif
v_add_f32 v211, v211, v215
v_mfma_f32_16x16x32_bf16 v[164:167], v[16:19], a[160:163], 0
v_add_f32 v219, v219, v223
v_add_f32 v208, v208, v216
v_mfma_f32_16x16x32_bf16 v[160:163], v[20:23], a[132:135], v[160:163]
v_add_f32 v209, v209, v217
v_add_f32 v210, v210, v218
v_mfma_f32_16x16x32_bf16 v[164:167], v[20:23], a[164:167], v[164:167]
v_add_f32 v211, v211, v219
v_cvt_pk_bf16_f32 v226, v208, v209
v_mfma_f32_16x16x32_bf16 v[160:163], v[24:27], a[136:139], v[160:163]
buffer_load_dwordx4 v[108:111], v5, s[8:11], s54 offen offset:3072 sc1
ds_write_b128 v2, v[152:155] offset:26624
v_mfma_f32_16x16x32_bf16 v[164:167], v[24:27], a[168:171], v[164:167]
s_mov_b32 m0, s68
v_cvt_pk_bf16_f32 v227, v210, v211
v_mfma_f32_16x16x32_bf16 v[160:163], v[28:31], a[140:143], v[160:163]
buffer_load_dwordx4 v243, s[12:15], s69 offen lds
buffer_store_dwordx4 v[224:227], v2, s[8:11], s56 offen sc1
v_mfma_f32_16x16x32_bf16 v[164:167], v[28:31], a[172:175], v[164:167]
s_add_u32 s68, s68, s70
s_add_u32 s69, s69, s71
ds_write_b128 v2, v[156:159] offset:27648
v_mfma_f32_16x16x32_bf16 v[160:163], v[32:35], a[144:147], v[160:163]
ds_read_b128 v[192:195], v2 offset:57344
v_mfma_f32_16x16x32_bf16 v[164:167], v[32:35], a[176:179], v[164:167]
ds_read_b128 v[196:199], v4 offset:20480
v_mfma_f32_16x16x32_bf16 v[160:163], v[36:39], a[148:151], v[160:163]
ds_read_b128 v[200:203], v4 offset:32768
v_mfma_f32_16x16x32_bf16 v[164:167], v[36:39], a[180:183], v[164:167]
ds_read_b128 v[204:207], v4 offset:45056
v_mfma_f32_16x16x32_bf16 v[160:163], v[40:43], a[152:155], v[160:163]
ds_read_b128 v[208:211], v2 offset:58368
v_mfma_f32_16x16x32_bf16 v[164:167], v[40:43], a[184:187], v[164:167]
ds_read_b128 v[212:215], v4 offset:21504
v_mfma_f32_16x16x32_bf16 v[160:163], v[44:47], a[156:159], v[160:163]
ds_read_b128 v[216:219], v4 offset:33792
v_mfma_f32_16x16x32_bf16 v[164:167], v[44:47], a[188:191], v[164:167]
ds_read_b128 v[220:223], v4 offset:46080
s_waitcnt vmcnt(27)
v_mfma_f32_16x16x32_bf16 v[168:171], a[0:3], v[48:51], 0
v_mfma_f32_16x16x32_bf16 v[172:175], a[32:35], v[48:51], 0
buffer_load_dwordx4 v[112:115], v2, s[8:11], s45 offen offset:0 sc1
v_mfma_f32_16x16x32_bf16 v[168:171], a[4:7], v[52:55], v[168:171]
v_mfma_f32_16x16x32_bf16 v[172:175], a[36:39], v[52:55], v[172:175]
v_mfma_f32_16x16x32_bf16 v[168:171], a[8:11], v[56:59], v[168:171]
ds_write_b128 v2, v[160:163] offset:28672
v_mfma_f32_16x16x32_bf16 v[172:175], a[40:43], v[56:59], v[172:175]
s_waitcnt lgkmcnt(0)
v_add_f32 v192, v192, v196
v_mfma_f32_16x16x32_bf16 v[168:171], a[12:15], v[60:63], v[168:171]
buffer_load_dwordx4 v[116:119], v2, s[8:11], s45 offen offset:1024 sc1
v_add_f32 v200, v200, v204
v_mfma_f32_16x16x32_bf16 v[172:175], a[44:47], v[60:63], v[172:175]
ds_write_b128 v2, v[164:167] offset:29696
v_add_f32 v193, v193, v197
v_mfma_f32_16x16x32_bf16 v[168:171], a[16:19], v[64:67], v[168:171]
v_add_f32 v201, v201, v205
v_add_f32 v194, v194, v198
v_mfma_f32_16x16x32_bf16 v[172:175], a[48:51], v[64:67], v[172:175]
v_add_f32 v202, v202, v206
v_add_f32 v195, v195, v199
v_mfma_f32_16x16x32_bf16 v[168:171], a[20:23], v[68:71], v[168:171]
v_add_f32 v203, v203, v207
v_add_f32 v192, v192, v200
v_mfma_f32_16x16x32_bf16 v[172:175], a[52:55], v[68:71], v[172:175]
buffer_load_dwordx4 v[120:123], v2, s[8:11], s45 offen offset:2048 sc1
v_add_f32 v193, v193, v201
v_mfma_f32_16x16x32_bf16 v[168:171], a[24:27], v[72:75], v[168:171]
v_add_f32 v194, v194, v202
v_add_f32 v195, v195, v203
v_mfma_f32_16x16x32_bf16 v[172:175], a[56:59], v[72:75], v[172:175]
v_cvt_pk_bf16_f32 v228, v192, v193
v_cvt_pk_bf16_f32 v229, v194, v195
v_mfma_f32_16x16x32_bf16 v[168:171], a[28:31], v[76:79], v[168:171]
v_add_f32 v208, v208, v212
v_add_f32 v216, v216, v220
v_mfma_f32_16x16x32_bf16 v[172:175], a[60:63], v[76:79], v[172:175]
v_add_f32 v209, v209, v213
v_add_f32 v217, v217, v221
v_mfma_f32_16x16x32_bf16 v[176:179], a[64:67], v[48:51], 0
buffer_load_dwordx4 v[124:127], v2, s[8:11], s45 offen offset:3072 sc1
v_add_f32 v210, v210, v214
v_mfma_f32_16x16x32_bf16 v[180:183], a[96:99], v[48:51], 0
v_add_f32 v218, v218, v222
v_add_f32 v211, v211, v215
v_mfma_f32_16x16x32_bf16 v[176:179], a[68:71], v[52:55], v[176:179]
v_add_f32 v219, v219, v223
v_add_f32 v208, v208, v216
v_mfma_f32_16x16x32_bf16 v[180:183], a[100:103], v[52:55], v[180:183]
v_add_f32 v209, v209, v217
v_add_f32 v210, v210, v218
v_mfma_f32_16x16x32_bf16 v[176:179], a[72:75], v[56:59], v[176:179]
ds_write_b128 v2, v[168:171] offset:30720
v_add_f32 v211, v211, v219
v_mfma_f32_16x16x32_bf16 v[180:183], a[104:107], v[56:59], v[180:183]
buffer_load_dwordx4 v[128:131], v5, s[8:11], s45 offen offset:0 sc1
v_cvt_pk_bf16_f32 v230, v208, v209
v_mfma_f32_16x16x32_bf16 v[176:179], a[76:79], v[60:63], v[176:179]
v_cvt_pk_bf16_f32 v231, v210, v211
buffer_store_dwordx4 v[228:231], v5, s[8:11], s56 offen sc1
v_mfma_f32_16x16x32_bf16 v[180:183], a[108:111], v[60:63], v[180:183]
ds_write_b128 v2, v[172:175] offset:31744
v_mfma_f32_16x16x32_bf16 v[176:179], a[80:83], v[64:67], v[176:179]
v_mfma_f32_16x16x32_bf16 v[180:183], a[112:115], v[64:67], v[180:183]
v_mfma_f32_16x16x32_bf16 v[176:179], a[84:87], v[68:71], v[176:179]
buffer_load_dwordx4 v[132:135], v5, s[8:11], s45 offen offset:1024 sc1
v_mfma_f32_16x16x32_bf16 v[180:183], a[116:119], v[68:71], v[180:183]
v_mfma_f32_16x16x32_bf16 v[176:179], a[88:91], v[72:75], v[176:179]
v_mfma_f32_16x16x32_bf16 v[180:183], a[120:123], v[72:75], v[180:183]
v_mfma_f32_16x16x32_bf16 v[176:179], a[92:95], v[76:79], v[176:179]
v_mfma_f32_16x16x32_bf16 v[180:183], a[124:127], v[76:79], v[180:183]
buffer_load_dwordx4 v[136:139], v5, s[8:11], s45 offen offset:2048 sc1
v_mfma_f32_16x16x32_bf16 v[184:187], v[48:51], a[128:131], 0
v_mfma_f32_16x16x32_bf16 v[188:191], v[48:51], a[160:163], 0
v_mfma_f32_16x16x32_bf16 v[184:187], v[52:55], a[132:135], v[184:187]
v_mfma_f32_16x16x32_bf16 v[188:191], v[52:55], a[164:167], v[188:191]
v_mfma_f32_16x16x32_bf16 v[184:187], v[56:59], a[136:139], v[184:187]
buffer_load_dwordx4 v[140:143], v5, s[8:11], s45 offen offset:3072 sc1
ds_write_b128 v2, v[176:179] offset:32768
v_mfma_f32_16x16x32_bf16 v[188:191], v[56:59], a[168:171], v[188:191]
s_mov_b32 m0, s68
v_mfma_f32_16x16x32_bf16 v[184:187], v[60:63], a[140:143], v[184:187]
buffer_load_dwordx4 v243, s[12:15], s69 offen lds
v_mfma_f32_16x16x32_bf16 v[188:191], v[60:63], a[172:175], v[188:191]
s_add_u32 s68, s68, s70
s_add_u32 s69, s69, s71
ds_write_b128 v2, v[180:183] offset:33792
v_mfma_f32_16x16x32_bf16 v[184:187], v[64:67], a[144:147], v[184:187]
v_mfma_f32_16x16x32_bf16 v[188:191], v[64:67], a[176:179], v[188:191]
v_mfma_f32_16x16x32_bf16 v[184:187], v[68:71], a[148:151], v[184:187]
v_mfma_f32_16x16x32_bf16 v[188:191], v[68:71], a[180:183], v[188:191]
v_mfma_f32_16x16x32_bf16 v[184:187], v[72:75], a[152:155], v[184:187]
v_mfma_f32_16x16x32_bf16 v[188:191], v[72:75], a[184:187], v[188:191]
v_mfma_f32_16x16x32_bf16 v[184:187], v[76:79], a[156:159], v[184:187]
v_mfma_f32_16x16x32_bf16 v[188:191], v[76:79], a[188:191], v[188:191]
s_nop 6
ds_write_b128 v2, v[184:187] offset:34816
ds_write_b128 v2, v[188:191] offset:35840
s_add_u32 s55, s55, 0x40000
s_add_u32 s56, s56, 0x40000
s_add_u32 s57, s57, 0x40000
s_cmp_eq_u32 s52, 60
s_cselect_b32 s45, 0x1000000, 0
s_sub_u32 s55, s55, s45
s_sub_u32 s56, s56, s45
s_sub_u32 s57, s57, s45
s_add_u32 s61, s61, 0x100000
s_add_u32 s62, s62, 0x100000
s_waitcnt vmcnt(4) lgkmcnt(0)
s_barrier
s_add_u32 s59, s59, 1
s_add_u32 s54, s54, 0x10000
s_cmp_eq_u32 s52, 58
s_cselect_b32 s45, 0x400000, 0
s_sub_u32 s54, s54, s45
s_add_u32 s45, s54, 0x8000
s_waitcnt vmcnt(12)
v_mfma_f32_16x16x32_bf16 v[144:147], a[0:3], v[80:83], 0
ds_read_b128 v[192:195], v2 offset:4096
v_mfma_f32_16x16x32_bf16 v[148:151], a[32:35], v[80:83], 0
buffer_load_dwordx4 v[16:19], v2, s[8:11], s54 offen offset:0 sc1
ds_read_b128 v[196:199], v2 offset:16384
v_mfma_f32_16x16x32_bf16 v[144:147], a[4:7], v[84:87], v[144:147]
ds_read_b128 v[200:203], v2 offset:28672
v_mfma_f32_16x16x32_bf16 v[148:151], a[36:39], v[84:87], v[148:151]
ds_read_b128 v[204:207], v2 offset:40960
v_mfma_f32_16x16x32_bf16 v[144:147], a[8:11], v[88:91], v[144:147]
.if \sf == 0
buffer_store_dwordx4 a[192:195], v2, s[8:11], s62 offen offset:0
.else
buffer_store_dwordx4 a[192:195], v2, s[8:11], s62 offen offset:0 sc1
.endif
ds_read_b128 v[208:211], v2 offset:10240
v_mfma_f32_16x16x32_bf16 v[148:151], a[40:43], v[88:91], v[148:151]
ds_read_b128 v[212:215], v2 offset:22528
v_mfma_f32_16x16x32_bf16 v[144:147], a[12:15], v[92:95], v[144:147]
buffer_load_dwordx4 v[20:23], v2, s[8:11], s54 offen offset:1024 sc1
ds_read_b128 v[216:219], v2 offset:34816
v_mfma_f32_16x16x32_bf16 v[148:151], a[44:47], v[92:95], v[148:151]
ds_read_b128 v[220:223], v2 offset:47104
v_mfma_f32_16x16x32_bf16 v[144:147], a[16:19], v[96:99], v[144:147]
.if \sf == 0
buffer_store_dwordx4 a[196:199], v2, s[8:11], s62 offen offset:1024
.else
buffer_store_dwordx4 a[196:199], v2, s[8:11], s62 offen offset:1024 sc1
.endif
v_mfma_f32_16x16x32_bf16 v[148:151], a[48:51], v[96:99], v[148:151]
v_mfma_f32_16x16x32_bf16 v[144:147], a[20:23], v[100:103], v[144:147]
v_mfma_f32_16x16x32_bf16 v[148:151], a[52:55], v[100:103], v[148:151]
buffer_load_dwordx4 v[24:27], v2, s[8:11], s54 offen offset:2048 sc1
v_mfma_f32_16x16x32_bf16 v[144:147], a[24:27], v[104:107], v[144:147]
.if \sf == 0
buffer_store_dwordx4 a[200:203], v2, s[8:11], s62 offen offset:2048
.else
buffer_store_dwordx4 a[200:203], v2, s[8:11], s62 offen offset:2048 sc1
.endif
v_mfma_f32_16x16x32_bf16 v[148:151], a[56:59], v[104:107], v[148:151]
s_waitcnt lgkmcnt(0)
v_add_f32 v192, v192, v196
v_mfma_f32_16x16x32_bf16 v[144:147], a[28:31], v[108:111], v[144:147]
v_add_f32 v200, v200, v204
v_add_f32 v193, v193, v197
v_mfma_f32_16x16x32_bf16 v[148:151], a[60:63], v[108:111], v[148:151]
v_add_f32 v201, v201, v205
v_add_f32 v194, v194, v198
v_mfma_f32_16x16x32_bf16 v[152:155], a[64:67], v[80:83], 0
buffer_load_dwordx4 v[28:31], v2, s[8:11], s54 offen offset:3072 sc1
.if \sf == 0
buffer_store_dwordx4 a[204:207], v2, s[8:11], s62 offen offset:3072
.else
buffer_store_dwordx4 a[204:207], v2, s[8:11], s62 offen offset:3072 sc1
.endif
v_mfma_f32_16x16x32_bf16 v[156:159], a[96:99], v[80:83], 0
v_add_f32 v202, v202, v206
v_add_f32 v195, v195, v199
v_mfma_f32_16x16x32_bf16 v[152:155], a[68:71], v[84:87], v[152:155]
v_add_f32 v203, v203, v207
v_add_f32 v192, v192, v200
v_mfma_f32_16x16x32_bf16 v[156:159], a[100:103], v[84:87], v[156:159]
v_add_f32 v193, v193, v201
v_add_f32 v194, v194, v202
v_mfma_f32_16x16x32_bf16 v[152:155], a[72:75], v[88:91], v[152:155]
.if \sf == 0
buffer_store_dwordx4 a[208:211], v5, s[8:11], s62 offen offset:0
.else
buffer_store_dwordx4 a[208:211], v5, s[8:11], s62 offen offset:0 sc1
.endif
ds_write_b128 v4, v[144:147] offset:24576
v_mfma_f32_16x16x32_bf16 v[156:159], a[104:107], v[88:91], v[156:159]
buffer_load_dwordx4 v[32:35], v5, s[8:11], s54 offen offset:0 sc1
v_add_f32 v195, v195, v203
v_mfma_f32_16x16x32_bf16 v[152:155], a[76:79], v[92:95], v[152:155]
v_cvt_pk_bf16_f32 v224, v192, v193
v_cvt_pk_bf16_f32 v225, v194, v195
v_mfma_f32_16x16x32_bf16 v[156:159], a[108:111], v[92:95], v[156:159]
ds_write_b128 v4, v[148:151] offset:25600
v_add_f32 v208, v208, v212
v_mfma_f32_16x16x32_bf16 v[152:155], a[80:83], v[96:99], v[152:155]
.if \sf == 0
buffer_store_dwordx4 a[212:215], v5, s[8:11], s62 offen offset:1024
.else
buffer_store_dwordx4 a[212:215], v5, s[8:11], s62 offen offset:1024 sc1
.endif
v_add_f32 v216, v216, v220
v_mfma_f32_16x16x32_bf16 v[156:159], a[112:115], v[96:99], v[156:159]
v_add_f32 v209, v209, v213
v_add_f32 v217, v217, v221
v_mfma_f32_16x16x32_bf16 v[152:155], a[84:87], v[100:103], v[152:155]
buffer_load_dwordx4 v[36:39], v5, s[8:11], s54 offen offset:1024 sc1
v_add_f32 v210, v210, v214
v_mfma_f32_16x16x32_bf16 v[156:159], a[116:119], v[100:103], v[156:159]
v_add_f32 v218, v218, v222
v_add_f32 v211, v211, v215
v_mfma_f32_16x16x32_bf16 v[152:155], a[88:91], v[104:107], v[152:155]
.if \sf == 0
buffer_store_dwordx4 a[216:219], v5, s[8:11], s62 offen offset:2048
.else
buffer_store_dwordx4 a[216:219], v5, s[8:11], s62 offen offset:2048 sc1
.endif
v_add_f32 v219, v219, v223
v_mfma_f32_16x16x32_bf16 v[156:159], a[120:123], v[104:107], v[156:159]
v_add_f32 v208, v208, v216
v_add_f32 v209, v209, v217
v_mfma_f32_16x16x32_bf16 v[152:155], a[92:95], v[108:111], v[152:155]
v_add_f32 v210, v210, v218
v_add_f32 v211, v211, v219
v_mfma_f32_16x16x32_bf16 v[156:159], a[124:127], v[108:111], v[156:159]
buffer_load_dwordx4 v[40:43], v5, s[8:11], s54 offen offset:2048 sc1
v_cvt_pk_bf16_f32 v226, v208, v209
v_mfma_f32_16x16x32_bf16 v[160:163], v[80:83], a[128:131], 0
.if \sf == 0
buffer_store_dwordx4 a[220:223], v5, s[8:11], s62 offen offset:3072
.else
buffer_store_dwordx4 a[220:223], v5, s[8:11], s62 offen offset:3072 sc1
.endif
v_cvt_pk_bf16_f32 v227, v210, v211
v_mfma_f32_16x16x32_bf16 v[164:167], v[80:83], a[160:163], 0
buffer_store_dwordx4 v[224:227], v2, s[8:11], s57 offen offset:0 sc1
v_mfma_f32_16x16x32_bf16 v[160:163], v[84:87], a[132:135], v[160:163]
v_mfma_f32_16x16x32_bf16 v[164:167], v[84:87], a[164:167], v[164:167]
v_mfma_f32_16x16x32_bf16 v[160:163], v[88:91], a[136:139], v[160:163]
buffer_load_dwordx4 v[44:47], v5, s[8:11], s54 offen offset:3072 sc1
ds_write_b128 v4, v[152:155] offset:26624
v_mfma_f32_16x16x32_bf16 v[164:167], v[88:91], a[168:171], v[164:167]
s_mov_b32 m0, s68
v_mfma_f32_16x16x32_bf16 v[160:163], v[92:95], a[140:143], v[160:163]
buffer_load_dwordx4 v243, s[12:15], s69 offen lds
v_mfma_f32_16x16x32_bf16 v[164:167], v[92:95], a[172:175], v[164:167]
s_add_u32 s68, s68, s70
s_add_u32 s69, s69, s71
ds_write_b128 v4, v[156:159] offset:27648
v_mfma_f32_16x16x32_bf16 v[160:163], v[96:99], a[144:147], v[160:163]
v_mfma_f32_16x16x32_bf16 v[164:167], v[96:99], a[176:179], v[164:167]
v_mfma_f32_16x16x32_bf16 v[160:163], v[100:103], a[148:151], v[160:163]
v_mfma_f32_16x16x32_bf16 v[164:167], v[100:103], a[180:183], v[164:167]
v_mfma_f32_16x16x32_bf16 v[160:163], v[104:107], a[152:155], v[160:163]
v_mfma_f32_16x16x32_bf16 v[164:167], v[104:107], a[184:187], v[164:167]
v_mfma_f32_16x16x32_bf16 v[160:163], v[108:111], a[156:159], v[160:163]
v_mfma_f32_16x16x32_bf16 v[164:167], v[108:111], a[188:191], v[164:167]
s_waitcnt vmcnt(19)
v_mfma_f32_16x16x32_bf16 v[168:171], a[0:3], v[112:115], 0
v_mfma_f32_16x16x32_bf16 v[172:175], a[32:35], v[112:115], 0
buffer_load_dwordx4 v[48:51], v2, s[8:11], s45 offen offset:0 sc1
v_mfma_f32_16x16x32_bf16 v[168:171], a[4:7], v[116:119], v[168:171]
v_mfma_f32_16x16x32_bf16 v[172:175], a[36:39], v[116:119], v[172:175]
v_mfma_f32_16x16x32_bf16 v[168:171], a[8:11], v[120:123], v[168:171]
ds_write_b128 v4, v[160:163] offset:28672
v_mfma_f32_16x16x32_bf16 v[172:175], a[40:43], v[120:123], v[172:175]
v_mfma_f32_16x16x32_bf16 v[168:171], a[12:15], v[124:127], v[168:171]
buffer_load_dwordx4 v[52:55], v2, s[8:11], s45 offen offset:1024 sc1
v_mfma_f32_16x16x32_bf16 v[172:175], a[44:47], v[124:127], v[172:175]
ds_write_b128 v4, v[164:167] offset:29696
v_mfma_f32_16x16x32_bf16 v[168:171], a[16:19], v[128:131], v[168:171]
v_mfma_f32_16x16x32_bf16 v[172:175], a[48:51], v[128:131], v[172:175]
v_mfma_f32_16x16x32_bf16 v[168:171], a[20:23], v[132:135], v[168:171]
v_mfma_f32_16x16x32_bf16 v[172:175], a[52:55], v[132:135], v[172:175]
buffer_load_dwordx4 v[56:59], v2, s[8:11], s45 offen offset:2048 sc1
v_mfma_f32_16x16x32_bf16 v[168:171], a[24:27], v[136:139], v[168:171]
v_mfma_f32_16x16x32_bf16 v[172:175], a[56:59], v[136:139], v[172:175]
v_mfma_f32_16x16x32_bf16 v[168:171], a[28:31], v[140:143], v[168:171]
v_mfma_f32_16x16x32_bf16 v[172:175], a[60:63], v[140:143], v[172:175]
v_mfma_f32_16x16x32_bf16 v[176:179], a[64:67], v[112:115], 0
buffer_load_dwordx4 v[60:63], v2, s[8:11], s45 offen offset:3072 sc1
v_mfma_f32_16x16x32_bf16 v[180:183], a[96:99], v[112:115], 0
v_mfma_f32_16x16x32_bf16 v[176:179], a[68:71], v[116:119], v[176:179]
v_mfma_f32_16x16x32_bf16 v[180:183], a[100:103], v[116:119], v[180:183]
v_mfma_f32_16x16x32_bf16 v[176:179], a[72:75], v[120:123], v[176:179]
s_nop 0
ds_write_b128 v4, v[168:171] offset:30720
v_mfma_f32_16x16x32_bf16 v[180:183], a[104:107], v[120:123], v[180:183]
buffer_load_dwordx4 v[64:67], v5, s[8:11], s45 offen offset:0 sc1
v_mfma_f32_16x16x32_bf16 v[176:179], a[76:79], v[124:127], v[176:179]
v_mfma_f32_16x16x32_bf16 v[180:183], a[108:111], v[124:127], v[180:183]
ds_write_b128 v4, v[172:175] offset:31744
v_mfma_f32_16x16x32_bf16 v[176:179], a[80:83], v[128:131], v[176:179]
v_mfma_f32_16x16x32_bf16 v[180:183], a[112:115], v[128:131], v[180:183]
v_mfma_f32_16x16x32_bf16 v[176:179], a[84:87], v[132:135], v[176:179]
buffer_load_dwordx4 v[68:71], v5, s[8:11], s45 offen offset:1024 sc1
v_mfma_f32_16x16x32_bf16 v[180:183], a[116:119], v[132:135], v[180:183]
v_mfma_f32_16x16x32_bf16 v[176:179], a[88:91], v[136:139], v[176:179]
v_mfma_f32_16x16x32_bf16 v[180:183], a[120:123], v[136:139], v[180:183]
v_mfma_f32_16x16x32_bf16 v[176:179], a[92:95], v[140:143], v[176:179]
v_mfma_f32_16x16x32_bf16 v[180:183], a[124:127], v[140:143], v[180:183]
buffer_load_dwordx4 v[72:75], v5, s[8:11], s45 offen offset:2048 sc1
v_mfma_f32_16x16x32_bf16 v[184:187], v[112:115], a[128:131], 0
v_mfma_f32_16x16x32_bf16 v[188:191], v[112:115], a[160:163], 0
v_mfma_f32_16x16x32_bf16 v[184:187], v[116:119], a[132:135], v[184:187]
v_mfma_f32_16x16x32_bf16 v[188:191], v[116:119], a[164:167], v[188:191]
v_mfma_f32_16x16x32_bf16 v[184:187], v[120:123], a[136:139], v[184:187]
buffer_load_dwordx4 v[76:79], v5, s[8:11], s45 offen offset:3072 sc1
ds_write_b128 v4, v[176:179] offset:32768
v_mfma_f32_16x16x32_bf16 v[188:191], v[120:123], a[168:171], v[188:191]
s_mov_b32 m0, s68
v_mfma_f32_16x16x32_bf16 v[184:187], v[124:127], a[140:143], v[184:187]
buffer_load_dwordx4 v243, s[12:15], s69 offen lds
v_mfma_f32_16x16x32_bf16 v[188:191], v[124:127], a[172:175], v[188:191]
s_add_u32 s68, s68, s70
s_add_u32 s69, s69, s71
ds_write_b128 v4, v[180:183] offset:33792
v_mfma_f32_16x16x32_bf16 v[184:187], v[128:131], a[144:147], v[184:187]
v_mfma_f32_16x16x32_bf16 v[188:191], v[128:131], a[176:179], v[188:191]
v_mfma_f32_16x16x32_bf16 v[184:187], v[132:135], a[148:151], v[184:187]
v_mfma_f32_16x16x32_bf16 v[188:191], v[132:135], a[180:183], v[188:191]
v_mfma_f32_16x16x32_bf16 v[184:187], v[136:139], a[152:155], v[184:187]
v_mfma_f32_16x16x32_bf16 v[188:191], v[136:139], a[184:187], v[188:191]
v_mfma_f32_16x16x32_bf16 v[184:187], v[140:143], a[156:159], v[184:187]
v_mfma_f32_16x16x32_bf16 v[188:191], v[140:143], a[188:191], v[188:191]
s_nop 6
ds_write_b128 v4, v[184:187] offset:34816
ds_write_b128 v4, v[188:191] offset:35840
s_add_u32 s55, s55, 0x40000
s_add_u32 s56, s56, 0x40000
s_add_u32 s57, s57, 0x40000
s_add_u32 s62, s62, 0x100000
s_waitcnt vmcnt(11) lgkmcnt(0)
s_barrier
s_add_u32 s59, s59, 1
s_add_u32 s54, s54, 0x10000
s_add_u32 s45, s54, 0x8000
s_waitcnt vmcnt(10)
v_mfma_f32_16x16x32_bf16 v[144:147], a[0:3], v[16:19], 0
ds_read_b128 v[192:195], v2 offset:51200
v_mfma_f32_16x16x32_bf16 v[148:151], a[32:35], v[16:19], 0
buffer_load_dwordx4 v[80:83], v2, s[8:11], s54 offen offset:0 sc1
v_mfma_f32_16x16x32_bf16 v[144:147], a[4:7], v[20:23], v[144:147]
ds_read_b128 v[196:199], v2 offset:63488
v_mfma_f32_16x16x32_bf16 v[148:151], a[36:39], v[20:23], v[148:151]
ds_read_b128 v[200:203], v4 offset:26624
v_mfma_f32_16x16x32_bf16 v[144:147], a[8:11], v[24:27], v[144:147]
ds_read_b128 v[204:207], v4 offset:38912
v_mfma_f32_16x16x32_bf16 v[148:151], a[40:43], v[24:27], v[148:151]
ds_read_b128 v[208:211], v2 offset:52224
v_mfma_f32_16x16x32_bf16 v[144:147], a[12:15], v[28:31], v[144:147]
buffer_load_dwordx4 v[84:87], v2, s[8:11], s54 offen offset:1024 sc1
v_mfma_f32_16x16x32_bf16 v[148:151], a[44:47], v[28:31], v[148:151]
ds_read_b128 v[212:215], v2 offset:64512
v_mfma_f32_16x16x32_bf16 v[144:147], a[16:19], v[32:35], v[144:147]
ds_read_b128 v[216:219], v4 offset:27648
v_mfma_f32_16x16x32_bf16 v[148:151], a[48:51], v[32:35], v[148:151]
ds_read_b128 v[220:223], v4 offset:39936
v_mfma_f32_16x16x32_bf16 v[144:147], a[20:23], v[36:39], v[144:147]
v_mfma_f32_16x16x32_bf16 v[148:151], a[52:55], v[36:39], v[148:151]
buffer_load_dwordx4 v[88:91], v2, s[8:11], s54 offen offset:2048 sc1
v_mfma_f32_16x16x32_bf16 v[144:147], a[24:27], v[40:43], v[144:147]
v_mfma_f32_16x16x32_bf16 v[148:151], a[56:59], v[40:43], v[148:151]
v_mfma_f32_16x16x32_bf16 v[144:147], a[28:31], v[44:47], v[144:147]
v_mfma_f32_16x16x32_bf16 v[148:151], a[60:63], v[44:47], v[148:151]
s_waitcnt lgkmcnt(0)
v_add_f32 v192, v192, v196
v_mfma_f32_16x16x32_bf16 v[152:155], a[64:67], v[16:19], 0
buffer_load_dwordx4 v[92:95], v2, s[8:11], s54 offen offset:3072 sc1
v_add_f32 v200, v200, v204
v_mfma_f32_16x16x32_bf16 v[156:159], a[96:99], v[16:19], 0
v_add_f32 v193, v193, v197
v_add_f32 v201, v201, v205
v_mfma_f32_16x16x32_bf16 v[152:155], a[68:71], v[20:23], v[152:155]
v_add_f32 v194, v194, v198
v_add_f32 v202, v202, v206
v_mfma_f32_16x16x32_bf16 v[156:159], a[100:103], v[20:23], v[156:159]
v_add_f32 v195, v195, v199
v_add_f32 v203, v203, v207
v_mfma_f32_16x16x32_bf16 v[152:155], a[72:75], v[24:27], v[152:155]
ds_write_b128 v2, v[144:147] offset:24576
v_add_f32 v192, v192, v200
v_mfma_f32_16x16x32_bf16 v[156:159], a[104:107], v[24:27], v[156:159]
buffer_load_dwordx4 v[96:99], v5, s[8:11], s54 offen offset:0 sc1
v_add_f32 v193, v193, v201
v_mfma_f32_16x16x32_bf16 v[152:155], a[76:79], v[28:31], v[152:155]
v_add_f32 v194, v194, v202
v_add_f32 v195, v195, v203
v_mfma_f32_16x16x32_bf16 v[156:159], a[108:111], v[28:31], v[156:159]
ds_write_b128 v2, v[148:151] offset:25600
v_cvt_pk_bf16_f32 v224, v192, v193
v_mfma_f32_16x16x32_bf16 v[152:155], a[80:83], v[32:35], v[152:155]
v_cvt_pk_bf16_f32 v225, v194, v195
v_add_f32 v208, v208, v212
v_mfma_f32_16x16x32_bf16 v[156:159], a[112:115], v[32:35], v[156:159]
v_add_f32 v216, v216, v220
v_add_f32 v209, v209, v213
v_mfma_f32_16x16x32_bf16 v[152:155], a[84:87], v[36:39], v[152:155]
buffer_load_dwordx4 v[100:103], v5, s[8:11], s54 offen offset:1024 sc1
v_add_f32 v217, v217, v221
v_mfma_f32_16x16x32_bf16 v[156:159], a[116:119], v[36:39], v[156:159]
v_add_f32 v210, v210, v214
v_add_f32 v218, v218, v222
v_mfma_f32_16x16x32_bf16 v[152:155], a[88:91], v[40:43], v[152:155]
v_add_f32 v211, v211, v215
v_add_f32 v219, v219, v223
v_mfma_f32_16x16x32_bf16 v[156:159], a[120:123], v[40:43], v[156:159]
v_add_f32 v208, v208, v216
v_add_f32 v209, v209, v217
v_mfma_f32_16x16x32_bf16 v[152:155], a[92:95], v[44:47], v[152:155]
v_add_f32 v210, v210, v218
v_add_f32 v211, v211, v219
v_mfma_f32_16x16x32_bf16 v[156:159], a[124:127], v[44:47], v[156:159]
buffer_load_dwordx4 v[104:107], v5, s[8:11], s54 offen offset:2048 sc1
v_cvt_pk_bf16_f32 v226, v208, v209
v_mfma_f32_16x16x32_bf16 v[160:163], v[16:19], a[128:131], 0
v_cvt_pk_bf16_f32 v227, v210, v211
buffer_store_dwordx4 v[224:227], v2, s[8:11], s56 offen sc1
v_mfma_f32_16x16x32_bf16 v[164:167], v[16:19], a[160:163], 0
ds_read_b128 v[192:195], v2 offset:57344
v_mfma_f32_16x16x32_bf16 v[160:163], v[20:23], a[132:135], v[160:163]
ds_read_b128 v[196:199], v4 offset:20480
v_mfma_f32_16x16x32_bf16 v[164:167], v[20:23], a[164:167], v[164:167]
ds_read_b128 v[200:203], v4 offset:32768
v_mfma_f32_16x16x32_bf16 v[160:163], v[24:27], a[136:139], v[160:163]
buffer_load_dwordx4 v[108:111], v5, s[8:11], s54 offen offset:3072 sc1
ds_write_b128 v2, v[152:155] offset:26624
v_mfma_f32_16x16x32_bf16 v[164:167], v[24:27], a[168:171], v[164:167]
s_mov_b32 m0, s68
v_mfma_f32_16x16x32_bf16 v[160:163], v[28:31], a[140:143], v[160:163]
buffer_load_dwordx4 v243, s[12:15], s69 offen lds
v_mfma_f32_16x16x32_bf16 v[164:167], v[28:31], a[172:175], v[164:167]
s_add_u32 s68, s68, s70
s_add_u32 s69, s69, s71
ds_write_b128 v2, v[156:159] offset:27648
v_mfma_f32_16x16x32_bf16 v[160:163], v[32:35], a[144:147], v[160:163]
ds_read_b128 v[204:207], v4 offset:45056
v_mfma_f32_16x16x32_bf16 v[164:167], v[32:35], a[176:179], v[164:167]
ds_read_b128 v[208:211], v2 offset:58368
v_mfma_f32_16x16x32_bf16 v[160:163], v[36:39], a[148:151], v[160:163]
ds_read_b128 v[212:215], v4 offset:21504
v_mfma_f32_16x16x32_bf16 v[164:167], v[36:39], a[180:183], v[164:167]
ds_read_b128 v[216:219], v4 offset:33792
v_mfma_f32_16x16x32_bf16 v[160:163], v[40:43], a[152:155], v[160:163]
ds_read_b128 v[220:223], v4 offset:46080
v_mfma_f32_16x16x32_bf16 v[164:167], v[40:43], a[184:187], v[164:167]
v_mfma_f32_16x16x32_bf16 v[160:163], v[44:47], a[156:159], v[160:163]
v_mfma_f32_16x16x32_bf16 v[164:167], v[44:47], a[188:191], v[164:167]
s_waitcnt vmcnt(11)
v_mfma_f32_16x16x32_bf16 v[168:171], a[0:3], v[48:51], 0
v_mfma_f32_16x16x32_bf16 v[172:175], a[32:35], v[48:51], 0
buffer_load_dwordx4 v[112:115], v2, s[8:11], s45 offen offset:0 sc1
v_mfma_f32_16x16x32_bf16 v[168:171], a[4:7], v[52:55], v[168:171]
s_waitcnt lgkmcnt(0)
v_add_f32 v192, v192, v196
v_mfma_f32_16x16x32_bf16 v[172:175], a[36:39], v[52:55], v[172:175]
v_add_f32 v200, v200, v204
v_add_f32 v193, v193, v197
v_mfma_f32_16x16x32_bf16 v[168:171], a[8:11], v[56:59], v[168:171]
ds_write_b128 v2, v[160:163] offset:28672
v_add_f32 v201, v201, v205
v_mfma_f32_16x16x32_bf16 v[172:175], a[40:43], v[56:59], v[172:175]
v_add_f32 v194, v194, v198
v_add_f32 v202, v202, v206
v_mfma_f32_16x16x32_bf16 v[168:171], a[12:15], v[60:63], v[168:171]
buffer_load_dwordx4 v[116:119], v2, s[8:11], s45 offen offset:1024 sc1
v_add_f32 v195, v195, v199
v_mfma_f32_16x16x32_bf16 v[172:175], a[44:47], v[60:63], v[172:175]
ds_write_b128 v2, v[164:167] offset:29696
v_add_f32 v203, v203, v207
v_mfma_f32_16x16x32_bf16 v[168:171], a[16:19], v[64:67], v[168:171]
v_add_f32 v192, v192, v200
v_add_f32 v193, v193, v201
v_mfma_f32_16x16x32_bf16 v[172:175], a[48:51], v[64:67], v[172:175]
v_add_f32 v194, v194, v202
v_add_f32 v195, v195, v203
v_mfma_f32_16x16x32_bf16 v[168:171], a[20:23], v[68:71], v[168:171]
v_cvt_pk_bf16_f32 v228, v192, v193
v_cvt_pk_bf16_f32 v229, v194, v195
v_mfma_f32_16x16x32_bf16 v[172:175], a[52:55], v[68:71], v[172:175]
buffer_load_dwordx4 v[120:123], v2, s[8:11], s45 offen offset:2048 sc1
v_add_f32 v208, v208, v212
v_mfma_f32_16x16x32_bf16 v[168:171], a[24:27], v[72:75], v[168:171]
v_add_f32 v216, v216, v220
v_add_f32 v209, v209, v213
v_mfma_f32_16x16x32_bf16 v[172:175], a[56:59], v[72:75], v[172:175]
v_add_f32 v217, v217, v221
v_add_f32 v210, v210, v214
v_mfma_f32_16x16x32_bf16 v[168:171], a[28:31], v[76:79], v[168:171]
v_add_f32 v218, v218, v222
v_add_f32 v211, v211, v215
v_mfma_f32_16x16x32_bf16 v[172:175], a[60:63], v[76:79], v[172:175]
v_add_f32 v219, v219, v223
v_add_f32 v208, v208, v216
v_mfma_f32_16x16x32_bf16 v[176:179], a[64:67], v[48:51], 0
buffer_load_dwordx4 v[124:127], v2, s[8:11], s45 offen offset:3072 sc1
v_add_f32 v209, v209, v217
v_mfma_f32_16x16x32_bf16 v[180:183], a[96:99], v[48:51], 0
v_add_f32 v210, v210, v218
v_add_f32 v211, v211, v219
v_mfma_f32_16x16x32_bf16 v[176:179], a[68:71], v[52:55], v[176:179]
v_cvt_pk_bf16_f32 v230, v208, v209
v_cvt_pk_bf16_f32 v231, v210, v211
v_mfma_f32_16x16x32_bf16 v[180:183], a[100:103], v[52:55], v[180:183]
buffer_store_dwordx4 v[228:231], v5, s[8:11], s56 offen sc1
v_mfma_f32_16x16x32_bf16 v[176:179], a[72:75], v[56:59], v[176:179]
ds_write_b128 v2, v[168:171] offset:30720
v_mfma_f32_16x16x32_bf16 v[180:183], a[104:107], v[56:59], v[180:183]
buffer_load_dwordx4 v[128:131], v5, s[8:11], s45 offen offset:0 sc1
v_mfma_f32_16x16x32_bf16 v[176:179], a[76:79], v[60:63], v[176:179]
v_mfma_f32_16x16x32_bf16 v[180:183], a[108:111], v[60:63], v[180:183]
ds_write_b128 v2, v[172:175] offset:31744
v_mfma_f32_16x16x32_bf16 v[176:179], a[80:83], v[64:67], v[176:179]
v_mfma_f32_16x16x32_bf16 v[180:183], a[112:115], v[64:67], v[180:183]
v_mfma_f32_16x16x32_bf16 v[176:179], a[84:87], v[68:71], v[176:179]
buffer_load_dwordx4 v[132:135], v5, s[8:11], s45 offen offset:1024 sc1
v_mfma_f32_16x16x32_bf16 v[180:183], a[116:119], v[68:71], v[180:183]
v_mfma_f32_16x16x32_bf16 v[176:179], a[88:91], v[72:75], v[176:179]
v_mfma_f32_16x16x32_bf16 v[180:183], a[120:123], v[72:75], v[180:183]
v_mfma_f32_16x16x32_bf16 v[176:179], a[92:95], v[76:79], v[176:179]
v_mfma_f32_16x16x32_bf16 v[180:183], a[124:127], v[76:79], v[180:183]
buffer_load_dwordx4 v[136:139], v5, s[8:11], s45 offen offset:2048 sc1
v_mfma_f32_16x16x32_bf16 v[184:187], v[48:51], a[128:131], 0
v_mfma_f32_16x16x32_bf16 v[188:191], v[48:51], a[160:163], 0
v_mfma_f32_16x16x32_bf16 v[184:187], v[52:55], a[132:135], v[184:187]
v_mfma_f32_16x16x32_bf16 v[188:191], v[52:55], a[164:167], v[188:191]
v_mfma_f32_16x16x32_bf16 v[184:187], v[56:59], a[136:139], v[184:187]
buffer_load_dwordx4 v[140:143], v5, s[8:11], s45 offen offset:3072 sc1
ds_write_b128 v2, v[176:179] offset:32768
v_mfma_f32_16x16x32_bf16 v[188:191], v[56:59], a[168:171], v[188:191]
s_mov_b32 m0, s68
v_mfma_f32_16x16x32_bf16 v[184:187], v[60:63], a[140:143], v[184:187]
buffer_load_dwordx4 v243, s[12:15], s69 offen lds
v_mfma_f32_16x16x32_bf16 v[188:191], v[60:63], a[172:175], v[188:191]
s_add_u32 s68, s68, s70
s_add_u32 s69, s69, s71
ds_write_b128 v2, v[180:183] offset:33792
v_mfma_f32_16x16x32_bf16 v[184:187], v[64:67], a[144:147], v[184:187]
v_mfma_f32_16x16x32_bf16 v[188:191], v[64:67], a[176:179], v[188:191]
v_mfma_f32_16x16x32_bf16 v[184:187], v[68:71], a[148:151], v[184:187]
v_mfma_f32_16x16x32_bf16 v[188:191], v[68:71], a[180:183], v[188:191]
v_mfma_f32_16x16x32_bf16 v[184:187], v[72:75], a[152:155], v[184:187]
v_mfma_f32_16x16x32_bf16 v[188:191], v[72:75], a[184:187], v[188:191]
v_mfma_f32_16x16x32_bf16 v[184:187], v[76:79], a[156:159], v[184:187]
v_mfma_f32_16x16x32_bf16 v[188:191], v[76:79], a[188:191], v[188:191]
s_nop 6
ds_write_b128 v2, v[184:187] offset:34816
ds_write_b128 v2, v[188:191] offset:35840
s_add_u32 s55, s55, 0x40000
s_add_u32 s56, s56, 0x40000
s_add_u32 s57, s57, 0x40000
s_cmp_eq_u32 s52, 60
s_cselect_b32 s45, 0x1000000, 0
s_sub_u32 s55, s55, s45
s_sub_u32 s56, s56, s45
s_sub_u32 s57, s57, s45
s_waitcnt vmcnt(20) lgkmcnt(0)
s_barrier
s_add_u32 s59, s59, 1
s_add_u32 s52, s52, 4
fg1_loop_w2_\sf:
s_and_b32 s45, s52, 3
s_cmp_lg_u32 s45, 0
s_cbranch_scc1 nocv_125_\sf
s_mov_b32 s90, 2
s_branch g1_side_\sf
g1_back_w2_\sf:
nocv_125_\sf:
s_add_u32 s54, s54, 0x10000
s_cmp_eq_u32 s52, 58
s_cselect_b32 s45, 0x400000, 0
s_sub_u32 s54, s54, s45
s_add_u32 s45, s54, 0x8000
s_waitcnt vmcnt(11)
v_mfma_f32_16x16x32_bf16 v[144:147], a[0:3], v[80:83], 0
ds_read_b128 v[192:195], v2 offset:4096
v_mfma_f32_16x16x32_bf16 v[148:151], a[32:35], v[80:83], 0
buffer_load_dwordx4 v[16:19], v2, s[8:11], s54 offen offset:0 sc1
v_mfma_f32_16x16x32_bf16 v[144:147], a[4:7], v[84:87], v[144:147]
ds_read_b128 v[196:199], v2 offset:16384
v_mfma_f32_16x16x32_bf16 v[148:151], a[36:39], v[84:87], v[148:151]
ds_read_b128 v[200:203], v2 offset:28672
v_mfma_f32_16x16x32_bf16 v[144:147], a[8:11], v[88:91], v[144:147]
ds_read_b128 v[204:207], v2 offset:40960
v_mfma_f32_16x16x32_bf16 v[148:151], a[40:43], v[88:91], v[148:151]
ds_read_b128 v[208:211], v2 offset:10240
v_mfma_f32_16x16x32_bf16 v[144:147], a[12:15], v[92:95], v[144:147]
buffer_load_dwordx4 v[20:23], v2, s[8:11], s54 offen offset:1024 sc1
v_mfma_f32_16x16x32_bf16 v[148:151], a[44:47], v[92:95], v[148:151]
ds_read_b128 v[212:215], v2 offset:22528
v_mfma_f32_16x16x32_bf16 v[144:147], a[16:19], v[96:99], v[144:147]
ds_read_b128 v[216:219], v2 offset:34816
v_mfma_f32_16x16x32_bf16 v[148:151], a[48:51], v[96:99], v[148:151]
ds_read_b128 v[220:223], v2 offset:47104
v_mfma_f32_16x16x32_bf16 v[144:147], a[20:23], v[100:103], v[144:147]
v_mfma_f32_16x16x32_bf16 v[148:151], a[52:55], v[100:103], v[148:151]
buffer_load_dwordx4 v[24:27], v2, s[8:11], s54 offen offset:2048 sc1
v_mfma_f32_16x16x32_bf16 v[144:147], a[24:27], v[104:107], v[144:147]
v_mfma_f32_16x16x32_bf16 v[148:151], a[56:59], v[104:107], v[148:151]
v_mfma_f32_16x16x32_bf16 v[144:147], a[28:31], v[108:111], v[144:147]
v_mfma_f32_16x16x32_bf16 v[148:151], a[60:63], v[108:111], v[148:151]
s_waitcnt lgkmcnt(0)
v_add_f32 v192, v192, v196
v_mfma_f32_16x16x32_bf16 v[152:155], a[64:67], v[80:83], 0
buffer_load_dwordx4 v[28:31], v2, s[8:11], s54 offen offset:3072 sc1
v_add_f32 v200, v200, v204
v_mfma_f32_16x16x32_bf16 v[156:159], a[96:99], v[80:83], 0
v_add_f32 v193, v193, v197
v_add_f32 v201, v201, v205
v_mfma_f32_16x16x32_bf16 v[152:155], a[68:71], v[84:87], v[152:155]
v_add_f32 v194, v194, v198
v_add_f32 v202, v202, v206
v_mfma_f32_16x16x32_bf16 v[156:159], a[100:103], v[84:87], v[156:159]
v_add_f32 v195, v195, v199
v_add_f32 v203, v203, v207
v_mfma_f32_16x16x32_bf16 v[152:155], a[72:75], v[88:91], v[152:155]
ds_write_b128 v4, v[144:147] offset:24576
v_add_f32 v192, v192, v200
v_mfma_f32_16x16x32_bf16 v[156:159], a[104:107], v[88:91], v[156:159]
buffer_load_dwordx4 v[32:35], v5, s[8:11], s54 offen offset:0 sc1
v_add_f32 v193, v193, v201
v_mfma_f32_16x16x32_bf16 v[152:155], a[76:79], v[92:95], v[152:155]
v_add_f32 v194, v194, v202
v_add_f32 v195, v195, v203
v_mfma_f32_16x16x32_bf16 v[156:159], a[108:111], v[92:95], v[156:159]
ds_write_b128 v4, v[148:151] offset:25600
v_cvt_pk_bf16_f32 v224, v192, v193
v_mfma_f32_16x16x32_bf16 v[152:155], a[80:83], v[96:99], v[152:155]
v_cvt_pk_bf16_f32 v225, v194, v195
v_add_f32 v208, v208, v212
v_mfma_f32_16x16x32_bf16 v[156:159], a[112:115], v[96:99], v[156:159]
v_add_f32 v216, v216, v220
v_add_f32 v209, v209, v213
v_mfma_f32_16x16x32_bf16 v[152:155], a[84:87], v[100:103], v[152:155]
buffer_load_dwordx4 v[36:39], v5, s[8:11], s54 offen offset:1024 sc1
v_add_f32 v217, v217, v221
v_mfma_f32_16x16x32_bf16 v[156:159], a[116:119], v[100:103], v[156:159]
v_add_f32 v210, v210, v214
v_add_f32 v218, v218, v222
v_mfma_f32_16x16x32_bf16 v[152:155], a[88:91], v[104:107], v[152:155]
v_add_f32 v211, v211, v215
v_add_f32 v219, v219, v223
v_mfma_f32_16x16x32_bf16 v[156:159], a[120:123], v[104:107], v[156:159]
v_add_f32 v208, v208, v216
v_add_f32 v209, v209, v217
v_mfma_f32_16x16x32_bf16 v[152:155], a[92:95], v[108:111], v[152:155]
v_add_f32 v210, v210, v218
v_add_f32 v211, v211, v219
v_mfma_f32_16x16x32_bf16 v[156:159], a[124:127], v[108:111], v[156:159]
buffer_load_dwordx4 v[40:43], v5, s[8:11], s54 offen offset:2048 sc1
v_cvt_pk_bf16_f32 v226, v208, v209
v_mfma_f32_16x16x32_bf16 v[160:163], v[80:83], a[128:131], 0
v_cvt_pk_bf16_f32 v227, v210, v211
buffer_store_dwordx4 v[224:227], v2, s[8:11], s57 offen offset:0 sc1
v_mfma_f32_16x16x32_bf16 v[164:167], v[80:83], a[160:163], 0
v_mfma_f32_16x16x32_bf16 v[160:163], v[84:87], a[132:135], v[160:163]
v_mfma_f32_16x16x32_bf16 v[164:167], v[84:87], a[164:167], v[164:167]
v_mfma_f32_16x16x32_bf16 v[160:163], v[88:91], a[136:139], v[160:163]
buffer_load_dwordx4 v[44:47], v5, s[8:11], s54 offen offset:3072 sc1
ds_write_b128 v4, v[152:155] offset:26624
v_mfma_f32_16x16x32_bf16 v[164:167], v[88:91], a[168:171], v[164:167]
s_mov_b32 m0, s68
v_mfma_f32_16x16x32_bf16 v[160:163], v[92:95], a[140:143], v[160:163]
buffer_load_dwordx4 v243, s[12:15], s69 offen lds
v_mfma_f32_16x16x32_bf16 v[164:167], v[92:95], a[172:175], v[164:167]
s_add_u32 s68, s68, s70
s_add_u32 s69, s69, s71
ds_write_b128 v4, v[156:159] offset:27648
v_mfma_f32_16x16x32_bf16 v[160:163], v[96:99], a[144:147], v[160:163]
v_mfma_f32_16x16x32_bf16 v[164:167], v[96:99], a[176:179], v[164:167]
v_mfma_f32_16x16x32_bf16 v[160:163], v[100:103], a[148:151], v[160:163]
v_mfma_f32_16x16x32_bf16 v[164:167], v[100:103], a[180:183], v[164:167]
v_mfma_f32_16x16x32_bf16 v[160:163], v[104:107], a[152:155], v[160:163]
v_mfma_f32_16x16x32_bf16 v[164:167], v[104:107], a[184:187], v[164:167]
v_mfma_f32_16x16x32_bf16 v[160:163], v[108:111], a[156:159], v[160:163]
v_mfma_f32_16x16x32_bf16 v[164:167], v[108:111], a[188:191], v[164:167]
s_waitcnt vmcnt(11)
v_mfma_f32_16x16x32_bf16 v[168:171], a[0:3], v[112:115], 0
v_mfma_f32_16x16x32_bf16 v[172:175], a[32:35], v[112:115], 0
buffer_load_dwordx4 v[48:51], v2, s[8:11], s45 offen offset:0 sc1
v_mfma_f32_16x16x32_bf16 v[168:171], a[4:7], v[116:119], v[168:171]
v_mfma_f32_16x16x32_bf16 v[172:175], a[36:39], v[116:119], v[172:175]
v_mfma_f32_16x16x32_bf16 v[168:171], a[8:11], v[120:123], v[168:171]
ds_write_b128 v4, v[160:163] offset:28672
v_mfma_f32_16x16x32_bf16 v[172:175], a[40:43], v[120:123], v[172:175]
v_mfma_f32_16x16x32_bf16 v[168:171], a[12:15], v[124:127], v[168:171]
buffer_load_dwordx4 v[52:55], v2, s[8:11], s45 offen offset:1024 sc1
v_mfma_f32_16x16x32_bf16 v[172:175], a[44:47], v[124:127], v[172:175]
ds_write_b128 v4, v[164:167] offset:29696
v_mfma_f32_16x16x32_bf16 v[168:171], a[16:19], v[128:131], v[168:171]
v_mfma_f32_16x16x32_bf16 v[172:175], a[48:51], v[128:131], v[172:175]
v_mfma_f32_16x16x32_bf16 v[168:171], a[20:23], v[132:135], v[168:171]
v_mfma_f32_16x16x32_bf16 v[172:175], a[52:55], v[132:135], v[172:175]
buffer_load_dwordx4 v[56:59], v2, s[8:11], s45 offen offset:2048 sc1
v_mfma_f32_16x16x32_bf16 v[168:171], a[24:27], v[136:139], v[168:171]
v_mfma_f32_16x16x32_bf16 v[172:175], a[56:59], v[136:139], v[172:175]
v_mfma_f32_16x16x32_bf16 v[168:171], a[28:31], v[140:143], v[168:171]
v_mfma_f32_16x16x32_bf16 v[172:175], a[60:63], v[140:143], v[172:175]
v_mfma_f32_16x16x32_bf16 v[176:179], a[64:67], v[112:115], 0
buffer_load_dwordx4 v[60:63], v2, s[8:11], s45 offen offset:3072 sc1
v_mfma_f32_16x16x32_bf16 v[180:183], a[96:99], v[112:115], 0
v_mfma_f32_16x16x32_bf16 v[176:179], a[68:71], v[116:119], v[176:179]
v_mfma_f32_16x16x32_bf16 v[180:183], a[100:103], v[116:119], v[180:183]
v_mfma_f32_16x16x32_bf16 v[176:179], a[72:75], v[120:123], v[176:179]
s_nop 0
ds_write_b128 v4, v[168:171] offset:30720
v_mfma_f32_16x16x32_bf16 v[180:183], a[104:107], v[120:123], v[180:183]
buffer_load_dwordx4 v[64:67], v5, s[8:11], s45 offen offset:0 sc1
v_mfma_f32_16x16x32_bf16 v[176:179], a[76:79], v[124:127], v[176:179]
v_mfma_f32_16x16x32_bf16 v[180:183], a[108:111], v[124:127], v[180:183]
ds_write_b128 v4, v[172:175] offset:31744
v_mfma_f32_16x16x32_bf16 v[176:179], a[80:83], v[128:131], v[176:179]
v_mfma_f32_16x16x32_bf16 v[180:183], a[112:115], v[128:131], v[180:183]
v_mfma_f32_16x16x32_bf16 v[176:179], a[84:87], v[132:135], v[176:179]
buffer_load_dwordx4 v[68:71], v5, s[8:11], s45 offen offset:1024 sc1
v_mfma_f32_16x16x32_bf16 v[180:183], a[116:119], v[132:135], v[180:183]
v_mfma_f32_16x16x32_bf16 v[176:179], a[88:91], v[136:139], v[176:179]
v_mfma_f32_16x16x32_bf16 v[180:183], a[120:123], v[136:139], v[180:183]
v_mfma_f32_16x16x32_bf16 v[176:179], a[92:95], v[140:143], v[176:179]
v_mfma_f32_16x16x32_bf16 v[180:183], a[124:127], v[140:143], v[180:183]
buffer_load_dwordx4 v[72:75], v5, s[8:11], s45 offen offset:2048 sc1
v_mfma_f32_16x16x32_bf16 v[184:187], v[112:115], a[128:131], 0
v_mfma_f32_16x16x32_bf16 v[188:191], v[112:115], a[160:163], 0
v_mfma_f32_16x16x32_bf16 v[184:187], v[116:119], a[132:135], v[184:187]
v_mfma_f32_16x16x32_bf16 v[188:191], v[116:119], a[164:167], v[188:191]
v_mfma_f32_16x16x32_bf16 v[184:187], v[120:123], a[136:139], v[184:187]
buffer_load_dwordx4 v[76:79], v5, s[8:11], s45 offen offset:3072 sc1
ds_write_b128 v4, v[176:179] offset:32768
v_mfma_f32_16x16x32_bf16 v[188:191], v[120:123], a[168:171], v[188:191]
s_mov_b32 m0, s68
v_mfma_f32_16x16x32_bf16 v[184:187], v[124:127], a[140:143], v[184:187]
buffer_load_dwordx4 v243, s[12:15], s69 offen lds
v_mfma_f32_16x16x32_bf16 v[188:191], v[124:127], a[172:175], v[188:191]
s_add_u32 s68, s68, s70
s_add_u32 s69, s69, s71
ds_write_b128 v4, v[180:183] offset:33792
v_mfma_f32_16x16x32_bf16 v[184:187], v[128:131], a[144:147], v[184:187]
v_mfma_f32_16x16x32_bf16 v[188:191], v[128:131], a[176:179], v[188:191]
v_mfma_f32_16x16x32_bf16 v[184:187], v[132:135], a[148:151], v[184:187]
v_mfma_f32_16x16x32_bf16 v[188:191], v[132:135], a[180:183], v[188:191]
v_mfma_f32_16x16x32_bf16 v[184:187], v[136:139], a[152:155], v[184:187]
v_mfma_f32_16x16x32_bf16 v[188:191], v[136:139], a[184:187], v[188:191]
v_mfma_f32_16x16x32_bf16 v[184:187], v[140:143], a[156:159], v[184:187]
v_mfma_f32_16x16x32_bf16 v[188:191], v[140:143], a[188:191], v[188:191]
s_nop 6
ds_write_b128 v4, v[184:187] offset:34816
ds_write_b128 v4, v[188:191] offset:35840
s_add_u32 s55, s55, 0x40000
s_add_u32 s56, s56, 0x40000
s_add_u32 s57, s57, 0x40000
s_waitcnt vmcnt(19) lgkmcnt(0)
s_barrier
s_add_u32 s59, s59, 1
s_add_u32 s52, s52, 2
s_cmp_ge_u32 s52, s53
s_cbranch_scc1 fg1_done_w2_\sf
s_add_u32 s54, s54, 0x10000
s_add_u32 s45, s54, 0x8000
s_waitcnt vmcnt(10)
v_mfma_f32_16x16x32_bf16 v[144:147], a[0:3], v[16:19], 0
ds_read_b128 v[192:195], v2 offset:51200
v_mfma_f32_16x16x32_bf16 v[148:151], a[32:35], v[16:19], 0
buffer_load_dwordx4 v[80:83], v2, s[8:11], s54 offen offset:0 sc1
v_mfma_f32_16x16x32_bf16 v[144:147], a[4:7], v[20:23], v[144:147]
ds_read_b128 v[196:199], v2 offset:63488
v_mfma_f32_16x16x32_bf16 v[148:151], a[36:39], v[20:23], v[148:151]
ds_read_b128 v[200:203], v4 offset:26624
v_mfma_f32_16x16x32_bf16 v[144:147], a[8:11], v[24:27], v[144:147]
ds_read_b128 v[204:207], v4 offset:38912
v_mfma_f32_16x16x32_bf16 v[148:151], a[40:43], v[24:27], v[148:151]
ds_read_b128 v[208:211], v2 offset:52224
v_mfma_f32_16x16x32_bf16 v[144:147], a[12:15], v[28:31], v[144:147]
buffer_load_dwordx4 v[84:87], v2, s[8:11], s54 offen offset:1024 sc1
v_mfma_f32_16x16x32_bf16 v[148:151], a[44:47], v[28:31], v[148:151]
ds_read_b128 v[212:215], v2 offset:64512
v_mfma_f32_16x16x32_bf16 v[144:147], a[16:19], v[32:35], v[144:147]
ds_read_b128 v[216:219], v4 offset:27648
v_mfma_f32_16x16x32_bf16 v[148:151], a[48:51], v[32:35], v[148:151]
ds_read_b128 v[220:223], v4 offset:39936
v_mfma_f32_16x16x32_bf16 v[144:147], a[20:23], v[36:39], v[144:147]
v_mfma_f32_16x16x32_bf16 v[148:151], a[52:55], v[36:39], v[148:151]
buffer_load_dwordx4 v[88:91], v2, s[8:11], s54 offen offset:2048 sc1
v_mfma_f32_16x16x32_bf16 v[144:147], a[24:27], v[40:43], v[144:147]
v_mfma_f32_16x16x32_bf16 v[148:151], a[56:59], v[40:43], v[148:151]
v_mfma_f32_16x16x32_bf16 v[144:147], a[28:31], v[44:47], v[144:147]
v_mfma_f32_16x16x32_bf16 v[148:151], a[60:63], v[44:47], v[148:151]
s_waitcnt lgkmcnt(0)
v_add_f32 v192, v192, v196
v_mfma_f32_16x16x32_bf16 v[152:155], a[64:67], v[16:19], 0
buffer_load_dwordx4 v[92:95], v2, s[8:11], s54 offen offset:3072 sc1
v_add_f32 v200, v200, v204
v_mfma_f32_16x16x32_bf16 v[156:159], a[96:99], v[16:19], 0
v_add_f32 v193, v193, v197
v_add_f32 v201, v201, v205
v_mfma_f32_16x16x32_bf16 v[152:155], a[68:71], v[20:23], v[152:155]
v_add_f32 v194, v194, v198
v_add_f32 v202, v202, v206
v_mfma_f32_16x16x32_bf16 v[156:159], a[100:103], v[20:23], v[156:159]
v_add_f32 v195, v195, v199
v_add_f32 v203, v203, v207
v_mfma_f32_16x16x32_bf16 v[152:155], a[72:75], v[24:27], v[152:155]
ds_write_b128 v2, v[144:147] offset:24576
v_add_f32 v192, v192, v200
v_mfma_f32_16x16x32_bf16 v[156:159], a[104:107], v[24:27], v[156:159]
buffer_load_dwordx4 v[96:99], v5, s[8:11], s54 offen offset:0 sc1
v_add_f32 v193, v193, v201
v_mfma_f32_16x16x32_bf16 v[152:155], a[76:79], v[28:31], v[152:155]
v_add_f32 v194, v194, v202
v_add_f32 v195, v195, v203
v_mfma_f32_16x16x32_bf16 v[156:159], a[108:111], v[28:31], v[156:159]
ds_write_b128 v2, v[148:151] offset:25600
v_cvt_pk_bf16_f32 v224, v192, v193
v_mfma_f32_16x16x32_bf16 v[152:155], a[80:83], v[32:35], v[152:155]
v_cvt_pk_bf16_f32 v225, v194, v195
v_add_f32 v208, v208, v212
v_mfma_f32_16x16x32_bf16 v[156:159], a[112:115], v[32:35], v[156:159]
v_add_f32 v216, v216, v220
v_add_f32 v209, v209, v213
v_mfma_f32_16x16x32_bf16 v[152:155], a[84:87], v[36:39], v[152:155]
buffer_load_dwordx4 v[100:103], v5, s[8:11], s54 offen offset:1024 sc1
v_add_f32 v217, v217, v221
v_mfma_f32_16x16x32_bf16 v[156:159], a[116:119], v[36:39], v[156:159]
v_add_f32 v210, v210, v214
v_add_f32 v218, v218, v222
v_mfma_f32_16x16x32_bf16 v[152:155], a[88:91], v[40:43], v[152:155]
v_add_f32 v211, v211, v215
v_add_f32 v219, v219, v223
v_mfma_f32_16x16x32_bf16 v[156:159], a[120:123], v[40:43], v[156:159]
v_add_f32 v208, v208, v216
v_add_f32 v209, v209, v217
v_mfma_f32_16x16x32_bf16 v[152:155], a[92:95], v[44:47], v[152:155]
v_add_f32 v210, v210, v218
v_add_f32 v211, v211, v219
v_mfma_f32_16x16x32_bf16 v[156:159], a[124:127], v[44:47], v[156:159]
buffer_load_dwordx4 v[104:107], v5, s[8:11], s54 offen offset:2048 sc1
v_cvt_pk_bf16_f32 v226, v208, v209
v_mfma_f32_16x16x32_bf16 v[160:163], v[16:19], a[128:131], 0
v_cvt_pk_bf16_f32 v227, v210, v211
buffer_store_dwordx4 v[224:227], v2, s[8:11], s56 offen sc1
v_mfma_f32_16x16x32_bf16 v[164:167], v[16:19], a[160:163], 0
ds_read_b128 v[192:195], v2 offset:57344
v_mfma_f32_16x16x32_bf16 v[160:163], v[20:23], a[132:135], v[160:163]
ds_read_b128 v[196:199], v4 offset:20480
v_mfma_f32_16x16x32_bf16 v[164:167], v[20:23], a[164:167], v[164:167]
ds_read_b128 v[200:203], v4 offset:32768
v_mfma_f32_16x16x32_bf16 v[160:163], v[24:27], a[136:139], v[160:163]
buffer_load_dwordx4 v[108:111], v5, s[8:11], s54 offen offset:3072 sc1
ds_write_b128 v2, v[152:155] offset:26624
v_mfma_f32_16x16x32_bf16 v[164:167], v[24:27], a[168:171], v[164:167]
s_mov_b32 m0, s68
v_mfma_f32_16x16x32_bf16 v[160:163], v[28:31], a[140:143], v[160:163]
buffer_load_dwordx4 v243, s[12:15], s69 offen lds
v_mfma_f32_16x16x32_bf16 v[164:167], v[28:31], a[172:175], v[164:167]
s_add_u32 s68, s68, s70
s_add_u32 s69, s69, s71
ds_write_b128 v2, v[156:159] offset:27648
v_mfma_f32_16x16x32_bf16 v[160:163], v[32:35], a[144:147], v[160:163]
ds_read_b128 v[204:207], v4 offset:45056
v_mfma_f32_16x16x32_bf16 v[164:167], v[32:35], a[176:179], v[164:167]
ds_read_b128 v[208:211], v2 offset:58368
v_mfma_f32_16x16x32_bf16 v[160:163], v[36:39], a[148:151], v[160:163]
ds_read_b128 v[212:215], v4 offset:21504
v_mfma_f32_16x16x32_bf16 v[164:167], v[36:39], a[180:183], v[164:167]
ds_read_b128 v[216:219], v4 offset:33792
v_mfma_f32_16x16x32_bf16 v[160:163], v[40:43], a[152:155], v[160:163]
ds_read_b128 v[220:223], v4 offset:46080
v_mfma_f32_16x16x32_bf16 v[164:167], v[40:43], a[184:187], v[164:167]
v_mfma_f32_16x16x32_bf16 v[160:163], v[44:47], a[156:159], v[160:163]
v_mfma_f32_16x16x32_bf16 v[164:167], v[44:47], a[188:191], v[164:167]
s_waitcnt vmcnt(11)
v_mfma_f32_16x16x32_bf16 v[168:171], a[0:3], v[48:51], 0
v_mfma_f32_16x16x32_bf16 v[172:175], a[32:35], v[48:51], 0
buffer_load_dwordx4 v[112:115], v2, s[8:11], s45 offen offset:0 sc1
v_mfma_f32_16x16x32_bf16 v[168:171], a[4:7], v[52:55], v[168:171]
s_waitcnt lgkmcnt(0)
v_add_f32 v192, v192, v196
v_mfma_f32_16x16x32_bf16 v[172:175], a[36:39], v[52:55], v[172:175]
v_add_f32 v200, v200, v204
v_add_f32 v193, v193, v197
v_mfma_f32_16x16x32_bf16 v[168:171], a[8:11], v[56:59], v[168:171]
ds_write_b128 v2, v[160:163] offset:28672
v_add_f32 v201, v201, v205
v_mfma_f32_16x16x32_bf16 v[172:175], a[40:43], v[56:59], v[172:175]
v_add_f32 v194, v194, v198
v_add_f32 v202, v202, v206
v_mfma_f32_16x16x32_bf16 v[168:171], a[12:15], v[60:63], v[168:171]
buffer_load_dwordx4 v[116:119], v2, s[8:11], s45 offen offset:1024 sc1
v_add_f32 v195, v195, v199
v_mfma_f32_16x16x32_bf16 v[172:175], a[44:47], v[60:63], v[172:175]
ds_write_b128 v2, v[164:167] offset:29696
v_add_f32 v203, v203, v207
v_mfma_f32_16x16x32_bf16 v[168:171], a[16:19], v[64:67], v[168:171]
v_add_f32 v192, v192, v200
v_add_f32 v193, v193, v201
v_mfma_f32_16x16x32_bf16 v[172:175], a[48:51], v[64:67], v[172:175]
v_add_f32 v194, v194, v202
v_add_f32 v195, v195, v203
v_mfma_f32_16x16x32_bf16 v[168:171], a[20:23], v[68:71], v[168:171]
v_cvt_pk_bf16_f32 v228, v192, v193
v_cvt_pk_bf16_f32 v229, v194, v195
v_mfma_f32_16x16x32_bf16 v[172:175], a[52:55], v[68:71], v[172:175]
buffer_load_dwordx4 v[120:123], v2, s[8:11], s45 offen offset:2048 sc1
v_add_f32 v208, v208, v212
v_mfma_f32_16x16x32_bf16 v[168:171], a[24:27], v[72:75], v[168:171]
v_add_f32 v216, v216, v220
v_add_f32 v209, v209, v213
v_mfma_f32_16x16x32_bf16 v[172:175], a[56:59], v[72:75], v[172:175]
v_add_f32 v217, v217, v221
v_add_f32 v210, v210, v214
v_mfma_f32_16x16x32_bf16 v[168:171], a[28:31], v[76:79], v[168:171]
v_add_f32 v218, v218, v222
v_add_f32 v211, v211, v215
v_mfma_f32_16x16x32_bf16 v[172:175], a[60:63], v[76:79], v[172:175]
v_add_f32 v219, v219, v223
v_add_f32 v208, v208, v216
v_mfma_f32_16x16x32_bf16 v[176:179], a[64:67], v[48:51], 0
buffer_load_dwordx4 v[124:127], v2, s[8:11], s45 offen offset:3072 sc1
v_add_f32 v209, v209, v217
v_mfma_f32_16x16x32_bf16 v[180:183], a[96:99], v[48:51], 0
v_add_f32 v210, v210, v218
v_add_f32 v211, v211, v219
v_mfma_f32_16x16x32_bf16 v[176:179], a[68:71], v[52:55], v[176:179]
v_cvt_pk_bf16_f32 v230, v208, v209
v_cvt_pk_bf16_f32 v231, v210, v211
v_mfma_f32_16x16x32_bf16 v[180:183], a[100:103], v[52:55], v[180:183]
buffer_store_dwordx4 v[228:231], v5, s[8:11], s56 offen sc1
v_mfma_f32_16x16x32_bf16 v[176:179], a[72:75], v[56:59], v[176:179]
ds_write_b128 v2, v[168:171] offset:30720
v_mfma_f32_16x16x32_bf16 v[180:183], a[104:107], v[56:59], v[180:183]
buffer_load_dwordx4 v[128:131], v5, s[8:11], s45 offen offset:0 sc1
v_mfma_f32_16x16x32_bf16 v[176:179], a[76:79], v[60:63], v[176:179]
v_mfma_f32_16x16x32_bf16 v[180:183], a[108:111], v[60:63], v[180:183]
ds_write_b128 v2, v[172:175] offset:31744
v_mfma_f32_16x16x32_bf16 v[176:179], a[80:83], v[64:67], v[176:179]
v_mfma_f32_16x16x32_bf16 v[180:183], a[112:115], v[64:67], v[180:183]
v_mfma_f32_16x16x32_bf16 v[176:179], a[84:87], v[68:71], v[176:179]
buffer_load_dwordx4 v[132:135], v5, s[8:11], s45 offen offset:1024 sc1
v_mfma_f32_16x16x32_bf16 v[180:183], a[116:119], v[68:71], v[180:183]
v_mfma_f32_16x16x32_bf16 v[176:179], a[88:91], v[72:75], v[176:179]
v_mfma_f32_16x16x32_bf16 v[180:183], a[120:123], v[72:75], v[180:183]
v_mfma_f32_16x16x32_bf16 v[176:179], a[92:95], v[76:79], v[176:179]
v_mfma_f32_16x16x32_bf16 v[180:183], a[124:127], v[76:79], v[180:183]
buffer_load_dwordx4 v[136:139], v5, s[8:11], s45 offen offset:2048 sc1
v_mfma_f32_16x16x32_bf16 v[184:187], v[48:51], a[128:131], 0
v_mfma_f32_16x16x32_bf16 v[188:191], v[48:51], a[160:163], 0
v_mfma_f32_16x16x32_bf16 v[184:187], v[52:55], a[132:135], v[184:187]
v_mfma_f32_16x16x32_bf16 v[188:191], v[52:55], a[164:167], v[188:191]
v_mfma_f32_16x16x32_bf16 v[184:187], v[56:59], a[136:139], v[184:187]
buffer_load_dwordx4 v[140:143], v5, s[8:11], s45 offen offset:3072 sc1
ds_write_b128 v2, v[176:179] offset:32768
v_mfma_f32_16x16x32_bf16 v[188:191], v[56:59], a[168:171], v[188:191]
s_mov_b32 m0, s68
v_mfma_f32_16x16x32_bf16 v[184:187], v[60:63], a[140:143], v[184:187]
buffer_load_dwordx4 v243, s[12:15], s69 offen lds
v_mfma_f32_16x16x32_bf16 v[188:191], v[60:63], a[172:175], v[188:191]
s_add_u32 s68, s68, s70
s_add_u32 s69, s69, s71
ds_write_b128 v2, v[180:183] offset:33792
v_mfma_f32_16x16x32_bf16 v[184:187], v[64:67], a[144:147], v[184:187]
v_mfma_f32_16x16x32_bf16 v[188:191], v[64:67], a[176:179], v[188:191]
v_mfma_f32_16x16x32_bf16 v[184:187], v[68:71], a[148:151], v[184:187]
v_mfma_f32_16x16x32_bf16 v[188:191], v[68:71], a[180:183], v[188:191]
v_mfma_f32_16x16x32_bf16 v[184:187], v[72:75], a[152:155], v[184:187]
v_mfma_f32_16x16x32_bf16 v[188:191], v[72:75], a[184:187], v[188:191]
v_mfma_f32_16x16x32_bf16 v[184:187], v[76:79], a[156:159], v[184:187]
v_mfma_f32_16x16x32_bf16 v[188:191], v[76:79], a[188:191], v[188:191]
s_nop 6
ds_write_b128 v2, v[184:187] offset:34816
ds_write_b128 v2, v[188:191] offset:35840
s_add_u32 s55, s55, 0x40000
s_add_u32 s56, s56, 0x40000
s_add_u32 s57, s57, 0x40000
s_cmp_eq_u32 s52, 60
s_cselect_b32 s45, 0x1000000, 0
s_sub_u32 s55, s55, s45
s_sub_u32 s56, s56, s45
s_sub_u32 s57, s57, s45
s_waitcnt vmcnt(20) lgkmcnt(0)
s_barrier
s_add_u32 s59, s59, 1
s_branch fg1_loop_w2_\sf
fg1_done_w2_\sf:
ds_read_b128 v[192:195], v2 offset:51200
ds_read_b128 v[196:199], v2 offset:63488
ds_read_b128 v[200:203], v4 offset:26624
ds_read_b128 v[204:207], v4 offset:38912
ds_read_b128 v[208:211], v2 offset:52224
ds_read_b128 v[212:215], v2 offset:64512
ds_read_b128 v[216:219], v4 offset:27648
ds_read_b128 v[220:223], v4 offset:39936
s_waitcnt lgkmcnt(0)
v_add_f32 v192, v192, v196
v_add_f32 v200, v200, v204
v_add_f32 v193, v193, v197
v_add_f32 v201, v201, v205
v_add_f32 v194, v194, v198
v_add_f32 v202, v202, v206
v_add_f32 v195, v195, v199
v_add_f32 v203, v203, v207
v_add_f32 v192, v192, v200
v_add_f32 v193, v193, v201
v_add_f32 v194, v194, v202
v_add_f32 v195, v195, v203
v_cvt_pk_bf16_f32 v224, v192, v193
v_cvt_pk_bf16_f32 v225, v194, v195
v_add_f32 v208, v208, v212
v_add_f32 v216, v216, v220
v_add_f32 v209, v209, v213
v_add_f32 v217, v217, v221
v_add_f32 v210, v210, v214
v_add_f32 v218, v218, v222
v_add_f32 v211, v211, v215
v_add_f32 v219, v219, v223
v_add_f32 v208, v208, v216
v_add_f32 v209, v209, v217
v_add_f32 v210, v210, v218
v_add_f32 v211, v211, v219
v_cvt_pk_bf16_f32 v226, v208, v209
v_cvt_pk_bf16_f32 v227, v210, v211
buffer_store_dwordx4 v[224:227], v2, s[8:11], s56 offen sc1
ds_read_b128 v[192:195], v2 offset:57344
ds_read_b128 v[196:199], v4 offset:20480
ds_read_b128 v[200:203], v4 offset:32768
ds_read_b128 v[204:207], v4 offset:45056
ds_read_b128 v[208:211], v2 offset:58368
ds_read_b128 v[212:215], v4 offset:21504
ds_read_b128 v[216:219], v4 offset:33792
ds_read_b128 v[220:223], v4 offset:46080
s_waitcnt lgkmcnt(0)
v_add_f32 v192, v192, v196
v_add_f32 v200, v200, v204
v_add_f32 v193, v193, v197
v_add_f32 v201, v201, v205
v_add_f32 v194, v194, v198
v_add_f32 v202, v202, v206
v_add_f32 v195, v195, v199
v_add_f32 v203, v203, v207
v_add_f32 v192, v192, v200
v_add_f32 v193, v193, v201
v_add_f32 v194, v194, v202
v_add_f32 v195, v195, v203
v_cvt_pk_bf16_f32 v228, v192, v193
v_cvt_pk_bf16_f32 v229, v194, v195
v_add_f32 v208, v208, v212
v_add_f32 v216, v216, v220
v_add_f32 v209, v209, v213
v_add_f32 v217, v217, v221
v_add_f32 v210, v210, v214
v_add_f32 v218, v218, v222
v_add_f32 v211, v211, v215
v_add_f32 v219, v219, v223
v_add_f32 v208, v208, v216
v_add_f32 v209, v209, v217
v_add_f32 v210, v210, v218
v_add_f32 v211, v211, v219
v_cvt_pk_bf16_f32 v230, v208, v209
v_cvt_pk_bf16_f32 v231, v210, v211
buffer_store_dwordx4 v[228:231], v5, s[8:11], s56 offen sc1
s_nop 1
s_branch fg1_join_\sf
fg1_wave3_\sf:
v_and_b32 v12, 15, v1
v_lshrrev_b32 v13, 4, v1
v_lshlrev_b32 v13, 5, v13
v_lshl_add_u32 v3, v12, 11, v13
v_add_u32 v4, 49152, v2
v_add_u32 v5, 4096, v2
s_lshl_b32 s54, s52, 16
s_lshl_b32 s45, s92, 22
s_add_u32 s54, s54, s45
s_lshl_b32 s45, s49, 2
s_add_u32 s45, s45, s50
s_and_b32 s45, s45, 31
s_lshl_b32 s45, s45, 11
s_add_u32 s60, s54, s45
.if \sf == 0
s_add_u32 s60, s60, 0x5ff0000
s_add_u32 s54, s54, 0x6006000
.else
s_add_u32 s60, s60, 0xdff0000
s_add_u32 s54, s54, 0xe006000
.endif
s_lshl_b32 s45, s52, 5
s_add_u32 s45, s45, s49
s_lshl_b32 s45, s45, 13
s_lshl_b32 s46, s50, 10
s_add_u32 s47, s45, s46
s_add_u32 s55, s47, 0x0
s_add_u32 s56, s47, 0x1000000
s_add_u32 s47, s47, s46
s_add_u32 s57, s47, 0x2000000
v_mov_b32 v9, s91
s_nop 1
dw_126_\sf:
buffer_load_dword v8, v9, s[32:35], 0 offen sc1
s_waitcnt vmcnt(0)
v_cmp_gt_u32 vcc, 32, v8
s_cbranch_vccz dwd_127_\sf
s_add_u32 s44, s44, 1
s_cmp_lt_u32 s44, 0x40000
s_cbranch_scc1 dw_126_\sf
s_nop 0
dwd_127_\sf:
s_add_u32 s45, s54, 0x8000
buffer_load_dwordx4 v[16:19], v2, s[8:11], s54 offen offset:0 sc1
buffer_load_dwordx4 v[20:23], v2, s[8:11], s54 offen offset:1024 sc1
buffer_load_dwordx4 v[24:27], v2, s[8:11], s54 offen offset:2048 sc1
buffer_load_dwordx4 v[28:31], v2, s[8:11], s54 offen offset:3072 sc1
buffer_load_dwordx4 v[32:35], v5, s[8:11], s54 offen offset:0 sc1
buffer_load_dwordx4 v[36:39], v5, s[8:11], s54 offen offset:1024 sc1
buffer_load_dwordx4 v[40:43], v5, s[8:11], s54 offen offset:2048 sc1
buffer_load_dwordx4 v[44:47], v5, s[8:11], s54 offen offset:3072 sc1
buffer_load_dwordx4 v[48:51], v2, s[8:11], s45 offen offset:0 sc1
buffer_load_dwordx4 v[52:55], v2, s[8:11], s45 offen offset:1024 sc1
buffer_load_dwordx4 v[56:59], v2, s[8:11], s45 offen offset:2048 sc1
buffer_load_dwordx4 v[60:63], v2, s[8:11], s45 offen offset:3072 sc1
buffer_load_dwordx4 v[64:67], v5, s[8:11], s45 offen offset:0 sc1
buffer_load_dwordx4 v[68:71], v5, s[8:11], s45 offen offset:1024 sc1
buffer_load_dwordx4 v[72:75], v5, s[8:11], s45 offen offset:2048 sc1
buffer_load_dwordx4 v[76:79], v5, s[8:11], s45 offen offset:3072 sc1
s_mov_b32 s52, 0
s_load_dwordx2 s[12:13], s[0:1], 88
s_waitcnt lgkmcnt(0)
s_and_b32 s13, s13, 0xffff
s_mov_b32 s14, 0x700000
s_mov_b32 s15, 0x20000
s_mov_b32 s14, 0
s_mov_b32 s68, 0x30000
s_mov_b32 s69, 0
s_mov_b32 s70, 0
s_mov_b32 s71, 0
v_mov_b32 v243, 0
s_barrier
s_add_u32 s54, s54, 0x10000
s_add_u32 s60, s60, 0x10000
s_add_u32 s45, s54, 0x8000
s_waitcnt vmcnt(0)
v_mfma_f32_16x16x32_bf16 v[144:147], a[0:3], v[16:19], 0
v_mfma_f32_16x16x32_bf16 v[148:151], a[32:35], v[16:19], 0
buffer_load_dwordx4 v[80:83], v2, s[8:11], s54 offen offset:0 sc1
v_mfma_f32_16x16x32_bf16 v[144:147], a[4:7], v[20:23], v[144:147]
buffer_load_dwordx4 a[192:195], v3, s[24:27], s61 offen offset:0
v_mfma_f32_16x16x32_bf16 v[148:151], a[36:39], v[20:23], v[148:151]
v_mfma_f32_16x16x32_bf16 v[144:147], a[8:11], v[24:27], v[144:147]
v_mfma_f32_16x16x32_bf16 v[148:151], a[40:43], v[24:27], v[148:151]
v_mfma_f32_16x16x32_bf16 v[144:147], a[12:15], v[28:31], v[144:147]
buffer_load_dwordx4 v[84:87], v2, s[8:11], s54 offen offset:1024 sc1
buffer_load_dwordx4 a[196:199], v3, s[24:27], s61 offen offset:16
v_mfma_f32_16x16x32_bf16 v[148:151], a[44:47], v[28:31], v[148:151]
v_mfma_f32_16x16x32_bf16 v[144:147], a[16:19], v[32:35], v[144:147]
v_mfma_f32_16x16x32_bf16 v[148:151], a[48:51], v[32:35], v[148:151]
v_mfma_f32_16x16x32_bf16 v[144:147], a[20:23], v[36:39], v[144:147]
buffer_load_dwordx4 a[200:203], v3, s[24:27], s61 offen offset:128
v_mfma_f32_16x16x32_bf16 v[148:151], a[52:55], v[36:39], v[148:151]
buffer_load_dwordx4 v[88:91], v2, s[8:11], s54 offen offset:2048 sc1
v_mfma_f32_16x16x32_bf16 v[144:147], a[24:27], v[40:43], v[144:147]
v_mfma_f32_16x16x32_bf16 v[148:151], a[56:59], v[40:43], v[148:151]
v_mfma_f32_16x16x32_bf16 v[144:147], a[28:31], v[44:47], v[144:147]
buffer_load_dwordx4 a[204:207], v3, s[24:27], s61 offen offset:144
v_mfma_f32_16x16x32_bf16 v[148:151], a[60:63], v[44:47], v[148:151]
v_mfma_f32_16x16x32_bf16 v[152:155], a[64:67], v[16:19], 0
buffer_load_dwordx4 v[92:95], v2, s[8:11], s54 offen offset:3072 sc1
v_mfma_f32_16x16x32_bf16 v[156:159], a[96:99], v[16:19], 0
v_mfma_f32_16x16x32_bf16 v[152:155], a[68:71], v[20:23], v[152:155]
buffer_load_dwordx4 a[208:211], v3, s[24:27], s61 offen offset:256
v_mfma_f32_16x16x32_bf16 v[156:159], a[100:103], v[20:23], v[156:159]
v_mfma_f32_16x16x32_bf16 v[152:155], a[72:75], v[24:27], v[152:155]
ds_write_b128 v2, v[144:147] offset:36864
v_mfma_f32_16x16x32_bf16 v[156:159], a[104:107], v[24:27], v[156:159]
buffer_load_dwordx4 v[96:99], v5, s[8:11], s54 offen offset:0 sc1
v_mfma_f32_16x16x32_bf16 v[152:155], a[76:79], v[28:31], v[152:155]
buffer_load_dwordx4 a[212:215], v3, s[24:27], s61 offen offset:272
v_mfma_f32_16x16x32_bf16 v[156:159], a[108:111], v[28:31], v[156:159]
ds_write_b128 v2, v[148:151] offset:37888
v_mfma_f32_16x16x32_bf16 v[152:155], a[80:83], v[32:35], v[152:155]
v_mfma_f32_16x16x32_bf16 v[156:159], a[112:115], v[32:35], v[156:159]
v_mfma_f32_16x16x32_bf16 v[152:155], a[84:87], v[36:39], v[152:155]
buffer_load_dwordx4 v[100:103], v5, s[8:11], s54 offen offset:1024 sc1
buffer_load_dwordx4 a[216:219], v3, s[24:27], s61 offen offset:384
v_mfma_f32_16x16x32_bf16 v[156:159], a[116:119], v[36:39], v[156:159]
v_mfma_f32_16x16x32_bf16 v[152:155], a[88:91], v[40:43], v[152:155]
v_mfma_f32_16x16x32_bf16 v[156:159], a[120:123], v[40:43], v[156:159]
v_mfma_f32_16x16x32_bf16 v[152:155], a[92:95], v[44:47], v[152:155]
buffer_load_dwordx4 a[220:223], v3, s[24:27], s61 offen offset:400
v_mfma_f32_16x16x32_bf16 v[156:159], a[124:127], v[44:47], v[156:159]
buffer_load_dwordx4 v[104:107], v5, s[8:11], s54 offen offset:2048 sc1
v_mfma_f32_16x16x32_bf16 v[160:163], v[16:19], a[128:131], 0
v_mfma_f32_16x16x32_bf16 v[164:167], v[16:19], a[160:163], 0
v_mfma_f32_16x16x32_bf16 v[160:163], v[20:23], a[132:135], v[160:163]
v_mfma_f32_16x16x32_bf16 v[164:167], v[20:23], a[164:167], v[164:167]
v_mfma_f32_16x16x32_bf16 v[160:163], v[24:27], a[136:139], v[160:163]
buffer_load_dwordx4 v[108:111], v5, s[8:11], s54 offen offset:3072 sc1
ds_write_b128 v2, v[152:155] offset:38912
v_mfma_f32_16x16x32_bf16 v[164:167], v[24:27], a[168:171], v[164:167]
s_mov_b32 m0, s68
v_mfma_f32_16x16x32_bf16 v[160:163], v[28:31], a[140:143], v[160:163]
buffer_load_dwordx4 v243, s[12:15], s69 offen lds
v_mfma_f32_16x16x32_bf16 v[164:167], v[28:31], a[172:175], v[164:167]
s_add_u32 s68, s68, s70
s_add_u32 s69, s69, s71
ds_write_b128 v2, v[156:159] offset:39936
v_mfma_f32_16x16x32_bf16 v[160:163], v[32:35], a[144:147], v[160:163]
v_mfma_f32_16x16x32_bf16 v[164:167], v[32:35], a[176:179], v[164:167]
v_mfma_f32_16x16x32_bf16 v[160:163], v[36:39], a[148:151], v[160:163]
v_mfma_f32_16x16x32_bf16 v[164:167], v[36:39], a[180:183], v[164:167]
v_mfma_f32_16x16x32_bf16 v[160:163], v[40:43], a[152:155], v[160:163]
v_mfma_f32_16x16x32_bf16 v[164:167], v[40:43], a[184:187], v[164:167]
v_mfma_f32_16x16x32_bf16 v[160:163], v[44:47], a[156:159], v[160:163]
v_mfma_f32_16x16x32_bf16 v[164:167], v[44:47], a[188:191], v[164:167]
v_mfma_f32_16x16x32_bf16 v[168:171], a[0:3], v[48:51], 0
v_mfma_f32_16x16x32_bf16 v[172:175], a[32:35], v[48:51], 0
buffer_load_dwordx4 v[112:115], v2, s[8:11], s45 offen offset:0 sc1
v_mfma_f32_16x16x32_bf16 v[168:171], a[4:7], v[52:55], v[168:171]
v_mfma_f32_16x16x32_bf16 v[172:175], a[36:39], v[52:55], v[172:175]
v_mfma_f32_16x16x32_bf16 v[168:171], a[8:11], v[56:59], v[168:171]
s_nop 0
ds_write_b128 v2, v[160:163] offset:40960
v_mfma_f32_16x16x32_bf16 v[172:175], a[40:43], v[56:59], v[172:175]
v_mfma_f32_16x16x32_bf16 v[168:171], a[12:15], v[60:63], v[168:171]
buffer_load_dwordx4 v[116:119], v2, s[8:11], s45 offen offset:1024 sc1
v_mfma_f32_16x16x32_bf16 v[172:175], a[44:47], v[60:63], v[172:175]
ds_write_b128 v2, v[164:167] offset:41984
v_mfma_f32_16x16x32_bf16 v[168:171], a[16:19], v[64:67], v[168:171]
v_mfma_f32_16x16x32_bf16 v[172:175], a[48:51], v[64:67], v[172:175]
v_mfma_f32_16x16x32_bf16 v[168:171], a[20:23], v[68:71], v[168:171]
v_mfma_f32_16x16x32_bf16 v[172:175], a[52:55], v[68:71], v[172:175]
buffer_load_dwordx4 v[120:123], v2, s[8:11], s45 offen offset:2048 sc1
v_mfma_f32_16x16x32_bf16 v[168:171], a[24:27], v[72:75], v[168:171]
v_mfma_f32_16x16x32_bf16 v[172:175], a[56:59], v[72:75], v[172:175]
v_mfma_f32_16x16x32_bf16 v[168:171], a[28:31], v[76:79], v[168:171]
v_mfma_f32_16x16x32_bf16 v[172:175], a[60:63], v[76:79], v[172:175]
v_mfma_f32_16x16x32_bf16 v[176:179], a[64:67], v[48:51], 0
buffer_load_dwordx4 v[124:127], v2, s[8:11], s45 offen offset:3072 sc1
v_mfma_f32_16x16x32_bf16 v[180:183], a[96:99], v[48:51], 0
v_mfma_f32_16x16x32_bf16 v[176:179], a[68:71], v[52:55], v[176:179]
v_mfma_f32_16x16x32_bf16 v[180:183], a[100:103], v[52:55], v[180:183]
v_mfma_f32_16x16x32_bf16 v[176:179], a[72:75], v[56:59], v[176:179]
s_nop 0
ds_write_b128 v2, v[168:171] offset:43008
v_mfma_f32_16x16x32_bf16 v[180:183], a[104:107], v[56:59], v[180:183]
buffer_load_dwordx4 v[128:131], v5, s[8:11], s45 offen offset:0 sc1
v_mfma_f32_16x16x32_bf16 v[176:179], a[76:79], v[60:63], v[176:179]
v_mfma_f32_16x16x32_bf16 v[180:183], a[108:111], v[60:63], v[180:183]
ds_write_b128 v2, v[172:175] offset:44032
v_mfma_f32_16x16x32_bf16 v[176:179], a[80:83], v[64:67], v[176:179]
v_mfma_f32_16x16x32_bf16 v[180:183], a[112:115], v[64:67], v[180:183]
v_mfma_f32_16x16x32_bf16 v[176:179], a[84:87], v[68:71], v[176:179]
buffer_load_dwordx4 v[132:135], v5, s[8:11], s45 offen offset:1024 sc1
v_mfma_f32_16x16x32_bf16 v[180:183], a[116:119], v[68:71], v[180:183]
v_mfma_f32_16x16x32_bf16 v[176:179], a[88:91], v[72:75], v[176:179]
v_mfma_f32_16x16x32_bf16 v[180:183], a[120:123], v[72:75], v[180:183]
v_mfma_f32_16x16x32_bf16 v[176:179], a[92:95], v[76:79], v[176:179]
v_mfma_f32_16x16x32_bf16 v[180:183], a[124:127], v[76:79], v[180:183]
buffer_load_dwordx4 v[136:139], v5, s[8:11], s45 offen offset:2048 sc1
v_mfma_f32_16x16x32_bf16 v[184:187], v[48:51], a[128:131], 0
v_mfma_f32_16x16x32_bf16 v[188:191], v[48:51], a[160:163], 0
v_mfma_f32_16x16x32_bf16 v[184:187], v[52:55], a[132:135], v[184:187]
v_mfma_f32_16x16x32_bf16 v[188:191], v[52:55], a[164:167], v[188:191]
v_mfma_f32_16x16x32_bf16 v[184:187], v[56:59], a[136:139], v[184:187]
buffer_load_dwordx4 v[140:143], v5, s[8:11], s45 offen offset:3072 sc1
ds_write_b128 v2, v[176:179] offset:45056
v_mfma_f32_16x16x32_bf16 v[188:191], v[56:59], a[168:171], v[188:191]
s_mov_b32 m0, s68
v_mfma_f32_16x16x32_bf16 v[184:187], v[60:63], a[140:143], v[184:187]
buffer_load_dwordx4 v243, s[12:15], s69 offen lds
v_mfma_f32_16x16x32_bf16 v[188:191], v[60:63], a[172:175], v[188:191]
s_add_u32 s68, s68, s70
s_add_u32 s69, s69, s71
ds_write_b128 v2, v[180:183] offset:46080
v_mfma_f32_16x16x32_bf16 v[184:187], v[64:67], a[144:147], v[184:187]
v_mfma_f32_16x16x32_bf16 v[188:191], v[64:67], a[176:179], v[188:191]
v_mfma_f32_16x16x32_bf16 v[184:187], v[68:71], a[148:151], v[184:187]
v_mfma_f32_16x16x32_bf16 v[188:191], v[68:71], a[180:183], v[188:191]
v_mfma_f32_16x16x32_bf16 v[184:187], v[72:75], a[152:155], v[184:187]
v_mfma_f32_16x16x32_bf16 v[188:191], v[72:75], a[184:187], v[188:191]
v_mfma_f32_16x16x32_bf16 v[184:187], v[76:79], a[156:159], v[184:187]
v_mfma_f32_16x16x32_bf16 v[188:191], v[76:79], a[188:191], v[188:191]
s_nop 6
ds_write_b128 v2, v[184:187] offset:47104
ds_write_b128 v2, v[188:191] offset:48128
s_add_u32 s61, s61, 0x100000
s_waitcnt lgkmcnt(0)
s_barrier
s_add_u32 s54, s54, 0x10000
s_cmp_eq_u32 s52, 58
s_cselect_b32 s45, 0x400000, 0
s_sub_u32 s54, s54, s45
s_add_u32 s60, s60, 0x10000
s_add_u32 s45, s54, 0x8000
s_waitcnt vmcnt(10)
v_mfma_f32_16x16x32_bf16 v[144:147], a[0:3], v[80:83], 0
ds_read_b128 v[192:195], v2 offset:5120
v_mfma_f32_16x16x32_bf16 v[148:151], a[32:35], v[80:83], 0
buffer_load_dwordx4 v[16:19], v2, s[8:11], s54 offen offset:0 sc1
ds_read_b128 v[196:199], v2 offset:17408
v_mfma_f32_16x16x32_bf16 v[144:147], a[4:7], v[84:87], v[144:147]
buffer_load_dwordx4 a[224:227], v3, s[24:27], s61 offen offset:0
ds_read_b128 v[200:203], v2 offset:29696
v_mfma_f32_16x16x32_bf16 v[148:151], a[36:39], v[84:87], v[148:151]
ds_read_b128 v[204:207], v2 offset:41984
v_mfma_f32_16x16x32_bf16 v[144:147], a[8:11], v[88:91], v[144:147]
.if \sf == 0
buffer_store_dwordx4 a[192:195], v2, s[8:11], s62 offen offset:0
.else
buffer_store_dwordx4 a[192:195], v2, s[8:11], s62 offen offset:0 sc1
.endif
ds_read_b128 v[208:211], v2 offset:11264
v_mfma_f32_16x16x32_bf16 v[148:151], a[40:43], v[88:91], v[148:151]
ds_read_b128 v[212:215], v2 offset:23552
v_mfma_f32_16x16x32_bf16 v[144:147], a[12:15], v[92:95], v[144:147]
buffer_load_dwordx4 v[20:23], v2, s[8:11], s54 offen offset:1024 sc1
buffer_load_dwordx4 a[228:231], v3, s[24:27], s61 offen offset:16
v_mfma_f32_16x16x32_bf16 v[148:151], a[44:47], v[92:95], v[148:151]
ds_read_b128 v[216:219], v2 offset:35840
v_mfma_f32_16x16x32_bf16 v[144:147], a[16:19], v[96:99], v[144:147]
.if \sf == 0
buffer_store_dwordx4 a[196:199], v2, s[8:11], s62 offen offset:1024
.else
buffer_store_dwordx4 a[196:199], v2, s[8:11], s62 offen offset:1024 sc1
.endif
ds_read_b128 v[220:223], v2 offset:48128
v_mfma_f32_16x16x32_bf16 v[148:151], a[48:51], v[96:99], v[148:151]
v_mfma_f32_16x16x32_bf16 v[144:147], a[20:23], v[100:103], v[144:147]
buffer_load_dwordx4 a[232:235], v3, s[24:27], s61 offen offset:128
v_mfma_f32_16x16x32_bf16 v[148:151], a[52:55], v[100:103], v[148:151]
buffer_load_dwordx4 v[24:27], v2, s[8:11], s54 offen offset:2048 sc1
v_mfma_f32_16x16x32_bf16 v[144:147], a[24:27], v[104:107], v[144:147]
.if \sf == 0
buffer_store_dwordx4 a[200:203], v2, s[8:11], s62 offen offset:2048
.else
buffer_store_dwordx4 a[200:203], v2, s[8:11], s62 offen offset:2048 sc1
.endif
v_mfma_f32_16x16x32_bf16 v[148:151], a[56:59], v[104:107], v[148:151]
v_mfma_f32_16x16x32_bf16 v[144:147], a[28:31], v[108:111], v[144:147]
buffer_load_dwordx4 a[236:239], v3, s[24:27], s61 offen offset:144
s_waitcnt lgkmcnt(0)
v_mfma_f32_16x16x32_bf16 v[148:151], a[60:63], v[108:111], v[148:151]
v_add_f32 v192, v192, v196
v_add_f32 v200, v200, v204
v_mfma_f32_16x16x32_bf16 v[152:155], a[64:67], v[80:83], 0
buffer_load_dwordx4 v[28:31], v2, s[8:11], s54 offen offset:3072 sc1
.if \sf == 0
buffer_store_dwordx4 a[204:207], v2, s[8:11], s62 offen offset:3072
.else
buffer_store_dwordx4 a[204:207], v2, s[8:11], s62 offen offset:3072 sc1
.endif
v_mfma_f32_16x16x32_bf16 v[156:159], a[96:99], v[80:83], 0
v_add_f32 v193, v193, v197
v_add_f32 v201, v201, v205
v_mfma_f32_16x16x32_bf16 v[152:155], a[68:71], v[84:87], v[152:155]
buffer_load_dwordx4 a[240:243], v3, s[24:27], s61 offen offset:256
v_add_f32 v194, v194, v198
v_mfma_f32_16x16x32_bf16 v[156:159], a[100:103], v[84:87], v[156:159]
v_add_f32 v202, v202, v206
v_add_f32 v195, v195, v199
v_mfma_f32_16x16x32_bf16 v[152:155], a[72:75], v[88:91], v[152:155]
.if \sf == 0
buffer_store_dwordx4 a[208:211], v5, s[8:11], s62 offen offset:0
.else
buffer_store_dwordx4 a[208:211], v5, s[8:11], s62 offen offset:0 sc1
.endif
ds_write_b128 v4, v[144:147] offset:36864
v_mfma_f32_16x16x32_bf16 v[156:159], a[104:107], v[88:91], v[156:159]
buffer_load_dwordx4 v[32:35], v5, s[8:11], s54 offen offset:0 sc1
v_add_f32 v203, v203, v207
v_mfma_f32_16x16x32_bf16 v[152:155], a[76:79], v[92:95], v[152:155]
buffer_load_dwordx4 a[244:247], v3, s[24:27], s61 offen offset:272
v_add_f32 v192, v192, v200
v_mfma_f32_16x16x32_bf16 v[156:159], a[108:111], v[92:95], v[156:159]
ds_write_b128 v4, v[148:151] offset:37888
v_add_f32 v193, v193, v201
v_mfma_f32_16x16x32_bf16 v[152:155], a[80:83], v[96:99], v[152:155]
.if \sf == 0
buffer_store_dwordx4 a[212:215], v5, s[8:11], s62 offen offset:1024
.else
buffer_store_dwordx4 a[212:215], v5, s[8:11], s62 offen offset:1024 sc1
.endif
v_add_f32 v194, v194, v202
v_mfma_f32_16x16x32_bf16 v[156:159], a[112:115], v[96:99], v[156:159]
v_add_f32 v195, v195, v203
v_cvt_pk_bf16_f32 v224, v192, v193
v_mfma_f32_16x16x32_bf16 v[152:155], a[84:87], v[100:103], v[152:155]
buffer_load_dwordx4 v[36:39], v5, s[8:11], s54 offen offset:1024 sc1
buffer_load_dwordx4 a[248:251], v3, s[24:27], s61 offen offset:384
v_mfma_f32_16x16x32_bf16 v[156:159], a[116:119], v[100:103], v[156:159]
v_cvt_pk_bf16_f32 v225, v194, v195
v_add_f32 v208, v208, v212
v_mfma_f32_16x16x32_bf16 v[152:155], a[88:91], v[104:107], v[152:155]
.if \sf == 0
buffer_store_dwordx4 a[216:219], v5, s[8:11], s62 offen offset:2048
.else
buffer_store_dwordx4 a[216:219], v5, s[8:11], s62 offen offset:2048 sc1
.endif
v_add_f32 v216, v216, v220
v_mfma_f32_16x16x32_bf16 v[156:159], a[120:123], v[104:107], v[156:159]
v_add_f32 v209, v209, v213
v_add_f32 v217, v217, v221
v_mfma_f32_16x16x32_bf16 v[152:155], a[92:95], v[108:111], v[152:155]
buffer_load_dwordx4 a[252:255], v3, s[24:27], s61 offen offset:400
v_add_f32 v210, v210, v214
v_mfma_f32_16x16x32_bf16 v[156:159], a[124:127], v[108:111], v[156:159]
buffer_load_dwordx4 v[40:43], v5, s[8:11], s54 offen offset:2048 sc1
v_add_f32 v218, v218, v222
v_mfma_f32_16x16x32_bf16 v[160:163], v[80:83], a[128:131], 0
.if \sf == 0
buffer_store_dwordx4 a[220:223], v5, s[8:11], s62 offen offset:3072
.else
buffer_store_dwordx4 a[220:223], v5, s[8:11], s62 offen offset:3072 sc1
.endif
v_add_f32 v211, v211, v215
v_mfma_f32_16x16x32_bf16 v[164:167], v[80:83], a[160:163], 0
v_add_f32 v219, v219, v223
v_add_f32 v208, v208, v216
v_mfma_f32_16x16x32_bf16 v[160:163], v[84:87], a[132:135], v[160:163]
v_add_f32 v209, v209, v217
v_add_f32 v210, v210, v218
v_mfma_f32_16x16x32_bf16 v[164:167], v[84:87], a[164:167], v[164:167]
v_add_f32 v211, v211, v219
v_cvt_pk_bf16_f32 v226, v208, v209
v_mfma_f32_16x16x32_bf16 v[160:163], v[88:91], a[136:139], v[160:163]
buffer_load_dwordx4 v[44:47], v5, s[8:11], s54 offen offset:3072 sc1
ds_write_b128 v4, v[152:155] offset:38912
v_mfma_f32_16x16x32_bf16 v[164:167], v[88:91], a[168:171], v[164:167]
s_mov_b32 m0, s68
v_cvt_pk_bf16_f32 v227, v210, v211
v_mfma_f32_16x16x32_bf16 v[160:163], v[92:95], a[140:143], v[160:163]
buffer_load_dwordx4 v243, s[12:15], s69 offen lds
buffer_store_dwordx4 v[224:227], v2, s[8:11], s57 offen offset:1024 sc1
v_mfma_f32_16x16x32_bf16 v[164:167], v[92:95], a[172:175], v[164:167]
s_add_u32 s68, s68, s70
s_add_u32 s69, s69, s71
ds_write_b128 v4, v[156:159] offset:39936
v_mfma_f32_16x16x32_bf16 v[160:163], v[96:99], a[144:147], v[160:163]
v_mfma_f32_16x16x32_bf16 v[164:167], v[96:99], a[176:179], v[164:167]
v_mfma_f32_16x16x32_bf16 v[160:163], v[100:103], a[148:151], v[160:163]
v_mfma_f32_16x16x32_bf16 v[164:167], v[100:103], a[180:183], v[164:167]
v_mfma_f32_16x16x32_bf16 v[160:163], v[104:107], a[152:155], v[160:163]
v_mfma_f32_16x16x32_bf16 v[164:167], v[104:107], a[184:187], v[164:167]
v_mfma_f32_16x16x32_bf16 v[160:163], v[108:111], a[156:159], v[160:163]
v_mfma_f32_16x16x32_bf16 v[164:167], v[108:111], a[188:191], v[164:167]
s_waitcnt vmcnt(27)
v_mfma_f32_16x16x32_bf16 v[168:171], a[0:3], v[112:115], 0
v_mfma_f32_16x16x32_bf16 v[172:175], a[32:35], v[112:115], 0
buffer_load_dwordx4 v[48:51], v2, s[8:11], s45 offen offset:0 sc1
v_mfma_f32_16x16x32_bf16 v[168:171], a[4:7], v[116:119], v[168:171]
v_mfma_f32_16x16x32_bf16 v[172:175], a[36:39], v[116:119], v[172:175]
v_mfma_f32_16x16x32_bf16 v[168:171], a[8:11], v[120:123], v[168:171]
ds_write_b128 v4, v[160:163] offset:40960
v_mfma_f32_16x16x32_bf16 v[172:175], a[40:43], v[120:123], v[172:175]
v_mfma_f32_16x16x32_bf16 v[168:171], a[12:15], v[124:127], v[168:171]
buffer_load_dwordx4 v[52:55], v2, s[8:11], s45 offen offset:1024 sc1
v_mfma_f32_16x16x32_bf16 v[172:175], a[44:47], v[124:127], v[172:175]
ds_write_b128 v4, v[164:167] offset:41984
v_mfma_f32_16x16x32_bf16 v[168:171], a[16:19], v[128:131], v[168:171]
v_mfma_f32_16x16x32_bf16 v[172:175], a[48:51], v[128:131], v[172:175]
v_mfma_f32_16x16x32_bf16 v[168:171], a[20:23], v[132:135], v[168:171]
v_mfma_f32_16x16x32_bf16 v[172:175], a[52:55], v[132:135], v[172:175]
buffer_load_dwordx4 v[56:59], v2, s[8:11], s45 offen offset:2048 sc1
v_mfma_f32_16x16x32_bf16 v[168:171], a[24:27], v[136:139], v[168:171]
v_mfma_f32_16x16x32_bf16 v[172:175], a[56:59], v[136:139], v[172:175]
v_mfma_f32_16x16x32_bf16 v[168:171], a[28:31], v[140:143], v[168:171]
v_mfma_f32_16x16x32_bf16 v[172:175], a[60:63], v[140:143], v[172:175]
v_mfma_f32_16x16x32_bf16 v[176:179], a[64:67], v[112:115], 0
buffer_load_dwordx4 v[60:63], v2, s[8:11], s45 offen offset:3072 sc1
v_mfma_f32_16x16x32_bf16 v[180:183], a[96:99], v[112:115], 0
v_mfma_f32_16x16x32_bf16 v[176:179], a[68:71], v[116:119], v[176:179]
v_mfma_f32_16x16x32_bf16 v[180:183], a[100:103], v[116:119], v[180:183]
v_mfma_f32_16x16x32_bf16 v[176:179], a[72:75], v[120:123], v[176:179]
s_nop 0
ds_write_b128 v4, v[168:171] offset:43008
v_mfma_f32_16x16x32_bf16 v[180:183], a[104:107], v[120:123], v[180:183]
buffer_load_dwordx4 v[64:67], v5, s[8:11], s45 offen offset:0 sc1
v_mfma_f32_16x16x32_bf16 v[176:179], a[76:79], v[124:127], v[176:179]
v_mfma_f32_16x16x32_bf16 v[180:183], a[108:111], v[124:127], v[180:183]
ds_write_b128 v4, v[172:175] offset:44032
v_mfma_f32_16x16x32_bf16 v[176:179], a[80:83], v[128:131], v[176:179]
v_mfma_f32_16x16x32_bf16 v[180:183], a[112:115], v[128:131], v[180:183]
v_mfma_f32_16x16x32_bf16 v[176:179], a[84:87], v[132:135], v[176:179]
buffer_load_dwordx4 v[68:71], v5, s[8:11], s45 offen offset:1024 sc1
v_mfma_f32_16x16x32_bf16 v[180:183], a[116:119], v[132:135], v[180:183]
v_mfma_f32_16x16x32_bf16 v[176:179], a[88:91], v[136:139], v[176:179]
v_mfma_f32_16x16x32_bf16 v[180:183], a[120:123], v[136:139], v[180:183]
v_mfma_f32_16x16x32_bf16 v[176:179], a[92:95], v[140:143], v[176:179]
v_mfma_f32_16x16x32_bf16 v[180:183], a[124:127], v[140:143], v[180:183]
buffer_load_dwordx4 v[72:75], v5, s[8:11], s45 offen offset:2048 sc1
v_mfma_f32_16x16x32_bf16 v[184:187], v[112:115], a[128:131], 0
v_mfma_f32_16x16x32_bf16 v[188:191], v[112:115], a[160:163], 0
v_mfma_f32_16x16x32_bf16 v[184:187], v[116:119], a[132:135], v[184:187]
v_mfma_f32_16x16x32_bf16 v[188:191], v[116:119], a[164:167], v[188:191]
v_mfma_f32_16x16x32_bf16 v[184:187], v[120:123], a[136:139], v[184:187]
buffer_load_dwordx4 v[76:79], v5, s[8:11], s45 offen offset:3072 sc1
ds_write_b128 v4, v[176:179] offset:45056
v_mfma_f32_16x16x32_bf16 v[188:191], v[120:123], a[168:171], v[188:191]
s_mov_b32 m0, s68
v_mfma_f32_16x16x32_bf16 v[184:187], v[124:127], a[140:143], v[184:187]
buffer_load_dwordx4 v243, s[12:15], s69 offen lds
v_mfma_f32_16x16x32_bf16 v[188:191], v[124:127], a[172:175], v[188:191]
s_add_u32 s68, s68, s70
s_add_u32 s69, s69, s71
ds_write_b128 v4, v[180:183] offset:46080
v_mfma_f32_16x16x32_bf16 v[184:187], v[128:131], a[144:147], v[184:187]
v_mfma_f32_16x16x32_bf16 v[188:191], v[128:131], a[176:179], v[188:191]
v_mfma_f32_16x16x32_bf16 v[184:187], v[132:135], a[148:151], v[184:187]
v_mfma_f32_16x16x32_bf16 v[188:191], v[132:135], a[180:183], v[188:191]
v_mfma_f32_16x16x32_bf16 v[184:187], v[136:139], a[152:155], v[184:187]
v_mfma_f32_16x16x32_bf16 v[188:191], v[136:139], a[184:187], v[188:191]
v_mfma_f32_16x16x32_bf16 v[184:187], v[140:143], a[156:159], v[184:187]
v_mfma_f32_16x16x32_bf16 v[188:191], v[140:143], a[188:191], v[188:191]
s_nop 6
ds_write_b128 v4, v[184:187] offset:47104
ds_write_b128 v4, v[188:191] offset:48128
s_add_u32 s55, s55, 0x40000
s_add_u32 s56, s56, 0x40000
s_add_u32 s57, s57, 0x40000
s_add_u32 s61, s61, 0x100000
s_add_u32 s62, s62, 0x100000
s_waitcnt vmcnt(9) lgkmcnt(0)
s_barrier
s_add_u32 s59, s59, 1
s_add_u32 s54, s54, 0x10000
s_add_u32 s60, s60, 0x10000
s_add_u32 s45, s54, 0x8000
s_waitcnt vmcnt(11)
v_mfma_f32_16x16x32_bf16 v[144:147], a[0:3], v[16:19], 0
ds_read_b128 v[192:195], v2 offset:53248
v_mfma_f32_16x16x32_bf16 v[148:151], a[32:35], v[16:19], 0
buffer_load_dwordx4 v[80:83], v2, s[8:11], s54 offen offset:0 sc1
ds_read_b128 v[196:199], v4 offset:16384
v_mfma_f32_16x16x32_bf16 v[144:147], a[4:7], v[20:23], v[144:147]
buffer_load_dwordx4 a[192:195], v3, s[24:27], s61 offen offset:0
ds_read_b128 v[200:203], v4 offset:28672
v_mfma_f32_16x16x32_bf16 v[148:151], a[36:39], v[20:23], v[148:151]
ds_read_b128 v[204:207], v4 offset:40960
v_mfma_f32_16x16x32_bf16 v[144:147], a[8:11], v[24:27], v[144:147]
.if \sf == 0
buffer_store_dwordx4 a[224:227], v2, s[8:11], s62 offen offset:0
.else
buffer_store_dwordx4 a[224:227], v2, s[8:11], s62 offen offset:0 sc1
.endif
ds_read_b128 v[208:211], v2 offset:59392
v_mfma_f32_16x16x32_bf16 v[148:151], a[40:43], v[24:27], v[148:151]
ds_read_b128 v[212:215], v4 offset:22528
v_mfma_f32_16x16x32_bf16 v[144:147], a[12:15], v[28:31], v[144:147]
buffer_load_dwordx4 v[84:87], v2, s[8:11], s54 offen offset:1024 sc1
buffer_load_dwordx4 a[196:199], v3, s[24:27], s61 offen offset:16
v_mfma_f32_16x16x32_bf16 v[148:151], a[44:47], v[28:31], v[148:151]
ds_read_b128 v[216:219], v4 offset:34816
v_mfma_f32_16x16x32_bf16 v[144:147], a[16:19], v[32:35], v[144:147]
.if \sf == 0
buffer_store_dwordx4 a[228:231], v2, s[8:11], s62 offen offset:1024
.else
buffer_store_dwordx4 a[228:231], v2, s[8:11], s62 offen offset:1024 sc1
.endif
ds_read_b128 v[220:223], v4 offset:47104
v_mfma_f32_16x16x32_bf16 v[148:151], a[48:51], v[32:35], v[148:151]
v_mfma_f32_16x16x32_bf16 v[144:147], a[20:23], v[36:39], v[144:147]
buffer_load_dwordx4 a[200:203], v3, s[24:27], s61 offen offset:128
v_mfma_f32_16x16x32_bf16 v[148:151], a[52:55], v[36:39], v[148:151]
buffer_load_dwordx4 v[88:91], v2, s[8:11], s54 offen offset:2048 sc1
v_mfma_f32_16x16x32_bf16 v[144:147], a[24:27], v[40:43], v[144:147]
.if \sf == 0
buffer_store_dwordx4 a[232:235], v2, s[8:11], s62 offen offset:2048
.else
buffer_store_dwordx4 a[232:235], v2, s[8:11], s62 offen offset:2048 sc1
.endif
v_mfma_f32_16x16x32_bf16 v[148:151], a[56:59], v[40:43], v[148:151]
v_mfma_f32_16x16x32_bf16 v[144:147], a[28:31], v[44:47], v[144:147]
buffer_load_dwordx4 a[204:207], v3, s[24:27], s61 offen offset:144
s_waitcnt lgkmcnt(0)
v_mfma_f32_16x16x32_bf16 v[148:151], a[60:63], v[44:47], v[148:151]
v_add_f32 v192, v192, v196
v_add_f32 v200, v200, v204
v_mfma_f32_16x16x32_bf16 v[152:155], a[64:67], v[16:19], 0
buffer_load_dwordx4 v[92:95], v2, s[8:11], s54 offen offset:3072 sc1
.if \sf == 0
buffer_store_dwordx4 a[236:239], v2, s[8:11], s62 offen offset:3072
.else
buffer_store_dwordx4 a[236:239], v2, s[8:11], s62 offen offset:3072 sc1
.endif
v_mfma_f32_16x16x32_bf16 v[156:159], a[96:99], v[16:19], 0
v_add_f32 v193, v193, v197
v_add_f32 v201, v201, v205
v_mfma_f32_16x16x32_bf16 v[152:155], a[68:71], v[20:23], v[152:155]
buffer_load_dwordx4 a[208:211], v3, s[24:27], s61 offen offset:256
v_add_f32 v194, v194, v198
v_mfma_f32_16x16x32_bf16 v[156:159], a[100:103], v[20:23], v[156:159]
v_add_f32 v202, v202, v206
v_add_f32 v195, v195, v199
v_mfma_f32_16x16x32_bf16 v[152:155], a[72:75], v[24:27], v[152:155]
.if \sf == 0
buffer_store_dwordx4 a[240:243], v5, s[8:11], s62 offen offset:0
.else
buffer_store_dwordx4 a[240:243], v5, s[8:11], s62 offen offset:0 sc1
.endif
ds_write_b128 v2, v[144:147] offset:36864
v_mfma_f32_16x16x32_bf16 v[156:159], a[104:107], v[24:27], v[156:159]
buffer_load_dwordx4 v[96:99], v5, s[8:11], s54 offen offset:0 sc1
v_add_f32 v203, v203, v207
v_mfma_f32_16x16x32_bf16 v[152:155], a[76:79], v[28:31], v[152:155]
buffer_load_dwordx4 a[212:215], v3, s[24:27], s61 offen offset:272
v_add_f32 v192, v192, v200
v_mfma_f32_16x16x32_bf16 v[156:159], a[108:111], v[28:31], v[156:159]
ds_write_b128 v2, v[148:151] offset:37888
v_add_f32 v193, v193, v201
v_mfma_f32_16x16x32_bf16 v[152:155], a[80:83], v[32:35], v[152:155]
.if \sf == 0
buffer_store_dwordx4 a[244:247], v5, s[8:11], s62 offen offset:1024
.else
buffer_store_dwordx4 a[244:247], v5, s[8:11], s62 offen offset:1024 sc1
.endif
v_add_f32 v194, v194, v202
v_mfma_f32_16x16x32_bf16 v[156:159], a[112:115], v[32:35], v[156:159]
v_add_f32 v195, v195, v203
v_cvt_pk_bf16_f32 v224, v192, v193
v_mfma_f32_16x16x32_bf16 v[152:155], a[84:87], v[36:39], v[152:155]
buffer_load_dwordx4 v[100:103], v5, s[8:11], s54 offen offset:1024 sc1
buffer_load_dwordx4 a[216:219], v3, s[24:27], s61 offen offset:384
v_mfma_f32_16x16x32_bf16 v[156:159], a[116:119], v[36:39], v[156:159]
v_cvt_pk_bf16_f32 v225, v194, v195
v_add_f32 v208, v208, v212
v_mfma_f32_16x16x32_bf16 v[152:155], a[88:91], v[40:43], v[152:155]
.if \sf == 0
buffer_store_dwordx4 a[248:251], v5, s[8:11], s62 offen offset:2048
.else
buffer_store_dwordx4 a[248:251], v5, s[8:11], s62 offen offset:2048 sc1
.endif
v_add_f32 v216, v216, v220
v_mfma_f32_16x16x32_bf16 v[156:159], a[120:123], v[40:43], v[156:159]
v_add_f32 v209, v209, v213
v_add_f32 v217, v217, v221
v_mfma_f32_16x16x32_bf16 v[152:155], a[92:95], v[44:47], v[152:155]
buffer_load_dwordx4 a[220:223], v3, s[24:27], s61 offen offset:400
v_add_f32 v210, v210, v214
v_mfma_f32_16x16x32_bf16 v[156:159], a[124:127], v[44:47], v[156:159]
buffer_load_dwordx4 v[104:107], v5, s[8:11], s54 offen offset:2048 sc1
v_add_f32 v218, v218, v222
v_mfma_f32_16x16x32_bf16 v[160:163], v[16:19], a[128:131], 0
.if \sf == 0
buffer_store_dwordx4 a[252:255], v5, s[8:11], s62 offen offset:3072
.else
buffer_store_dwordx4 a[252:255], v5, s[8:11], s62 offen offset:3072 sc1
.endif
v_add_f32 v211, v211, v215
v_mfma_f32_16x16x32_bf16 v[164:167], v[16:19], a[160:163], 0
v_add_f32 v219, v219, v223
v_add_f32 v208, v208, v216
v_mfma_f32_16x16x32_bf16 v[160:163], v[20:23], a[132:135], v[160:163]
v_add_f32 v209, v209, v217
v_add_f32 v210, v210, v218
v_mfma_f32_16x16x32_bf16 v[164:167], v[20:23], a[164:167], v[164:167]
v_add_f32 v211, v211, v219
v_cvt_pk_bf16_f32 v226, v208, v209
v_mfma_f32_16x16x32_bf16 v[160:163], v[24:27], a[136:139], v[160:163]
buffer_load_dwordx4 v[108:111], v5, s[8:11], s54 offen offset:3072 sc1
ds_write_b128 v2, v[152:155] offset:38912
v_mfma_f32_16x16x32_bf16 v[164:167], v[24:27], a[168:171], v[164:167]
s_mov_b32 m0, s68
v_cvt_pk_bf16_f32 v227, v210, v211
v_mfma_f32_16x16x32_bf16 v[160:163], v[28:31], a[140:143], v[160:163]
buffer_load_dwordx4 v243, s[12:15], s69 offen lds
buffer_store_dwordx4 v[224:227], v2, s[8:11], s57 offen offset:0 sc1
v_mfma_f32_16x16x32_bf16 v[164:167], v[28:31], a[172:175], v[164:167]
s_add_u32 s68, s68, s70
s_add_u32 s69, s69, s71
ds_write_b128 v2, v[156:159] offset:39936
v_mfma_f32_16x16x32_bf16 v[160:163], v[32:35], a[144:147], v[160:163]
ds_read_b128 v[192:195], v2 offset:54272
v_mfma_f32_16x16x32_bf16 v[164:167], v[32:35], a[176:179], v[164:167]
ds_read_b128 v[196:199], v4 offset:17408
v_mfma_f32_16x16x32_bf16 v[160:163], v[36:39], a[148:151], v[160:163]
ds_read_b128 v[200:203], v4 offset:29696
v_mfma_f32_16x16x32_bf16 v[164:167], v[36:39], a[180:183], v[164:167]
ds_read_b128 v[204:207], v4 offset:41984
v_mfma_f32_16x16x32_bf16 v[160:163], v[40:43], a[152:155], v[160:163]
ds_read_b128 v[208:211], v2 offset:60416
v_mfma_f32_16x16x32_bf16 v[164:167], v[40:43], a[184:187], v[164:167]
ds_read_b128 v[212:215], v4 offset:23552
v_mfma_f32_16x16x32_bf16 v[160:163], v[44:47], a[156:159], v[160:163]
ds_read_b128 v[216:219], v4 offset:35840
v_mfma_f32_16x16x32_bf16 v[164:167], v[44:47], a[188:191], v[164:167]
ds_read_b128 v[220:223], v4 offset:48128
s_waitcnt vmcnt(27)
v_mfma_f32_16x16x32_bf16 v[168:171], a[0:3], v[48:51], 0
v_mfma_f32_16x16x32_bf16 v[172:175], a[32:35], v[48:51], 0
buffer_load_dwordx4 v[112:115], v2, s[8:11], s45 offen offset:0 sc1
v_mfma_f32_16x16x32_bf16 v[168:171], a[4:7], v[52:55], v[168:171]
v_mfma_f32_16x16x32_bf16 v[172:175], a[36:39], v[52:55], v[172:175]
v_mfma_f32_16x16x32_bf16 v[168:171], a[8:11], v[56:59], v[168:171]
ds_write_b128 v2, v[160:163] offset:40960
v_mfma_f32_16x16x32_bf16 v[172:175], a[40:43], v[56:59], v[172:175]
s_waitcnt lgkmcnt(0)
v_add_f32 v192, v192, v196
v_mfma_f32_16x16x32_bf16 v[168:171], a[12:15], v[60:63], v[168:171]
buffer_load_dwordx4 v[116:119], v2, s[8:11], s45 offen offset:1024 sc1
v_add_f32 v200, v200, v204
v_mfma_f32_16x16x32_bf16 v[172:175], a[44:47], v[60:63], v[172:175]
ds_write_b128 v2, v[164:167] offset:41984
v_add_f32 v193, v193, v197
v_mfma_f32_16x16x32_bf16 v[168:171], a[16:19], v[64:67], v[168:171]
v_add_f32 v201, v201, v205
v_add_f32 v194, v194, v198
v_mfma_f32_16x16x32_bf16 v[172:175], a[48:51], v[64:67], v[172:175]
v_add_f32 v202, v202, v206
v_add_f32 v195, v195, v199
v_mfma_f32_16x16x32_bf16 v[168:171], a[20:23], v[68:71], v[168:171]
v_add_f32 v203, v203, v207
v_add_f32 v192, v192, v200
v_mfma_f32_16x16x32_bf16 v[172:175], a[52:55], v[68:71], v[172:175]
buffer_load_dwordx4 v[120:123], v2, s[8:11], s45 offen offset:2048 sc1
v_add_f32 v193, v193, v201
v_mfma_f32_16x16x32_bf16 v[168:171], a[24:27], v[72:75], v[168:171]
v_add_f32 v194, v194, v202
v_add_f32 v195, v195, v203
v_mfma_f32_16x16x32_bf16 v[172:175], a[56:59], v[72:75], v[172:175]
v_cvt_pk_bf16_f32 v228, v192, v193
v_cvt_pk_bf16_f32 v229, v194, v195
v_mfma_f32_16x16x32_bf16 v[168:171], a[28:31], v[76:79], v[168:171]
v_add_f32 v208, v208, v212
v_add_f32 v216, v216, v220
v_mfma_f32_16x16x32_bf16 v[172:175], a[60:63], v[76:79], v[172:175]
v_add_f32 v209, v209, v213
v_add_f32 v217, v217, v221
v_mfma_f32_16x16x32_bf16 v[176:179], a[64:67], v[48:51], 0
buffer_load_dwordx4 v[124:127], v2, s[8:11], s45 offen offset:3072 sc1
v_add_f32 v210, v210, v214
v_mfma_f32_16x16x32_bf16 v[180:183], a[96:99], v[48:51], 0
v_add_f32 v218, v218, v222
v_add_f32 v211, v211, v215
v_mfma_f32_16x16x32_bf16 v[176:179], a[68:71], v[52:55], v[176:179]
v_add_f32 v219, v219, v223
v_add_f32 v208, v208, v216
v_mfma_f32_16x16x32_bf16 v[180:183], a[100:103], v[52:55], v[180:183]
v_add_f32 v209, v209, v217
v_add_f32 v210, v210, v218
v_mfma_f32_16x16x32_bf16 v[176:179], a[72:75], v[56:59], v[176:179]
ds_write_b128 v2, v[168:171] offset:43008
v_add_f32 v211, v211, v219
v_mfma_f32_16x16x32_bf16 v[180:183], a[104:107], v[56:59], v[180:183]
buffer_load_dwordx4 v[128:131], v5, s[8:11], s45 offen offset:0 sc1
v_cvt_pk_bf16_f32 v230, v208, v209
v_mfma_f32_16x16x32_bf16 v[176:179], a[76:79], v[60:63], v[176:179]
v_cvt_pk_bf16_f32 v231, v210, v211
buffer_store_dwordx4 v[228:231], v2, s[8:11], s57 offen offset:1024 sc1
v_mfma_f32_16x16x32_bf16 v[180:183], a[108:111], v[60:63], v[180:183]
ds_write_b128 v2, v[172:175] offset:44032
v_mfma_f32_16x16x32_bf16 v[176:179], a[80:83], v[64:67], v[176:179]
v_mfma_f32_16x16x32_bf16 v[180:183], a[112:115], v[64:67], v[180:183]
v_mfma_f32_16x16x32_bf16 v[176:179], a[84:87], v[68:71], v[176:179]
buffer_load_dwordx4 v[132:135], v5, s[8:11], s45 offen offset:1024 sc1
v_mfma_f32_16x16x32_bf16 v[180:183], a[116:119], v[68:71], v[180:183]
v_mfma_f32_16x16x32_bf16 v[176:179], a[88:91], v[72:75], v[176:179]
v_mfma_f32_16x16x32_bf16 v[180:183], a[120:123], v[72:75], v[180:183]
v_mfma_f32_16x16x32_bf16 v[176:179], a[92:95], v[76:79], v[176:179]
v_mfma_f32_16x16x32_bf16 v[180:183], a[124:127], v[76:79], v[180:183]
buffer_load_dwordx4 v[136:139], v5, s[8:11], s45 offen offset:2048 sc1
v_mfma_f32_16x16x32_bf16 v[184:187], v[48:51], a[128:131], 0
v_mfma_f32_16x16x32_bf16 v[188:191], v[48:51], a[160:163], 0
v_mfma_f32_16x16x32_bf16 v[184:187], v[52:55], a[132:135], v[184:187]
v_mfma_f32_16x16x32_bf16 v[188:191], v[52:55], a[164:167], v[188:191]
v_mfma_f32_16x16x32_bf16 v[184:187], v[56:59], a[136:139], v[184:187]
buffer_load_dwordx4 v[140:143], v5, s[8:11], s45 offen offset:3072 sc1
ds_write_b128 v2, v[176:179] offset:45056
v_mfma_f32_16x16x32_bf16 v[188:191], v[56:59], a[168:171], v[188:191]
s_mov_b32 m0, s68
v_mfma_f32_16x16x32_bf16 v[184:187], v[60:63], a[140:143], v[184:187]
buffer_load_dwordx4 v243, s[12:15], s69 offen lds
v_mfma_f32_16x16x32_bf16 v[188:191], v[60:63], a[172:175], v[188:191]
s_add_u32 s68, s68, s70
s_add_u32 s69, s69, s71
ds_write_b128 v2, v[180:183] offset:46080
v_mfma_f32_16x16x32_bf16 v[184:187], v[64:67], a[144:147], v[184:187]
v_mfma_f32_16x16x32_bf16 v[188:191], v[64:67], a[176:179], v[188:191]
v_mfma_f32_16x16x32_bf16 v[184:187], v[68:71], a[148:151], v[184:187]
v_mfma_f32_16x16x32_bf16 v[188:191], v[68:71], a[180:183], v[188:191]
v_mfma_f32_16x16x32_bf16 v[184:187], v[72:75], a[152:155], v[184:187]
v_mfma_f32_16x16x32_bf16 v[188:191], v[72:75], a[184:187], v[188:191]
v_mfma_f32_16x16x32_bf16 v[184:187], v[76:79], a[156:159], v[184:187]
v_mfma_f32_16x16x32_bf16 v[188:191], v[76:79], a[188:191], v[188:191]
s_nop 6
ds_write_b128 v2, v[184:187] offset:47104
ds_write_b128 v2, v[188:191] offset:48128
s_add_u32 s55, s55, 0x40000
s_add_u32 s56, s56, 0x40000
s_add_u32 s57, s57, 0x40000
s_cmp_eq_u32 s52, 60
s_cselect_b32 s45, 0x1000000, 0
s_sub_u32 s55, s55, s45
s_sub_u32 s56, s56, s45
s_sub_u32 s57, s57, s45
s_add_u32 s61, s61, 0x100000
s_add_u32 s62, s62, 0x100000
s_waitcnt vmcnt(4) lgkmcnt(0)
s_barrier
s_add_u32 s59, s59, 1
s_add_u32 s54, s54, 0x10000
s_cmp_eq_u32 s52, 58
s_cselect_b32 s45, 0x400000, 0
s_sub_u32 s54, s54, s45
s_add_u32 s60, s60, 0x10000
s_add_u32 s45, s54, 0x8000
s_waitcnt vmcnt(12)
v_mfma_f32_16x16x32_bf16 v[144:147], a[0:3], v[80:83], 0
ds_read_b128 v[192:195], v2 offset:5120
v_mfma_f32_16x16x32_bf16 v[148:151], a[32:35], v[80:83], 0
buffer_load_dwordx4 v[16:19], v2, s[8:11], s54 offen offset:0 sc1
ds_read_b128 v[196:199], v2 offset:17408
v_mfma_f32_16x16x32_bf16 v[144:147], a[4:7], v[84:87], v[144:147]
ds_read_b128 v[200:203], v2 offset:29696
v_mfma_f32_16x16x32_bf16 v[148:151], a[36:39], v[84:87], v[148:151]
ds_read_b128 v[204:207], v2 offset:41984
v_mfma_f32_16x16x32_bf16 v[144:147], a[8:11], v[88:91], v[144:147]
.if \sf == 0
buffer_store_dwordx4 a[192:195], v2, s[8:11], s62 offen offset:0
.else
buffer_store_dwordx4 a[192:195], v2, s[8:11], s62 offen offset:0 sc1
.endif
ds_read_b128 v[208:211], v2 offset:11264
v_mfma_f32_16x16x32_bf16 v[148:151], a[40:43], v[88:91], v[148:151]
ds_read_b128 v[212:215], v2 offset:23552
v_mfma_f32_16x16x32_bf16 v[144:147], a[12:15], v[92:95], v[144:147]
buffer_load_dwordx4 v[20:23], v2, s[8:11], s54 offen offset:1024 sc1
ds_read_b128 v[216:219], v2 offset:35840
v_mfma_f32_16x16x32_bf16 v[148:151], a[44:47], v[92:95], v[148:151]
ds_read_b128 v[220:223], v2 offset:48128
v_mfma_f32_16x16x32_bf16 v[144:147], a[16:19], v[96:99], v[144:147]
.if \sf == 0
buffer_store_dwordx4 a[196:199], v2, s[8:11], s62 offen offset:1024
.else
buffer_store_dwordx4 a[196:199], v2, s[8:11], s62 offen offset:1024 sc1
.endif
v_mfma_f32_16x16x32_bf16 v[148:151], a[48:51], v[96:99], v[148:151]
v_mfma_f32_16x16x32_bf16 v[144:147], a[20:23], v[100:103], v[144:147]
v_mfma_f32_16x16x32_bf16 v[148:151], a[52:55], v[100:103], v[148:151]
buffer_load_dwordx4 v[24:27], v2, s[8:11], s54 offen offset:2048 sc1
v_mfma_f32_16x16x32_bf16 v[144:147], a[24:27], v[104:107], v[144:147]
.if \sf == 0
buffer_store_dwordx4 a[200:203], v2, s[8:11], s62 offen offset:2048
.else
buffer_store_dwordx4 a[200:203], v2, s[8:11], s62 offen offset:2048 sc1
.endif
v_mfma_f32_16x16x32_bf16 v[148:151], a[56:59], v[104:107], v[148:151]
s_waitcnt lgkmcnt(0)
v_add_f32 v192, v192, v196
v_mfma_f32_16x16x32_bf16 v[144:147], a[28:31], v[108:111], v[144:147]
v_add_f32 v200, v200, v204
v_add_f32 v193, v193, v197
v_mfma_f32_16x16x32_bf16 v[148:151], a[60:63], v[108:111], v[148:151]
v_add_f32 v201, v201, v205
v_add_f32 v194, v194, v198
v_mfma_f32_16x16x32_bf16 v[152:155], a[64:67], v[80:83], 0
buffer_load_dwordx4 v[28:31], v2, s[8:11], s54 offen offset:3072 sc1
.if \sf == 0
buffer_store_dwordx4 a[204:207], v2, s[8:11], s62 offen offset:3072
.else
buffer_store_dwordx4 a[204:207], v2, s[8:11], s62 offen offset:3072 sc1
.endif
v_mfma_f32_16x16x32_bf16 v[156:159], a[96:99], v[80:83], 0
v_add_f32 v202, v202, v206
v_add_f32 v195, v195, v199
v_mfma_f32_16x16x32_bf16 v[152:155], a[68:71], v[84:87], v[152:155]
v_add_f32 v203, v203, v207
v_add_f32 v192, v192, v200
v_mfma_f32_16x16x32_bf16 v[156:159], a[100:103], v[84:87], v[156:159]
v_add_f32 v193, v193, v201
v_add_f32 v194, v194, v202
v_mfma_f32_16x16x32_bf16 v[152:155], a[72:75], v[88:91], v[152:155]
.if \sf == 0
buffer_store_dwordx4 a[208:211], v5, s[8:11], s62 offen offset:0
.else
buffer_store_dwordx4 a[208:211], v5, s[8:11], s62 offen offset:0 sc1
.endif
ds_write_b128 v4, v[144:147] offset:36864
v_mfma_f32_16x16x32_bf16 v[156:159], a[104:107], v[88:91], v[156:159]
buffer_load_dwordx4 v[32:35], v5, s[8:11], s54 offen offset:0 sc1
v_add_f32 v195, v195, v203
v_mfma_f32_16x16x32_bf16 v[152:155], a[76:79], v[92:95], v[152:155]
v_cvt_pk_bf16_f32 v224, v192, v193
v_cvt_pk_bf16_f32 v225, v194, v195
v_mfma_f32_16x16x32_bf16 v[156:159], a[108:111], v[92:95], v[156:159]
ds_write_b128 v4, v[148:151] offset:37888
v_add_f32 v208, v208, v212
v_mfma_f32_16x16x32_bf16 v[152:155], a[80:83], v[96:99], v[152:155]
.if \sf == 0
buffer_store_dwordx4 a[212:215], v5, s[8:11], s62 offen offset:1024
.else
buffer_store_dwordx4 a[212:215], v5, s[8:11], s62 offen offset:1024 sc1
.endif
v_add_f32 v216, v216, v220
v_mfma_f32_16x16x32_bf16 v[156:159], a[112:115], v[96:99], v[156:159]
v_add_f32 v209, v209, v213
v_add_f32 v217, v217, v221
v_mfma_f32_16x16x32_bf16 v[152:155], a[84:87], v[100:103], v[152:155]
buffer_load_dwordx4 v[36:39], v5, s[8:11], s54 offen offset:1024 sc1
v_add_f32 v210, v210, v214
v_mfma_f32_16x16x32_bf16 v[156:159], a[116:119], v[100:103], v[156:159]
v_add_f32 v218, v218, v222
v_add_f32 v211, v211, v215
v_mfma_f32_16x16x32_bf16 v[152:155], a[88:91], v[104:107], v[152:155]
.if \sf == 0
buffer_store_dwordx4 a[216:219], v5, s[8:11], s62 offen offset:2048
.else
buffer_store_dwordx4 a[216:219], v5, s[8:11], s62 offen offset:2048 sc1
.endif
v_add_f32 v219, v219, v223
v_mfma_f32_16x16x32_bf16 v[156:159], a[120:123], v[104:107], v[156:159]
v_add_f32 v208, v208, v216
v_add_f32 v209, v209, v217
v_mfma_f32_16x16x32_bf16 v[152:155], a[92:95], v[108:111], v[152:155]
v_add_f32 v210, v210, v218
v_add_f32 v211, v211, v219
v_mfma_f32_16x16x32_bf16 v[156:159], a[124:127], v[108:111], v[156:159]
buffer_load_dwordx4 v[40:43], v5, s[8:11], s54 offen offset:2048 sc1
v_cvt_pk_bf16_f32 v226, v208, v209
v_mfma_f32_16x16x32_bf16 v[160:163], v[80:83], a[128:131], 0
.if \sf == 0
buffer_store_dwordx4 a[220:223], v5, s[8:11], s62 offen offset:3072
.else
buffer_store_dwordx4 a[220:223], v5, s[8:11], s62 offen offset:3072 sc1
.endif
v_cvt_pk_bf16_f32 v227, v210, v211
v_mfma_f32_16x16x32_bf16 v[164:167], v[80:83], a[160:163], 0
buffer_store_dwordx4 v[224:227], v2, s[8:11], s57 offen offset:1024 sc1
v_mfma_f32_16x16x32_bf16 v[160:163], v[84:87], a[132:135], v[160:163]
v_mfma_f32_16x16x32_bf16 v[164:167], v[84:87], a[164:167], v[164:167]
v_mfma_f32_16x16x32_bf16 v[160:163], v[88:91], a[136:139], v[160:163]
buffer_load_dwordx4 v[44:47], v5, s[8:11], s54 offen offset:3072 sc1
ds_write_b128 v4, v[152:155] offset:38912
v_mfma_f32_16x16x32_bf16 v[164:167], v[88:91], a[168:171], v[164:167]
s_mov_b32 m0, s68
v_mfma_f32_16x16x32_bf16 v[160:163], v[92:95], a[140:143], v[160:163]
buffer_load_dwordx4 v243, s[12:15], s69 offen lds
v_mfma_f32_16x16x32_bf16 v[164:167], v[92:95], a[172:175], v[164:167]
s_add_u32 s68, s68, s70
s_add_u32 s69, s69, s71
ds_write_b128 v4, v[156:159] offset:39936
v_mfma_f32_16x16x32_bf16 v[160:163], v[96:99], a[144:147], v[160:163]
v_mfma_f32_16x16x32_bf16 v[164:167], v[96:99], a[176:179], v[164:167]
v_mfma_f32_16x16x32_bf16 v[160:163], v[100:103], a[148:151], v[160:163]
v_mfma_f32_16x16x32_bf16 v[164:167], v[100:103], a[180:183], v[164:167]
v_mfma_f32_16x16x32_bf16 v[160:163], v[104:107], a[152:155], v[160:163]
v_mfma_f32_16x16x32_bf16 v[164:167], v[104:107], a[184:187], v[164:167]
v_mfma_f32_16x16x32_bf16 v[160:163], v[108:111], a[156:159], v[160:163]
v_mfma_f32_16x16x32_bf16 v[164:167], v[108:111], a[188:191], v[164:167]
s_waitcnt vmcnt(19)
v_mfma_f32_16x16x32_bf16 v[168:171], a[0:3], v[112:115], 0
v_mfma_f32_16x16x32_bf16 v[172:175], a[32:35], v[112:115], 0
buffer_load_dwordx4 v[48:51], v2, s[8:11], s45 offen offset:0 sc1
v_mfma_f32_16x16x32_bf16 v[168:171], a[4:7], v[116:119], v[168:171]
v_mfma_f32_16x16x32_bf16 v[172:175], a[36:39], v[116:119], v[172:175]
v_mfma_f32_16x16x32_bf16 v[168:171], a[8:11], v[120:123], v[168:171]
ds_write_b128 v4, v[160:163] offset:40960
v_mfma_f32_16x16x32_bf16 v[172:175], a[40:43], v[120:123], v[172:175]
v_mfma_f32_16x16x32_bf16 v[168:171], a[12:15], v[124:127], v[168:171]
buffer_load_dwordx4 v[52:55], v2, s[8:11], s45 offen offset:1024 sc1
v_mfma_f32_16x16x32_bf16 v[172:175], a[44:47], v[124:127], v[172:175]
ds_write_b128 v4, v[164:167] offset:41984
v_mfma_f32_16x16x32_bf16 v[168:171], a[16:19], v[128:131], v[168:171]
v_mfma_f32_16x16x32_bf16 v[172:175], a[48:51], v[128:131], v[172:175]
v_mfma_f32_16x16x32_bf16 v[168:171], a[20:23], v[132:135], v[168:171]
v_mfma_f32_16x16x32_bf16 v[172:175], a[52:55], v[132:135], v[172:175]
buffer_load_dwordx4 v[56:59], v2, s[8:11], s45 offen offset:2048 sc1
v_mfma_f32_16x16x32_bf16 v[168:171], a[24:27], v[136:139], v[168:171]
v_mfma_f32_16x16x32_bf16 v[172:175], a[56:59], v[136:139], v[172:175]
v_mfma_f32_16x16x32_bf16 v[168:171], a[28:31], v[140:143], v[168:171]
v_mfma_f32_16x16x32_bf16 v[172:175], a[60:63], v[140:143], v[172:175]
v_mfma_f32_16x16x32_bf16 v[176:179], a[64:67], v[112:115], 0
buffer_load_dwordx4 v[60:63], v2, s[8:11], s45 offen offset:3072 sc1
v_mfma_f32_16x16x32_bf16 v[180:183], a[96:99], v[112:115], 0
v_mfma_f32_16x16x32_bf16 v[176:179], a[68:71], v[116:119], v[176:179]
v_mfma_f32_16x16x32_bf16 v[180:183], a[100:103], v[116:119], v[180:183]
v_mfma_f32_16x16x32_bf16 v[176:179], a[72:75], v[120:123], v[176:179]
s_nop 0
ds_write_b128 v4, v[168:171] offset:43008
v_mfma_f32_16x16x32_bf16 v[180:183], a[104:107], v[120:123], v[180:183]
buffer_load_dwordx4 v[64:67], v5, s[8:11], s45 offen offset:0 sc1
v_mfma_f32_16x16x32_bf16 v[176:179], a[76:79], v[124:127], v[176:179]
v_mfma_f32_16x16x32_bf16 v[180:183], a[108:111], v[124:127], v[180:183]
ds_write_b128 v4, v[172:175] offset:44032
v_mfma_f32_16x16x32_bf16 v[176:179], a[80:83], v[128:131], v[176:179]
v_mfma_f32_16x16x32_bf16 v[180:183], a[112:115], v[128:131], v[180:183]
v_mfma_f32_16x16x32_bf16 v[176:179], a[84:87], v[132:135], v[176:179]
buffer_load_dwordx4 v[68:71], v5, s[8:11], s45 offen offset:1024 sc1
v_mfma_f32_16x16x32_bf16 v[180:183], a[116:119], v[132:135], v[180:183]
v_mfma_f32_16x16x32_bf16 v[176:179], a[88:91], v[136:139], v[176:179]
v_mfma_f32_16x16x32_bf16 v[180:183], a[120:123], v[136:139], v[180:183]
v_mfma_f32_16x16x32_bf16 v[176:179], a[92:95], v[140:143], v[176:179]
v_mfma_f32_16x16x32_bf16 v[180:183], a[124:127], v[140:143], v[180:183]
buffer_load_dwordx4 v[72:75], v5, s[8:11], s45 offen offset:2048 sc1
v_mfma_f32_16x16x32_bf16 v[184:187], v[112:115], a[128:131], 0
v_mfma_f32_16x16x32_bf16 v[188:191], v[112:115], a[160:163], 0
v_mfma_f32_16x16x32_bf16 v[184:187], v[116:119], a[132:135], v[184:187]
v_mfma_f32_16x16x32_bf16 v[188:191], v[116:119], a[164:167], v[188:191]
v_mfma_f32_16x16x32_bf16 v[184:187], v[120:123], a[136:139], v[184:187]
buffer_load_dwordx4 v[76:79], v5, s[8:11], s45 offen offset:3072 sc1
ds_write_b128 v4, v[176:179] offset:45056
v_mfma_f32_16x16x32_bf16 v[188:191], v[120:123], a[168:171], v[188:191]
s_mov_b32 m0, s68
v_mfma_f32_16x16x32_bf16 v[184:187], v[124:127], a[140:143], v[184:187]
buffer_load_dwordx4 v243, s[12:15], s69 offen lds
v_mfma_f32_16x16x32_bf16 v[188:191], v[124:127], a[172:175], v[188:191]
s_add_u32 s68, s68, s70
s_add_u32 s69, s69, s71
ds_write_b128 v4, v[180:183] offset:46080
v_mfma_f32_16x16x32_bf16 v[184:187], v[128:131], a[144:147], v[184:187]
v_mfma_f32_16x16x32_bf16 v[188:191], v[128:131], a[176:179], v[188:191]
v_mfma_f32_16x16x32_bf16 v[184:187], v[132:135], a[148:151], v[184:187]
v_mfma_f32_16x16x32_bf16 v[188:191], v[132:135], a[180:183], v[188:191]
v_mfma_f32_16x16x32_bf16 v[184:187], v[136:139], a[152:155], v[184:187]
v_mfma_f32_16x16x32_bf16 v[188:191], v[136:139], a[184:187], v[188:191]
v_mfma_f32_16x16x32_bf16 v[184:187], v[140:143], a[156:159], v[184:187]
v_mfma_f32_16x16x32_bf16 v[188:191], v[140:143], a[188:191], v[188:191]
s_nop 6
ds_write_b128 v4, v[184:187] offset:47104
ds_write_b128 v4, v[188:191] offset:48128
s_add_u32 s55, s55, 0x40000
s_add_u32 s56, s56, 0x40000
s_add_u32 s57, s57, 0x40000
s_add_u32 s62, s62, 0x100000
s_waitcnt vmcnt(11) lgkmcnt(0)
s_barrier
s_add_u32 s59, s59, 1
s_add_u32 s54, s54, 0x10000
s_add_u32 s60, s60, 0x10000
s_add_u32 s45, s54, 0x8000
s_waitcnt vmcnt(10)
v_mfma_f32_16x16x32_bf16 v[144:147], a[0:3], v[16:19], 0
ds_read_b128 v[192:195], v2 offset:53248
v_mfma_f32_16x16x32_bf16 v[148:151], a[32:35], v[16:19], 0
buffer_load_dwordx4 v[80:83], v2, s[8:11], s54 offen offset:0 sc1
v_mfma_f32_16x16x32_bf16 v[144:147], a[4:7], v[20:23], v[144:147]
ds_read_b128 v[196:199], v4 offset:16384
v_mfma_f32_16x16x32_bf16 v[148:151], a[36:39], v[20:23], v[148:151]
ds_read_b128 v[200:203], v4 offset:28672
v_mfma_f32_16x16x32_bf16 v[144:147], a[8:11], v[24:27], v[144:147]
ds_read_b128 v[204:207], v4 offset:40960
v_mfma_f32_16x16x32_bf16 v[148:151], a[40:43], v[24:27], v[148:151]
ds_read_b128 v[208:211], v2 offset:59392
v_mfma_f32_16x16x32_bf16 v[144:147], a[12:15], v[28:31], v[144:147]
buffer_load_dwordx4 v[84:87], v2, s[8:11], s54 offen offset:1024 sc1
v_mfma_f32_16x16x32_bf16 v[148:151], a[44:47], v[28:31], v[148:151]
ds_read_b128 v[212:215], v4 offset:22528
v_mfma_f32_16x16x32_bf16 v[144:147], a[16:19], v[32:35], v[144:147]
ds_read_b128 v[216:219], v4 offset:34816
v_mfma_f32_16x16x32_bf16 v[148:151], a[48:51], v[32:35], v[148:151]
ds_read_b128 v[220:223], v4 offset:47104
v_mfma_f32_16x16x32_bf16 v[144:147], a[20:23], v[36:39], v[144:147]
v_mfma_f32_16x16x32_bf16 v[148:151], a[52:55], v[36:39], v[148:151]
buffer_load_dwordx4 v[88:91], v2, s[8:11], s54 offen offset:2048 sc1
v_mfma_f32_16x16x32_bf16 v[144:147], a[24:27], v[40:43], v[144:147]
v_mfma_f32_16x16x32_bf16 v[148:151], a[56:59], v[40:43], v[148:151]
v_mfma_f32_16x16x32_bf16 v[144:147], a[28:31], v[44:47], v[144:147]
v_mfma_f32_16x16x32_bf16 v[148:151], a[60:63], v[44:47], v[148:151]
s_waitcnt lgkmcnt(0)
v_add_f32 v192, v192, v196
v_mfma_f32_16x16x32_bf16 v[152:155], a[64:67], v[16:19], 0
buffer_load_dwordx4 v[92:95], v2, s[8:11], s54 offen offset:3072 sc1
v_add_f32 v200, v200, v204
v_mfma_f32_16x16x32_bf16 v[156:159], a[96:99], v[16:19], 0
v_add_f32 v193, v193, v197
v_add_f32 v201, v201, v205
v_mfma_f32_16x16x32_bf16 v[152:155], a[68:71], v[20:23], v[152:155]
v_add_f32 v194, v194, v198
v_add_f32 v202, v202, v206
v_mfma_f32_16x16x32_bf16 v[156:159], a[100:103], v[20:23], v[156:159]
v_add_f32 v195, v195, v199
v_add_f32 v203, v203, v207
v_mfma_f32_16x16x32_bf16 v[152:155], a[72:75], v[24:27], v[152:155]
ds_write_b128 v2, v[144:147] offset:36864
v_add_f32 v192, v192, v200
v_mfma_f32_16x16x32_bf16 v[156:159], a[104:107], v[24:27], v[156:159]
buffer_load_dwordx4 v[96:99], v5, s[8:11], s54 offen offset:0 sc1
v_add_f32 v193, v193, v201
v_mfma_f32_16x16x32_bf16 v[152:155], a[76:79], v[28:31], v[152:155]
v_add_f32 v194, v194, v202
v_add_f32 v195, v195, v203
v_mfma_f32_16x16x32_bf16 v[156:159], a[108:111], v[28:31], v[156:159]
ds_write_b128 v2, v[148:151] offset:37888
v_cvt_pk_bf16_f32 v224, v192, v193
v_mfma_f32_16x16x32_bf16 v[152:155], a[80:83], v[32:35], v[152:155]
v_cvt_pk_bf16_f32 v225, v194, v195
v_add_f32 v208, v208, v212
v_mfma_f32_16x16x32_bf16 v[156:159], a[112:115], v[32:35], v[156:159]
v_add_f32 v216, v216, v220
v_add_f32 v209, v209, v213
v_mfma_f32_16x16x32_bf16 v[152:155], a[84:87], v[36:39], v[152:155]
buffer_load_dwordx4 v[100:103], v5, s[8:11], s54 offen offset:1024 sc1
v_add_f32 v217, v217, v221
v_mfma_f32_16x16x32_bf16 v[156:159], a[116:119], v[36:39], v[156:159]
v_add_f32 v210, v210, v214
v_add_f32 v218, v218, v222
v_mfma_f32_16x16x32_bf16 v[152:155], a[88:91], v[40:43], v[152:155]
v_add_f32 v211, v211, v215
v_add_f32 v219, v219, v223
v_mfma_f32_16x16x32_bf16 v[156:159], a[120:123], v[40:43], v[156:159]
v_add_f32 v208, v208, v216
v_add_f32 v209, v209, v217
v_mfma_f32_16x16x32_bf16 v[152:155], a[92:95], v[44:47], v[152:155]
v_add_f32 v210, v210, v218
v_add_f32 v211, v211, v219
v_mfma_f32_16x16x32_bf16 v[156:159], a[124:127], v[44:47], v[156:159]
buffer_load_dwordx4 v[104:107], v5, s[8:11], s54 offen offset:2048 sc1
v_cvt_pk_bf16_f32 v226, v208, v209
v_mfma_f32_16x16x32_bf16 v[160:163], v[16:19], a[128:131], 0
v_cvt_pk_bf16_f32 v227, v210, v211
buffer_store_dwordx4 v[224:227], v2, s[8:11], s57 offen offset:0 sc1
v_mfma_f32_16x16x32_bf16 v[164:167], v[16:19], a[160:163], 0
ds_read_b128 v[192:195], v2 offset:54272
v_mfma_f32_16x16x32_bf16 v[160:163], v[20:23], a[132:135], v[160:163]
ds_read_b128 v[196:199], v4 offset:17408
v_mfma_f32_16x16x32_bf16 v[164:167], v[20:23], a[164:167], v[164:167]
ds_read_b128 v[200:203], v4 offset:29696
v_mfma_f32_16x16x32_bf16 v[160:163], v[24:27], a[136:139], v[160:163]
buffer_load_dwordx4 v[108:111], v5, s[8:11], s54 offen offset:3072 sc1
ds_write_b128 v2, v[152:155] offset:38912
v_mfma_f32_16x16x32_bf16 v[164:167], v[24:27], a[168:171], v[164:167]
s_mov_b32 m0, s68
v_mfma_f32_16x16x32_bf16 v[160:163], v[28:31], a[140:143], v[160:163]
buffer_load_dwordx4 v243, s[12:15], s69 offen lds
v_mfma_f32_16x16x32_bf16 v[164:167], v[28:31], a[172:175], v[164:167]
s_add_u32 s68, s68, s70
s_add_u32 s69, s69, s71
ds_write_b128 v2, v[156:159] offset:39936
v_mfma_f32_16x16x32_bf16 v[160:163], v[32:35], a[144:147], v[160:163]
ds_read_b128 v[204:207], v4 offset:41984
v_mfma_f32_16x16x32_bf16 v[164:167], v[32:35], a[176:179], v[164:167]
ds_read_b128 v[208:211], v2 offset:60416
v_mfma_f32_16x16x32_bf16 v[160:163], v[36:39], a[148:151], v[160:163]
ds_read_b128 v[212:215], v4 offset:23552
v_mfma_f32_16x16x32_bf16 v[164:167], v[36:39], a[180:183], v[164:167]
ds_read_b128 v[216:219], v4 offset:35840
v_mfma_f32_16x16x32_bf16 v[160:163], v[40:43], a[152:155], v[160:163]
ds_read_b128 v[220:223], v4 offset:48128
v_mfma_f32_16x16x32_bf16 v[164:167], v[40:43], a[184:187], v[164:167]
v_mfma_f32_16x16x32_bf16 v[160:163], v[44:47], a[156:159], v[160:163]
v_mfma_f32_16x16x32_bf16 v[164:167], v[44:47], a[188:191], v[164:167]
s_waitcnt vmcnt(11)
v_mfma_f32_16x16x32_bf16 v[168:171], a[0:3], v[48:51], 0
v_mfma_f32_16x16x32_bf16 v[172:175], a[32:35], v[48:51], 0
buffer_load_dwordx4 v[112:115], v2, s[8:11], s45 offen offset:0 sc1
v_mfma_f32_16x16x32_bf16 v[168:171], a[4:7], v[52:55], v[168:171]
s_waitcnt lgkmcnt(0)
v_add_f32 v192, v192, v196
v_mfma_f32_16x16x32_bf16 v[172:175], a[36:39], v[52:55], v[172:175]
v_add_f32 v200, v200, v204
v_add_f32 v193, v193, v197
v_mfma_f32_16x16x32_bf16 v[168:171], a[8:11], v[56:59], v[168:171]
ds_write_b128 v2, v[160:163] offset:40960
v_add_f32 v201, v201, v205
v_mfma_f32_16x16x32_bf16 v[172:175], a[40:43], v[56:59], v[172:175]
v_add_f32 v194, v194, v198
v_add_f32 v202, v202, v206
v_mfma_f32_16x16x32_bf16 v[168:171], a[12:15], v[60:63], v[168:171]
buffer_load_dwordx4 v[116:119], v2, s[8:11], s45 offen offset:1024 sc1
v_add_f32 v195, v195, v199
v_mfma_f32_16x16x32_bf16 v[172:175], a[44:47], v[60:63], v[172:175]
ds_write_b128 v2, v[164:167] offset:41984
v_add_f32 v203, v203, v207
v_mfma_f32_16x16x32_bf16 v[168:171], a[16:19], v[64:67], v[168:171]
v_add_f32 v192, v192, v200
v_add_f32 v193, v193, v201
v_mfma_f32_16x16x32_bf16 v[172:175], a[48:51], v[64:67], v[172:175]
v_add_f32 v194, v194, v202
v_add_f32 v195, v195, v203
v_mfma_f32_16x16x32_bf16 v[168:171], a[20:23], v[68:71], v[168:171]
v_cvt_pk_bf16_f32 v228, v192, v193
v_cvt_pk_bf16_f32 v229, v194, v195
v_mfma_f32_16x16x32_bf16 v[172:175], a[52:55], v[68:71], v[172:175]
buffer_load_dwordx4 v[120:123], v2, s[8:11], s45 offen offset:2048 sc1
v_add_f32 v208, v208, v212
v_mfma_f32_16x16x32_bf16 v[168:171], a[24:27], v[72:75], v[168:171]
v_add_f32 v216, v216, v220
v_add_f32 v209, v209, v213
v_mfma_f32_16x16x32_bf16 v[172:175], a[56:59], v[72:75], v[172:175]
v_add_f32 v217, v217, v221
v_add_f32 v210, v210, v214
v_mfma_f32_16x16x32_bf16 v[168:171], a[28:31], v[76:79], v[168:171]
v_add_f32 v218, v218, v222
v_add_f32 v211, v211, v215
v_mfma_f32_16x16x32_bf16 v[172:175], a[60:63], v[76:79], v[172:175]
v_add_f32 v219, v219, v223
v_add_f32 v208, v208, v216
v_mfma_f32_16x16x32_bf16 v[176:179], a[64:67], v[48:51], 0
buffer_load_dwordx4 v[124:127], v2, s[8:11], s45 offen offset:3072 sc1
v_add_f32 v209, v209, v217
v_mfma_f32_16x16x32_bf16 v[180:183], a[96:99], v[48:51], 0
v_add_f32 v210, v210, v218
v_add_f32 v211, v211, v219
v_mfma_f32_16x16x32_bf16 v[176:179], a[68:71], v[52:55], v[176:179]
v_cvt_pk_bf16_f32 v230, v208, v209
v_cvt_pk_bf16_f32 v231, v210, v211
v_mfma_f32_16x16x32_bf16 v[180:183], a[100:103], v[52:55], v[180:183]
buffer_store_dwordx4 v[228:231], v2, s[8:11], s57 offen offset:1024 sc1
v_mfma_f32_16x16x32_bf16 v[176:179], a[72:75], v[56:59], v[176:179]
ds_write_b128 v2, v[168:171] offset:43008
v_mfma_f32_16x16x32_bf16 v[180:183], a[104:107], v[56:59], v[180:183]
buffer_load_dwordx4 v[128:131], v5, s[8:11], s45 offen offset:0 sc1
v_mfma_f32_16x16x32_bf16 v[176:179], a[76:79], v[60:63], v[176:179]
v_mfma_f32_16x16x32_bf16 v[180:183], a[108:111], v[60:63], v[180:183]
ds_write_b128 v2, v[172:175] offset:44032
v_mfma_f32_16x16x32_bf16 v[176:179], a[80:83], v[64:67], v[176:179]
v_mfma_f32_16x16x32_bf16 v[180:183], a[112:115], v[64:67], v[180:183]
v_mfma_f32_16x16x32_bf16 v[176:179], a[84:87], v[68:71], v[176:179]
buffer_load_dwordx4 v[132:135], v5, s[8:11], s45 offen offset:1024 sc1
v_mfma_f32_16x16x32_bf16 v[180:183], a[116:119], v[68:71], v[180:183]
v_mfma_f32_16x16x32_bf16 v[176:179], a[88:91], v[72:75], v[176:179]
v_mfma_f32_16x16x32_bf16 v[180:183], a[120:123], v[72:75], v[180:183]
v_mfma_f32_16x16x32_bf16 v[176:179], a[92:95], v[76:79], v[176:179]
v_mfma_f32_16x16x32_bf16 v[180:183], a[124:127], v[76:79], v[180:183]
buffer_load_dwordx4 v[136:139], v5, s[8:11], s45 offen offset:2048 sc1
v_mfma_f32_16x16x32_bf16 v[184:187], v[48:51], a[128:131], 0
v_mfma_f32_16x16x32_bf16 v[188:191], v[48:51], a[160:163], 0
v_mfma_f32_16x16x32_bf16 v[184:187], v[52:55], a[132:135], v[184:187]
v_mfma_f32_16x16x32_bf16 v[188:191], v[52:55], a[164:167], v[188:191]
v_mfma_f32_16x16x32_bf16 v[184:187], v[56:59], a[136:139], v[184:187]
buffer_load_dwordx4 v[140:143], v5, s[8:11], s45 offen offset:3072 sc1
ds_write_b128 v2, v[176:179] offset:45056
v_mfma_f32_16x16x32_bf16 v[188:191], v[56:59], a[168:171], v[188:191]
s_mov_b32 m0, s68
v_mfma_f32_16x16x32_bf16 v[184:187], v[60:63], a[140:143], v[184:187]
buffer_load_dwordx4 v243, s[12:15], s69 offen lds
v_mfma_f32_16x16x32_bf16 v[188:191], v[60:63], a[172:175], v[188:191]
s_add_u32 s68, s68, s70
s_add_u32 s69, s69, s71
ds_write_b128 v2, v[180:183] offset:46080
v_mfma_f32_16x16x32_bf16 v[184:187], v[64:67], a[144:147], v[184:187]
v_mfma_f32_16x16x32_bf16 v[188:191], v[64:67], a[176:179], v[188:191]
v_mfma_f32_16x16x32_bf16 v[184:187], v[68:71], a[148:151], v[184:187]
v_mfma_f32_16x16x32_bf16 v[188:191], v[68:71], a[180:183], v[188:191]
v_mfma_f32_16x16x32_bf16 v[184:187], v[72:75], a[152:155], v[184:187]
v_mfma_f32_16x16x32_bf16 v[188:191], v[72:75], a[184:187], v[188:191]
v_mfma_f32_16x16x32_bf16 v[184:187], v[76:79], a[156:159], v[184:187]
v_mfma_f32_16x16x32_bf16 v[188:191], v[76:79], a[188:191], v[188:191]
s_nop 6
ds_write_b128 v2, v[184:187] offset:47104
ds_write_b128 v2, v[188:191] offset:48128
s_add_u32 s55, s55, 0x40000
s_add_u32 s56, s56, 0x40000
s_add_u32 s57, s57, 0x40000
s_cmp_eq_u32 s52, 60
s_cselect_b32 s45, 0x1000000, 0
s_sub_u32 s55, s55, s45
s_sub_u32 s56, s56, s45
s_sub_u32 s57, s57, s45
s_waitcnt vmcnt(20) lgkmcnt(0)
s_barrier
s_add_u32 s59, s59, 1
s_add_u32 s52, s52, 4
fg1_loop_w3_\sf:
s_and_b32 s45, s52, 3
s_cmp_lg_u32 s45, 0
s_cbranch_scc1 nocv_128_\sf
s_mov_b32 s90, 3
s_branch g1_side_\sf
g1_back_w3_\sf:
nocv_128_\sf:
s_add_u32 s54, s54, 0x10000
s_cmp_eq_u32 s52, 58
s_cselect_b32 s45, 0x400000, 0
s_sub_u32 s54, s54, s45
s_add_u32 s60, s60, 0x10000
s_add_u32 s45, s54, 0x8000
s_waitcnt vmcnt(11)
v_mfma_f32_16x16x32_bf16 v[144:147], a[0:3], v[80:83], 0
ds_read_b128 v[192:195], v2 offset:5120
v_mfma_f32_16x16x32_bf16 v[148:151], a[32:35], v[80:83], 0
buffer_load_dwordx4 v[16:19], v2, s[8:11], s54 offen offset:0 sc1
v_mfma_f32_16x16x32_bf16 v[144:147], a[4:7], v[84:87], v[144:147]
ds_read_b128 v[196:199], v2 offset:17408
v_mfma_f32_16x16x32_bf16 v[148:151], a[36:39], v[84:87], v[148:151]
ds_read_b128 v[200:203], v2 offset:29696
v_mfma_f32_16x16x32_bf16 v[144:147], a[8:11], v[88:91], v[144:147]
ds_read_b128 v[204:207], v2 offset:41984
v_mfma_f32_16x16x32_bf16 v[148:151], a[40:43], v[88:91], v[148:151]
ds_read_b128 v[208:211], v2 offset:11264
v_mfma_f32_16x16x32_bf16 v[144:147], a[12:15], v[92:95], v[144:147]
buffer_load_dwordx4 v[20:23], v2, s[8:11], s54 offen offset:1024 sc1
v_mfma_f32_16x16x32_bf16 v[148:151], a[44:47], v[92:95], v[148:151]
ds_read_b128 v[212:215], v2 offset:23552
v_mfma_f32_16x16x32_bf16 v[144:147], a[16:19], v[96:99], v[144:147]
ds_read_b128 v[216:219], v2 offset:35840
v_mfma_f32_16x16x32_bf16 v[148:151], a[48:51], v[96:99], v[148:151]
ds_read_b128 v[220:223], v2 offset:48128
v_mfma_f32_16x16x32_bf16 v[144:147], a[20:23], v[100:103], v[144:147]
v_mfma_f32_16x16x32_bf16 v[148:151], a[52:55], v[100:103], v[148:151]
buffer_load_dwordx4 v[24:27], v2, s[8:11], s54 offen offset:2048 sc1
v_mfma_f32_16x16x32_bf16 v[144:147], a[24:27], v[104:107], v[144:147]
v_mfma_f32_16x16x32_bf16 v[148:151], a[56:59], v[104:107], v[148:151]
v_mfma_f32_16x16x32_bf16 v[144:147], a[28:31], v[108:111], v[144:147]
v_mfma_f32_16x16x32_bf16 v[148:151], a[60:63], v[108:111], v[148:151]
s_waitcnt lgkmcnt(0)
v_add_f32 v192, v192, v196
v_mfma_f32_16x16x32_bf16 v[152:155], a[64:67], v[80:83], 0
buffer_load_dwordx4 v[28:31], v2, s[8:11], s54 offen offset:3072 sc1
v_add_f32 v200, v200, v204
v_mfma_f32_16x16x32_bf16 v[156:159], a[96:99], v[80:83], 0
v_add_f32 v193, v193, v197
v_add_f32 v201, v201, v205
v_mfma_f32_16x16x32_bf16 v[152:155], a[68:71], v[84:87], v[152:155]
v_add_f32 v194, v194, v198
v_add_f32 v202, v202, v206
v_mfma_f32_16x16x32_bf16 v[156:159], a[100:103], v[84:87], v[156:159]
v_add_f32 v195, v195, v199
v_add_f32 v203, v203, v207
v_mfma_f32_16x16x32_bf16 v[152:155], a[72:75], v[88:91], v[152:155]
ds_write_b128 v4, v[144:147] offset:36864
v_add_f32 v192, v192, v200
v_mfma_f32_16x16x32_bf16 v[156:159], a[104:107], v[88:91], v[156:159]
buffer_load_dwordx4 v[32:35], v5, s[8:11], s54 offen offset:0 sc1
v_add_f32 v193, v193, v201
v_mfma_f32_16x16x32_bf16 v[152:155], a[76:79], v[92:95], v[152:155]
v_add_f32 v194, v194, v202
v_add_f32 v195, v195, v203
v_mfma_f32_16x16x32_bf16 v[156:159], a[108:111], v[92:95], v[156:159]
ds_write_b128 v4, v[148:151] offset:37888
v_cvt_pk_bf16_f32 v224, v192, v193
v_mfma_f32_16x16x32_bf16 v[152:155], a[80:83], v[96:99], v[152:155]
v_cvt_pk_bf16_f32 v225, v194, v195
v_add_f32 v208, v208, v212
v_mfma_f32_16x16x32_bf16 v[156:159], a[112:115], v[96:99], v[156:159]
v_add_f32 v216, v216, v220
v_add_f32 v209, v209, v213
v_mfma_f32_16x16x32_bf16 v[152:155], a[84:87], v[100:103], v[152:155]
buffer_load_dwordx4 v[36:39], v5, s[8:11], s54 offen offset:1024 sc1
v_add_f32 v217, v217, v221
v_mfma_f32_16x16x32_bf16 v[156:159], a[116:119], v[100:103], v[156:159]
v_add_f32 v210, v210, v214
v_add_f32 v218, v218, v222
v_mfma_f32_16x16x32_bf16 v[152:155], a[88:91], v[104:107], v[152:155]
v_add_f32 v211, v211, v215
v_add_f32 v219, v219, v223
v_mfma_f32_16x16x32_bf16 v[156:159], a[120:123], v[104:107], v[156:159]
v_add_f32 v208, v208, v216
v_add_f32 v209, v209, v217
v_mfma_f32_16x16x32_bf16 v[152:155], a[92:95], v[108:111], v[152:155]
v_add_f32 v210, v210, v218
v_add_f32 v211, v211, v219
v_mfma_f32_16x16x32_bf16 v[156:159], a[124:127], v[108:111], v[156:159]
buffer_load_dwordx4 v[40:43], v5, s[8:11], s54 offen offset:2048 sc1
v_cvt_pk_bf16_f32 v226, v208, v209
v_mfma_f32_16x16x32_bf16 v[160:163], v[80:83], a[128:131], 0
v_cvt_pk_bf16_f32 v227, v210, v211
buffer_store_dwordx4 v[224:227], v2, s[8:11], s57 offen offset:1024 sc1
v_mfma_f32_16x16x32_bf16 v[164:167], v[80:83], a[160:163], 0
v_mfma_f32_16x16x32_bf16 v[160:163], v[84:87], a[132:135], v[160:163]
v_mfma_f32_16x16x32_bf16 v[164:167], v[84:87], a[164:167], v[164:167]
v_mfma_f32_16x16x32_bf16 v[160:163], v[88:91], a[136:139], v[160:163]
buffer_load_dwordx4 v[44:47], v5, s[8:11], s54 offen offset:3072 sc1
ds_write_b128 v4, v[152:155] offset:38912
v_mfma_f32_16x16x32_bf16 v[164:167], v[88:91], a[168:171], v[164:167]
s_mov_b32 m0, s68
v_mfma_f32_16x16x32_bf16 v[160:163], v[92:95], a[140:143], v[160:163]
buffer_load_dwordx4 v243, s[12:15], s69 offen lds
v_mfma_f32_16x16x32_bf16 v[164:167], v[92:95], a[172:175], v[164:167]
s_add_u32 s68, s68, s70
s_add_u32 s69, s69, s71
ds_write_b128 v4, v[156:159] offset:39936
v_mfma_f32_16x16x32_bf16 v[160:163], v[96:99], a[144:147], v[160:163]
v_mfma_f32_16x16x32_bf16 v[164:167], v[96:99], a[176:179], v[164:167]
v_mfma_f32_16x16x32_bf16 v[160:163], v[100:103], a[148:151], v[160:163]
v_mfma_f32_16x16x32_bf16 v[164:167], v[100:103], a[180:183], v[164:167]
v_mfma_f32_16x16x32_bf16 v[160:163], v[104:107], a[152:155], v[160:163]
v_mfma_f32_16x16x32_bf16 v[164:167], v[104:107], a[184:187], v[164:167]
v_mfma_f32_16x16x32_bf16 v[160:163], v[108:111], a[156:159], v[160:163]
v_mfma_f32_16x16x32_bf16 v[164:167], v[108:111], a[188:191], v[164:167]
s_waitcnt vmcnt(11)
v_mfma_f32_16x16x32_bf16 v[168:171], a[0:3], v[112:115], 0
v_mfma_f32_16x16x32_bf16 v[172:175], a[32:35], v[112:115], 0
buffer_load_dwordx4 v[48:51], v2, s[8:11], s45 offen offset:0 sc1
v_mfma_f32_16x16x32_bf16 v[168:171], a[4:7], v[116:119], v[168:171]
v_mfma_f32_16x16x32_bf16 v[172:175], a[36:39], v[116:119], v[172:175]
v_mfma_f32_16x16x32_bf16 v[168:171], a[8:11], v[120:123], v[168:171]
ds_write_b128 v4, v[160:163] offset:40960
v_mfma_f32_16x16x32_bf16 v[172:175], a[40:43], v[120:123], v[172:175]
v_mfma_f32_16x16x32_bf16 v[168:171], a[12:15], v[124:127], v[168:171]
buffer_load_dwordx4 v[52:55], v2, s[8:11], s45 offen offset:1024 sc1
v_mfma_f32_16x16x32_bf16 v[172:175], a[44:47], v[124:127], v[172:175]
ds_write_b128 v4, v[164:167] offset:41984
v_mfma_f32_16x16x32_bf16 v[168:171], a[16:19], v[128:131], v[168:171]
v_mfma_f32_16x16x32_bf16 v[172:175], a[48:51], v[128:131], v[172:175]
v_mfma_f32_16x16x32_bf16 v[168:171], a[20:23], v[132:135], v[168:171]
v_mfma_f32_16x16x32_bf16 v[172:175], a[52:55], v[132:135], v[172:175]
buffer_load_dwordx4 v[56:59], v2, s[8:11], s45 offen offset:2048 sc1
v_mfma_f32_16x16x32_bf16 v[168:171], a[24:27], v[136:139], v[168:171]
v_mfma_f32_16x16x32_bf16 v[172:175], a[56:59], v[136:139], v[172:175]
v_mfma_f32_16x16x32_bf16 v[168:171], a[28:31], v[140:143], v[168:171]
v_mfma_f32_16x16x32_bf16 v[172:175], a[60:63], v[140:143], v[172:175]
v_mfma_f32_16x16x32_bf16 v[176:179], a[64:67], v[112:115], 0
buffer_load_dwordx4 v[60:63], v2, s[8:11], s45 offen offset:3072 sc1
v_mfma_f32_16x16x32_bf16 v[180:183], a[96:99], v[112:115], 0
v_mfma_f32_16x16x32_bf16 v[176:179], a[68:71], v[116:119], v[176:179]
v_mfma_f32_16x16x32_bf16 v[180:183], a[100:103], v[116:119], v[180:183]
v_mfma_f32_16x16x32_bf16 v[176:179], a[72:75], v[120:123], v[176:179]
s_nop 0
ds_write_b128 v4, v[168:171] offset:43008
v_mfma_f32_16x16x32_bf16 v[180:183], a[104:107], v[120:123], v[180:183]
buffer_load_dwordx4 v[64:67], v5, s[8:11], s45 offen offset:0 sc1
v_mfma_f32_16x16x32_bf16 v[176:179], a[76:79], v[124:127], v[176:179]
v_mfma_f32_16x16x32_bf16 v[180:183], a[108:111], v[124:127], v[180:183]
ds_write_b128 v4, v[172:175] offset:44032
v_mfma_f32_16x16x32_bf16 v[176:179], a[80:83], v[128:131], v[176:179]
v_mfma_f32_16x16x32_bf16 v[180:183], a[112:115], v[128:131], v[180:183]
v_mfma_f32_16x16x32_bf16 v[176:179], a[84:87], v[132:135], v[176:179]
buffer_load_dwordx4 v[68:71], v5, s[8:11], s45 offen offset:1024 sc1
v_mfma_f32_16x16x32_bf16 v[180:183], a[116:119], v[132:135], v[180:183]
v_mfma_f32_16x16x32_bf16 v[176:179], a[88:91], v[136:139], v[176:179]
v_mfma_f32_16x16x32_bf16 v[180:183], a[120:123], v[136:139], v[180:183]
v_mfma_f32_16x16x32_bf16 v[176:179], a[92:95], v[140:143], v[176:179]
v_mfma_f32_16x16x32_bf16 v[180:183], a[124:127], v[140:143], v[180:183]
buffer_load_dwordx4 v[72:75], v5, s[8:11], s45 offen offset:2048 sc1
v_mfma_f32_16x16x32_bf16 v[184:187], v[112:115], a[128:131], 0
v_mfma_f32_16x16x32_bf16 v[188:191], v[112:115], a[160:163], 0
v_mfma_f32_16x16x32_bf16 v[184:187], v[116:119], a[132:135], v[184:187]
v_mfma_f32_16x16x32_bf16 v[188:191], v[116:119], a[164:167], v[188:191]
v_mfma_f32_16x16x32_bf16 v[184:187], v[120:123], a[136:139], v[184:187]
buffer_load_dwordx4 v[76:79], v5, s[8:11], s45 offen offset:3072 sc1
ds_write_b128 v4, v[176:179] offset:45056
v_mfma_f32_16x16x32_bf16 v[188:191], v[120:123], a[168:171], v[188:191]
s_mov_b32 m0, s68
v_mfma_f32_16x16x32_bf16 v[184:187], v[124:127], a[140:143], v[184:187]
buffer_load_dwordx4 v243, s[12:15], s69 offen lds
v_mfma_f32_16x16x32_bf16 v[188:191], v[124:127], a[172:175], v[188:191]
s_add_u32 s68, s68, s70
s_add_u32 s69, s69, s71
ds_write_b128 v4, v[180:183] offset:46080
v_mfma_f32_16x16x32_bf16 v[184:187], v[128:131], a[144:147], v[184:187]
v_mfma_f32_16x16x32_bf16 v[188:191], v[128:131], a[176:179], v[188:191]
v_mfma_f32_16x16x32_bf16 v[184:187], v[132:135], a[148:151], v[184:187]
v_mfma_f32_16x16x32_bf16 v[188:191], v[132:135], a[180:183], v[188:191]
v_mfma_f32_16x16x32_bf16 v[184:187], v[136:139], a[152:155], v[184:187]
v_mfma_f32_16x16x32_bf16 v[188:191], v[136:139], a[184:187], v[188:191]
v_mfma_f32_16x16x32_bf16 v[184:187], v[140:143], a[156:159], v[184:187]
v_mfma_f32_16x16x32_bf16 v[188:191], v[140:143], a[188:191], v[188:191]
s_nop 6
ds_write_b128 v4, v[184:187] offset:47104
ds_write_b128 v4, v[188:191] offset:48128
s_add_u32 s55, s55, 0x40000
s_add_u32 s56, s56, 0x40000
s_add_u32 s57, s57, 0x40000
s_waitcnt vmcnt(19) lgkmcnt(0)
s_barrier
s_add_u32 s59, s59, 1
s_add_u32 s52, s52, 2
s_cmp_ge_u32 s52, s53
s_cbranch_scc1 fg1_done_w3_\sf
s_add_u32 s54, s54, 0x10000
s_add_u32 s60, s60, 0x10000
s_add_u32 s45, s54, 0x8000
s_waitcnt vmcnt(10)
v_mfma_f32_16x16x32_bf16 v[144:147], a[0:3], v[16:19], 0
ds_read_b128 v[192:195], v2 offset:53248
v_mfma_f32_16x16x32_bf16 v[148:151], a[32:35], v[16:19], 0
buffer_load_dwordx4 v[80:83], v2, s[8:11], s54 offen offset:0 sc1
v_mfma_f32_16x16x32_bf16 v[144:147], a[4:7], v[20:23], v[144:147]
ds_read_b128 v[196:199], v4 offset:16384
v_mfma_f32_16x16x32_bf16 v[148:151], a[36:39], v[20:23], v[148:151]
ds_read_b128 v[200:203], v4 offset:28672
v_mfma_f32_16x16x32_bf16 v[144:147], a[8:11], v[24:27], v[144:147]
ds_read_b128 v[204:207], v4 offset:40960
v_mfma_f32_16x16x32_bf16 v[148:151], a[40:43], v[24:27], v[148:151]
ds_read_b128 v[208:211], v2 offset:59392
v_mfma_f32_16x16x32_bf16 v[144:147], a[12:15], v[28:31], v[144:147]
buffer_load_dwordx4 v[84:87], v2, s[8:11], s54 offen offset:1024 sc1
v_mfma_f32_16x16x32_bf16 v[148:151], a[44:47], v[28:31], v[148:151]
ds_read_b128 v[212:215], v4 offset:22528
v_mfma_f32_16x16x32_bf16 v[144:147], a[16:19], v[32:35], v[144:147]
ds_read_b128 v[216:219], v4 offset:34816
v_mfma_f32_16x16x32_bf16 v[148:151], a[48:51], v[32:35], v[148:151]
ds_read_b128 v[220:223], v4 offset:47104
v_mfma_f32_16x16x32_bf16 v[144:147], a[20:23], v[36:39], v[144:147]
v_mfma_f32_16x16x32_bf16 v[148:151], a[52:55], v[36:39], v[148:151]
buffer_load_dwordx4 v[88:91], v2, s[8:11], s54 offen offset:2048 sc1
v_mfma_f32_16x16x32_bf16 v[144:147], a[24:27], v[40:43], v[144:147]
v_mfma_f32_16x16x32_bf16 v[148:151], a[56:59], v[40:43], v[148:151]
v_mfma_f32_16x16x32_bf16 v[144:147], a[28:31], v[44:47], v[144:147]
v_mfma_f32_16x16x32_bf16 v[148:151], a[60:63], v[44:47], v[148:151]
s_waitcnt lgkmcnt(0)
v_add_f32 v192, v192, v196
v_mfma_f32_16x16x32_bf16 v[152:155], a[64:67], v[16:19], 0
buffer_load_dwordx4 v[92:95], v2, s[8:11], s54 offen offset:3072 sc1
v_add_f32 v200, v200, v204
v_mfma_f32_16x16x32_bf16 v[156:159], a[96:99], v[16:19], 0
v_add_f32 v193, v193, v197
v_add_f32 v201, v201, v205
v_mfma_f32_16x16x32_bf16 v[152:155], a[68:71], v[20:23], v[152:155]
v_add_f32 v194, v194, v198
v_add_f32 v202, v202, v206
v_mfma_f32_16x16x32_bf16 v[156:159], a[100:103], v[20:23], v[156:159]
v_add_f32 v195, v195, v199
v_add_f32 v203, v203, v207
v_mfma_f32_16x16x32_bf16 v[152:155], a[72:75], v[24:27], v[152:155]
ds_write_b128 v2, v[144:147] offset:36864
v_add_f32 v192, v192, v200
v_mfma_f32_16x16x32_bf16 v[156:159], a[104:107], v[24:27], v[156:159]
buffer_load_dwordx4 v[96:99], v5, s[8:11], s54 offen offset:0 sc1
v_add_f32 v193, v193, v201
v_mfma_f32_16x16x32_bf16 v[152:155], a[76:79], v[28:31], v[152:155]
v_add_f32 v194, v194, v202
v_add_f32 v195, v195, v203
v_mfma_f32_16x16x32_bf16 v[156:159], a[108:111], v[28:31], v[156:159]
ds_write_b128 v2, v[148:151] offset:37888
v_cvt_pk_bf16_f32 v224, v192, v193
v_mfma_f32_16x16x32_bf16 v[152:155], a[80:83], v[32:35], v[152:155]
v_cvt_pk_bf16_f32 v225, v194, v195
v_add_f32 v208, v208, v212
v_mfma_f32_16x16x32_bf16 v[156:159], a[112:115], v[32:35], v[156:159]
v_add_f32 v216, v216, v220
v_add_f32 v209, v209, v213
v_mfma_f32_16x16x32_bf16 v[152:155], a[84:87], v[36:39], v[152:155]
buffer_load_dwordx4 v[100:103], v5, s[8:11], s54 offen offset:1024 sc1
v_add_f32 v217, v217, v221
v_mfma_f32_16x16x32_bf16 v[156:159], a[116:119], v[36:39], v[156:159]
v_add_f32 v210, v210, v214
v_add_f32 v218, v218, v222
v_mfma_f32_16x16x32_bf16 v[152:155], a[88:91], v[40:43], v[152:155]
v_add_f32 v211, v211, v215
v_add_f32 v219, v219, v223
v_mfma_f32_16x16x32_bf16 v[156:159], a[120:123], v[40:43], v[156:159]
v_add_f32 v208, v208, v216
v_add_f32 v209, v209, v217
v_mfma_f32_16x16x32_bf16 v[152:155], a[92:95], v[44:47], v[152:155]
v_add_f32 v210, v210, v218
v_add_f32 v211, v211, v219
v_mfma_f32_16x16x32_bf16 v[156:159], a[124:127], v[44:47], v[156:159]
buffer_load_dwordx4 v[104:107], v5, s[8:11], s54 offen offset:2048 sc1
v_cvt_pk_bf16_f32 v226, v208, v209
v_mfma_f32_16x16x32_bf16 v[160:163], v[16:19], a[128:131], 0
v_cvt_pk_bf16_f32 v227, v210, v211
buffer_store_dwordx4 v[224:227], v2, s[8:11], s57 offen offset:0 sc1
v_mfma_f32_16x16x32_bf16 v[164:167], v[16:19], a[160:163], 0
ds_read_b128 v[192:195], v2 offset:54272
v_mfma_f32_16x16x32_bf16 v[160:163], v[20:23], a[132:135], v[160:163]
ds_read_b128 v[196:199], v4 offset:17408
v_mfma_f32_16x16x32_bf16 v[164:167], v[20:23], a[164:167], v[164:167]
ds_read_b128 v[200:203], v4 offset:29696
v_mfma_f32_16x16x32_bf16 v[160:163], v[24:27], a[136:139], v[160:163]
buffer_load_dwordx4 v[108:111], v5, s[8:11], s54 offen offset:3072 sc1
ds_write_b128 v2, v[152:155] offset:38912
v_mfma_f32_16x16x32_bf16 v[164:167], v[24:27], a[168:171], v[164:167]
s_mov_b32 m0, s68
v_mfma_f32_16x16x32_bf16 v[160:163], v[28:31], a[140:143], v[160:163]
buffer_load_dwordx4 v243, s[12:15], s69 offen lds
v_mfma_f32_16x16x32_bf16 v[164:167], v[28:31], a[172:175], v[164:167]
s_add_u32 s68, s68, s70
s_add_u32 s69, s69, s71
ds_write_b128 v2, v[156:159] offset:39936
v_mfma_f32_16x16x32_bf16 v[160:163], v[32:35], a[144:147], v[160:163]
ds_read_b128 v[204:207], v4 offset:41984
v_mfma_f32_16x16x32_bf16 v[164:167], v[32:35], a[176:179], v[164:167]
ds_read_b128 v[208:211], v2 offset:60416
v_mfma_f32_16x16x32_bf16 v[160:163], v[36:39], a[148:151], v[160:163]
ds_read_b128 v[212:215], v4 offset:23552
v_mfma_f32_16x16x32_bf16 v[164:167], v[36:39], a[180:183], v[164:167]
ds_read_b128 v[216:219], v4 offset:35840
v_mfma_f32_16x16x32_bf16 v[160:163], v[40:43], a[152:155], v[160:163]
ds_read_b128 v[220:223], v4 offset:48128
v_mfma_f32_16x16x32_bf16 v[164:167], v[40:43], a[184:187], v[164:167]
v_mfma_f32_16x16x32_bf16 v[160:163], v[44:47], a[156:159], v[160:163]
v_mfma_f32_16x16x32_bf16 v[164:167], v[44:47], a[188:191], v[164:167]
s_waitcnt vmcnt(11)
v_mfma_f32_16x16x32_bf16 v[168:171], a[0:3], v[48:51], 0
v_mfma_f32_16x16x32_bf16 v[172:175], a[32:35], v[48:51], 0
buffer_load_dwordx4 v[112:115], v2, s[8:11], s45 offen offset:0 sc1
v_mfma_f32_16x16x32_bf16 v[168:171], a[4:7], v[52:55], v[168:171]
s_waitcnt lgkmcnt(0)
v_add_f32 v192, v192, v196
v_mfma_f32_16x16x32_bf16 v[172:175], a[36:39], v[52:55], v[172:175]
v_add_f32 v200, v200, v204
v_add_f32 v193, v193, v197
v_mfma_f32_16x16x32_bf16 v[168:171], a[8:11], v[56:59], v[168:171]
ds_write_b128 v2, v[160:163] offset:40960
v_add_f32 v201, v201, v205
v_mfma_f32_16x16x32_bf16 v[172:175], a[40:43], v[56:59], v[172:175]
v_add_f32 v194, v194, v198
v_add_f32 v202, v202, v206
v_mfma_f32_16x16x32_bf16 v[168:171], a[12:15], v[60:63], v[168:171]
buffer_load_dwordx4 v[116:119], v2, s[8:11], s45 offen offset:1024 sc1
v_add_f32 v195, v195, v199
v_mfma_f32_16x16x32_bf16 v[172:175], a[44:47], v[60:63], v[172:175]
ds_write_b128 v2, v[164:167] offset:41984
v_add_f32 v203, v203, v207
v_mfma_f32_16x16x32_bf16 v[168:171], a[16:19], v[64:67], v[168:171]
v_add_f32 v192, v192, v200
v_add_f32 v193, v193, v201
v_mfma_f32_16x16x32_bf16 v[172:175], a[48:51], v[64:67], v[172:175]
v_add_f32 v194, v194, v202
v_add_f32 v195, v195, v203
v_mfma_f32_16x16x32_bf16 v[168:171], a[20:23], v[68:71], v[168:171]
v_cvt_pk_bf16_f32 v228, v192, v193
v_cvt_pk_bf16_f32 v229, v194, v195
v_mfma_f32_16x16x32_bf16 v[172:175], a[52:55], v[68:71], v[172:175]
buffer_load_dwordx4 v[120:123], v2, s[8:11], s45 offen offset:2048 sc1
v_add_f32 v208, v208, v212
v_mfma_f32_16x16x32_bf16 v[168:171], a[24:27], v[72:75], v[168:171]
v_add_f32 v216, v216, v220
v_add_f32 v209, v209, v213
v_mfma_f32_16x16x32_bf16 v[172:175], a[56:59], v[72:75], v[172:175]
v_add_f32 v217, v217, v221
v_add_f32 v210, v210, v214
v_mfma_f32_16x16x32_bf16 v[168:171], a[28:31], v[76:79], v[168:171]
v_add_f32 v218, v218, v222
v_add_f32 v211, v211, v215
v_mfma_f32_16x16x32_bf16 v[172:175], a[60:63], v[76:79], v[172:175]
v_add_f32 v219, v219, v223
v_add_f32 v208, v208, v216
v_mfma_f32_16x16x32_bf16 v[176:179], a[64:67], v[48:51], 0
buffer_load_dwordx4 v[124:127], v2, s[8:11], s45 offen offset:3072 sc1
v_add_f32 v209, v209, v217
v_mfma_f32_16x16x32_bf16 v[180:183], a[96:99], v[48:51], 0
v_add_f32 v210, v210, v218
v_add_f32 v211, v211, v219
v_mfma_f32_16x16x32_bf16 v[176:179], a[68:71], v[52:55], v[176:179]
v_cvt_pk_bf16_f32 v230, v208, v209
v_cvt_pk_bf16_f32 v231, v210, v211
v_mfma_f32_16x16x32_bf16 v[180:183], a[100:103], v[52:55], v[180:183]
buffer_store_dwordx4 v[228:231], v2, s[8:11], s57 offen offset:1024 sc1
v_mfma_f32_16x16x32_bf16 v[176:179], a[72:75], v[56:59], v[176:179]
ds_write_b128 v2, v[168:171] offset:43008
v_mfma_f32_16x16x32_bf16 v[180:183], a[104:107], v[56:59], v[180:183]
buffer_load_dwordx4 v[128:131], v5, s[8:11], s45 offen offset:0 sc1
v_mfma_f32_16x16x32_bf16 v[176:179], a[76:79], v[60:63], v[176:179]
v_mfma_f32_16x16x32_bf16 v[180:183], a[108:111], v[60:63], v[180:183]
ds_write_b128 v2, v[172:175] offset:44032
v_mfma_f32_16x16x32_bf16 v[176:179], a[80:83], v[64:67], v[176:179]
v_mfma_f32_16x16x32_bf16 v[180:183], a[112:115], v[64:67], v[180:183]
v_mfma_f32_16x16x32_bf16 v[176:179], a[84:87], v[68:71], v[176:179]
buffer_load_dwordx4 v[132:135], v5, s[8:11], s45 offen offset:1024 sc1
v_mfma_f32_16x16x32_bf16 v[180:183], a[116:119], v[68:71], v[180:183]
v_mfma_f32_16x16x32_bf16 v[176:179], a[88:91], v[72:75], v[176:179]
v_mfma_f32_16x16x32_bf16 v[180:183], a[120:123], v[72:75], v[180:183]
v_mfma_f32_16x16x32_bf16 v[176:179], a[92:95], v[76:79], v[176:179]
v_mfma_f32_16x16x32_bf16 v[180:183], a[124:127], v[76:79], v[180:183]
buffer_load_dwordx4 v[136:139], v5, s[8:11], s45 offen offset:2048 sc1
v_mfma_f32_16x16x32_bf16 v[184:187], v[48:51], a[128:131], 0
v_mfma_f32_16x16x32_bf16 v[188:191], v[48:51], a[160:163], 0
v_mfma_f32_16x16x32_bf16 v[184:187], v[52:55], a[132:135], v[184:187]
v_mfma_f32_16x16x32_bf16 v[188:191], v[52:55], a[164:167], v[188:191]
v_mfma_f32_16x16x32_bf16 v[184:187], v[56:59], a[136:139], v[184:187]
buffer_load_dwordx4 v[140:143], v5, s[8:11], s45 offen offset:3072 sc1
ds_write_b128 v2, v[176:179] offset:45056
v_mfma_f32_16x16x32_bf16 v[188:191], v[56:59], a[168:171], v[188:191]
s_mov_b32 m0, s68
v_mfma_f32_16x16x32_bf16 v[184:187], v[60:63], a[140:143], v[184:187]
buffer_load_dwordx4 v243, s[12:15], s69 offen lds
v_mfma_f32_16x16x32_bf16 v[188:191], v[60:63], a[172:175], v[188:191]
s_add_u32 s68, s68, s70
s_add_u32 s69, s69, s71
ds_write_b128 v2, v[180:183] offset:46080
v_mfma_f32_16x16x32_bf16 v[184:187], v[64:67], a[144:147], v[184:187]
v_mfma_f32_16x16x32_bf16 v[188:191], v[64:67], a[176:179], v[188:191]
v_mfma_f32_16x16x32_bf16 v[184:187], v[68:71], a[148:151], v[184:187]
v_mfma_f32_16x16x32_bf16 v[188:191], v[68:71], a[180:183], v[188:191]
v_mfma_f32_16x16x32_bf16 v[184:187], v[72:75], a[152:155], v[184:187]
v_mfma_f32_16x16x32_bf16 v[188:191], v[72:75], a[184:187], v[188:191]
v_mfma_f32_16x16x32_bf16 v[184:187], v[76:79], a[156:159], v[184:187]
v_mfma_f32_16x16x32_bf16 v[188:191], v[76:79], a[188:191], v[188:191]
s_nop 6
ds_write_b128 v2, v[184:187] offset:47104
ds_write_b128 v2, v[188:191] offset:48128
s_add_u32 s55, s55, 0x40000
s_add_u32 s56, s56, 0x40000
s_add_u32 s57, s57, 0x40000
s_cmp_eq_u32 s52, 60
s_cselect_b32 s45, 0x1000000, 0
s_sub_u32 s55, s55, s45
s_sub_u32 s56, s56, s45
s_sub_u32 s57, s57, s45
s_waitcnt vmcnt(20) lgkmcnt(0)
s_barrier
s_add_u32 s59, s59, 1
s_branch fg1_loop_w3_\sf
fg1_done_w3_\sf:
ds_read_b128 v[192:195], v2 offset:53248
ds_read_b128 v[196:199], v4 offset:16384
ds_read_b128 v[200:203], v4 offset:28672
ds_read_b128 v[204:207], v4 offset:40960
ds_read_b128 v[208:211], v2 offset:59392
ds_read_b128 v[212:215], v4 offset:22528
ds_read_b128 v[216:219], v4 offset:34816
ds_read_b128 v[220:223], v4 offset:47104
s_waitcnt lgkmcnt(0)
v_add_f32 v192, v192, v196
v_add_f32 v200, v200, v204
v_add_f32 v193, v193, v197
v_add_f32 v201, v201, v205
v_add_f32 v194, v194, v198
v_add_f32 v202, v202, v206
v_add_f32 v195, v195, v199
v_add_f32 v203, v203, v207
v_add_f32 v192, v192, v200
v_add_f32 v193, v193, v201
v_add_f32 v194, v194, v202
v_add_f32 v195, v195, v203
v_cvt_pk_bf16_f32 v224, v192, v193
v_cvt_pk_bf16_f32 v225, v194, v195
v_add_f32 v208, v208, v212
v_add_f32 v216, v216, v220
v_add_f32 v209, v209, v213
v_add_f32 v217, v217, v221
v_add_f32 v210, v210, v214
v_add_f32 v218, v218, v222
v_add_f32 v211, v211, v215
v_add_f32 v219, v219, v223
v_add_f32 v208, v208, v216
v_add_f32 v209, v209, v217
v_add_f32 v210, v210, v218
v_add_f32 v211, v211, v219
v_cvt_pk_bf16_f32 v226, v208, v209
v_cvt_pk_bf16_f32 v227, v210, v211
buffer_store_dwordx4 v[224:227], v2, s[8:11], s57 offen offset:0 sc1
ds_read_b128 v[192:195], v2 offset:54272
ds_read_b128 v[196:199], v4 offset:17408
ds_read_b128 v[200:203], v4 offset:29696
ds_read_b128 v[204:207], v4 offset:41984
ds_read_b128 v[208:211], v2 offset:60416
ds_read_b128 v[212:215], v4 offset:23552
ds_read_b128 v[216:219], v4 offset:35840
ds_read_b128 v[220:223], v4 offset:48128
s_waitcnt lgkmcnt(0)
v_add_f32 v192, v192, v196
v_add_f32 v200, v200, v204
v_add_f32 v193, v193, v197
v_add_f32 v201, v201, v205
v_add_f32 v194, v194, v198
v_add_f32 v202, v202, v206
v_add_f32 v195, v195, v199
v_add_f32 v203, v203, v207
v_add_f32 v192, v192, v200
v_add_f32 v193, v193, v201
v_add_f32 v194, v194, v202
v_add_f32 v195, v195, v203
v_cvt_pk_bf16_f32 v228, v192, v193
v_cvt_pk_bf16_f32 v229, v194, v195
v_add_f32 v208, v208, v212
v_add_f32 v216, v216, v220
v_add_f32 v209, v209, v213
v_add_f32 v217, v217, v221
v_add_f32 v210, v210, v214
v_add_f32 v218, v218, v222
v_add_f32 v211, v211, v215
v_add_f32 v219, v219, v223
v_add_f32 v208, v208, v216
v_add_f32 v209, v209, v217
v_add_f32 v210, v210, v218
v_add_f32 v211, v211, v219
v_cvt_pk_bf16_f32 v230, v208, v209
v_cvt_pk_bf16_f32 v231, v210, v211
buffer_store_dwordx4 v[228:231], v2, s[8:11], s57 offen offset:1024 sc1
s_nop 1
s_branch fg1_join_\sf
g1_side_\sf:
s_cmp_eq_u32 s52, 8
s_cbranch_scc1 side_130_\sf
s_cmp_eq_u32 s52, 12
s_cbranch_scc1 side_131_\sf
s_cmp_eq_u32 s52, 16
s_cbranch_scc1 side_132_\sf
s_cmp_eq_u32 s52, 20
s_cbranch_scc1 side_133_\sf
s_cmp_eq_u32 s52, 28
s_cbranch_scc1 side_134_\sf
s_cmp_eq_u32 s52, 32
s_cbranch_scc1 side_135_\sf
s_cmp_eq_u32 s52, 36
s_cbranch_scc1 side_136_\sf
s_cmp_eq_u32 s52, 40
s_cbranch_scc1 side_137_\sf
s_cmp_eq_u32 s52, 44
s_cbranch_scc1 side_138_\sf
s_cmp_eq_u32 s52, 48
s_cbranch_scc1 side_139_\sf
s_cmp_eq_u32 s52, 56
s_cbranch_scc1 side_140_\sf
s_branch sidee_129_\sf
side_130_\sf:
v_mov_b32 v9, s91
s_nop 1
dw_141_\sf:
buffer_load_dword v8, v9, s[32:35], 0 offen sc1
s_waitcnt vmcnt(0)
v_cmp_gt_u32 vcc, 64, v8
s_cbranch_vccz dwd_142_\sf
s_add_u32 s44, s44, 1
s_cmp_lt_u32 s44, 0x40000
s_cbranch_scc1 dw_141_\sf
s_nop 0
dwd_142_\sf:
v_and_b32 v6, 15, v1
v_lshrrev_b32 v7, 4, v1
v_lshlrev_b32 v240, 5, v7
s_lshl_b32 s45, s95, 15
s_lshl_b32 s46, s94, 13
s_add_u32 s45, s45, s46
s_lshl_b32 s46, s92, 22
s_add_u32 s45, s45, s46
.if \sf == 0
s_add_u32 s45, s45, 0x6000000
.else
s_add_u32 s45, s45, 0xe000000
.endif
buffer_load_dwordx4 a[192:195], v2, s[8:11], s45 offen offset:0 sc1
buffer_load_dwordx4 a[196:199], v2, s[8:11], s45 offen offset:1024 sc1
buffer_load_dwordx4 a[200:203], v2, s[8:11], s45 offen offset:2048 sc1
buffer_load_dwordx4 a[204:207], v2, s[8:11], s45 offen offset:3072 sc1
buffer_load_dwordx4 a[208:211], v5, s[8:11], s45 offen offset:0 sc1
buffer_load_dwordx4 a[212:215], v5, s[8:11], s45 offen offset:1024 sc1
buffer_load_dwordx4 a[216:219], v5, s[8:11], s45 offen offset:2048 sc1
buffer_load_dwordx4 a[220:223], v5, s[8:11], s45 offen offset:3072 sc1
s_lshl_b32 s46, s94, 9
v_accvgpr_write_b32 a224, 0
v_accvgpr_write_b32 a225, 0
v_accvgpr_write_b32 a226, 0
v_accvgpr_write_b32 a227, 0
v_accvgpr_write_b32 a228, 0
v_accvgpr_write_b32 a229, 0
v_accvgpr_write_b32 a230, 0
v_accvgpr_write_b32 a231, 0
v_accvgpr_write_b32 a232, 0
v_accvgpr_write_b32 a233, 0
v_accvgpr_write_b32 a234, 0
v_accvgpr_write_b32 a235, 0
v_accvgpr_write_b32 a236, 0
v_accvgpr_write_b32 a237, 0
v_accvgpr_write_b32 a238, 0
v_accvgpr_write_b32 a239, 0
v_accvgpr_write_b32 a240, 0
v_accvgpr_write_b32 a241, 0
v_accvgpr_write_b32 a242, 0
v_accvgpr_write_b32 a243, 0
v_accvgpr_write_b32 a244, 0
v_accvgpr_write_b32 a245, 0
v_accvgpr_write_b32 a246, 0
v_accvgpr_write_b32 a247, 0
v_accvgpr_write_b32 a248, 0
v_accvgpr_write_b32 a249, 0
v_accvgpr_write_b32 a250, 0
v_accvgpr_write_b32 a251, 0
v_accvgpr_write_b32 a252, 0
v_accvgpr_write_b32 a253, 0
v_accvgpr_write_b32 a254, 0
v_accvgpr_write_b32 a255, 0
v_cmp_eq_u32 vcc, 0, v6
s_mov_b64 exec, vcc
buffer_load_dwordx4 a[224:227], v240, s[28:31], s46 offen offset:0
buffer_load_dwordx4 a[228:231], v240, s[28:31], s46 offen offset:16
buffer_load_dwordx4 a[232:235], v240, s[28:31], s46 offen offset:128
buffer_load_dwordx4 a[236:239], v240, s[28:31], s46 offen offset:144
buffer_load_dwordx4 a[240:243], v240, s[28:31], s46 offen offset:256
buffer_load_dwordx4 a[244:247], v240, s[28:31], s46 offen offset:272
buffer_load_dwordx4 a[248:251], v240, s[28:31], s46 offen offset:384
buffer_load_dwordx4 a[252:255], v240, s[28:31], s46 offen offset:400
s_mov_b64 exec, -1
v_cmp_eq_u32 vcc, 1, v6
s_mov_b64 exec, vcc
buffer_load_dwordx4 a[224:227], v240, s[36:39], s46 offen offset:0
buffer_load_dwordx4 a[228:231], v240, s[36:39], s46 offen offset:16
buffer_load_dwordx4 a[232:235], v240, s[36:39], s46 offen offset:128
buffer_load_dwordx4 a[236:239], v240, s[36:39], s46 offen offset:144
buffer_load_dwordx4 a[240:243], v240, s[36:39], s46 offen offset:256
buffer_load_dwordx4 a[244:247], v240, s[36:39], s46 offen offset:272
buffer_load_dwordx4 a[248:251], v240, s[36:39], s46 offen offset:384
buffer_load_dwordx4 a[252:255], v240, s[36:39], s46 offen offset:400
s_mov_b64 exec, -1
s_waitcnt vmcnt(0)
v_mfma_f32_16x16x32_bf16 v[232:235], a[224:227], a[192:195], 0
v_mfma_f32_16x16x32_bf16 v[232:235], a[228:231], a[196:199], v[232:235]
v_mfma_f32_16x16x32_bf16 v[232:235], a[232:235], a[200:203], v[232:235]
v_mfma_f32_16x16x32_bf16 v[232:235], a[236:239], a[204:207], v[232:235]
v_mfma_f32_16x16x32_bf16 v[232:235], a[240:243], a[208:211], v[232:235]
v_mfma_f32_16x16x32_bf16 v[232:235], a[244:247], a[212:215], v[232:235]
v_mfma_f32_16x16x32_bf16 v[232:235], a[248:251], a[216:219], v[232:235]
v_mfma_f32_16x16x32_bf16 v[232:235], a[252:255], a[220:223], v[232:235]
s_lshl_b32 s46, s94, 7
v_lshlrev_b32 v8, 3, v1
v_add_u32 v8, 98304, v8
v_add_u32 v9, s46, v8
s_mov_b64 exec, 0xffff
s_nop 2
ds_write_b64 v9, v[232:233]
s_waitcnt lgkmcnt(0)
s_mov_b64 exec, -1
s_barrier
s_cmp_lg_u32 s94, 2
s_cbranch_scc1 pre_done_143_\sf
s_mov_b64 exec, 0xffff
ds_read_b64 v[232:233], v8 offset:0
ds_read_b64 v[234:235], v8 offset:128
ds_read_b64 v[236:237], v8 offset:256
ds_read_b64 v[238:239], v8 offset:384
s_waitcnt lgkmcnt(0)
v_pk_add_f32 v[232:233], v[232:233], v[234:235]
v_pk_add_f32 v[236:237], v[236:237], v[238:239]
v_pk_add_f32 v[232:233], v[232:233], v[236:237]
v_cvt_pk_bf16_f32 v234, v232, v233
v_lshlrev_b32 v232, 16, v234
v_and_b32 v233, 0xffff0000, v234
v_mul_f32 v232, 0xbfb8aa3b, v232
v_exp_f32 v232, v232
s_nop 0
v_add_f32 v232, 1.0, v232
v_rcp_f32 v232, v232
s_nop 0
v_cvt_pk_bf16_f32 v232, v232, v232
v_lshlrev_b32 v232, 16, v232
s_lshl_b32 s45, s95, 6
s_add_u32 s45, s45, 0x5400000
s_add_u32 s46, s45, 8192
v_lshlrev_b32 v8, 2, v1
buffer_store_dword v232, v8, s[8:11], s45 offen sc1
buffer_store_dword v233, v8, s[8:11], s46 offen sc1
s_mov_b64 exec, -1
pre_done_143_\sf:
s_barrier
s_load_dwordx2 s[12:13], s[0:1], 72
s_waitcnt lgkmcnt(0)
s_and_b32 s13, s13, 0xffff
s_mov_b32 s14, 0x700000
s_mov_b32 s15, 0x20000
v_lshrrev_b32 v6, 2, v1
v_mul_u32_u24 v6, 7168, v6
v_and_b32 v7, 3, v1
v_lshl_add_u32 v8, v7, 4, v6
v_mov_b32 v243, v8
s_lshl_b32 s68, s94, 14
s_add_u32 s68, s68, 98304
s_mov_b32 s70, 1024
s_mov_b32 s71, 114688
s_mul_i32 s69, s94, 1835008
s_min_u32 s46, s95, 111
s_lshl_b32 s46, s46, 6
s_add_u32 s69, s69, s46
s_branch sidee_129_\sf
side_131_\sf:
s_cmp_lg_u32 s94, 0
s_cbranch_scc1 arr_144_\sf
v_mov_b32 v6, 1
v_mov_b32 v7, 152
s_mov_b64 exec, 1
buffer_atomic_add v6, v7, s[32:35], 0 offen sc1
s_mov_b64 exec, -1
arr_144_\sf:
s_branch sidee_129_\sf
side_132_\sf:
s_load_dwordx2 s[12:13], s[0:1], 88
s_waitcnt lgkmcnt(0)
s_and_b32 s13, s13, 0xffff
s_mov_b32 s14, 0x700000
s_mov_b32 s15, 0x20000
s_mov_b32 s14, 0
s_mov_b32 s68, 0x30000
s_mov_b32 s69, 0
s_mov_b32 s70, 0
s_mov_b32 s71, 0
s_cmp_ge_u32 s95, 112
s_cbranch_scc1 mb_145_\sf
v_mov_b32 v7, 152
s_nop 1
dw_146_\sf:
buffer_load_dword v6, v7, s[32:35], 0 offen sc1
s_waitcnt vmcnt(0)
v_cmp_gt_u32 vcc, 128, v6
s_cbranch_vccz dwd_147_\sf
s_sleep 1
s_add_u32 s44, s44, 1
s_cmp_lt_u32 s44, 0x40000
s_cbranch_scc1 dw_146_\sf
dwd_147_\sf:
s_mov_b32 s47, 0xffff0000
v_lshlrev_b32 v6, 7, v1
s_mov_b32 s45, 0x5402000
buffer_load_dwordx4 v[160:163], v6, s[8:11], s45 offen offset:0 sc1
buffer_load_dwordx4 v[164:167], v6, s[8:11], s45 offen offset:16 sc1
buffer_load_dwordx4 v[168:171], v6, s[8:11], s45 offen offset:32 sc1
buffer_load_dwordx4 v[172:175], v6, s[8:11], s45 offen offset:48 sc1
buffer_load_dwordx4 v[176:179], v6, s[8:11], s45 offen offset:64 sc1
buffer_load_dwordx4 v[180:183], v6, s[8:11], s45 offen offset:80 sc1
buffer_load_dwordx4 v[184:187], v6, s[8:11], s45 offen offset:96 sc1
buffer_load_dwordx4 v[188:191], v6, s[8:11], s45 offen offset:112 sc1
v_lshlrev_b32 v7, 5, v1
v_sub_u32 v7, 0xffff, v7
s_waitcnt vmcnt(0)
v_ashrrev_i32 v8, 31, v160
v_or_b32 v8, 0x80000000, v8
v_cmp_u_f32 vcc, v160, v160
v_xor_b32 v160, v160, v8
v_subrev_u32 v9, 0, v7
v_cndmask_b32 v160, v160, 0, vcc
v_and_or_b32 v160, v160, s47, v9
v_ashrrev_i32 v8, 31, v161
v_or_b32 v8, 0x80000000, v8
v_cmp_u_f32 vcc, v161, v161
v_xor_b32 v161, v161, v8
v_subrev_u32 v9, 1, v7
v_cndmask_b32 v161, v161, 0, vcc
v_and_or_b32 v161, v161, s47, v9
v_ashrrev_i32 v8, 31, v162
v_or_b32 v8, 0x80000000, v8
v_cmp_u_f32 vcc, v162, v162
v_xor_b32 v162, v162, v8
v_subrev_u32 v9, 2, v7
v_cndmask_b32 v162, v162, 0, vcc
v_and_or_b32 v162, v162, s47, v9
v_ashrrev_i32 v8, 31, v163
v_or_b32 v8, 0x80000000, v8
v_cmp_u_f32 vcc, v163, v163
v_xor_b32 v163, v163, v8
v_subrev_u32 v9, 3, v7
v_cndmask_b32 v163, v163, 0, vcc
v_and_or_b32 v163, v163, s47, v9
v_ashrrev_i32 v8, 31, v164
v_or_b32 v8, 0x80000000, v8
v_cmp_u_f32 vcc, v164, v164
v_xor_b32 v164, v164, v8
v_subrev_u32 v9, 4, v7
v_cndmask_b32 v164, v164, 0, vcc
v_and_or_b32 v164, v164, s47, v9
v_ashrrev_i32 v8, 31, v165
v_or_b32 v8, 0x80000000, v8
v_cmp_u_f32 vcc, v165, v165
v_xor_b32 v165, v165, v8
v_subrev_u32 v9, 5, v7
v_cndmask_b32 v165, v165, 0, vcc
v_and_or_b32 v165, v165, s47, v9
v_ashrrev_i32 v8, 31, v166
v_or_b32 v8, 0x80000000, v8
v_cmp_u_f32 vcc, v166, v166
v_xor_b32 v166, v166, v8
v_subrev_u32 v9, 6, v7
v_cndmask_b32 v166, v166, 0, vcc
v_and_or_b32 v166, v166, s47, v9
v_ashrrev_i32 v8, 31, v167
v_or_b32 v8, 0x80000000, v8
v_cmp_u_f32 vcc, v167, v167
v_xor_b32 v167, v167, v8
v_subrev_u32 v9, 7, v7
v_cndmask_b32 v167, v167, 0, vcc
v_and_or_b32 v167, v167, s47, v9
v_ashrrev_i32 v8, 31, v168
v_or_b32 v8, 0x80000000, v8
v_cmp_u_f32 vcc, v168, v168
v_xor_b32 v168, v168, v8
v_subrev_u32 v9, 8, v7
v_cndmask_b32 v168, v168, 0, vcc
v_and_or_b32 v168, v168, s47, v9
v_ashrrev_i32 v8, 31, v169
v_or_b32 v8, 0x80000000, v8
v_cmp_u_f32 vcc, v169, v169
v_xor_b32 v169, v169, v8
v_subrev_u32 v9, 9, v7
v_cndmask_b32 v169, v169, 0, vcc
v_and_or_b32 v169, v169, s47, v9
v_ashrrev_i32 v8, 31, v170
v_or_b32 v8, 0x80000000, v8
v_cmp_u_f32 vcc, v170, v170
v_xor_b32 v170, v170, v8
v_subrev_u32 v9, 10, v7
v_cndmask_b32 v170, v170, 0, vcc
v_and_or_b32 v170, v170, s47, v9
v_ashrrev_i32 v8, 31, v171
v_or_b32 v8, 0x80000000, v8
v_cmp_u_f32 vcc, v171, v171
v_xor_b32 v171, v171, v8
v_subrev_u32 v9, 11, v7
v_cndmask_b32 v171, v171, 0, vcc
v_and_or_b32 v171, v171, s47, v9
v_ashrrev_i32 v8, 31, v172
v_or_b32 v8, 0x80000000, v8
v_cmp_u_f32 vcc, v172, v172
v_xor_b32 v172, v172, v8
v_subrev_u32 v9, 12, v7
v_cndmask_b32 v172, v172, 0, vcc
v_and_or_b32 v172, v172, s47, v9
v_ashrrev_i32 v8, 31, v173
v_or_b32 v8, 0x80000000, v8
v_cmp_u_f32 vcc, v173, v173
v_xor_b32 v173, v173, v8
v_subrev_u32 v9, 13, v7
v_cndmask_b32 v173, v173, 0, vcc
v_and_or_b32 v173, v173, s47, v9
v_ashrrev_i32 v8, 31, v174
v_or_b32 v8, 0x80000000, v8
v_cmp_u_f32 vcc, v174, v174
v_xor_b32 v174, v174, v8
v_subrev_u32 v9, 14, v7
v_cndmask_b32 v174, v174, 0, vcc
v_and_or_b32 v174, v174, s47, v9
v_ashrrev_i32 v8, 31, v175
v_or_b32 v8, 0x80000000, v8
v_cmp_u_f32 vcc, v175, v175
v_xor_b32 v175, v175, v8
v_subrev_u32 v9, 15, v7
v_cndmask_b32 v175, v175, 0, vcc
v_and_or_b32 v175, v175, s47, v9
v_ashrrev_i32 v8, 31, v176
v_or_b32 v8, 0x80000000, v8
v_cmp_u_f32 vcc, v176, v176
v_xor_b32 v176, v176, v8
v_subrev_u32 v9, 16, v7
v_cndmask_b32 v176, v176, 0, vcc
v_and_or_b32 v176, v176, s47, v9
v_ashrrev_i32 v8, 31, v177
v_or_b32 v8, 0x80000000, v8
v_cmp_u_f32 vcc, v177, v177
v_xor_b32 v177, v177, v8
v_subrev_u32 v9, 17, v7
v_cndmask_b32 v177, v177, 0, vcc
v_and_or_b32 v177, v177, s47, v9
v_ashrrev_i32 v8, 31, v178
v_or_b32 v8, 0x80000000, v8
v_cmp_u_f32 vcc, v178, v178
v_xor_b32 v178, v178, v8
v_subrev_u32 v9, 18, v7
v_cndmask_b32 v178, v178, 0, vcc
v_and_or_b32 v178, v178, s47, v9
v_ashrrev_i32 v8, 31, v179
v_or_b32 v8, 0x80000000, v8
v_cmp_u_f32 vcc, v179, v179
v_xor_b32 v179, v179, v8
v_subrev_u32 v9, 19, v7
v_cndmask_b32 v179, v179, 0, vcc
v_and_or_b32 v179, v179, s47, v9
v_ashrrev_i32 v8, 31, v180
v_or_b32 v8, 0x80000000, v8
v_cmp_u_f32 vcc, v180, v180
v_xor_b32 v180, v180, v8
v_subrev_u32 v9, 20, v7
v_cndmask_b32 v180, v180, 0, vcc
v_and_or_b32 v180, v180, s47, v9
v_ashrrev_i32 v8, 31, v181
v_or_b32 v8, 0x80000000, v8
v_cmp_u_f32 vcc, v181, v181
v_xor_b32 v181, v181, v8
v_subrev_u32 v9, 21, v7
v_cndmask_b32 v181, v181, 0, vcc
v_and_or_b32 v181, v181, s47, v9
v_ashrrev_i32 v8, 31, v182
v_or_b32 v8, 0x80000000, v8
v_cmp_u_f32 vcc, v182, v182
v_xor_b32 v182, v182, v8
v_subrev_u32 v9, 22, v7
v_cndmask_b32 v182, v182, 0, vcc
v_and_or_b32 v182, v182, s47, v9
v_ashrrev_i32 v8, 31, v183
v_or_b32 v8, 0x80000000, v8
v_cmp_u_f32 vcc, v183, v183
v_xor_b32 v183, v183, v8
v_subrev_u32 v9, 23, v7
v_cndmask_b32 v183, v183, 0, vcc
v_and_or_b32 v183, v183, s47, v9
v_ashrrev_i32 v8, 31, v184
v_or_b32 v8, 0x80000000, v8
v_cmp_u_f32 vcc, v184, v184
v_xor_b32 v184, v184, v8
v_subrev_u32 v9, 24, v7
v_cndmask_b32 v184, v184, 0, vcc
v_and_or_b32 v184, v184, s47, v9
v_ashrrev_i32 v8, 31, v185
v_or_b32 v8, 0x80000000, v8
v_cmp_u_f32 vcc, v185, v185
v_xor_b32 v185, v185, v8
v_subrev_u32 v9, 25, v7
v_cndmask_b32 v185, v185, 0, vcc
v_and_or_b32 v185, v185, s47, v9
v_ashrrev_i32 v8, 31, v186
v_or_b32 v8, 0x80000000, v8
v_cmp_u_f32 vcc, v186, v186
v_xor_b32 v186, v186, v8
v_subrev_u32 v9, 26, v7
v_cndmask_b32 v186, v186, 0, vcc
v_and_or_b32 v186, v186, s47, v9
v_ashrrev_i32 v8, 31, v187
v_or_b32 v8, 0x80000000, v8
v_cmp_u_f32 vcc, v187, v187
v_xor_b32 v187, v187, v8
v_subrev_u32 v9, 27, v7
v_cndmask_b32 v187, v187, 0, vcc
v_and_or_b32 v187, v187, s47, v9
v_ashrrev_i32 v8, 31, v188
v_or_b32 v8, 0x80000000, v8
v_cmp_u_f32 vcc, v188, v188
v_xor_b32 v188, v188, v8
v_subrev_u32 v9, 28, v7
v_cndmask_b32 v188, v188, 0, vcc
v_and_or_b32 v188, v188, s47, v9
v_ashrrev_i32 v8, 31, v189
v_or_b32 v8, 0x80000000, v8
v_cmp_u_f32 vcc, v189, v189
v_xor_b32 v189, v189, v8
v_subrev_u32 v9, 29, v7
v_cndmask_b32 v189, v189, 0, vcc
v_and_or_b32 v189, v189, s47, v9
v_ashrrev_i32 v8, 31, v190
v_or_b32 v8, 0x80000000, v8
v_cmp_u_f32 vcc, v190, v190
v_xor_b32 v190, v190, v8
v_subrev_u32 v9, 30, v7
v_cndmask_b32 v190, v190, 0, vcc
v_and_or_b32 v190, v190, s47, v9
v_ashrrev_i32 v8, 31, v191
v_or_b32 v8, 0x80000000, v8
v_cmp_u_f32 vcc, v191, v191
v_xor_b32 v191, v191, v8
v_subrev_u32 v9, 31, v7
v_cndmask_b32 v191, v191, 0, vcc
v_and_or_b32 v191, v191, s47, v9
v_max3_u32 v144, v160, v161, v162
v_max3_u32 v144, v144, v163, v164
v_max3_u32 v144, v144, v165, v166
v_max3_u32 v144, v144, v167, v168
v_max3_u32 v144, v144, v169, v170
v_max3_u32 v144, v144, v171, v172
v_max3_u32 v144, v144, v173, v174
v_max3_u32 v144, v144, v175, v176
v_max3_u32 v144, v144, v177, v178
v_max3_u32 v144, v144, v179, v180
v_max3_u32 v144, v144, v181, v182
v_max3_u32 v144, v144, v183, v184
v_max3_u32 v144, v144, v185, v186
v_max3_u32 v144, v144, v187, v188
v_max3_u32 v144, v144, v189, v190
v_max_u32 v144, v144, v191
s_nop 1
v_max_u32_dpp v144, v144, v144 row_ror:1 row_mask:0xf bank_mask:0xf
s_nop 1
v_max_u32_dpp v144, v144, v144 row_ror:2 row_mask:0xf bank_mask:0xf
s_nop 1
v_max_u32_dpp v144, v144, v144 row_ror:4 row_mask:0xf bank_mask:0xf
s_nop 1
v_max_u32_dpp v144, v144, v144 row_ror:8 row_mask:0xf bank_mask:0xf
v_mov_b32 v145, v144
s_nop 1
v_permlane16_swap_b32 v144, v145
v_max_u32 v144, v144, v145
v_mov_b32 v145, v144
s_nop 1
v_permlane32_swap_b32 v144, v145
v_max_u32 v144, v144, v145
s_nop 0
v_readfirstlane_b32 s66, v144
v_cmp_eq_u32 vcc, v160, v144
s_nop 1
v_cndmask_b32 v160, v160, 0, vcc
v_cmp_eq_u32 vcc, v161, v144
s_nop 1
v_cndmask_b32 v161, v161, 0, vcc
v_cmp_eq_u32 vcc, v162, v144
s_nop 1
v_cndmask_b32 v162, v162, 0, vcc
v_cmp_eq_u32 vcc, v163, v144
s_nop 1
v_cndmask_b32 v163, v163, 0, vcc
v_cmp_eq_u32 vcc, v164, v144
s_nop 1
v_cndmask_b32 v164, v164, 0, vcc
v_cmp_eq_u32 vcc, v165, v144
s_nop 1
v_cndmask_b32 v165, v165, 0, vcc
v_cmp_eq_u32 vcc, v166, v144
s_nop 1
v_cndmask_b32 v166, v166, 0, vcc
v_cmp_eq_u32 vcc, v167, v144
s_nop 1
v_cndmask_b32 v167, v167, 0, vcc
v_cmp_eq_u32 vcc, v168, v144
s_nop 1
v_cndmask_b32 v168, v168, 0, vcc
v_cmp_eq_u32 vcc, v169, v144
s_nop 1
v_cndmask_b32 v169, v169, 0, vcc
v_cmp_eq_u32 vcc, v170, v144
s_nop 1
v_cndmask_b32 v170, v170, 0, vcc
v_cmp_eq_u32 vcc, v171, v144
s_nop 1
v_cndmask_b32 v171, v171, 0, vcc
v_cmp_eq_u32 vcc, v172, v144
s_nop 1
v_cndmask_b32 v172, v172, 0, vcc
v_cmp_eq_u32 vcc, v173, v144
s_nop 1
v_cndmask_b32 v173, v173, 0, vcc
v_cmp_eq_u32 vcc, v174, v144
s_nop 1
v_cndmask_b32 v174, v174, 0, vcc
v_cmp_eq_u32 vcc, v175, v144
s_nop 1
v_cndmask_b32 v175, v175, 0, vcc
v_cmp_eq_u32 vcc, v176, v144
s_nop 1
v_cndmask_b32 v176, v176, 0, vcc
v_cmp_eq_u32 vcc, v177, v144
s_nop 1
v_cndmask_b32 v177, v177, 0, vcc
v_cmp_eq_u32 vcc, v178, v144
s_nop 1
v_cndmask_b32 v178, v178, 0, vcc
v_cmp_eq_u32 vcc, v179, v144
s_nop 1
v_cndmask_b32 v179, v179, 0, vcc
v_cmp_eq_u32 vcc, v180, v144
s_nop 1
v_cndmask_b32 v180, v180, 0, vcc
v_cmp_eq_u32 vcc, v181, v144
s_nop 1
v_cndmask_b32 v181, v181, 0, vcc
v_cmp_eq_u32 vcc, v182, v144
s_nop 1
v_cndmask_b32 v182, v182, 0, vcc
v_cmp_eq_u32 vcc, v183, v144
s_nop 1
v_cndmask_b32 v183, v183, 0, vcc
v_cmp_eq_u32 vcc, v184, v144
s_nop 1
v_cndmask_b32 v184, v184, 0, vcc
v_cmp_eq_u32 vcc, v185, v144
s_nop 1
v_cndmask_b32 v185, v185, 0, vcc
v_cmp_eq_u32 vcc, v186, v144
s_nop 1
v_cndmask_b32 v186, v186, 0, vcc
v_cmp_eq_u32 vcc, v187, v144
s_nop 1
v_cndmask_b32 v187, v187, 0, vcc
v_cmp_eq_u32 vcc, v188, v144
s_nop 1
v_cndmask_b32 v188, v188, 0, vcc
v_cmp_eq_u32 vcc, v189, v144
s_nop 1
v_cndmask_b32 v189, v189, 0, vcc
v_cmp_eq_u32 vcc, v190, v144
s_nop 1
v_cndmask_b32 v190, v190, 0, vcc
v_cmp_eq_u32 vcc, v191, v144
s_nop 1
v_cndmask_b32 v191, v191, 0, vcc
v_max3_u32 v144, v160, v161, v162
v_max3_u32 v144, v144, v163, v164
v_max3_u32 v144, v144, v165, v166
v_max3_u32 v144, v144, v167, v168
v_max3_u32 v144, v144, v169, v170
v_max3_u32 v144, v144, v171, v172
v_max3_u32 v144, v144, v173, v174
v_max3_u32 v144, v144, v175, v176
v_max3_u32 v144, v144, v177, v178
v_max3_u32 v144, v144, v179, v180
v_max3_u32 v144, v144, v181, v182
v_max3_u32 v144, v144, v183, v184
v_max3_u32 v144, v144, v185, v186
v_max3_u32 v144, v144, v187, v188
v_max3_u32 v144, v144, v189, v190
v_max_u32 v144, v144, v191
s_nop 1
v_max_u32_dpp v144, v144, v144 row_ror:1 row_mask:0xf bank_mask:0xf
s_nop 1
v_max_u32_dpp v144, v144, v144 row_ror:2 row_mask:0xf bank_mask:0xf
s_nop 1
v_max_u32_dpp v144, v144, v144 row_ror:4 row_mask:0xf bank_mask:0xf
s_nop 1
v_max_u32_dpp v144, v144, v144 row_ror:8 row_mask:0xf bank_mask:0xf
v_mov_b32 v145, v144
s_nop 1
v_permlane16_swap_b32 v144, v145
v_max_u32 v144, v144, v145
v_mov_b32 v145, v144
s_nop 1
v_permlane32_swap_b32 v144, v145
v_max_u32 v144, v144, v145
s_nop 0
v_readfirstlane_b32 s67, v144
s_and_b32 s45, s66, 0xffff
s_sub_u32 s45, 0xffff, s45
s_and_b32 s46, s67, 0xffff
s_sub_u32 s46, 0xffff, s46
v_and_b32 v6, 1, v1
v_cmp_eq_u32 vcc, 1, v6
v_mov_b32 v7, s45
v_mov_b32 v8, s46
v_cndmask_b32 v7, v7, v8, vcc
v_lshrrev_b32 v8, 4, v1
v_lshlrev_b32 v8, 5, v8
v_lshl_add_u32 v10, v7, 11, v8
s_lshl_b32 s47, s94, 9
buffer_load_dwordx4 a[200:203], v10, s[24:27], s47 offen offset:0
buffer_load_dwordx4 a[204:207], v10, s[24:27], s47 offen offset:16
buffer_load_dwordx4 a[208:211], v10, s[24:27], s47 offen offset:128
buffer_load_dwordx4 a[212:215], v10, s[24:27], s47 offen offset:144
buffer_load_dwordx4 a[216:219], v10, s[24:27], s47 offen offset:256
buffer_load_dwordx4 a[220:223], v10, s[24:27], s47 offen offset:272
buffer_load_dwordx4 a[224:227], v10, s[24:27], s47 offen offset:384
buffer_load_dwordx4 a[228:231], v10, s[24:27], s47 offen offset:400
s_or_b32 s47, s95, s94
s_cmp_lg_u32 s47, 0
s_cbranch_scc1 m1np_148_\sf
v_mov_b32 v144, s45
v_mov_b32 v145, s46
s_and_b32 s47, s66, 0xffff0000
s_xor_b32 s48, s47, 0x80000000
s_not_b32 s47, s47
s_and_b32 s47, s47, 0xffff0000
s_bitcmp1_b32 s66, 31
s_cselect_b32 s47, s48, s47
v_mov_b32 v146, s47
v_mul_f32 v146, 0xbfb8aa3b, v146
v_exp_f32 v146, v146
s_nop 0
v_add_f32 v146, 1.0, v146
v_rcp_f32 v146, v146
s_nop 0
v_cvt_pk_bf16_f32 v146, v146, v146
v_lshlrev_b32 v146, 16, v146
s_and_b32 s47, s67, 0xffff0000
s_xor_b32 s48, s47, 0x80000000
s_not_b32 s47, s47
s_and_b32 s47, s47, 0xffff0000
s_bitcmp1_b32 s67, 31
s_cselect_b32 s47, s48, s47
v_mov_b32 v147, s47
v_mul_f32 v147, 0xbfb8aa3b, v147
v_exp_f32 v147, v147
s_nop 0
v_add_f32 v147, 1.0, v147
v_rcp_f32 v147, v147
s_nop 0
v_cvt_pk_bf16_f32 v147, v147, v147
v_lshlrev_b32 v147, 16, v147
v_mov_b32 v148, 0
s_mov_b32 s47, 0x541c000
s_mov_b64 exec, 1
buffer_store_dwordx4 v[144:147], v148, s[8:11], s47 offen sc1
s_mov_b64 exec, -1
s_nop 0
m1np_148_\sf:
mb_145_\sf:
s_branch sidee_129_\sf
side_133_\sf:
s_cmp_ge_u32 s95, 112
s_cbranch_scc1 mg_149_\sf
s_lshl_b32 s45, s94, 14
s_add_u32 s45, s45, 98304
v_add_u32 v12, s45, v2
v_lshrrev_b32 v6, 4, v1
v_bfe_u32 v7, v1, 2, 2
v_and_b32 v8, 3, v1
v_lshl_add_u32 v9, v6, 4, v7
v_lshlrev_b32 v9, 6, v9
v_lshl_add_u32 v9, v8, 3, v9
v_add_u32 v13, s45, v9
v_accvgpr_read_b32 v160, a200
v_accvgpr_read_b32 v161, a201
v_accvgpr_read_b32 v162, a202
v_accvgpr_read_b32 v163, a203
v_accvgpr_read_b32 v164, a204
v_accvgpr_read_b32 v165, a205
v_accvgpr_read_b32 v166, a206
v_accvgpr_read_b32 v167, a207
v_accvgpr_read_b32 v168, a208
v_accvgpr_read_b32 v169, a209
v_accvgpr_read_b32 v170, a210
v_accvgpr_read_b32 v171, a211
v_accvgpr_read_b32 v172, a212
v_accvgpr_read_b32 v173, a213
v_accvgpr_read_b32 v174, a214
v_accvgpr_read_b32 v175, a215
v_accvgpr_read_b32 v176, a216
v_accvgpr_read_b32 v177, a217
v_accvgpr_read_b32 v178, a218
v_accvgpr_read_b32 v179, a219
v_accvgpr_read_b32 v180, a220
v_accvgpr_read_b32 v181, a221
v_accvgpr_read_b32 v182, a222
v_accvgpr_read_b32 v183, a223
v_accvgpr_read_b32 v184, a224
v_accvgpr_read_b32 v185, a225
v_accvgpr_read_b32 v186, a226
v_accvgpr_read_b32 v187, a227
v_accvgpr_read_b32 v188, a228
v_accvgpr_read_b32 v189, a229
v_accvgpr_read_b32 v190, a230
v_accvgpr_read_b32 v191, a231
ds_read_b64_tr_b16 v[192:193], v13 offset:0
ds_read_b64_tr_b16 v[194:195], v13 offset:256
ds_read_b64_tr_b16 v[196:197], v13 offset:512
ds_read_b64_tr_b16 v[198:199], v13 offset:768
ds_read_b64_tr_b16 v[200:201], v13 offset:4096
ds_read_b64_tr_b16 v[202:203], v13 offset:4352
ds_read_b64_tr_b16 v[204:205], v13 offset:4608
ds_read_b64_tr_b16 v[206:207], v13 offset:4864
ds_read_b64_tr_b16 v[208:209], v13 offset:8192
ds_read_b64_tr_b16 v[210:211], v13 offset:8448
ds_read_b64_tr_b16 v[212:213], v13 offset:8704
ds_read_b64_tr_b16 v[214:215], v13 offset:8960
ds_read_b64_tr_b16 v[216:217], v13 offset:12288
ds_read_b64_tr_b16 v[218:219], v13 offset:12544
ds_read_b64_tr_b16 v[220:221], v13 offset:12800
ds_read_b64_tr_b16 v[222:223], v13 offset:13056
s_waitcnt lgkmcnt(0)
v_mfma_f32_16x16x32_bf16 v[224:227], v[192:195], v[160:163], 0
v_mfma_f32_16x16x32_bf16 v[224:227], v[196:199], v[164:167], v[224:227]
v_mfma_f32_16x16x32_bf16 v[224:227], v[200:203], v[168:171], v[224:227]
v_mfma_f32_16x16x32_bf16 v[224:227], v[204:207], v[172:175], v[224:227]
v_mfma_f32_16x16x32_bf16 v[224:227], v[208:211], v[176:179], v[224:227]
v_mfma_f32_16x16x32_bf16 v[224:227], v[212:215], v[180:183], v[224:227]
v_mfma_f32_16x16x32_bf16 v[224:227], v[216:219], v[184:187], v[224:227]
v_mfma_f32_16x16x32_bf16 v[224:227], v[220:223], v[188:191], v[224:227]
ds_read_b64_tr_b16 v[192:193], v13 offset:32
ds_read_b64_tr_b16 v[194:195], v13 offset:288
ds_read_b64_tr_b16 v[196:197], v13 offset:544
ds_read_b64_tr_b16 v[198:199], v13 offset:800
ds_read_b64_tr_b16 v[200:201], v13 offset:4128
ds_read_b64_tr_b16 v[202:203], v13 offset:4384
ds_read_b64_tr_b16 v[204:205], v13 offset:4640
ds_read_b64_tr_b16 v[206:207], v13 offset:4896
ds_read_b64_tr_b16 v[208:209], v13 offset:8224
ds_read_b64_tr_b16 v[210:211], v13 offset:8480
ds_read_b64_tr_b16 v[212:213], v13 offset:8736
ds_read_b64_tr_b16 v[214:215], v13 offset:8992
ds_read_b64_tr_b16 v[216:217], v13 offset:12320
ds_read_b64_tr_b16 v[218:219], v13 offset:12576
ds_read_b64_tr_b16 v[220:221], v13 offset:12832
ds_read_b64_tr_b16 v[222:223], v13 offset:13088
s_waitcnt lgkmcnt(0)
v_mfma_f32_16x16x32_bf16 v[228:231], v[192:195], v[160:163], 0
v_mfma_f32_16x16x32_bf16 v[228:231], v[196:199], v[164:167], v[228:231]
v_mfma_f32_16x16x32_bf16 v[228:231], v[200:203], v[168:171], v[228:231]
v_mfma_f32_16x16x32_bf16 v[228:231], v[204:207], v[172:175], v[228:231]
v_mfma_f32_16x16x32_bf16 v[228:231], v[208:211], v[176:179], v[228:231]
v_mfma_f32_16x16x32_bf16 v[228:231], v[212:215], v[180:183], v[228:231]
v_mfma_f32_16x16x32_bf16 v[228:231], v[216:219], v[184:187], v[228:231]
v_mfma_f32_16x16x32_bf16 v[228:231], v[220:223], v[188:191], v[228:231]
v_accvgpr_write_b32 a192, v224
v_accvgpr_write_b32 a193, v225
v_accvgpr_write_b32 a194, v226
v_accvgpr_write_b32 a195, v227
s_nop 3
v_accvgpr_write_b32 a196, v228
v_accvgpr_write_b32 a197, v229
v_accvgpr_write_b32 a198, v230
v_accvgpr_write_b32 a199, v231
s_nop 1
mg_149_\sf:
s_load_dwordx2 s[12:13], s[0:1], 80
s_waitcnt lgkmcnt(0)
s_and_b32 s13, s13, 0xffff
s_mov_b32 s14, 0x700000
s_mov_b32 s15, 0x20000
v_lshrrev_b32 v6, 2, v1
v_mul_u32_u24 v6, 7168, v6
v_and_b32 v7, 3, v1
v_lshl_add_u32 v8, v7, 4, v6
v_mov_b32 v243, v8
s_lshl_b32 s68, s94, 14
s_add_u32 s68, s68, 98304
s_mov_b32 s70, 1024
s_mov_b32 s71, 114688
s_mul_i32 s69, s94, 1835008
s_min_u32 s46, s95, 111
s_lshl_b32 s46, s46, 6
s_add_u32 s69, s69, s46
s_branch sidee_129_\sf
side_134_\sf:
s_cmp_ge_u32 s95, 112
s_cbranch_scc1 mu_150_\sf
s_lshl_b32 s45, s94, 14
s_add_u32 s45, s45, 98304
v_add_u32 v12, s45, v2
v_lshrrev_b32 v6, 4, v1
v_bfe_u32 v7, v1, 2, 2
v_and_b32 v8, 3, v1
v_lshl_add_u32 v9, v6, 4, v7
v_lshlrev_b32 v9, 6, v9
v_lshl_add_u32 v9, v8, 3, v9
v_add_u32 v13, s45, v9
v_accvgpr_read_b32 v160, a200
v_accvgpr_read_b32 v161, a201
v_accvgpr_read_b32 v162, a202
v_accvgpr_read_b32 v163, a203
v_accvgpr_read_b32 v164, a204
v_accvgpr_read_b32 v165, a205
v_accvgpr_read_b32 v166, a206
v_accvgpr_read_b32 v167, a207
v_accvgpr_read_b32 v168, a208
v_accvgpr_read_b32 v169, a209
v_accvgpr_read_b32 v170, a210
v_accvgpr_read_b32 v171, a211
v_accvgpr_read_b32 v172, a212
v_accvgpr_read_b32 v173, a213
v_accvgpr_read_b32 v174, a214
v_accvgpr_read_b32 v175, a215
v_accvgpr_read_b32 v176, a216
v_accvgpr_read_b32 v177, a217
v_accvgpr_read_b32 v178, a218
v_accvgpr_read_b32 v179, a219
v_accvgpr_read_b32 v180, a220
v_accvgpr_read_b32 v181, a221
v_accvgpr_read_b32 v182, a222
v_accvgpr_read_b32 v183, a223
v_accvgpr_read_b32 v184, a224
v_accvgpr_read_b32 v185, a225
v_accvgpr_read_b32 v186, a226
v_accvgpr_read_b32 v187, a227
v_accvgpr_read_b32 v188, a228
v_accvgpr_read_b32 v189, a229
v_accvgpr_read_b32 v190, a230
v_accvgpr_read_b32 v191, a231
v_accvgpr_read_b32 v224, a192
v_accvgpr_read_b32 v225, a193
v_accvgpr_read_b32 v226, a194
v_accvgpr_read_b32 v227, a195
v_accvgpr_read_b32 v228, a196
v_accvgpr_read_b32 v229, a197
v_accvgpr_read_b32 v230, a198
v_accvgpr_read_b32 v231, a199
s_waitcnt vmcnt(0)
ds_read_b64_tr_b16 v[192:193], v13 offset:0
ds_read_b64_tr_b16 v[194:195], v13 offset:256
ds_read_b64_tr_b16 v[196:197], v13 offset:512
ds_read_b64_tr_b16 v[198:199], v13 offset:768
ds_read_b64_tr_b16 v[200:201], v13 offset:4096
ds_read_b64_tr_b16 v[202:203], v13 offset:4352
ds_read_b64_tr_b16 v[204:205], v13 offset:4608
ds_read_b64_tr_b16 v[206:207], v13 offset:4864
ds_read_b64_tr_b16 v[208:209], v13 offset:8192
ds_read_b64_tr_b16 v[210:211], v13 offset:8448
ds_read_b64_tr_b16 v[212:213], v13 offset:8704
ds_read_b64_tr_b16 v[214:215], v13 offset:8960
ds_read_b64_tr_b16 v[216:217], v13 offset:12288
ds_read_b64_tr_b16 v[218:219], v13 offset:12544
ds_read_b64_tr_b16 v[220:221], v13 offset:12800
ds_read_b64_tr_b16 v[222:223], v13 offset:13056
s_waitcnt lgkmcnt(0)
v_mfma_f32_16x16x32_bf16 v[232:235], v[192:195], v[160:163], 0
v_mfma_f32_16x16x32_bf16 v[232:235], v[196:199], v[164:167], v[232:235]
v_mfma_f32_16x16x32_bf16 v[232:235], v[200:203], v[168:171], v[232:235]
v_mfma_f32_16x16x32_bf16 v[232:235], v[204:207], v[172:175], v[232:235]
v_mfma_f32_16x16x32_bf16 v[232:235], v[208:211], v[176:179], v[232:235]
v_mfma_f32_16x16x32_bf16 v[232:235], v[212:215], v[180:183], v[232:235]
v_mfma_f32_16x16x32_bf16 v[232:235], v[216:219], v[184:187], v[232:235]
v_mfma_f32_16x16x32_bf16 v[232:235], v[220:223], v[188:191], v[232:235]
ds_read_b64_tr_b16 v[192:193], v13 offset:32
ds_read_b64_tr_b16 v[194:195], v13 offset:288
ds_read_b64_tr_b16 v[196:197], v13 offset:544
ds_read_b64_tr_b16 v[198:199], v13 offset:800
ds_read_b64_tr_b16 v[200:201], v13 offset:4128
ds_read_b64_tr_b16 v[202:203], v13 offset:4384
ds_read_b64_tr_b16 v[204:205], v13 offset:4640
ds_read_b64_tr_b16 v[206:207], v13 offset:4896
ds_read_b64_tr_b16 v[208:209], v13 offset:8224
ds_read_b64_tr_b16 v[210:211], v13 offset:8480
ds_read_b64_tr_b16 v[212:213], v13 offset:8736
ds_read_b64_tr_b16 v[214:215], v13 offset:8992
ds_read_b64_tr_b16 v[216:217], v13 offset:12320
ds_read_b64_tr_b16 v[218:219], v13 offset:12576
ds_read_b64_tr_b16 v[220:221], v13 offset:12832
ds_read_b64_tr_b16 v[222:223], v13 offset:13088
s_waitcnt lgkmcnt(0)
v_mfma_f32_16x16x32_bf16 v[236:239], v[192:195], v[160:163], 0
v_mfma_f32_16x16x32_bf16 v[236:239], v[196:199], v[164:167], v[236:239]
v_mfma_f32_16x16x32_bf16 v[236:239], v[200:203], v[168:171], v[236:239]
v_mfma_f32_16x16x32_bf16 v[236:239], v[204:207], v[172:175], v[236:239]
v_mfma_f32_16x16x32_bf16 v[236:239], v[208:211], v[176:179], v[236:239]
v_mfma_f32_16x16x32_bf16 v[236:239], v[212:215], v[180:183], v[236:239]
v_mfma_f32_16x16x32_bf16 v[236:239], v[216:219], v[184:187], v[236:239]
v_mfma_f32_16x16x32_bf16 v[236:239], v[220:223], v[188:191], v[236:239]
ds_write_b128 v12, v[224:227] offset:0
ds_write_b128 v12, v[228:231] offset:1024
ds_write_b128 v12, v[232:235] offset:2048
s_nop 4
ds_write_b128 v12, v[236:239] offset:3072
s_waitcnt lgkmcnt(0)
s_barrier
s_cmp_gt_u32 s94, 1
s_cbranch_scc1 m1done_151_\sf
s_lshl_b32 s45, s94, 10
s_add_u32 s45, s45, 98304
v_add_u32 v6, s45, v2
ds_read_b128 v[192:195], v6 offset:0
ds_read_b128 v[196:199], v6 offset:16384
ds_read_b128 v[200:203], v6 offset:32768
ds_read_b128 v[204:207], v6 offset:49152
ds_read_b128 v[208:211], v6 offset:2048
ds_read_b128 v[212:215], v6 offset:18432
ds_read_b128 v[216:219], v6 offset:34816
ds_read_b128 v[220:223], v6 offset:51200
s_waitcnt lgkmcnt(0)
v_pk_add_f32 v[192:193], v[192:193], v[196:197]
v_pk_add_f32 v[200:201], v[200:201], v[204:205]
v_pk_add_f32 v[194:195], v[194:195], v[198:199]
v_pk_add_f32 v[202:203], v[202:203], v[206:207]
v_pk_add_f32 v[192:193], v[192:193], v[200:201]
v_pk_add_f32 v[194:195], v[194:195], v[202:203]
v_pk_add_f32 v[208:209], v[208:209], v[212:213]
v_pk_add_f32 v[216:217], v[216:217], v[220:221]
v_pk_add_f32 v[210:211], v[210:211], v[214:215]
v_pk_add_f32 v[218:219], v[218:219], v[222:223]
v_pk_add_f32 v[208:209], v[208:209], v[216:217]
v_pk_add_f32 v[210:211], v[210:211], v[218:219]
v_cvt_pk_bf16_f32 v240, v192, v193
v_cvt_pk_bf16_f32 v241, v194, v195
v_lshlrev_b32 v192, 16, v240
v_and_b32 v193, 0xffff0000, v240
v_lshlrev_b32 v194, 16, v241
v_and_b32 v195, 0xffff0000, v241
v_cvt_pk_bf16_f32 v242, v208, v209
v_cvt_pk_bf16_f32 v243, v210, v211
v_lshlrev_b32 v208, 16, v242
v_and_b32 v209, 0xffff0000, v242
v_lshlrev_b32 v210, 16, v243
v_and_b32 v211, 0xffff0000, v243
v_mul_f32 v244, 0xbfb8aa3b, v192
v_exp_f32 v244, v244
s_nop 0
v_add_f32 v244, 1.0, v244
v_rcp_f32 v244, v244
s_nop 0
v_mul_f32 v192, v192, v244
v_mul_f32 v245, 0xbfb8aa3b, v193
v_exp_f32 v245, v245
s_nop 0
v_add_f32 v245, 1.0, v245
v_rcp_f32 v245, v245
s_nop 0
v_mul_f32 v193, v193, v245
v_mul_f32 v246, 0xbfb8aa3b, v194
v_exp_f32 v246, v246
s_nop 0
v_add_f32 v246, 1.0, v246
v_rcp_f32 v246, v246
s_nop 0
v_mul_f32 v194, v194, v246
v_mul_f32 v247, 0xbfb8aa3b, v195
v_exp_f32 v247, v247
s_nop 0
v_add_f32 v247, 1.0, v247
v_rcp_f32 v247, v247
s_nop 0
v_mul_f32 v195, v195, v247
v_cvt_pk_bf16_f32 v240, v192, v193
v_cvt_pk_bf16_f32 v241, v194, v195
v_lshlrev_b32 v192, 16, v240
v_and_b32 v193, 0xffff0000, v240
v_lshlrev_b32 v194, 16, v241
v_and_b32 v195, 0xffff0000, v241
v_mul_f32 v192, v192, v208
v_mul_f32 v193, v193, v209
v_mul_f32 v194, v194, v210
v_mul_f32 v195, v195, v211
v_cvt_pk_bf16_f32 v240, v192, v193
v_cvt_pk_bf16_f32 v241, v194, v195
v_and_b32 v6, 15, v1
v_lshrrev_b32 v7, 4, v1
v_mul_u32_u24 v8, 7168, v6
v_lshl_add_u32 v8, v7, 3, v8
s_lshl_b32 s45, s95, 6
s_lshl_b32 s46, s94, 5
s_add_u32 s45, s45, s46
s_add_u32 s45, s45, 0x5404000
v_cmp_gt_u32 vcc, 2, v6
s_mov_b64 exec, vcc
buffer_store_dwordx2 v[240:241], v8, s[8:11], s45 offen sc1
s_mov_b64 exec, -1
s_nop 1
m1done_151_\sf:
s_barrier
mu_150_\sf:
s_load_dwordx2 s[12:13], s[0:1], 88
s_waitcnt lgkmcnt(0)
s_and_b32 s13, s13, 0xffff
s_mov_b32 s14, 0x700000
s_mov_b32 s15, 0x20000
v_lshrrev_b32 v6, 2, v1
v_mul_u32_u24 v6, 2048, v6
v_and_b32 v7, 3, v1
v_lshl_add_u32 v8, v7, 4, v6
v_mov_b32 v243, v8
s_lshl_b32 s68, s94, 14
s_add_u32 s68, s68, 98304
s_mov_b32 s70, 1024
s_mov_b32 s71, 32768
s_add_u32 s48, s95, 0
s_min_u32 s48, s48, 223
s_lshr_b32 s47, s48, 5
s_lshl_b32 s45, s47, 2
s_add_u32 s45, s45, s94
s_lshl_b32 s69, s45, 18
s_and_b32 s46, s48, 31
s_lshl_b32 s46, s46, 6
s_add_u32 s69, s69, s46
s_branch sidee_129_\sf
side_135_\sf:
s_cmp_lg_u32 s94, 0
s_cbranch_scc1 arr_152_\sf
s_cmp_ge_u32 s95, 112
s_cbranch_scc1 arr_152_\sf
v_mov_b32 v6, 1
v_mov_b32 v7, 144
s_mov_b64 exec, 1
buffer_atomic_add v6, v7, s[32:35], 0 offen sc1
s_mov_b64 exec, -1
arr_152_\sf:
s_load_dwordx2 s[12:13], s[0:1], 88
s_waitcnt lgkmcnt(0)
s_and_b32 s13, s13, 0xffff
s_mov_b32 s14, 0x700000
s_mov_b32 s15, 0x20000
v_lshrrev_b32 v6, 2, v1
v_mul_u32_u24 v6, 2048, v6
v_and_b32 v7, 3, v1
v_lshl_add_u32 v8, v7, 4, v6
v_mov_b32 v243, v8
s_lshl_b32 s68, s94, 14
s_add_u32 s68, s68, 106496
s_mov_b32 s70, 1024
s_mov_b32 s71, 32768
s_add_u32 s48, s95, 128
s_min_u32 s48, s48, 223
s_lshr_b32 s47, s48, 5
s_lshl_b32 s45, s47, 2
s_add_u32 s45, s45, s94
s_lshl_b32 s69, s45, 18
s_and_b32 s46, s48, 31
s_lshl_b32 s46, s46, 6
s_add_u32 s69, s69, s46
s_branch sidee_129_\sf
side_136_\sf:
s_load_dwordx2 s[12:13], s[0:1], 88
s_waitcnt lgkmcnt(0)
s_and_b32 s13, s13, 0xffff
s_mov_b32 s14, 0x700000
s_mov_b32 s15, 0x20000
s_mov_b32 s14, 0
s_mov_b32 s68, 0x30000
s_mov_b32 s69, 0
s_mov_b32 s70, 0
s_mov_b32 s71, 0
s_branch sidee_129_\sf
side_137_\sf:
v_mov_b32 v7, 144
s_nop 1
dw_153_\sf:
buffer_load_dword v6, v7, s[32:35], 0 offen sc1
s_waitcnt vmcnt(0)
v_cmp_gt_u32 vcc, 112, v6
s_cbranch_vccz dwd_154_\sf
s_sleep 1
s_add_u32 s44, s44, 1
s_cmp_lt_u32 s44, 0x40000
s_cbranch_scc1 dw_153_\sf
dwd_154_\sf:
s_lshl_b32 s45, s94, 14
s_add_u32 s45, s45, 98304
v_add_u32 v12, s45, v2
v_lshrrev_b32 v6, 4, v1
v_bfe_u32 v7, v1, 2, 2
v_and_b32 v8, 3, v1
v_lshl_add_u32 v9, v6, 4, v7
v_lshlrev_b32 v9, 6, v9
v_lshl_add_u32 v9, v8, 3, v9
v_add_u32 v13, s45, v9
v_and_b32 v6, 1, v1
v_mul_u32_u24 v6, 7168, v6
v_lshrrev_b32 v7, 4, v1
v_lshl_add_u32 v10, v7, 5, v6
s_add_u32 s48, s95, 0
s_min_u32 s48, s48, 223
s_lshr_b32 s47, s48, 5
s_lshl_b32 s45, s47, 2
s_add_u32 s45, s45, s94
s_lshl_b32 s45, s45, 8
s_add_u32 s45, s45, 0x5404000
buffer_load_dwordx4 v[160:163], v10, s[8:11], s45 offen offset:0 sc1
buffer_load_dwordx4 v[164:167], v10, s[8:11], s45 offen offset:16 sc1
buffer_load_dwordx4 v[168:171], v10, s[8:11], s45 offen offset:128 sc1
buffer_load_dwordx4 v[172:175], v10, s[8:11], s45 offen offset:144 sc1
s_waitcnt vmcnt(0)
ds_read_b64_tr_b16 v[192:193], v13 offset:0
ds_read_b64_tr_b16 v[194:195], v13 offset:256
ds_read_b64_tr_b16 v[196:197], v13 offset:512
ds_read_b64_tr_b16 v[198:199], v13 offset:768
ds_read_b64_tr_b16 v[200:201], v13 offset:4096
ds_read_b64_tr_b16 v[202:203], v13 offset:4352
ds_read_b64_tr_b16 v[204:205], v13 offset:4608
ds_read_b64_tr_b16 v[206:207], v13 offset:4864
s_waitcnt lgkmcnt(0)
v_mfma_f32_16x16x32_bf16 v[224:227], v[192:195], v[160:163], 0
v_mfma_f32_16x16x32_bf16 v[224:227], v[196:199], v[164:167], v[224:227]
v_mfma_f32_16x16x32_bf16 v[224:227], v[200:203], v[168:171], v[224:227]
v_mfma_f32_16x16x32_bf16 v[224:227], v[204:207], v[172:175], v[224:227]
ds_read_b64_tr_b16 v[192:193], v13 offset:32
ds_read_b64_tr_b16 v[194:195], v13 offset:288
ds_read_b64_tr_b16 v[196:197], v13 offset:544
ds_read_b64_tr_b16 v[198:199], v13 offset:800
ds_read_b64_tr_b16 v[200:201], v13 offset:4128
ds_read_b64_tr_b16 v[202:203], v13 offset:4384
ds_read_b64_tr_b16 v[204:205], v13 offset:4640
ds_read_b64_tr_b16 v[206:207], v13 offset:4896
s_waitcnt lgkmcnt(0)
v_mfma_f32_16x16x32_bf16 v[228:231], v[192:195], v[160:163], 0
v_mfma_f32_16x16x32_bf16 v[228:231], v[196:199], v[164:167], v[228:231]
v_mfma_f32_16x16x32_bf16 v[228:231], v[200:203], v[168:171], v[228:231]
v_mfma_f32_16x16x32_bf16 v[228:231], v[204:207], v[172:175], v[228:231]
s_add_u32 s48, s95, 128
s_min_u32 s48, s48, 223
s_lshr_b32 s47, s48, 5
s_lshl_b32 s45, s47, 2
s_add_u32 s45, s45, s94
s_lshl_b32 s45, s45, 8
s_add_u32 s45, s45, 0x5404000
buffer_load_dwordx4 v[160:163], v10, s[8:11], s45 offen offset:0 sc1
buffer_load_dwordx4 v[164:167], v10, s[8:11], s45 offen offset:16 sc1
buffer_load_dwordx4 v[168:171], v10, s[8:11], s45 offen offset:128 sc1
buffer_load_dwordx4 v[172:175], v10, s[8:11], s45 offen offset:144 sc1
s_waitcnt vmcnt(0)
ds_read_b64_tr_b16 v[192:193], v13 offset:8192
ds_read_b64_tr_b16 v[194:195], v13 offset:8448
ds_read_b64_tr_b16 v[196:197], v13 offset:8704
ds_read_b64_tr_b16 v[198:199], v13 offset:8960
ds_read_b64_tr_b16 v[200:201], v13 offset:12288
ds_read_b64_tr_b16 v[202:203], v13 offset:12544
ds_read_b64_tr_b16 v[204:205], v13 offset:12800
ds_read_b64_tr_b16 v[206:207], v13 offset:13056
s_waitcnt lgkmcnt(0)
v_mfma_f32_16x16x32_bf16 v[232:235], v[192:195], v[160:163], 0
v_mfma_f32_16x16x32_bf16 v[232:235], v[196:199], v[164:167], v[232:235]
v_mfma_f32_16x16x32_bf16 v[232:235], v[200:203], v[168:171], v[232:235]
v_mfma_f32_16x16x32_bf16 v[232:235], v[204:207], v[172:175], v[232:235]
ds_read_b64_tr_b16 v[192:193], v13 offset:8224
ds_read_b64_tr_b16 v[194:195], v13 offset:8480
ds_read_b64_tr_b16 v[196:197], v13 offset:8736
ds_read_b64_tr_b16 v[198:199], v13 offset:8992
ds_read_b64_tr_b16 v[200:201], v13 offset:12320
ds_read_b64_tr_b16 v[202:203], v13 offset:12576
ds_read_b64_tr_b16 v[204:205], v13 offset:12832
ds_read_b64_tr_b16 v[206:207], v13 offset:13088
s_waitcnt lgkmcnt(0)
v_mfma_f32_16x16x32_bf16 v[236:239], v[192:195], v[160:163], 0
v_mfma_f32_16x16x32_bf16 v[236:239], v[196:199], v[164:167], v[236:239]
v_mfma_f32_16x16x32_bf16 v[236:239], v[200:203], v[168:171], v[236:239]
v_mfma_f32_16x16x32_bf16 v[236:239], v[204:207], v[172:175], v[236:239]
ds_write_b128 v12, v[224:227] offset:0
ds_write_b128 v12, v[228:231] offset:1024
ds_write_b128 v12, v[232:235] offset:2048
s_nop 4
ds_write_b128 v12, v[236:239] offset:3072
s_waitcnt lgkmcnt(0)
s_barrier
s_lshr_b32 s48, s94, 1
s_lshl_b32 s48, s48, 7
s_add_u32 s48, s48, s95
s_cmp_ge_u32 s48, 224
s_cbranch_scc1 m2done_155_\sf
s_lshl_b32 s45, s94, 10
s_add_u32 s45, s45, 98304
v_add_u32 v6, s45, v2
ds_read_b128 v[192:195], v6 offset:0
ds_read_b128 v[196:199], v6 offset:16384
ds_read_b128 v[200:203], v6 offset:32768
ds_read_b128 v[204:207], v6 offset:49152
s_waitcnt lgkmcnt(0)
v_pk_add_f32 v[192:193], v[192:193], v[196:197]
v_pk_add_f32 v[200:201], v[200:201], v[204:205]
v_pk_add_f32 v[194:195], v[194:195], v[198:199]
v_pk_add_f32 v[202:203], v[202:203], v[206:207]
v_pk_add_f32 v[192:193], v[192:193], v[200:201]
v_pk_add_f32 v[194:195], v[194:195], v[202:203]
v_and_b32 v6, 15, v1
v_lshrrev_b32 v7, 4, v1
v_lshlrev_b32 v8, 12, v6
v_lshl_add_u32 v8, v7, 4, v8
s_lshr_b32 s47, s48, 5
s_lshl_b32 s45, s47, 13
s_and_b32 s46, s48, 31
s_lshl_b32 s46, s46, 7
s_add_u32 s45, s45, s46
s_and_b32 s46, s94, 1
s_lshl_b32 s46, s46, 6
s_add_u32 s45, s45, s46
s_add_u32 s45, s45, 0x540c000
v_cmp_gt_u32 vcc, 2, v6
s_mov_b64 exec, vcc
buffer_store_dwordx4 v[192:195], v8, s[8:11], s45 offen sc1
s_mov_b64 exec, -1
s_nop 1
m2done_155_\sf:
s_barrier
s_load_dwordx2 s[12:13], s[0:1], 40
s_waitcnt lgkmcnt(0)
s_and_b32 s13, s13, 0xffff
s_mov_b32 s14, 0x800000
s_mov_b32 s15, 0x20000
v_lshrrev_b32 v6, 2, v1
v_mul_u32_u24 v6, 2048, v6
v_and_b32 v7, 3, v1
v_lshl_add_u32 v8, v7, 4, v6
v_mov_b32 v243, v8
s_lshl_b32 s68, s94, 14
s_add_u32 s68, s68, 98304
s_mov_b32 s70, 1024
s_mov_b32 s71, 32768
s_lshr_b32 s69, s93, 3
s_lshl_b32 s69, s69, 21
s_and_b32 s46, s93, 7
s_lshl_b32 s46, s46, 2
s_add_u32 s46, s46, s94
s_lshl_b32 s46, s46, 6
s_add_u32 s69, s69, 0x180000
s_add_u32 s69, s69, s46
s_branch sidee_129_\sf
side_138_\sf:
s_cmp_lg_u32 s94, 0
s_cbranch_scc1 arr_156_\sf
v_mov_b32 v6, 1
v_mov_b32 v7, 148
s_mov_b64 exec, 1
buffer_atomic_add v6, v7, s[32:35], 0 offen sc1
s_mov_b64 exec, -1
arr_156_\sf:
s_branch sidee_129_\sf
side_139_\sf:
s_waitcnt vmcnt(0)
s_lshl_b32 s45, s94, 14
s_add_u32 s45, s45, 98304
v_lshrrev_b32 v6, 4, v1
v_bfe_u32 v7, v1, 2, 2
v_and_b32 v8, 3, v1
v_lshl_add_u32 v9, v6, 2, v7
v_lshlrev_b32 v9, 6, v9
v_lshl_add_u32 v9, v8, 4, v9
v_add_u32 v13, s45, v9
ds_read_b64_tr_b16 a[192:193], v13 offset:0
ds_read_b64_tr_b16 a[194:195], v13 offset:1024
ds_read_b64_tr_b16 a[196:197], v13 offset:2048
ds_read_b64_tr_b16 a[198:199], v13 offset:3072
ds_read_b64_tr_b16 a[200:201], v13 offset:4096
ds_read_b64_tr_b16 a[202:203], v13 offset:5120
ds_read_b64_tr_b16 a[204:205], v13 offset:6144
ds_read_b64_tr_b16 a[206:207], v13 offset:7168
ds_read_b64_tr_b16 a[208:209], v13 offset:8192
ds_read_b64_tr_b16 a[210:211], v13 offset:9216
ds_read_b64_tr_b16 a[212:213], v13 offset:10240
ds_read_b64_tr_b16 a[214:215], v13 offset:11264
ds_read_b64_tr_b16 a[216:217], v13 offset:12288
ds_read_b64_tr_b16 a[218:219], v13 offset:13312
ds_read_b64_tr_b16 a[220:221], v13 offset:14336
ds_read_b64_tr_b16 a[222:223], v13 offset:15360
ds_read_b64_tr_b16 a[224:225], v13 offset:8
ds_read_b64_tr_b16 a[226:227], v13 offset:1032
ds_read_b64_tr_b16 a[228:229], v13 offset:2056
ds_read_b64_tr_b16 a[230:231], v13 offset:3080
ds_read_b64_tr_b16 a[232:233], v13 offset:4104
ds_read_b64_tr_b16 a[234:235], v13 offset:5128
ds_read_b64_tr_b16 a[236:237], v13 offset:6152
ds_read_b64_tr_b16 a[238:239], v13 offset:7176
ds_read_b64_tr_b16 a[240:241], v13 offset:8200
ds_read_b64_tr_b16 a[242:243], v13 offset:9224
ds_read_b64_tr_b16 a[244:245], v13 offset:10248
ds_read_b64_tr_b16 a[246:247], v13 offset:11272
ds_read_b64_tr_b16 a[248:249], v13 offset:12296
ds_read_b64_tr_b16 a[250:251], v13 offset:13320
ds_read_b64_tr_b16 a[252:253], v13 offset:14344
ds_read_b64_tr_b16 a[254:255], v13 offset:15368
s_waitcnt lgkmcnt(0)
s_load_dwordx2 s[12:13], s[0:1], 40
s_waitcnt lgkmcnt(0)
s_and_b32 s13, s13, 0xffff
s_mov_b32 s14, 0x800000
s_mov_b32 s15, 0x20000
v_lshrrev_b32 v6, 2, v1
v_mul_u32_u24 v6, 2048, v6
v_and_b32 v7, 3, v1
v_lshl_add_u32 v8, v7, 4, v6
v_mov_b32 v243, v8
s_lshl_b32 s68, s94, 14
s_add_u32 s68, s68, 98304
s_mov_b32 s70, 1024
s_mov_b32 s71, 32768
s_lshr_b32 s69, s93, 3
s_lshl_b32 s69, s69, 21
s_and_b32 s46, s93, 7
s_lshl_b32 s46, s46, 2
s_add_u32 s46, s46, s94
s_lshl_b32 s46, s46, 6
s_add_u32 s69, s69, 0x100000
s_add_u32 s69, s69, s46
s_branch sidee_129_\sf
side_140_\sf:
s_load_dwordx2 s[12:13], s[0:1], 88
s_waitcnt lgkmcnt(0)
s_and_b32 s13, s13, 0xffff
s_mov_b32 s14, 0x700000
s_mov_b32 s15, 0x20000
s_mov_b32 s14, 0
s_mov_b32 s68, 0x30000
s_mov_b32 s69, 0
s_mov_b32 s70, 0
s_mov_b32 s71, 0
s_branch sidee_129_\sf
sidee_129_\sf:
s_cmp_eq_u32 s90, 0
s_cbranch_scc1 g1_back_w0_\sf
s_cmp_eq_u32 s90, 1
s_cbranch_scc1 g1_back_w1_\sf
s_cmp_eq_u32 s90, 2
s_cbranch_scc1 g1_back_w2_\sf
s_branch g1_back_w3_\sf
fg1_join_\sf:
s_lshl_b32 s45, s42, 13
v_add_u32 v242, s45, v2
s_lshl_b32 s45, s42, 11
v_add_u32 v240, s45, v2
s_lshr_b32 s45, s42, 1
s_lshl_b32 s45, s45, 18
s_lshl_b32 s46, s49, 13
s_add_u32 s45, s45, s46
s_and_b32 s46, s42, 1
s_lshl_b32 s46, s46, 12
s_add_u32 s45, s45, s46
s_lshl_b32 s46, s50, 10
s_add_u32 s55, s45, s46
s_add_u32 s54, s54, 0x10000
s_add_u32 s45, s54, 0x8000
buffer_load_dwordx4 v[80:83], v2, s[8:11], s54 offen offset:0 sc1
buffer_load_dwordx4 v[84:87], v2, s[8:11], s54 offen offset:1024 sc1
buffer_load_dwordx4 v[88:91], v2, s[8:11], s54 offen offset:2048 sc1
buffer_load_dwordx4 v[92:95], v2, s[8:11], s54 offen offset:3072 sc1
buffer_load_dwordx4 v[96:99], v5, s[8:11], s54 offen offset:0 sc1
buffer_load_dwordx4 v[100:103], v5, s[8:11], s54 offen offset:1024 sc1
buffer_load_dwordx4 v[104:107], v5, s[8:11], s54 offen offset:2048 sc1
buffer_load_dwordx4 v[108:111], v5, s[8:11], s54 offen offset:3072 sc1
buffer_load_dwordx4 v[112:115], v2, s[8:11], s45 offen offset:0 sc1
buffer_load_dwordx4 v[116:119], v2, s[8:11], s45 offen offset:1024 sc1
buffer_load_dwordx4 v[120:123], v2, s[8:11], s45 offen offset:2048 sc1
buffer_load_dwordx4 v[124:127], v2, s[8:11], s45 offen offset:3072 sc1
buffer_load_dwordx4 v[128:131], v5, s[8:11], s45 offen offset:0 sc1
buffer_load_dwordx4 v[132:135], v5, s[8:11], s45 offen offset:1024 sc1
buffer_load_dwordx4 v[136:139], v5, s[8:11], s45 offen offset:2048 sc1
buffer_load_dwordx4 v[140:143], v5, s[8:11], s45 offen offset:3072 sc1
s_barrier
s_waitcnt vmcnt(16)
v_mfma_f32_16x16x32_bf16 v[144:147], a[0:3], v[16:19], 0
v_mfma_f32_16x16x32_bf16 v[148:151], a[32:35], v[16:19], 0
v_mfma_f32_16x16x32_bf16 v[144:147], a[4:7], v[20:23], v[144:147]
v_mfma_f32_16x16x32_bf16 v[148:151], a[36:39], v[20:23], v[148:151]
v_mfma_f32_16x16x32_bf16 v[144:147], a[8:11], v[24:27], v[144:147]
v_mfma_f32_16x16x32_bf16 v[148:151], a[40:43], v[24:27], v[148:151]
v_mfma_f32_16x16x32_bf16 v[144:147], a[12:15], v[28:31], v[144:147]
v_mfma_f32_16x16x32_bf16 v[148:151], a[44:47], v[28:31], v[148:151]
v_mfma_f32_16x16x32_bf16 v[144:147], a[16:19], v[32:35], v[144:147]
v_mfma_f32_16x16x32_bf16 v[148:151], a[48:51], v[32:35], v[148:151]
v_mfma_f32_16x16x32_bf16 v[144:147], a[20:23], v[36:39], v[144:147]
v_mfma_f32_16x16x32_bf16 v[148:151], a[52:55], v[36:39], v[148:151]
v_mfma_f32_16x16x32_bf16 v[144:147], a[24:27], v[40:43], v[144:147]
v_mfma_f32_16x16x32_bf16 v[148:151], a[56:59], v[40:43], v[148:151]
v_mfma_f32_16x16x32_bf16 v[144:147], a[28:31], v[44:47], v[144:147]
v_mfma_f32_16x16x32_bf16 v[148:151], a[60:63], v[44:47], v[148:151]
v_mfma_f32_16x16x32_bf16 v[152:155], a[0:3], v[48:51], 0
v_mfma_f32_16x16x32_bf16 v[156:159], a[32:35], v[48:51], 0
v_mfma_f32_16x16x32_bf16 v[152:155], a[4:7], v[52:55], v[152:155]
v_mfma_f32_16x16x32_bf16 v[156:159], a[36:39], v[52:55], v[156:159]
v_mfma_f32_16x16x32_bf16 v[152:155], a[8:11], v[56:59], v[152:155]
v_mfma_f32_16x16x32_bf16 v[156:159], a[40:43], v[56:59], v[156:159]
v_mfma_f32_16x16x32_bf16 v[152:155], a[12:15], v[60:63], v[152:155]
v_mfma_f32_16x16x32_bf16 v[156:159], a[44:47], v[60:63], v[156:159]
v_mfma_f32_16x16x32_bf16 v[152:155], a[16:19], v[64:67], v[152:155]
v_mfma_f32_16x16x32_bf16 v[156:159], a[48:51], v[64:67], v[156:159]
v_mfma_f32_16x16x32_bf16 v[152:155], a[20:23], v[68:71], v[152:155]
v_mfma_f32_16x16x32_bf16 v[156:159], a[52:55], v[68:71], v[156:159]
v_mfma_f32_16x16x32_bf16 v[152:155], a[24:27], v[72:75], v[152:155]
v_mfma_f32_16x16x32_bf16 v[156:159], a[56:59], v[72:75], v[156:159]
v_mfma_f32_16x16x32_bf16 v[152:155], a[28:31], v[76:79], v[152:155]
v_mfma_f32_16x16x32_bf16 v[156:159], a[60:63], v[76:79], v[156:159]
s_add_u32 s54, s54, 0x10000
s_add_u32 s45, s54, 0x8000
buffer_load_dwordx4 v[16:19], v2, s[8:11], s54 offen offset:0 sc1
buffer_load_dwordx4 v[20:23], v2, s[8:11], s54 offen offset:1024 sc1
buffer_load_dwordx4 v[24:27], v2, s[8:11], s54 offen offset:2048 sc1
buffer_load_dwordx4 v[28:31], v2, s[8:11], s54 offen offset:3072 sc1
buffer_load_dwordx4 v[32:35], v5, s[8:11], s54 offen offset:0 sc1
buffer_load_dwordx4 v[36:39], v5, s[8:11], s54 offen offset:1024 sc1
buffer_load_dwordx4 v[40:43], v5, s[8:11], s54 offen offset:2048 sc1
buffer_load_dwordx4 v[44:47], v5, s[8:11], s54 offen offset:3072 sc1
buffer_load_dwordx4 v[48:51], v2, s[8:11], s45 offen offset:0 sc1
buffer_load_dwordx4 v[52:55], v2, s[8:11], s45 offen offset:1024 sc1
buffer_load_dwordx4 v[56:59], v2, s[8:11], s45 offen offset:2048 sc1
buffer_load_dwordx4 v[60:63], v2, s[8:11], s45 offen offset:3072 sc1
buffer_load_dwordx4 v[64:67], v5, s[8:11], s45 offen offset:0 sc1
buffer_load_dwordx4 v[68:71], v5, s[8:11], s45 offen offset:1024 sc1
buffer_load_dwordx4 v[72:75], v5, s[8:11], s45 offen offset:2048 sc1
buffer_load_dwordx4 v[76:79], v5, s[8:11], s45 offen offset:3072 sc1
s_waitcnt vmcnt(16)
v_mfma_f32_16x16x32_bf16 v[160:163], a[0:3], v[80:83], 0
v_mfma_f32_16x16x32_bf16 v[164:167], a[32:35], v[80:83], 0
v_mfma_f32_16x16x32_bf16 v[160:163], a[4:7], v[84:87], v[160:163]
v_mfma_f32_16x16x32_bf16 v[164:167], a[36:39], v[84:87], v[164:167]
v_mfma_f32_16x16x32_bf16 v[160:163], a[8:11], v[88:91], v[160:163]
v_mfma_f32_16x16x32_bf16 v[164:167], a[40:43], v[88:91], v[164:167]
v_mfma_f32_16x16x32_bf16 v[160:163], a[12:15], v[92:95], v[160:163]
v_mfma_f32_16x16x32_bf16 v[164:167], a[44:47], v[92:95], v[164:167]
v_mfma_f32_16x16x32_bf16 v[160:163], a[16:19], v[96:99], v[160:163]
v_mfma_f32_16x16x32_bf16 v[164:167], a[48:51], v[96:99], v[164:167]
v_mfma_f32_16x16x32_bf16 v[160:163], a[20:23], v[100:103], v[160:163]
v_mfma_f32_16x16x32_bf16 v[164:167], a[52:55], v[100:103], v[164:167]
v_mfma_f32_16x16x32_bf16 v[160:163], a[24:27], v[104:107], v[160:163]
v_mfma_f32_16x16x32_bf16 v[164:167], a[56:59], v[104:107], v[164:167]
v_mfma_f32_16x16x32_bf16 v[160:163], a[28:31], v[108:111], v[160:163]
v_mfma_f32_16x16x32_bf16 v[164:167], a[60:63], v[108:111], v[164:167]
v_mfma_f32_16x16x32_bf16 v[168:171], a[0:3], v[112:115], 0
v_mfma_f32_16x16x32_bf16 v[172:175], a[32:35], v[112:115], 0
v_mfma_f32_16x16x32_bf16 v[168:171], a[4:7], v[116:119], v[168:171]
v_mfma_f32_16x16x32_bf16 v[172:175], a[36:39], v[116:119], v[172:175]
v_mfma_f32_16x16x32_bf16 v[168:171], a[8:11], v[120:123], v[168:171]
v_mfma_f32_16x16x32_bf16 v[172:175], a[40:43], v[120:123], v[172:175]
v_mfma_f32_16x16x32_bf16 v[168:171], a[12:15], v[124:127], v[168:171]
v_mfma_f32_16x16x32_bf16 v[172:175], a[44:47], v[124:127], v[172:175]
v_mfma_f32_16x16x32_bf16 v[168:171], a[16:19], v[128:131], v[168:171]
v_mfma_f32_16x16x32_bf16 v[172:175], a[48:51], v[128:131], v[172:175]
v_mfma_f32_16x16x32_bf16 v[168:171], a[20:23], v[132:135], v[168:171]
v_mfma_f32_16x16x32_bf16 v[172:175], a[52:55], v[132:135], v[172:175]
v_mfma_f32_16x16x32_bf16 v[168:171], a[24:27], v[136:139], v[168:171]
v_mfma_f32_16x16x32_bf16 v[172:175], a[56:59], v[136:139], v[172:175]
v_mfma_f32_16x16x32_bf16 v[168:171], a[28:31], v[140:143], v[168:171]
v_mfma_f32_16x16x32_bf16 v[172:175], a[60:63], v[140:143], v[172:175]
s_add_u32 s54, s54, 0x10000
s_add_u32 s45, s54, 0x8000
buffer_load_dwordx4 v[80:83], v2, s[8:11], s54 offen offset:0 sc1
buffer_load_dwordx4 v[84:87], v2, s[8:11], s54 offen offset:1024 sc1
buffer_load_dwordx4 v[88:91], v2, s[8:11], s54 offen offset:2048 sc1
buffer_load_dwordx4 v[92:95], v2, s[8:11], s54 offen offset:3072 sc1
buffer_load_dwordx4 v[96:99], v5, s[8:11], s54 offen offset:0 sc1
buffer_load_dwordx4 v[100:103], v5, s[8:11], s54 offen offset:1024 sc1
buffer_load_dwordx4 v[104:107], v5, s[8:11], s54 offen offset:2048 sc1
buffer_load_dwordx4 v[108:111], v5, s[8:11], s54 offen offset:3072 sc1
buffer_load_dwordx4 v[112:115], v2, s[8:11], s45 offen offset:0 sc1
buffer_load_dwordx4 v[116:119], v2, s[8:11], s45 offen offset:1024 sc1
buffer_load_dwordx4 v[120:123], v2, s[8:11], s45 offen offset:2048 sc1
buffer_load_dwordx4 v[124:127], v2, s[8:11], s45 offen offset:3072 sc1
buffer_load_dwordx4 v[128:131], v5, s[8:11], s45 offen offset:0 sc1
buffer_load_dwordx4 v[132:135], v5, s[8:11], s45 offen offset:1024 sc1
buffer_load_dwordx4 v[136:139], v5, s[8:11], s45 offen offset:2048 sc1
buffer_load_dwordx4 v[140:143], v5, s[8:11], s45 offen offset:3072 sc1
ds_write_b128 v242, v[144:147] offset:0
ds_write_b128 v242, v[148:151] offset:1024
ds_write_b128 v242, v[152:155] offset:2048
ds_write_b128 v242, v[156:159] offset:3072
ds_write_b128 v242, v[160:163] offset:4096
ds_write_b128 v242, v[164:167] offset:5120
ds_write_b128 v242, v[168:171] offset:6144
ds_write_b128 v242, v[172:175] offset:7168
s_waitcnt lgkmcnt(0)
s_barrier
ds_read_b128 v[192:195], v240 offset:0
ds_read_b128 v[196:199], v240 offset:8192
ds_read_b128 v[200:203], v240 offset:16384
ds_read_b128 v[204:207], v240 offset:24576
ds_read_b128 v[208:211], v240 offset:1024
ds_read_b128 v[212:215], v240 offset:9216
ds_read_b128 v[216:219], v240 offset:17408
ds_read_b128 v[220:223], v240 offset:25600
s_waitcnt lgkmcnt(0)
s_barrier
v_pk_add_f32 v[192:193], v[192:193], v[196:197]
v_pk_add_f32 v[200:201], v[200:201], v[204:205]
v_pk_add_f32 v[194:195], v[194:195], v[198:199]
v_pk_add_f32 v[202:203], v[202:203], v[206:207]
v_pk_add_f32 v[192:193], v[192:193], v[200:201]
v_pk_add_f32 v[194:195], v[194:195], v[202:203]
v_cvt_pk_bf16_f32 v224, v192, v193
v_cvt_pk_bf16_f32 v225, v194, v195
v_pk_add_f32 v[208:209], v[208:209], v[212:213]
v_pk_add_f32 v[216:217], v[216:217], v[220:221]
v_pk_add_f32 v[210:211], v[210:211], v[214:215]
v_pk_add_f32 v[218:219], v[218:219], v[222:223]
v_pk_add_f32 v[208:209], v[208:209], v[216:217]
v_pk_add_f32 v[210:211], v[210:211], v[218:219]
v_cvt_pk_bf16_f32 v226, v208, v209
v_cvt_pk_bf16_f32 v227, v210, v211
buffer_store_dwordx4 v[224:227], v2, s[8:11], s55 offen sc1
s_add_u32 s55, s55, 0x80000
s_waitcnt vmcnt(16)
v_mfma_f32_16x16x32_bf16 v[144:147], a[0:3], v[16:19], 0
v_mfma_f32_16x16x32_bf16 v[148:151], a[32:35], v[16:19], 0
v_mfma_f32_16x16x32_bf16 v[144:147], a[4:7], v[20:23], v[144:147]
v_mfma_f32_16x16x32_bf16 v[148:151], a[36:39], v[20:23], v[148:151]
v_mfma_f32_16x16x32_bf16 v[144:147], a[8:11], v[24:27], v[144:147]
v_mfma_f32_16x16x32_bf16 v[148:151], a[40:43], v[24:27], v[148:151]
v_mfma_f32_16x16x32_bf16 v[144:147], a[12:15], v[28:31], v[144:147]
v_mfma_f32_16x16x32_bf16 v[148:151], a[44:47], v[28:31], v[148:151]
v_mfma_f32_16x16x32_bf16 v[144:147], a[16:19], v[32:35], v[144:147]
v_mfma_f32_16x16x32_bf16 v[148:151], a[48:51], v[32:35], v[148:151]
v_mfma_f32_16x16x32_bf16 v[144:147], a[20:23], v[36:39], v[144:147]
v_mfma_f32_16x16x32_bf16 v[148:151], a[52:55], v[36:39], v[148:151]
v_mfma_f32_16x16x32_bf16 v[144:147], a[24:27], v[40:43], v[144:147]
v_mfma_f32_16x16x32_bf16 v[148:151], a[56:59], v[40:43], v[148:151]
v_mfma_f32_16x16x32_bf16 v[144:147], a[28:31], v[44:47], v[144:147]
v_mfma_f32_16x16x32_bf16 v[148:151], a[60:63], v[44:47], v[148:151]
v_mfma_f32_16x16x32_bf16 v[152:155], a[0:3], v[48:51], 0
v_mfma_f32_16x16x32_bf16 v[156:159], a[32:35], v[48:51], 0
v_mfma_f32_16x16x32_bf16 v[152:155], a[4:7], v[52:55], v[152:155]
v_mfma_f32_16x16x32_bf16 v[156:159], a[36:39], v[52:55], v[156:159]
v_mfma_f32_16x16x32_bf16 v[152:155], a[8:11], v[56:59], v[152:155]
v_mfma_f32_16x16x32_bf16 v[156:159], a[40:43], v[56:59], v[156:159]
v_mfma_f32_16x16x32_bf16 v[152:155], a[12:15], v[60:63], v[152:155]
v_mfma_f32_16x16x32_bf16 v[156:159], a[44:47], v[60:63], v[156:159]
v_mfma_f32_16x16x32_bf16 v[152:155], a[16:19], v[64:67], v[152:155]
v_mfma_f32_16x16x32_bf16 v[156:159], a[48:51], v[64:67], v[156:159]
v_mfma_f32_16x16x32_bf16 v[152:155], a[20:23], v[68:71], v[152:155]
v_mfma_f32_16x16x32_bf16 v[156:159], a[52:55], v[68:71], v[156:159]
v_mfma_f32_16x16x32_bf16 v[152:155], a[24:27], v[72:75], v[152:155]
v_mfma_f32_16x16x32_bf16 v[156:159], a[56:59], v[72:75], v[156:159]
v_mfma_f32_16x16x32_bf16 v[152:155], a[28:31], v[76:79], v[152:155]
v_mfma_f32_16x16x32_bf16 v[156:159], a[60:63], v[76:79], v[156:159]
s_waitcnt vmcnt(0)
v_mfma_f32_16x16x32_bf16 v[160:163], a[0:3], v[80:83], 0
v_mfma_f32_16x16x32_bf16 v[164:167], a[32:35], v[80:83], 0
v_mfma_f32_16x16x32_bf16 v[160:163], a[4:7], v[84:87], v[160:163]
v_mfma_f32_16x16x32_bf16 v[164:167], a[36:39], v[84:87], v[164:167]
v_mfma_f32_16x16x32_bf16 v[160:163], a[8:11], v[88:91], v[160:163]
v_mfma_f32_16x16x32_bf16 v[164:167], a[40:43], v[88:91], v[164:167]
v_mfma_f32_16x16x32_bf16 v[160:163], a[12:15], v[92:95], v[160:163]
v_mfma_f32_16x16x32_bf16 v[164:167], a[44:47], v[92:95], v[164:167]
v_mfma_f32_16x16x32_bf16 v[160:163], a[16:19], v[96:99], v[160:163]
v_mfma_f32_16x16x32_bf16 v[164:167], a[48:51], v[96:99], v[164:167]
v_mfma_f32_16x16x32_bf16 v[160:163], a[20:23], v[100:103], v[160:163]
v_mfma_f32_16x16x32_bf16 v[164:167], a[52:55], v[100:103], v[164:167]
v_mfma_f32_16x16x32_bf16 v[160:163], a[24:27], v[104:107], v[160:163]
v_mfma_f32_16x16x32_bf16 v[164:167], a[56:59], v[104:107], v[164:167]
v_mfma_f32_16x16x32_bf16 v[160:163], a[28:31], v[108:111], v[160:163]
v_mfma_f32_16x16x32_bf16 v[164:167], a[60:63], v[108:111], v[164:167]
v_mfma_f32_16x16x32_bf16 v[168:171], a[0:3], v[112:115], 0
v_mfma_f32_16x16x32_bf16 v[172:175], a[32:35], v[112:115], 0
v_mfma_f32_16x16x32_bf16 v[168:171], a[4:7], v[116:119], v[168:171]
v_mfma_f32_16x16x32_bf16 v[172:175], a[36:39], v[116:119], v[172:175]
v_mfma_f32_16x16x32_bf16 v[168:171], a[8:11], v[120:123], v[168:171]
v_mfma_f32_16x16x32_bf16 v[172:175], a[40:43], v[120:123], v[172:175]
v_mfma_f32_16x16x32_bf16 v[168:171], a[12:15], v[124:127], v[168:171]
v_mfma_f32_16x16x32_bf16 v[172:175], a[44:47], v[124:127], v[172:175]
v_mfma_f32_16x16x32_bf16 v[168:171], a[16:19], v[128:131], v[168:171]
v_mfma_f32_16x16x32_bf16 v[172:175], a[48:51], v[128:131], v[172:175]
v_mfma_f32_16x16x32_bf16 v[168:171], a[20:23], v[132:135], v[168:171]
v_mfma_f32_16x16x32_bf16 v[172:175], a[52:55], v[132:135], v[172:175]
v_mfma_f32_16x16x32_bf16 v[168:171], a[24:27], v[136:139], v[168:171]
v_mfma_f32_16x16x32_bf16 v[172:175], a[56:59], v[136:139], v[172:175]
v_mfma_f32_16x16x32_bf16 v[168:171], a[28:31], v[140:143], v[168:171]
v_mfma_f32_16x16x32_bf16 v[172:175], a[60:63], v[140:143], v[172:175]
ds_write_b128 v242, v[144:147] offset:0
ds_write_b128 v242, v[148:151] offset:1024
ds_write_b128 v242, v[152:155] offset:2048
ds_write_b128 v242, v[156:159] offset:3072
ds_write_b128 v242, v[160:163] offset:4096
ds_write_b128 v242, v[164:167] offset:5120
s_nop 0
ds_write_b128 v242, v[168:171] offset:6144
ds_write_b128 v242, v[172:175] offset:7168
s_waitcnt lgkmcnt(0)
s_barrier
ds_read_b128 v[192:195], v240 offset:0
ds_read_b128 v[196:199], v240 offset:8192
ds_read_b128 v[200:203], v240 offset:16384
ds_read_b128 v[204:207], v240 offset:24576
ds_read_b128 v[208:211], v240 offset:1024
ds_read_b128 v[212:215], v240 offset:9216
ds_read_b128 v[216:219], v240 offset:17408
ds_read_b128 v[220:223], v240 offset:25600
s_waitcnt lgkmcnt(0)
s_barrier
v_pk_add_f32 v[192:193], v[192:193], v[196:197]
v_pk_add_f32 v[200:201], v[200:201], v[204:205]
v_pk_add_f32 v[194:195], v[194:195], v[198:199]
v_pk_add_f32 v[202:203], v[202:203], v[206:207]
v_pk_add_f32 v[192:193], v[192:193], v[200:201]
v_pk_add_f32 v[194:195], v[194:195], v[202:203]
v_cvt_pk_bf16_f32 v224, v192, v193
v_cvt_pk_bf16_f32 v225, v194, v195
v_pk_add_f32 v[208:209], v[208:209], v[212:213]
v_pk_add_f32 v[216:217], v[216:217], v[220:221]
v_pk_add_f32 v[210:211], v[210:211], v[214:215]
v_pk_add_f32 v[218:219], v[218:219], v[222:223]
v_pk_add_f32 v[208:209], v[208:209], v[216:217]
v_pk_add_f32 v[210:211], v[210:211], v[218:219]
v_cvt_pk_bf16_f32 v226, v208, v209
v_cvt_pk_bf16_f32 v227, v210, v211
buffer_store_dwordx4 v[224:227], v2, s[8:11], s55 offen sc1
s_add_u32 s55, s55, 0x80000
s_waitcnt vmcnt(0)
s_barrier
s_mov_b32 s59, 65
s_cmp_lg_u32 s42, 0
s_cbranch_scc1 qtp_157_\sf
s_min_u32 s46, s59, 65
v_mov_b32 v6, s46
v_mov_b32 v7, 0
s_mov_b64 exec, 1
buffer_store_dword v6, v7, s[8:11], s58 offen sc1
s_mov_b64 exec, -1
qtp_157_\sf:
s_load_dwordx2 s[12:13], s[0:1], 40
s_load_dwordx2 s[16:17], s[0:1], 0
s_load_dwordx2 s[20:21], s[0:1], 104
s_waitcnt lgkmcnt(0)
s_and_b32 s13, s13, 0xffff
s_mov_b32 s14, 0x800000
s_mov_b32 s15, 0x20000
s_and_b32 s17, s17, 0xffff
s_mov_b32 s18, 0x400000
s_mov_b32 s19, 0x20000
s_and_b32 s21, s21, 0xffff
s_mov_b32 s22, 0x400000
s_mov_b32 s23, 0x20000
v_and_b32 v1, 63, v0
v_lshlrev_b32 v2, 4, v1
v_add_u32 v3, 0x1000, v2
v_and_b32 v8, 15, v1
v_lshlrev_b32 v5, 2, v8
v_lshrrev_b32 v9, 4, v1
v_lshlrev_b32 v9, 4, v9
v_lshl_add_u32 v4, v8, 11, v9
s_lshr_b32 s60, s93, 3
s_and_b32 s61, s93, 7
s_lshl_b32 s62, s61, 2
s_add_u32 s62, s62, s94
v_lshrrev_b32 v8, 2, v1
v_and_b32 v9, 3, v1
v_lshlrev_b32 v9, 4, v9
v_lshl_add_u32 v11, v8, 11, v9
s_lshl_b32 s45, s60, 21
s_lshl_b32 s46, s62, 6
s_add_u32 s45, s45, s46
buffer_load_dwordx4 a[0:3], v11, s[12:15], s45 offen
s_add_u32 s45, s45, 0x8000
buffer_load_dwordx4 a[4:7], v11, s[12:15], s45 offen
s_add_u32 s45, s45, 0x8000
buffer_load_dwordx4 a[8:11], v11, s[12:15], s45 offen
s_add_u32 s45, s45, 0x8000
buffer_load_dwordx4 a[12:15], v11, s[12:15], s45 offen
s_add_u32 s45, s45, 0x8000
buffer_load_dwordx4 a[16:19], v11, s[12:15], s45 offen
s_add_u32 s45, s45, 0x8000
buffer_load_dwordx4 a[20:23], v11, s[12:15], s45 offen
s_add_u32 s45, s45, 0x8000
buffer_load_dwordx4 a[24:27], v11, s[12:15], s45 offen
s_add_u32 s45, s45, 0x8000
buffer_load_dwordx4 a[28:31], v11, s[12:15], s45 offen
s_add_u32 s45, s45, 0x8000
buffer_load_dwordx4 a[32:35], v11, s[12:15], s45 offen
s_add_u32 s45, s45, 0x8000
buffer_load_dwordx4 a[36:39], v11, s[12:15], s45 offen
s_add_u32 s45, s45, 0x8000
buffer_load_dwordx4 a[40:43], v11, s[12:15], s45 offen
s_add_u32 s45, s45, 0x8000
buffer_load_dwordx4 a[44:47], v11, s[12:15], s45 offen
s_add_u32 s45, s45, 0x8000
buffer_load_dwordx4 a[48:51], v11, s[12:15], s45 offen
s_add_u32 s45, s45, 0x8000
buffer_load_dwordx4 a[52:55], v11, s[12:15], s45 offen
s_add_u32 s45, s45, 0x8000
buffer_load_dwordx4 a[56:59], v11, s[12:15], s45 offen
s_add_u32 s45, s45, 0x8000
buffer_load_dwordx4 a[60:63], v11, s[12:15], s45 offen
s_add_u32 s45, s45, 0x8000
buffer_load_dwordx4 a[64:67], v11, s[12:15], s45 offen
s_add_u32 s45, s45, 0x8000
buffer_load_dwordx4 a[68:71], v11, s[12:15], s45 offen
s_add_u32 s45, s45, 0x8000
buffer_load_dwordx4 a[72:75], v11, s[12:15], s45 offen
s_add_u32 s45, s45, 0x8000
buffer_load_dwordx4 a[76:79], v11, s[12:15], s45 offen
s_add_u32 s45, s45, 0x8000
buffer_load_dwordx4 a[80:83], v11, s[12:15], s45 offen
s_add_u32 s45, s45, 0x8000
buffer_load_dwordx4 a[84:87], v11, s[12:15], s45 offen
s_add_u32 s45, s45, 0x8000
buffer_load_dwordx4 a[88:91], v11, s[12:15], s45 offen
s_add_u32 s45, s45, 0x8000
buffer_load_dwordx4 a[92:95], v11, s[12:15], s45 offen
s_add_u32 s45, s45, 0x8000
buffer_load_dwordx4 a[96:99], v11, s[12:15], s45 offen
s_add_u32 s45, s45, 0x8000
buffer_load_dwordx4 a[100:103], v11, s[12:15], s45 offen
s_add_u32 s45, s45, 0x8000
buffer_load_dwordx4 a[104:107], v11, s[12:15], s45 offen
s_add_u32 s45, s45, 0x8000
buffer_load_dwordx4 a[108:111], v11, s[12:15], s45 offen
s_add_u32 s45, s45, 0x8000
buffer_load_dwordx4 a[112:115], v11, s[12:15], s45 offen
s_add_u32 s45, s45, 0x8000
buffer_load_dwordx4 a[116:119], v11, s[12:15], s45 offen
s_add_u32 s45, s45, 0x8000
buffer_load_dwordx4 a[120:123], v11, s[12:15], s45 offen
s_add_u32 s45, s45, 0x8000
buffer_load_dwordx4 a[124:127], v11, s[12:15], s45 offen
s_lshl_b32 s45, s94, 14
s_add_u32 s45, s45, 98304
v_lshrrev_b32 v6, 4, v1
v_bfe_u32 v7, v1, 2, 2
v_and_b32 v8, 3, v1
v_lshl_add_u32 v9, v6, 2, v7
v_lshlrev_b32 v9, 6, v9
v_lshl_add_u32 v9, v8, 4, v9
v_add_u32 v13, s45, v9
ds_read_b64_tr_b16 a[128:129], v13 offset:0
ds_read_b64_tr_b16 a[130:131], v13 offset:1024
ds_read_b64_tr_b16 a[132:133], v13 offset:2048
ds_read_b64_tr_b16 a[134:135], v13 offset:3072
ds_read_b64_tr_b16 a[136:137], v13 offset:4096
ds_read_b64_tr_b16 a[138:139], v13 offset:5120
ds_read_b64_tr_b16 a[140:141], v13 offset:6144
ds_read_b64_tr_b16 a[142:143], v13 offset:7168
ds_read_b64_tr_b16 a[144:145], v13 offset:8192
ds_read_b64_tr_b16 a[146:147], v13 offset:9216
ds_read_b64_tr_b16 a[148:149], v13 offset:10240
ds_read_b64_tr_b16 a[150:151], v13 offset:11264
ds_read_b64_tr_b16 a[152:153], v13 offset:12288
ds_read_b64_tr_b16 a[154:155], v13 offset:13312
ds_read_b64_tr_b16 a[156:157], v13 offset:14336
ds_read_b64_tr_b16 a[158:159], v13 offset:15360
ds_read_b64_tr_b16 a[160:161], v13 offset:8
ds_read_b64_tr_b16 a[162:163], v13 offset:1032
ds_read_b64_tr_b16 a[164:165], v13 offset:2056
ds_read_b64_tr_b16 a[166:167], v13 offset:3080
ds_read_b64_tr_b16 a[168:169], v13 offset:4104
ds_read_b64_tr_b16 a[170:171], v13 offset:5128
ds_read_b64_tr_b16 a[172:173], v13 offset:6152
ds_read_b64_tr_b16 a[174:175], v13 offset:7176
ds_read_b64_tr_b16 a[176:177], v13 offset:8200
ds_read_b64_tr_b16 a[178:179], v13 offset:9224
ds_read_b64_tr_b16 a[180:181], v13 offset:10248
ds_read_b64_tr_b16 a[182:183], v13 offset:11272
ds_read_b64_tr_b16 a[184:185], v13 offset:12296
ds_read_b64_tr_b16 a[186:187], v13 offset:13320
ds_read_b64_tr_b16 a[188:189], v13 offset:14344
ds_read_b64_tr_b16 a[190:191], v13 offset:15368
s_waitcnt lgkmcnt(0)
s_lshl_b32 s45, s94, 14
v_add_u32 v12, s45, v2
v_lshrrev_b32 v8, 4, v1
v_bfe_u32 v9, v1, 2, 2
v_and_b32 v10, 3, v1
v_lshl_add_u32 v11, v8, 2, v9
v_lshlrev_b32 v11, 6, v11
v_lshl_add_u32 v11, v10, 4, v11
v_add_u32 v13, s45, v11
s_waitcnt vmcnt(16)
ds_write_b128 v12, a[0:3] offset:0
ds_write_b128 v12, a[4:7] offset:1024
ds_write_b128 v12, a[8:11] offset:2048
ds_write_b128 v12, a[12:15] offset:3072
ds_write_b128 v12, a[16:19] offset:4096
ds_write_b128 v12, a[20:23] offset:5120
ds_write_b128 v12, a[24:27] offset:6144
ds_write_b128 v12, a[28:31] offset:7168
ds_write_b128 v12, a[32:35] offset:8192
ds_write_b128 v12, a[36:39] offset:9216
ds_write_b128 v12, a[40:43] offset:10240
ds_write_b128 v12, a[44:47] offset:11264
ds_write_b128 v12, a[48:51] offset:12288
ds_write_b128 v12, a[52:55] offset:13312
ds_write_b128 v12, a[56:59] offset:14336
ds_write_b128 v12, a[60:63] offset:15360
s_waitcnt lgkmcnt(0)
ds_read_b64_tr_b16 a[0:1], v13 offset:0
ds_read_b64_tr_b16 a[2:3], v13 offset:1024
ds_read_b64_tr_b16 a[4:5], v13 offset:2048
ds_read_b64_tr_b16 a[6:7], v13 offset:3072
ds_read_b64_tr_b16 a[8:9], v13 offset:4096
ds_read_b64_tr_b16 a[10:11], v13 offset:5120
ds_read_b64_tr_b16 a[12:13], v13 offset:6144
ds_read_b64_tr_b16 a[14:15], v13 offset:7168
ds_read_b64_tr_b16 a[16:17], v13 offset:8192
ds_read_b64_tr_b16 a[18:19], v13 offset:9216
ds_read_b64_tr_b16 a[20:21], v13 offset:10240
ds_read_b64_tr_b16 a[22:23], v13 offset:11264
ds_read_b64_tr_b16 a[24:25], v13 offset:12288
ds_read_b64_tr_b16 a[26:27], v13 offset:13312
ds_read_b64_tr_b16 a[28:29], v13 offset:14336
ds_read_b64_tr_b16 a[30:31], v13 offset:15360
ds_read_b64_tr_b16 a[32:33], v13 offset:8
ds_read_b64_tr_b16 a[34:35], v13 offset:1032
ds_read_b64_tr_b16 a[36:37], v13 offset:2056
ds_read_b64_tr_b16 a[38:39], v13 offset:3080
ds_read_b64_tr_b16 a[40:41], v13 offset:4104
ds_read_b64_tr_b16 a[42:43], v13 offset:5128
ds_read_b64_tr_b16 a[44:45], v13 offset:6152
ds_read_b64_tr_b16 a[46:47], v13 offset:7176
ds_read_b64_tr_b16 a[48:49], v13 offset:8200
ds_read_b64_tr_b16 a[50:51], v13 offset:9224
ds_read_b64_tr_b16 a[52:53], v13 offset:10248
ds_read_b64_tr_b16 a[54:55], v13 offset:11272
ds_read_b64_tr_b16 a[56:57], v13 offset:12296
ds_read_b64_tr_b16 a[58:59], v13 offset:13320
ds_read_b64_tr_b16 a[60:61], v13 offset:14344
ds_read_b64_tr_b16 a[62:63], v13 offset:15368
s_waitcnt lgkmcnt(0)
s_waitcnt vmcnt(0)
ds_write_b128 v12, a[64:67] offset:0
ds_write_b128 v12, a[68:71] offset:1024
ds_write_b128 v12, a[72:75] offset:2048
ds_write_b128 v12, a[76:79] offset:3072
ds_write_b128 v12, a[80:83] offset:4096
ds_write_b128 v12, a[84:87] offset:5120
ds_write_b128 v12, a[88:91] offset:6144
ds_write_b128 v12, a[92:95] offset:7168
ds_write_b128 v12, a[96:99] offset:8192
ds_write_b128 v12, a[100:103] offset:9216
ds_write_b128 v12, a[104:107] offset:10240
ds_write_b128 v12, a[108:111] offset:11264
ds_write_b128 v12, a[112:115] offset:12288
ds_write_b128 v12, a[116:119] offset:13312
ds_write_b128 v12, a[120:123] offset:14336
ds_write_b128 v12, a[124:127] offset:15360
s_waitcnt lgkmcnt(0)
ds_read_b64_tr_b16 a[64:65], v13 offset:0
ds_read_b64_tr_b16 a[66:67], v13 offset:1024
ds_read_b64_tr_b16 a[68:69], v13 offset:2048
ds_read_b64_tr_b16 a[70:71], v13 offset:3072
ds_read_b64_tr_b16 a[72:73], v13 offset:4096
ds_read_b64_tr_b16 a[74:75], v13 offset:5120
ds_read_b64_tr_b16 a[76:77], v13 offset:6144
ds_read_b64_tr_b16 a[78:79], v13 offset:7168
ds_read_b64_tr_b16 a[80:81], v13 offset:8192
ds_read_b64_tr_b16 a[82:83], v13 offset:9216
ds_read_b64_tr_b16 a[84:85], v13 offset:10240
ds_read_b64_tr_b16 a[86:87], v13 offset:11264
ds_read_b64_tr_b16 a[88:89], v13 offset:12288
ds_read_b64_tr_b16 a[90:91], v13 offset:13312
ds_read_b64_tr_b16 a[92:93], v13 offset:14336
ds_read_b64_tr_b16 a[94:95], v13 offset:15360
ds_read_b64_tr_b16 a[96:97], v13 offset:8
ds_read_b64_tr_b16 a[98:99], v13 offset:1032
ds_read_b64_tr_b16 a[100:101], v13 offset:2056
ds_read_b64_tr_b16 a[102:103], v13 offset:3080
ds_read_b64_tr_b16 a[104:105], v13 offset:4104
ds_read_b64_tr_b16 a[106:107], v13 offset:5128
ds_read_b64_tr_b16 a[108:109], v13 offset:6152
ds_read_b64_tr_b16 a[110:111], v13 offset:7176
ds_read_b64_tr_b16 a[112:113], v13 offset:8200
ds_read_b64_tr_b16 a[114:115], v13 offset:9224
ds_read_b64_tr_b16 a[116:117], v13 offset:10248
ds_read_b64_tr_b16 a[118:119], v13 offset:11272
ds_read_b64_tr_b16 a[120:121], v13 offset:12296
ds_read_b64_tr_b16 a[122:123], v13 offset:13320
ds_read_b64_tr_b16 a[124:125], v13 offset:14344
ds_read_b64_tr_b16 a[126:127], v13 offset:15368
s_waitcnt lgkmcnt(0)
s_cmp_lg_u32 s94, 0
s_cbranch_scc1 dww_158_\sf
v_mov_b32 v9, 148
s_nop 1
dw_159_\sf:
buffer_load_dword v8, v9, s[32:35], 0 offen sc1
s_waitcnt vmcnt(0)
v_cmp_gt_u32 vcc, 128, v8
s_cbranch_vccz dwd_160_\sf
s_sleep 1
s_add_u32 s44, s44, 1
s_cmp_lt_u32 s44, 0x40000
s_cbranch_scc1 dw_159_\sf
dwd_160_\sf:
dww_158_\sf:
s_barrier
v_mov_b32 v8, 0
s_lshl_b32 s46, s93, 8
s_add_u32 s46, s46, 0x5502000
g65_161_\sf:
buffer_load_dwordx4 v[12:15], v8, s[8:11], s46 offen sc1
s_waitcnt vmcnt(0)
v_min3_u32 v12, v12, v13, v14
v_min_u32 v12, v12, v15
v_cmp_gt_u32 vcc, 65, v12
s_cbranch_vccz g65d_162_\sf
s_sleep 4
s_add_u32 s44, s44, 1
s_cmp_lt_u32 s44, 0x40000
s_cbranch_scc1 g65_161_\sf
g65d_162_\sf:
s_mov_b32 s45, 0x541c000
buffer_load_dwordx2 v[10:11], v8, s[8:11], s45 offen sc1
s_waitcnt vmcnt(0)
v_readfirstlane_b32 s52, v10
v_readfirstlane_b32 s53, v11
s_mov_b32 s88, 0
s_mov_b32 s73, 0
s_mov_b32 s89, 0
s_barrier
s_nop 0
g2_loop_\sf:
s_mov_b32 s58, 0
s_cmp_lg_u32 s94, 0
s_cbranch_scc1 ctl_163_\sf
v_and_b32 v8, 31, v0
v_lshlrev_b32 v8, 2, v8
v_and_b32 v9, 3, v0
v_lshlrev_b32 v9, 2, v9
s_lshl_b32 s45, s92, 7
s_add_u32 s45, s45, 0x5504000
s_lshl_b32 s46, s93, 8
s_add_u32 s46, s46, 0x5500000
buffer_load_dword v10, v8, s[8:11], s45 offen sc1
v_mov_b32 v11, 64
s_cmp_ge_u32 s88, 16
s_cbranch_scc1 noprog_164_\sf
buffer_load_dword v11, v9, s[8:11], s46 offen sc1
noprog_164_\sf:
s_waitcnt vmcnt(0)
v_min_u32_dpp v10, v10, v10 row_ror:1 row_mask:0xf bank_mask:0xf
v_min_u32_dpp v11, v11, v11 row_ror:1 row_mask:0xf bank_mask:0xf
s_nop 0
v_min_u32_dpp v10, v10, v10 row_ror:2 row_mask:0xf bank_mask:0xf
v_min_u32_dpp v11, v11, v11 row_ror:2 row_mask:0xf bank_mask:0xf
s_nop 0
v_min_u32_dpp v10, v10, v10 row_ror:4 row_mask:0xf bank_mask:0xf
s_nop 1
v_min_u32_dpp v10, v10, v10 row_ror:8 row_mask:0xf bank_mask:0xf
v_mov_b32 v12, v10
s_nop 1
v_permlane16_swap_b32 v10, v12
v_min_u32 v10, v10, v12
v_mov_b32 v12, 147456
ds_write_b64 v12, v[10:11]
s_waitcnt lgkmcnt(0)
ctl_163_\sf:
s_barrier
v_mov_b32 v12, 147456
ds_read_b64 v[10:11], v12
s_waitcnt lgkmcnt(0)
v_readfirstlane_b32 s55, v10
v_readfirstlane_b32 s54, v11
s_barrier
s_add_u32 s54, s54, 3
s_sub_u32 s54, s54, s92
s_lshr_b32 s54, s54, 2
s_cmp_le_u32 s54, s88
s_cbranch_scc1 noattn_165_\sf
s_add_u32 s45, s88, 4
s_min_u32 s54, s54, s45
s_add_u32 s45, s88, s94
s_cmp_ge_u32 s45, s54
s_cbranch_scc1 notask_166_\sf
s_lshl_b32 s45, s45, 2
s_add_u32 s45, s45, s92
s_lshl_b32 s45, s45, 5
s_add_u32 s41, s45, s93
s_add_u32 s45, s41, 1
s_cmp_eq_u32 s45, s73
s_cbranch_scc1 havepf_169_\sf
v_and_b32 v1, 63, v0
v_lshlrev_b32 v2, 4, v1
v_lshlrev_b32 v3, 3, v1
v_add_u32 v5, 0x1000, v2
v_lshrrev_b32 v8, 4, v1
v_and_b32 v9, 7, v1
v_lshl_add_u32 v4, v8, 3, v9
v_lshlrev_b32 v4, 4, v4
v_cmp_gt_u32 vcc, 32, v1
s_nop 1
v_cndmask_b32 v6, 0, -1, vcc
v_cndmask_b32 v7, -1, 0, vcc
v_cndmask_b32 v14, 0, 1.0, vcc
v_mov_b32 v15, 0xff7fffff
v_and_b32 v9, 15, v1
v_lshlrev_b32 v8, 2, v8
v_add_u32 v10, 0, v8
v_cmp_le_u32 s[80:81], v10, v9
v_add_u32 v10, 1, v8
v_cmp_le_u32 s[82:83], v10, v9
v_add_u32 v10, 2, v8
v_cmp_le_u32 s[84:85], v10, v9
v_add_u32 v10, 3, v8
v_cmp_le_u32 s[86:87], v10, v9
s_mov_b32 s65, 0x3e0293ee
s_lshl_b32 s45, s41, 13
s_add_u32 s46, s45, 0x1000000
s_add_u32 s47, s45, 0x2000000
buffer_load_dwordx4 v[16:19], v2, s[8:11], s45 offen offset:0 sc1
buffer_load_dwordx4 v[20:23], v2, s[8:11], s45 offen offset:1024 sc1
buffer_load_dwordx4 v[24:27], v2, s[8:11], s45 offen offset:2048 sc1
buffer_load_dwordx4 v[28:31], v2, s[8:11], s45 offen offset:3072 sc1
buffer_load_dwordx4 v[32:35], v5, s[8:11], s45 offen offset:0 sc1
buffer_load_dwordx4 v[36:39], v5, s[8:11], s45 offen offset:1024 sc1
buffer_load_dwordx4 v[40:43], v5, s[8:11], s45 offen offset:2048 sc1
buffer_load_dwordx4 v[44:47], v5, s[8:11], s45 offen offset:3072 sc1
buffer_load_dwordx4 v[48:51], v2, s[8:11], s46 offen offset:0 sc1
buffer_load_dwordx4 v[52:55], v2, s[8:11], s46 offen offset:1024 sc1
buffer_load_dwordx4 v[56:59], v2, s[8:11], s46 offen offset:2048 sc1
buffer_load_dwordx4 v[60:63], v2, s[8:11], s46 offen offset:3072 sc1
buffer_load_dwordx4 v[64:67], v5, s[8:11], s46 offen offset:0 sc1
buffer_load_dwordx4 v[68:71], v5, s[8:11], s46 offen offset:1024 sc1
buffer_load_dwordx4 v[72:75], v5, s[8:11], s46 offen offset:2048 sc1
buffer_load_dwordx4 v[76:79], v5, s[8:11], s46 offen offset:3072 sc1
buffer_load_dwordx4 v[96:99], v2, s[8:11], s47 offen offset:0 sc1
buffer_load_dwordx4 v[100:103], v2, s[8:11], s47 offen offset:1024 sc1
buffer_load_dwordx4 v[104:107], v2, s[8:11], s47 offen offset:2048 sc1
buffer_load_dwordx4 v[108:111], v2, s[8:11], s47 offen offset:3072 sc1
buffer_load_dwordx4 v[112:115], v5, s[8:11], s47 offen offset:0 sc1
buffer_load_dwordx4 v[116:119], v5, s[8:11], s47 offen offset:1024 sc1
buffer_load_dwordx4 v[120:123], v5, s[8:11], s47 offen offset:2048 sc1
buffer_load_dwordx4 v[124:127], v5, s[8:11], s47 offen offset:3072 sc1
havepf_169_\sf:
s_lshl_b32 s45, s41, 11
s_add_u32 s46, s45, 0x4000000
s_add_u32 s45, s45, 0x4400000
buffer_load_dwordx4 v[80:83], v4, s[8:11], s46 offen offset:0 sc1
buffer_load_dwordx4 v[84:87], v4, s[8:11], s46 offen offset:512 sc1
buffer_load_dwordx4 v[88:91], v4, s[8:11], s46 offen offset:1024 sc1
buffer_load_dwordx4 v[92:95], v4, s[8:11], s46 offen offset:1536 sc1
buffer_load_dwordx2 v[128:129], v3, s[8:11], s45 offen offset:0 sc1
buffer_load_dwordx2 v[130:131], v3, s[8:11], s45 offen offset:512 sc1
buffer_load_dwordx2 v[132:133], v3, s[8:11], s45 offen offset:1024 sc1
buffer_load_dwordx2 v[134:135], v3, s[8:11], s45 offen offset:1536 sc1
s_waitcnt vmcnt(4)
v_mfma_f32_16x16x32_bf16 v[136:139], v[48:51], v[16:19], 0
v_mfma_f32_16x16x32_bf16 v[140:143], v[80:83], v[16:19], 0
v_mfma_f32_16x16x32_bf16 v[144:147], v[48:51], v[32:35], 0
v_mfma_f32_16x16x32_bf16 v[148:151], v[64:67], v[32:35], 0
v_mfma_f32_16x16x32_bf16 v[152:155], v[80:83], v[32:35], 0
v_mfma_f32_16x16x32_bf16 v[136:139], v[52:55], v[20:23], v[136:139]
v_mfma_f32_16x16x32_bf16 v[140:143], v[84:87], v[20:23], v[140:143]
v_mfma_f32_16x16x32_bf16 v[144:147], v[52:55], v[36:39], v[144:147]
v_mfma_f32_16x16x32_bf16 v[148:151], v[68:71], v[36:39], v[148:151]
v_mfma_f32_16x16x32_bf16 v[152:155], v[84:87], v[36:39], v[152:155]
v_mfma_f32_16x16x32_bf16 v[136:139], v[56:59], v[24:27], v[136:139]
v_mfma_f32_16x16x32_bf16 v[140:143], v[88:91], v[24:27], v[140:143]
v_mfma_f32_16x16x32_bf16 v[144:147], v[56:59], v[40:43], v[144:147]
v_mfma_f32_16x16x32_bf16 v[148:151], v[72:75], v[40:43], v[148:151]
v_mfma_f32_16x16x32_bf16 v[152:155], v[88:91], v[40:43], v[152:155]
v_mfma_f32_16x16x32_bf16 v[136:139], v[60:63], v[28:31], v[136:139]
v_mfma_f32_16x16x32_bf16 v[140:143], v[92:95], v[28:31], v[140:143]
v_mfma_f32_16x16x32_bf16 v[144:147], v[60:63], v[44:47], v[144:147]
v_mfma_f32_16x16x32_bf16 v[148:151], v[76:79], v[44:47], v[148:151]
v_mfma_f32_16x16x32_bf16 v[152:155], v[92:95], v[44:47], v[152:155]
s_lshr_b32 s45, s41, 5
s_lshl_b32 s45, s45, 18
s_and_b32 s46, s41, 31
s_lshl_b32 s46, s46, 12
s_add_u32 s45, s45, s46
s_add_u32 s45, s45, 0x3000000
s_add_u32 s46, s45, 0x20000
v_cndmask_b32 v136, v15, v136, s[80:81]
v_cndmask_b32 v137, v15, v137, s[82:83]
v_cndmask_b32 v138, v15, v138, s[84:85]
v_cndmask_b32 v139, v15, v139, s[86:87]
v_cndmask_b32 v148, v15, v148, s[80:81]
v_cndmask_b32 v149, v15, v149, s[82:83]
v_cndmask_b32 v150, v15, v150, s[84:85]
v_cndmask_b32 v151, v15, v151, s[86:87]
v_max3_f32 v8, v136, v137, v138
v_max3_f32 v8, v8, v139, v140
v_max3_f32 v8, v8, v141, v142
v_max_f32 v8, v8, v143
v_max3_f32 v10, v144, v145, v146
v_max3_f32 v10, v10, v147, v148
v_max3_f32 v10, v10, v149, v150
v_max3_f32 v10, v10, v151, v152
v_max3_f32 v10, v10, v153, v154
v_max_f32 v10, v10, v155
v_mov_b32 v9, v8
v_mov_b32 v11, v10
s_nop 0
v_permlane16_swap_b32 v8, v9
v_permlane16_swap_b32 v10, v11
v_max_f32 v8, v8, v9
v_max_f32 v10, v10, v11
v_mov_b32 v9, v8
v_mov_b32 v11, v10
s_nop 0
v_permlane32_swap_b32 v8, v9
v_permlane32_swap_b32 v10, v11
v_max_f32 v8, v8, v9
v_max_f32 v10, v10, v11
v_mul_f32 v8, s65, v8
v_mul_f32 v10, s65, v10
v_fma_f32 v136, v136, s65, -v8
v_fma_f32 v137, v137, s65, -v8
v_fma_f32 v138, v138, s65, -v8
v_fma_f32 v139, v139, s65, -v8
v_fma_f32 v140, v140, s65, -v8
v_fma_f32 v141, v141, s65, -v8
v_fma_f32 v142, v142, s65, -v8
v_fma_f32 v143, v143, s65, -v8
v_fma_f32 v144, v144, s65, -v10
v_fma_f32 v145, v145, s65, -v10
v_fma_f32 v146, v146, s65, -v10
v_fma_f32 v147, v147, s65, -v10
v_fma_f32 v148, v148, s65, -v10
v_fma_f32 v149, v149, s65, -v10
v_fma_f32 v150, v150, s65, -v10
v_fma_f32 v151, v151, s65, -v10
v_fma_f32 v152, v152, s65, -v10
v_fma_f32 v153, v153, s65, -v10
v_fma_f32 v154, v154, s65, -v10
v_fma_f32 v155, v155, s65, -v10
v_exp_f32 v136, v136
v_exp_f32 v137, v137
v_exp_f32 v138, v138
v_exp_f32 v139, v139
v_exp_f32 v140, v140
v_exp_f32 v141, v141
v_exp_f32 v142, v142
v_exp_f32 v143, v143
v_exp_f32 v144, v144
v_exp_f32 v145, v145
v_exp_f32 v146, v146
v_exp_f32 v147, v147
v_exp_f32 v148, v148
v_exp_f32 v149, v149
v_exp_f32 v150, v150
v_exp_f32 v151, v151
v_exp_f32 v152, v152
v_exp_f32 v153, v153
v_exp_f32 v154, v154
v_exp_f32 v155, v155
v_cvt_pk_bf16_f32 v156, v136, v137
v_cvt_pk_bf16_f32 v157, v138, v139
v_mov_b32 v158, 0
v_mov_b32 v159, 0
v_cvt_pk_bf16_f32 v160, v140, v141
v_cvt_pk_bf16_f32 v161, v142, v143
v_and_b32 v162, v160, v6
v_and_b32 v163, v161, v6
v_and_b32 v164, v160, v7
v_and_b32 v165, v161, v7
v_cvt_pk_bf16_f32 v166, v144, v145
v_cvt_pk_bf16_f32 v167, v146, v147
v_cvt_pk_bf16_f32 v168, v148, v149
v_cvt_pk_bf16_f32 v169, v150, v151
v_cvt_pk_bf16_f32 v170, v152, v153
v_cvt_pk_bf16_f32 v171, v154, v155
v_and_b32 v172, v170, v6
v_and_b32 v173, v171, v6
v_and_b32 v174, v170, v7
v_and_b32 v175, v171, v7
s_waitcnt vmcnt(0)
v_pk_add_f32 v[140:141], v[140:141], v[142:143]
v_pk_add_f32 v[136:137], v[136:137], v[138:139]
v_add_f32 v9, v140, v141
v_add_f32 v8, v136, v137
v_fma_f32 v8, v9, v14, v8
v_pk_add_f32 v[152:153], v[152:153], v[154:155]
v_pk_add_f32 v[144:145], v[144:145], v[146:147]
v_pk_add_f32 v[148:149], v[148:149], v[150:151]
v_pk_add_f32 v[144:145], v[144:145], v[148:149]
v_add_f32 v11, v152, v153
v_add_f32 v10, v144, v145
v_fma_f32 v10, v11, v14, v10
v_mfma_f32_16x16x32_bf16 v[16:19], v[96:99], v[156:159], 0
v_mov_b32 v9, v8
v_mov_b32 v11, v10
s_nop 0
v_permlane16_swap_b32 v8, v9
v_permlane16_swap_b32 v10, v11
v_add_f32 v8, v8, v9
v_add_f32 v10, v10, v11
v_mfma_f32_16x16x32_bf16 v[20:23], v[100:103], v[156:159], 0
v_mfma_f32_16x16x32_bf16 v[24:27], v[104:107], v[156:159], 0
v_mfma_f32_16x16x32_bf16 v[28:31], v[108:111], v[156:159], 0
v_mov_b32 v9, v8
v_mov_b32 v11, v10
s_nop 0
v_permlane32_swap_b32 v8, v9
v_permlane32_swap_b32 v10, v11
v_add_f32 v8, v8, v9
v_add_f32 v10, v10, v11
v_mfma_f32_16x16x32_bf16 v[32:35], v[112:115], v[156:159], 0
v_mfma_f32_16x16x32_bf16 v[36:39], v[116:119], v[156:159], 0
v_mfma_f32_16x16x32_bf16 v[40:43], v[120:123], v[156:159], 0
v_rcp_f32 v176, v8
v_rcp_f32 v178, v10
v_mov_b32 v177, v176
v_mov_b32 v179, v178
v_mfma_f32_16x16x32_bf16 v[44:47], v[124:127], v[156:159], 0
v_mfma_f32_16x16x16_bf16 v[16:19], v[128:129], v[162:163], v[16:19]
v_mfma_f32_16x16x16_bf16 v[20:23], v[128:129], v[164:165], v[20:23]
v_mfma_f32_16x16x16_bf16 v[24:27], v[130:131], v[162:163], v[24:27]
v_mfma_f32_16x16x16_bf16 v[28:31], v[130:131], v[164:165], v[28:31]
v_mfma_f32_16x16x16_bf16 v[32:35], v[132:133], v[162:163], v[32:35]
v_mfma_f32_16x16x16_bf16 v[36:39], v[132:133], v[164:165], v[36:39]
v_mfma_f32_16x16x16_bf16 v[40:43], v[134:135], v[162:163], v[40:43]
v_mfma_f32_16x16x16_bf16 v[44:47], v[134:135], v[164:165], v[44:47]
v_mfma_f32_16x16x32_bf16 v[48:51], v[96:99], v[166:169], 0
v_mfma_f32_16x16x32_bf16 v[52:55], v[100:103], v[166:169], 0
v_mfma_f32_16x16x32_bf16 v[56:59], v[104:107], v[166:169], 0
v_mfma_f32_16x16x32_bf16 v[60:63], v[108:111], v[166:169], 0
v_mfma_f32_16x16x32_bf16 v[64:67], v[112:115], v[166:169], 0
v_mfma_f32_16x16x32_bf16 v[68:71], v[116:119], v[166:169], 0
v_mfma_f32_16x16x32_bf16 v[72:75], v[120:123], v[166:169], 0
v_mfma_f32_16x16x32_bf16 v[76:79], v[124:127], v[166:169], 0
v_mfma_f32_16x16x16_bf16 v[48:51], v[128:129], v[172:173], v[48:51]
v_mfma_f32_16x16x16_bf16 v[52:55], v[128:129], v[174:175], v[52:55]
v_mfma_f32_16x16x16_bf16 v[56:59], v[130:131], v[172:173], v[56:59]
v_mfma_f32_16x16x16_bf16 v[60:63], v[130:131], v[174:175], v[60:63]
v_mfma_f32_16x16x16_bf16 v[64:67], v[132:133], v[172:173], v[64:67]
v_mfma_f32_16x16x16_bf16 v[68:71], v[132:133], v[174:175], v[68:71]
v_mfma_f32_16x16x16_bf16 v[72:75], v[134:135], v[172:173], v[72:75]
v_mfma_f32_16x16x16_bf16 v[76:79], v[134:135], v[174:175], v[76:79]
v_pk_mul_f32 v[16:17], v[16:17], v[176:177]
v_pk_mul_f32 v[18:19], v[18:19], v[176:177]
v_pk_mul_f32 v[20:21], v[20:21], v[176:177]
v_pk_mul_f32 v[22:23], v[22:23], v[176:177]
v_cvt_pk_bf16_f32 v16, v16, v17
v_cvt_pk_bf16_f32 v17, v18, v19
v_cvt_pk_bf16_f32 v18, v20, v21
v_cvt_pk_bf16_f32 v19, v22, v23
.if \sf == 0
buffer_store_dwordx4 v[16:19], v2, s[8:11], s45 offen offset:0
.else
buffer_store_dwordx4 v[16:19], v2, s[8:11], s45 offen offset:0 sc1
.endif
v_pk_mul_f32 v[24:25], v[24:25], v[176:177]
v_pk_mul_f32 v[26:27], v[26:27], v[176:177]
v_pk_mul_f32 v[28:29], v[28:29], v[176:177]
v_pk_mul_f32 v[30:31], v[30:31], v[176:177]
v_cvt_pk_bf16_f32 v24, v24, v25
v_cvt_pk_bf16_f32 v25, v26, v27
v_cvt_pk_bf16_f32 v26, v28, v29
v_cvt_pk_bf16_f32 v27, v30, v31
.if \sf == 0
buffer_store_dwordx4 v[24:27], v2, s[8:11], s45 offen offset:1024
.else
buffer_store_dwordx4 v[24:27], v2, s[8:11], s45 offen offset:1024 sc1
.endif
v_pk_mul_f32 v[32:33], v[32:33], v[176:177]
v_pk_mul_f32 v[34:35], v[34:35], v[176:177]
v_pk_mul_f32 v[36:37], v[36:37], v[176:177]
v_pk_mul_f32 v[38:39], v[38:39], v[176:177]
v_cvt_pk_bf16_f32 v32, v32, v33
v_cvt_pk_bf16_f32 v33, v34, v35
v_cvt_pk_bf16_f32 v34, v36, v37
v_cvt_pk_bf16_f32 v35, v38, v39
.if \sf == 0
buffer_store_dwordx4 v[32:35], v2, s[8:11], s45 offen offset:2048
.else
buffer_store_dwordx4 v[32:35], v2, s[8:11], s45 offen offset:2048 sc1
.endif
v_pk_mul_f32 v[40:41], v[40:41], v[176:177]
v_pk_mul_f32 v[42:43], v[42:43], v[176:177]
v_pk_mul_f32 v[44:45], v[44:45], v[176:177]
v_pk_mul_f32 v[46:47], v[46:47], v[176:177]
v_cvt_pk_bf16_f32 v40, v40, v41
v_cvt_pk_bf16_f32 v41, v42, v43
v_cvt_pk_bf16_f32 v42, v44, v45
v_cvt_pk_bf16_f32 v43, v46, v47
.if \sf == 0
buffer_store_dwordx4 v[40:43], v2, s[8:11], s45 offen offset:3072
.else
buffer_store_dwordx4 v[40:43], v2, s[8:11], s45 offen offset:3072 sc1
.endif
v_pk_mul_f32 v[48:49], v[48:49], v[178:179]
v_pk_mul_f32 v[50:51], v[50:51], v[178:179]
v_pk_mul_f32 v[52:53], v[52:53], v[178:179]
v_pk_mul_f32 v[54:55], v[54:55], v[178:179]
v_cvt_pk_bf16_f32 v48, v48, v49
v_cvt_pk_bf16_f32 v49, v50, v51
v_cvt_pk_bf16_f32 v50, v52, v53
v_cvt_pk_bf16_f32 v51, v54, v55
.if \sf == 0
buffer_store_dwordx4 v[48:51], v2, s[8:11], s46 offen offset:0
.else
buffer_store_dwordx4 v[48:51], v2, s[8:11], s46 offen offset:0 sc1
.endif
v_pk_mul_f32 v[56:57], v[56:57], v[178:179]
v_pk_mul_f32 v[58:59], v[58:59], v[178:179]
v_pk_mul_f32 v[60:61], v[60:61], v[178:179]
v_pk_mul_f32 v[62:63], v[62:63], v[178:179]
v_cvt_pk_bf16_f32 v56, v56, v57
v_cvt_pk_bf16_f32 v57, v58, v59
v_cvt_pk_bf16_f32 v58, v60, v61
v_cvt_pk_bf16_f32 v59, v62, v63
.if \sf == 0
buffer_store_dwordx4 v[56:59], v2, s[8:11], s46 offen offset:1024
.else
buffer_store_dwordx4 v[56:59], v2, s[8:11], s46 offen offset:1024 sc1
.endif
v_pk_mul_f32 v[64:65], v[64:65], v[178:179]
v_pk_mul_f32 v[66:67], v[66:67], v[178:179]
v_pk_mul_f32 v[68:69], v[68:69], v[178:179]
v_pk_mul_f32 v[70:71], v[70:71], v[178:179]
v_cvt_pk_bf16_f32 v64, v64, v65
v_cvt_pk_bf16_f32 v65, v66, v67
v_cvt_pk_bf16_f32 v66, v68, v69
v_cvt_pk_bf16_f32 v67, v70, v71
.if \sf == 0
buffer_store_dwordx4 v[64:67], v2, s[8:11], s46 offen offset:2048
.else
buffer_store_dwordx4 v[64:67], v2, s[8:11], s46 offen offset:2048 sc1
.endif
v_pk_mul_f32 v[72:73], v[72:73], v[178:179]
v_pk_mul_f32 v[74:75], v[74:75], v[178:179]
v_pk_mul_f32 v[76:77], v[76:77], v[178:179]
v_pk_mul_f32 v[78:79], v[78:79], v[178:179]
v_cvt_pk_bf16_f32 v72, v72, v73
v_cvt_pk_bf16_f32 v73, v74, v75
v_cvt_pk_bf16_f32 v74, v76, v77
v_cvt_pk_bf16_f32 v75, v78, v79
.if \sf == 0
buffer_store_dwordx4 v[72:75], v2, s[8:11], s46 offen offset:3072
.else
buffer_store_dwordx4 v[72:75], v2, s[8:11], s46 offen offset:3072 sc1
.endif
s_waitcnt vmcnt(0)
s_nop 0
notask_166_\sf:
s_barrier
s_mov_b32 s88, s54
s_mov_b32 s58, 1
s_cmp_lg_u32 s94, 0
s_cbranch_scc1 nopub_168_\sf
s_lshl_b32 s45, s95, 2
s_add_u32 s45, s45, 0x5504000
v_mov_b32 v10, s88
v_mov_b32 v11, 0
s_mov_b64 exec, 1
.if \sf == 0
buffer_store_dword v10, v11, s[8:11], s45 offen
.else
buffer_store_dword v10, v11, s[8:11], s45 offen sc1
.endif
s_mov_b64 exec, -1
nopub_168_\sf:
noattn_165_\sf:
s_cmp_le_u32 s55, s89
s_cbranch_scc1 nowo_167_\sf
s_lshl_b32 s45, s89, 2
s_add_u32 s45, s45, s92
s_lshl_b32 s43, s45, 1
s_sub_u32 s57, s55, s89
s_min_u32 s57, s57, 4
s_lshl_b32 s59, s89, 1
s_add_u32 s89, s89, s57
s_lshl_b32 s49, s89, 1
v_and_b32 v1, 63, v0
v_lshlrev_b32 v2, 4, v1
v_add_u32 v3, 0x1000, v2
v_and_b32 v8, 15, v1
v_lshlrev_b32 v5, 2, v8
v_lshrrev_b32 v9, 4, v1
v_lshlrev_b32 v9, 4, v9
v_lshl_add_u32 v4, v8, 11, v9
s_mov_b32 s56, s59
s_mov_b32 s63, 0
s_lshr_b32 s74, s59, 1
s_lshl_b32 s74, s74, 2
s_add_u32 s74, s74, s92
s_lshl_b32 s74, s74, 1
s_and_b32 s48, s59, 1
s_add_u32 s74, s74, s48
s_lshl_b32 s74, s74, 17
s_lshl_b32 s46, s60, 15
s_add_u32 s74, s74, s46
s_lshl_b32 s46, s94, 13
s_add_u32 s74, s74, s46
s_add_u32 s74, s74, 0x3000000
s_lshl_b32 s75, s63, 15
s_add_u32 s75, s75, s46
s_mov_b32 m0, s75
s_nop 0
buffer_load_dwordx4 v2, s[8:11], s74 offen offset:0 sc1 lds
buffer_load_dwordx4 v2, s[8:11], s74 offen offset:1024 sc1 lds
buffer_load_dwordx4 v2, s[8:11], s74 offen offset:2048 sc1 lds
buffer_load_dwordx4 v2, s[8:11], s74 offen offset:3072 sc1 lds
s_add_u32 m0, s75, 4096
s_add_u32 s74, s74, 4096
buffer_load_dwordx4 v2, s[8:11], s74 offen offset:0 sc1 lds
buffer_load_dwordx4 v2, s[8:11], s74 offen offset:1024 sc1 lds
buffer_load_dwordx4 v2, s[8:11], s74 offen offset:2048 sc1 lds
buffer_load_dwordx4 v2, s[8:11], s74 offen offset:3072 sc1 lds
s_add_u32 s50, s59, 1
s_mov_b32 s51, 1
s_lshr_b32 s74, s50, 1
s_lshl_b32 s74, s74, 2
s_add_u32 s74, s74, s92
s_lshl_b32 s74, s74, 1
s_and_b32 s48, s50, 1
s_add_u32 s74, s74, s48
s_lshl_b32 s74, s74, 17
s_lshl_b32 s46, s60, 15
s_add_u32 s74, s74, s46
s_lshl_b32 s46, s94, 13
s_add_u32 s74, s74, s46
s_add_u32 s74, s74, 0x3000000
s_lshl_b32 s75, s51, 15
s_add_u32 s75, s75, s46
s_mov_b32 m0, s75
s_nop 0
buffer_load_dwordx4 v2, s[8:11], s74 offen offset:0 sc1 lds
buffer_load_dwordx4 v2, s[8:11], s74 offen offset:1024 sc1 lds
buffer_load_dwordx4 v2, s[8:11], s74 offen offset:2048 sc1 lds
buffer_load_dwordx4 v2, s[8:11], s74 offen offset:3072 sc1 lds
s_add_u32 m0, s75, 4096
s_add_u32 s74, s74, 4096
buffer_load_dwordx4 v2, s[8:11], s74 offen offset:0 sc1 lds
buffer_load_dwordx4 v2, s[8:11], s74 offen offset:1024 sc1 lds
buffer_load_dwordx4 v2, s[8:11], s74 offen offset:2048 sc1 lds
buffer_load_dwordx4 v2, s[8:11], s74 offen offset:3072 sc1 lds
s_lshl_b32 s64, s92, 23
s_lshl_b32 s45, s60, 16
s_add_u32 s64, s64, s45
s_lshl_b32 s45, s62, 11
s_add_u32 s64, s64, s45
s_add_u32 s64, s64, 0x7000000
s_lshl_b32 s57, s61, 2
s_add_u32 s57, s57, s60
s_add_u32 s51, s59, s94
s_lshr_b32 s47, s51, 1
s_lshl_b32 s47, s47, 2
s_add_u32 s47, s47, s92
s_lshl_b32 s47, s47, 1
s_and_b32 s48, s51, 1
s_add_u32 s47, s47, s48
s_lshl_b32 s45, s47, 15
s_lshl_b32 s46, s57, 6
s_add_u32 s45, s45, s46
buffer_load_dwordx4 v[152:155], v4, s[16:19], s45 offen
s_lshl_b32 s45, s47, 6
s_add_u32 s45, s45, 0x5400000
buffer_load_dword v160, v5, s[8:11], s45 offen sc1
s_add_u32 s51, s51, 4
s_lshr_b32 s47, s51, 1
s_lshl_b32 s47, s47, 2
s_add_u32 s47, s47, s92
s_lshl_b32 s47, s47, 1
s_and_b32 s48, s51, 1
s_add_u32 s47, s47, s48
s_lshl_b32 s45, s47, 15
s_lshl_b32 s46, s57, 6
s_add_u32 s45, s45, s46
buffer_load_dwordx4 v[156:159], v4, s[16:19], s45 offen
s_lshl_b32 s45, s47, 6
s_add_u32 s45, s45, 0x5400000
buffer_load_dword v161, v5, s[8:11], s45 offen sc1
s_waitcnt vmcnt(4)
w2l_170_\sf:
s_barrier
s_add_u32 s50, s59, 2
s_cmp_ge_u32 s50, s49
s_cbranch_scc1 w2last_171_\sf
s_lshl_b32 s45, s63, 15
v_add_u32 v8, s45, v2
ds_read_b128 v[16:19], v8 offset:0
ds_read_b128 v[20:23], v8 offset:1024
ds_read_b128 v[24:27], v8 offset:2048
ds_read_b128 v[28:31], v8 offset:3072
ds_read_b128 v[32:35], v8 offset:4096
ds_read_b128 v[36:39], v8 offset:5120
ds_read_b128 v[40:43], v8 offset:6144
ds_read_b128 v[44:47], v8 offset:7168
s_add_u32 s50, s59, 2
s_xor_b32 s51, s63, 2
s_lshr_b32 s74, s50, 1
s_lshl_b32 s74, s74, 2
s_add_u32 s74, s74, s92
s_lshl_b32 s74, s74, 1
s_and_b32 s48, s50, 1
s_add_u32 s74, s74, s48
s_lshl_b32 s74, s74, 17
s_lshl_b32 s46, s60, 15
s_add_u32 s74, s74, s46
s_lshl_b32 s46, s94, 13
s_add_u32 s74, s74, s46
s_add_u32 s74, s74, 0x3000000
s_lshl_b32 s75, s51, 15
s_add_u32 s75, s75, s46
s_lshl_b32 s47, s59, 18
s_add_u32 s47, s47, s64
s_add_u32 s45, s47, 0x40000
s_waitcnt lgkmcnt(7)
v_mfma_f32_16x16x32_bf16 v[96:99], a[0:3], v[16:19], 0
ds_read_b128 v[48:51], v8 offset:8192
v_mfma_f32_16x16x32_bf16 v[100:103], a[32:35], v[16:19], 0
s_waitcnt lgkmcnt(7)
v_mfma_f32_16x16x32_bf16 v[96:99], a[4:7], v[20:23], v[96:99]
ds_read_b128 v[52:55], v8 offset:9216
v_mfma_f32_16x16x32_bf16 v[100:103], a[36:39], v[20:23], v[100:103]
s_mov_b32 m0, s75
s_nop 0
buffer_load_dwordx4 v2, s[8:11], s74 offen offset:0 sc1 lds
s_waitcnt lgkmcnt(7)
v_mfma_f32_16x16x32_bf16 v[96:99], a[8:11], v[24:27], v[96:99]
ds_read_b128 v[56:59], v8 offset:10240
v_mfma_f32_16x16x32_bf16 v[100:103], a[40:43], v[24:27], v[100:103]
s_waitcnt lgkmcnt(7)
v_mfma_f32_16x16x32_bf16 v[96:99], a[12:15], v[28:31], v[96:99]
ds_read_b128 v[60:63], v8 offset:11264
v_mfma_f32_16x16x32_bf16 v[100:103], a[44:47], v[28:31], v[100:103]
buffer_load_dwordx4 v2, s[8:11], s74 offen offset:1024 sc1 lds
s_waitcnt lgkmcnt(7)
v_mfma_f32_16x16x32_bf16 v[96:99], a[16:19], v[32:35], v[96:99]
ds_read_b128 v[64:67], v8 offset:12288
v_mfma_f32_16x16x32_bf16 v[100:103], a[48:51], v[32:35], v[100:103]
s_waitcnt lgkmcnt(7)
v_mfma_f32_16x16x32_bf16 v[96:99], a[20:23], v[36:39], v[96:99]
ds_read_b128 v[68:71], v8 offset:13312
v_mfma_f32_16x16x32_bf16 v[100:103], a[52:55], v[36:39], v[100:103]
buffer_load_dwordx4 v2, s[8:11], s74 offen offset:2048 sc1 lds
s_waitcnt lgkmcnt(7)
v_mfma_f32_16x16x32_bf16 v[96:99], a[24:27], v[40:43], v[96:99]
ds_read_b128 v[72:75], v8 offset:14336
v_mfma_f32_16x16x32_bf16 v[100:103], a[56:59], v[40:43], v[100:103]
s_waitcnt lgkmcnt(7)
v_mfma_f32_16x16x32_bf16 v[96:99], a[28:31], v[44:47], v[96:99]
ds_read_b128 v[76:79], v8 offset:15360
v_mfma_f32_16x16x32_bf16 v[100:103], a[60:63], v[44:47], v[100:103]
buffer_load_dwordx4 v2, s[8:11], s74 offen offset:3072 sc1 lds
s_waitcnt lgkmcnt(7)
v_mfma_f32_16x16x32_bf16 v[96:99], a[64:67], v[48:51], v[96:99]
ds_read_b128 v[16:19], v8 offset:16384
v_mfma_f32_16x16x32_bf16 v[100:103], a[96:99], v[48:51], v[100:103]
s_waitcnt lgkmcnt(7)
v_mfma_f32_16x16x32_bf16 v[96:99], a[68:71], v[52:55], v[96:99]
ds_read_b128 v[20:23], v8 offset:17408
v_mfma_f32_16x16x32_bf16 v[100:103], a[100:103], v[52:55], v[100:103]
s_add_u32 m0, s75, 4096
s_add_u32 s74, s74, 4096
buffer_load_dwordx4 v2, s[8:11], s74 offen offset:0 sc1 lds
s_waitcnt lgkmcnt(7)
v_mfma_f32_16x16x32_bf16 v[96:99], a[72:75], v[56:59], v[96:99]
ds_read_b128 v[24:27], v8 offset:18432
v_mfma_f32_16x16x32_bf16 v[100:103], a[104:107], v[56:59], v[100:103]
s_waitcnt lgkmcnt(7)
v_mfma_f32_16x16x32_bf16 v[96:99], a[76:79], v[60:63], v[96:99]
ds_read_b128 v[28:31], v8 offset:19456
v_mfma_f32_16x16x32_bf16 v[100:103], a[108:111], v[60:63], v[100:103]
buffer_load_dwordx4 v2, s[8:11], s74 offen offset:1024 sc1 lds
s_waitcnt lgkmcnt(7)
v_mfma_f32_16x16x32_bf16 v[96:99], a[80:83], v[64:67], v[96:99]
ds_read_b128 v[32:35], v8 offset:20480
v_mfma_f32_16x16x32_bf16 v[100:103], a[112:115], v[64:67], v[100:103]
s_waitcnt lgkmcnt(7)
v_mfma_f32_16x16x32_bf16 v[96:99], a[84:87], v[68:71], v[96:99]
ds_read_b128 v[36:39], v8 offset:21504
v_mfma_f32_16x16x32_bf16 v[100:103], a[116:119], v[68:71], v[100:103]
buffer_load_dwordx4 v2, s[8:11], s74 offen offset:2048 sc1 lds
s_waitcnt lgkmcnt(7)
v_mfma_f32_16x16x32_bf16 v[96:99], a[88:91], v[72:75], v[96:99]
ds_read_b128 v[40:43], v8 offset:22528
v_mfma_f32_16x16x32_bf16 v[100:103], a[120:123], v[72:75], v[100:103]
s_waitcnt lgkmcnt(7)
v_mfma_f32_16x16x32_bf16 v[96:99], a[92:95], v[76:79], v[96:99]
ds_read_b128 v[44:47], v8 offset:23552
v_mfma_f32_16x16x32_bf16 v[100:103], a[124:127], v[76:79], v[100:103]
buffer_load_dwordx4 v2, s[8:11], s74 offen offset:3072 sc1 lds
s_waitcnt lgkmcnt(7)
v_mfma_f32_16x16x32_bf16 v[96:99], a[128:131], v[16:19], v[96:99]
ds_read_b128 v[48:51], v8 offset:24576
v_mfma_f32_16x16x32_bf16 v[100:103], a[160:163], v[16:19], v[100:103]
s_waitcnt lgkmcnt(7)
v_mfma_f32_16x16x32_bf16 v[96:99], a[132:135], v[20:23], v[96:99]
ds_read_b128 v[52:55], v8 offset:25600
v_mfma_f32_16x16x32_bf16 v[100:103], a[164:167], v[20:23], v[100:103]
s_add_u32 s74, s74, 0x1f000
s_add_u32 s75, s75, 0x8000
s_mov_b32 m0, s75
s_nop 0
buffer_load_dwordx4 v2, s[8:11], s74 offen offset:0 sc1 lds
s_waitcnt lgkmcnt(7)
v_mfma_f32_16x16x32_bf16 v[96:99], a[136:139], v[24:27], v[96:99]
ds_read_b128 v[56:59], v8 offset:26624
v_mfma_f32_16x16x32_bf16 v[100:103], a[168:171], v[24:27], v[100:103]
s_waitcnt lgkmcnt(7)
v_mfma_f32_16x16x32_bf16 v[96:99], a[140:143], v[28:31], v[96:99]
ds_read_b128 v[60:63], v8 offset:27648
v_mfma_f32_16x16x32_bf16 v[100:103], a[172:175], v[28:31], v[100:103]
buffer_load_dwordx4 v2, s[8:11], s74 offen offset:1024 sc1 lds
s_waitcnt lgkmcnt(7)
v_mfma_f32_16x16x32_bf16 v[96:99], a[144:147], v[32:35], v[96:99]
ds_read_b128 v[64:67], v8 offset:28672
v_mfma_f32_16x16x32_bf16 v[100:103], a[176:179], v[32:35], v[100:103]
s_waitcnt lgkmcnt(7)
v_mfma_f32_16x16x32_bf16 v[96:99], a[148:151], v[36:39], v[96:99]
ds_read_b128 v[68:71], v8 offset:29696
v_mfma_f32_16x16x32_bf16 v[100:103], a[180:183], v[36:39], v[100:103]
buffer_load_dwordx4 v2, s[8:11], s74 offen offset:2048 sc1 lds
s_waitcnt lgkmcnt(7)
v_mfma_f32_16x16x32_bf16 v[96:99], a[152:155], v[40:43], v[96:99]
ds_read_b128 v[72:75], v8 offset:30720
v_mfma_f32_16x16x32_bf16 v[100:103], a[184:187], v[40:43], v[100:103]
s_waitcnt lgkmcnt(7)
v_mfma_f32_16x16x32_bf16 v[96:99], a[156:159], v[44:47], v[96:99]
ds_read_b128 v[76:79], v8 offset:31744
v_mfma_f32_16x16x32_bf16 v[100:103], a[188:191], v[44:47], v[100:103]
buffer_load_dwordx4 v2, s[8:11], s74 offen offset:3072 sc1 lds
s_waitcnt lgkmcnt(7)
v_mfma_f32_16x16x32_bf16 v[96:99], a[192:195], v[48:51], v[96:99]
ds_read_b128 v[16:19], v8 offset:32768
v_mfma_f32_16x16x32_bf16 v[100:103], a[224:227], v[48:51], v[100:103]
s_waitcnt lgkmcnt(7)
v_mfma_f32_16x16x32_bf16 v[96:99], a[196:199], v[52:55], v[96:99]
ds_read_b128 v[20:23], v8 offset:33792
v_mfma_f32_16x16x32_bf16 v[100:103], a[228:231], v[52:55], v[100:103]
s_add_u32 m0, s75, 4096
s_add_u32 s74, s74, 4096
buffer_load_dwordx4 v2, s[8:11], s74 offen offset:0 sc1 lds
s_waitcnt lgkmcnt(7)
v_mfma_f32_16x16x32_bf16 v[96:99], a[200:203], v[56:59], v[96:99]
ds_read_b128 v[24:27], v8 offset:34816
v_mfma_f32_16x16x32_bf16 v[100:103], a[232:235], v[56:59], v[100:103]
s_waitcnt lgkmcnt(7)
v_mfma_f32_16x16x32_bf16 v[96:99], a[204:207], v[60:63], v[96:99]
ds_read_b128 v[28:31], v8 offset:35840
v_mfma_f32_16x16x32_bf16 v[100:103], a[236:239], v[60:63], v[100:103]
buffer_load_dwordx4 v2, s[8:11], s74 offen offset:1024 sc1 lds
s_waitcnt lgkmcnt(7)
v_mfma_f32_16x16x32_bf16 v[96:99], a[208:211], v[64:67], v[96:99]
ds_read_b128 v[32:35], v8 offset:36864
v_mfma_f32_16x16x32_bf16 v[100:103], a[240:243], v[64:67], v[100:103]
s_waitcnt lgkmcnt(7)
v_mfma_f32_16x16x32_bf16 v[96:99], a[212:215], v[68:71], v[96:99]
ds_read_b128 v[36:39], v8 offset:37888
v_mfma_f32_16x16x32_bf16 v[100:103], a[244:247], v[68:71], v[100:103]
buffer_load_dwordx4 v2, s[8:11], s74 offen offset:2048 sc1 lds
s_waitcnt lgkmcnt(7)
v_mfma_f32_16x16x32_bf16 v[96:99], a[216:219], v[72:75], v[96:99]
ds_read_b128 v[40:43], v8 offset:38912
v_mfma_f32_16x16x32_bf16 v[100:103], a[248:251], v[72:75], v[100:103]
s_waitcnt lgkmcnt(7)
v_mfma_f32_16x16x32_bf16 v[96:99], a[220:223], v[76:79], v[96:99]
ds_read_b128 v[44:47], v8 offset:39936
v_mfma_f32_16x16x32_bf16 v[100:103], a[252:255], v[76:79], v[100:103]
buffer_load_dwordx4 v2, s[8:11], s74 offen offset:3072 sc1 lds
s_waitcnt lgkmcnt(7)
v_mfma_f32_16x16x32_bf16 v[104:107], a[0:3], v[16:19], 0
ds_read_b128 v[48:51], v8 offset:40960
v_mfma_f32_16x16x32_bf16 v[108:111], a[32:35], v[16:19], 0
s_waitcnt lgkmcnt(7)
v_mfma_f32_16x16x32_bf16 v[104:107], a[4:7], v[20:23], v[104:107]
ds_read_b128 v[52:55], v8 offset:41984
v_mfma_f32_16x16x32_bf16 v[108:111], a[36:39], v[20:23], v[108:111]
s_waitcnt lgkmcnt(7)
v_mfma_f32_16x16x32_bf16 v[104:107], a[8:11], v[24:27], v[104:107]
ds_read_b128 v[56:59], v8 offset:43008
v_mfma_f32_16x16x32_bf16 v[108:111], a[40:43], v[24:27], v[108:111]
s_waitcnt lgkmcnt(7)
v_mfma_f32_16x16x32_bf16 v[104:107], a[12:15], v[28:31], v[104:107]
ds_read_b128 v[60:63], v8 offset:44032
v_mfma_f32_16x16x32_bf16 v[108:111], a[44:47], v[28:31], v[108:111]
s_waitcnt lgkmcnt(7)
v_mfma_f32_16x16x32_bf16 v[104:107], a[16:19], v[32:35], v[104:107]
ds_read_b128 v[64:67], v8 offset:45056
v_mfma_f32_16x16x32_bf16 v[108:111], a[48:51], v[32:35], v[108:111]
s_waitcnt lgkmcnt(7)
v_mfma_f32_16x16x32_bf16 v[104:107], a[20:23], v[36:39], v[104:107]
ds_read_b128 v[68:71], v8 offset:46080
v_mfma_f32_16x16x32_bf16 v[108:111], a[52:55], v[36:39], v[108:111]
.if \sf == 0
buffer_store_dwordx4 v[96:99], v2, s[8:11], s47 offen offset:0
buffer_store_dwordx4 v[100:103], v2, s[8:11], s47 offen offset:1024
.else
buffer_store_dwordx4 v[96:99], v2, s[8:11], s47 offen offset:0 sc1
buffer_store_dwordx4 v[100:103], v2, s[8:11], s47 offen offset:1024 sc1
.endif
s_waitcnt lgkmcnt(7)
v_mfma_f32_16x16x32_bf16 v[104:107], a[24:27], v[40:43], v[104:107]
ds_read_b128 v[72:75], v8 offset:47104
v_mfma_f32_16x16x32_bf16 v[108:111], a[56:59], v[40:43], v[108:111]
s_waitcnt lgkmcnt(7)
v_mfma_f32_16x16x32_bf16 v[104:107], a[28:31], v[44:47], v[104:107]
ds_read_b128 v[76:79], v8 offset:48128
v_mfma_f32_16x16x32_bf16 v[108:111], a[60:63], v[44:47], v[108:111]
s_waitcnt lgkmcnt(7)
v_mfma_f32_16x16x32_bf16 v[104:107], a[64:67], v[48:51], v[104:107]
ds_read_b128 v[16:19], v8 offset:49152
v_mfma_f32_16x16x32_bf16 v[108:111], a[96:99], v[48:51], v[108:111]
s_waitcnt lgkmcnt(7)
v_mfma_f32_16x16x32_bf16 v[104:107], a[68:71], v[52:55], v[104:107]
ds_read_b128 v[20:23], v8 offset:50176
v_mfma_f32_16x16x32_bf16 v[108:111], a[100:103], v[52:55], v[108:111]
s_waitcnt lgkmcnt(7)
v_mfma_f32_16x16x32_bf16 v[104:107], a[72:75], v[56:59], v[104:107]
ds_read_b128 v[24:27], v8 offset:51200
v_mfma_f32_16x16x32_bf16 v[108:111], a[104:107], v[56:59], v[108:111]
s_waitcnt lgkmcnt(7)
v_mfma_f32_16x16x32_bf16 v[104:107], a[76:79], v[60:63], v[104:107]
ds_read_b128 v[28:31], v8 offset:52224
v_mfma_f32_16x16x32_bf16 v[108:111], a[108:111], v[60:63], v[108:111]
s_waitcnt lgkmcnt(7)
v_mfma_f32_16x16x32_bf16 v[104:107], a[80:83], v[64:67], v[104:107]
ds_read_b128 v[32:35], v8 offset:53248
v_mfma_f32_16x16x32_bf16 v[108:111], a[112:115], v[64:67], v[108:111]
s_waitcnt lgkmcnt(7)
v_mfma_f32_16x16x32_bf16 v[104:107], a[84:87], v[68:71], v[104:107]
ds_read_b128 v[36:39], v8 offset:54272
v_mfma_f32_16x16x32_bf16 v[108:111], a[116:119], v[68:71], v[108:111]
s_waitcnt lgkmcnt(7)
v_mfma_f32_16x16x32_bf16 v[104:107], a[88:91], v[72:75], v[104:107]
ds_read_b128 v[40:43], v8 offset:55296
v_mfma_f32_16x16x32_bf16 v[108:111], a[120:123], v[72:75], v[108:111]
s_waitcnt lgkmcnt(7)
v_mfma_f32_16x16x32_bf16 v[104:107], a[92:95], v[76:79], v[104:107]
ds_read_b128 v[44:47], v8 offset:56320
v_mfma_f32_16x16x32_bf16 v[108:111], a[124:127], v[76:79], v[108:111]
s_waitcnt lgkmcnt(7)
v_mfma_f32_16x16x32_bf16 v[104:107], a[128:131], v[16:19], v[104:107]
ds_read_b128 v[48:51], v8 offset:57344
v_mfma_f32_16x16x32_bf16 v[108:111], a[160:163], v[16:19], v[108:111]
s_waitcnt lgkmcnt(7)
v_mfma_f32_16x16x32_bf16 v[104:107], a[132:135], v[20:23], v[104:107]
ds_read_b128 v[52:55], v8 offset:58368
v_mfma_f32_16x16x32_bf16 v[108:111], a[164:167], v[20:23], v[108:111]
s_waitcnt lgkmcnt(7)
v_mfma_f32_16x16x32_bf16 v[104:107], a[136:139], v[24:27], v[104:107]
ds_read_b128 v[56:59], v8 offset:59392
v_mfma_f32_16x16x32_bf16 v[108:111], a[168:171], v[24:27], v[108:111]
s_waitcnt lgkmcnt(7)
v_mfma_f32_16x16x32_bf16 v[104:107], a[140:143], v[28:31], v[104:107]
ds_read_b128 v[60:63], v8 offset:60416
v_mfma_f32_16x16x32_bf16 v[108:111], a[172:175], v[28:31], v[108:111]
s_waitcnt lgkmcnt(7)
v_mfma_f32_16x16x32_bf16 v[104:107], a[144:147], v[32:35], v[104:107]
ds_read_b128 v[64:67], v8 offset:61440
v_mfma_f32_16x16x32_bf16 v[108:111], a[176:179], v[32:35], v[108:111]
s_waitcnt lgkmcnt(7)
v_mfma_f32_16x16x32_bf16 v[104:107], a[148:151], v[36:39], v[104:107]
ds_read_b128 v[68:71], v8 offset:62464
v_mfma_f32_16x16x32_bf16 v[108:111], a[180:183], v[36:39], v[108:111]
s_waitcnt lgkmcnt(7)
v_mfma_f32_16x16x32_bf16 v[104:107], a[152:155], v[40:43], v[104:107]
ds_read_b128 v[72:75], v8 offset:63488
v_mfma_f32_16x16x32_bf16 v[108:111], a[184:187], v[40:43], v[108:111]
s_waitcnt lgkmcnt(7)
v_mfma_f32_16x16x32_bf16 v[104:107], a[156:159], v[44:47], v[104:107]
ds_read_b128 v[76:79], v8 offset:64512
v_mfma_f32_16x16x32_bf16 v[108:111], a[188:191], v[44:47], v[108:111]
s_waitcnt lgkmcnt(7)
v_mfma_f32_16x16x32_bf16 v[104:107], a[192:195], v[48:51], v[104:107]
v_mfma_f32_16x16x32_bf16 v[108:111], a[224:227], v[48:51], v[108:111]
s_waitcnt lgkmcnt(6)
v_mfma_f32_16x16x32_bf16 v[104:107], a[196:199], v[52:55], v[104:107]
v_mfma_f32_16x16x32_bf16 v[108:111], a[228:231], v[52:55], v[108:111]
s_waitcnt lgkmcnt(5)
v_mfma_f32_16x16x32_bf16 v[104:107], a[200:203], v[56:59], v[104:107]
v_mfma_f32_16x16x32_bf16 v[108:111], a[232:235], v[56:59], v[108:111]
s_waitcnt lgkmcnt(4)
v_mfma_f32_16x16x32_bf16 v[104:107], a[204:207], v[60:63], v[104:107]
v_mfma_f32_16x16x32_bf16 v[108:111], a[236:239], v[60:63], v[108:111]
s_waitcnt lgkmcnt(3)
v_mfma_f32_16x16x32_bf16 v[104:107], a[208:211], v[64:67], v[104:107]
v_mfma_f32_16x16x32_bf16 v[108:111], a[240:243], v[64:67], v[108:111]
s_waitcnt lgkmcnt(2)
v_mfma_f32_16x16x32_bf16 v[104:107], a[212:215], v[68:71], v[104:107]
v_mfma_f32_16x16x32_bf16 v[108:111], a[244:247], v[68:71], v[108:111]
s_waitcnt lgkmcnt(1)
v_mfma_f32_16x16x32_bf16 v[104:107], a[216:219], v[72:75], v[104:107]
v_mfma_f32_16x16x32_bf16 v[108:111], a[248:251], v[72:75], v[108:111]
s_waitcnt lgkmcnt(0)
v_mfma_f32_16x16x32_bf16 v[104:107], a[220:223], v[76:79], v[104:107]
v_mfma_f32_16x16x32_bf16 v[108:111], a[252:255], v[76:79], v[108:111]
s_add_u32 s59, s59, 2
s_xor_b32 s63, s63, 2
s_nop 4
.if \sf == 0
buffer_store_dwordx4 v[104:107], v2, s[8:11], s45 offen offset:0
buffer_store_dwordx4 v[108:111], v2, s[8:11], s45 offen offset:1024
.else
buffer_store_dwordx4 v[104:107], v2, s[8:11], s45 offen offset:0 sc1
buffer_store_dwordx4 v[108:111], v2, s[8:11], s45 offen offset:1024 sc1
.endif
s_waitcnt vmcnt(4)
s_nop 0
s_branch w2l_170_\sf
w2last_171_\sf:
s_lshl_b32 s45, s63, 15
v_add_u32 v8, s45, v2
ds_read_b128 v[16:19], v8 offset:0
ds_read_b128 v[20:23], v8 offset:1024
ds_read_b128 v[24:27], v8 offset:2048
ds_read_b128 v[28:31], v8 offset:3072
ds_read_b128 v[32:35], v8 offset:4096
ds_read_b128 v[36:39], v8 offset:5120
ds_read_b128 v[40:43], v8 offset:6144
ds_read_b128 v[44:47], v8 offset:7168
s_lshl_b32 s47, s59, 18
s_add_u32 s47, s47, s64
s_add_u32 s45, s47, 0x40000
s_waitcnt lgkmcnt(7)
v_mfma_f32_16x16x32_bf16 v[96:99], a[0:3], v[16:19], 0
ds_read_b128 v[48:51], v8 offset:8192
v_mfma_f32_16x16x32_bf16 v[100:103], a[32:35], v[16:19], 0
s_waitcnt lgkmcnt(7)
v_mfma_f32_16x16x32_bf16 v[96:99], a[4:7], v[20:23], v[96:99]
ds_read_b128 v[52:55], v8 offset:9216
v_mfma_f32_16x16x32_bf16 v[100:103], a[36:39], v[20:23], v[100:103]
s_waitcnt lgkmcnt(7)
v_mfma_f32_16x16x32_bf16 v[96:99], a[8:11], v[24:27], v[96:99]
ds_read_b128 v[56:59], v8 offset:10240
v_mfma_f32_16x16x32_bf16 v[100:103], a[40:43], v[24:27], v[100:103]
s_waitcnt lgkmcnt(7)
v_mfma_f32_16x16x32_bf16 v[96:99], a[12:15], v[28:31], v[96:99]
ds_read_b128 v[60:63], v8 offset:11264
v_mfma_f32_16x16x32_bf16 v[100:103], a[44:47], v[28:31], v[100:103]
s_waitcnt lgkmcnt(7)
v_mfma_f32_16x16x32_bf16 v[96:99], a[16:19], v[32:35], v[96:99]
ds_read_b128 v[64:67], v8 offset:12288
v_mfma_f32_16x16x32_bf16 v[100:103], a[48:51], v[32:35], v[100:103]
s_waitcnt lgkmcnt(7)
v_mfma_f32_16x16x32_bf16 v[96:99], a[20:23], v[36:39], v[96:99]
ds_read_b128 v[68:71], v8 offset:13312
v_mfma_f32_16x16x32_bf16 v[100:103], a[52:55], v[36:39], v[100:103]
s_waitcnt lgkmcnt(7)
v_mfma_f32_16x16x32_bf16 v[96:99], a[24:27], v[40:43], v[96:99]
ds_read_b128 v[72:75], v8 offset:14336
v_mfma_f32_16x16x32_bf16 v[100:103], a[56:59], v[40:43], v[100:103]
s_waitcnt lgkmcnt(7)
v_mfma_f32_16x16x32_bf16 v[96:99], a[28:31], v[44:47], v[96:99]
ds_read_b128 v[76:79], v8 offset:15360
v_mfma_f32_16x16x32_bf16 v[100:103], a[60:63], v[44:47], v[100:103]
s_waitcnt lgkmcnt(7)
v_mfma_f32_16x16x32_bf16 v[96:99], a[64:67], v[48:51], v[96:99]
ds_read_b128 v[16:19], v8 offset:16384
v_mfma_f32_16x16x32_bf16 v[100:103], a[96:99], v[48:51], v[100:103]
s_waitcnt lgkmcnt(7)
v_mfma_f32_16x16x32_bf16 v[96:99], a[68:71], v[52:55], v[96:99]
ds_read_b128 v[20:23], v8 offset:17408
v_mfma_f32_16x16x32_bf16 v[100:103], a[100:103], v[52:55], v[100:103]
s_waitcnt lgkmcnt(7)
v_mfma_f32_16x16x32_bf16 v[96:99], a[72:75], v[56:59], v[96:99]
ds_read_b128 v[24:27], v8 offset:18432
v_mfma_f32_16x16x32_bf16 v[100:103], a[104:107], v[56:59], v[100:103]
s_waitcnt lgkmcnt(7)
v_mfma_f32_16x16x32_bf16 v[96:99], a[76:79], v[60:63], v[96:99]
ds_read_b128 v[28:31], v8 offset:19456
v_mfma_f32_16x16x32_bf16 v[100:103], a[108:111], v[60:63], v[100:103]
s_waitcnt lgkmcnt(7)
v_mfma_f32_16x16x32_bf16 v[96:99], a[80:83], v[64:67], v[96:99]
ds_read_b128 v[32:35], v8 offset:20480
v_mfma_f32_16x16x32_bf16 v[100:103], a[112:115], v[64:67], v[100:103]
s_waitcnt lgkmcnt(7)
v_mfma_f32_16x16x32_bf16 v[96:99], a[84:87], v[68:71], v[96:99]
ds_read_b128 v[36:39], v8 offset:21504
v_mfma_f32_16x16x32_bf16 v[100:103], a[116:119], v[68:71], v[100:103]
s_waitcnt lgkmcnt(7)
v_mfma_f32_16x16x32_bf16 v[96:99], a[88:91], v[72:75], v[96:99]
ds_read_b128 v[40:43], v8 offset:22528
v_mfma_f32_16x16x32_bf16 v[100:103], a[120:123], v[72:75], v[100:103]
s_waitcnt lgkmcnt(7)
v_mfma_f32_16x16x32_bf16 v[96:99], a[92:95], v[76:79], v[96:99]
ds_read_b128 v[44:47], v8 offset:23552
v_mfma_f32_16x16x32_bf16 v[100:103], a[124:127], v[76:79], v[100:103]
s_waitcnt lgkmcnt(7)
v_mfma_f32_16x16x32_bf16 v[96:99], a[128:131], v[16:19], v[96:99]
ds_read_b128 v[48:51], v8 offset:24576
v_mfma_f32_16x16x32_bf16 v[100:103], a[160:163], v[16:19], v[100:103]
s_waitcnt lgkmcnt(7)
v_mfma_f32_16x16x32_bf16 v[96:99], a[132:135], v[20:23], v[96:99]
ds_read_b128 v[52:55], v8 offset:25600
v_mfma_f32_16x16x32_bf16 v[100:103], a[164:167], v[20:23], v[100:103]
s_waitcnt lgkmcnt(7)
v_mfma_f32_16x16x32_bf16 v[96:99], a[136:139], v[24:27], v[96:99]
ds_read_b128 v[56:59], v8 offset:26624
v_mfma_f32_16x16x32_bf16 v[100:103], a[168:171], v[24:27], v[100:103]
s_waitcnt lgkmcnt(7)
v_mfma_f32_16x16x32_bf16 v[96:99], a[140:143], v[28:31], v[96:99]
ds_read_b128 v[60:63], v8 offset:27648
v_mfma_f32_16x16x32_bf16 v[100:103], a[172:175], v[28:31], v[100:103]
s_waitcnt lgkmcnt(7)
v_mfma_f32_16x16x32_bf16 v[96:99], a[144:147], v[32:35], v[96:99]
ds_read_b128 v[64:67], v8 offset:28672
v_mfma_f32_16x16x32_bf16 v[100:103], a[176:179], v[32:35], v[100:103]
s_waitcnt lgkmcnt(7)
v_mfma_f32_16x16x32_bf16 v[96:99], a[148:151], v[36:39], v[96:99]
ds_read_b128 v[68:71], v8 offset:29696
v_mfma_f32_16x16x32_bf16 v[100:103], a[180:183], v[36:39], v[100:103]
s_waitcnt lgkmcnt(7)
v_mfma_f32_16x16x32_bf16 v[96:99], a[152:155], v[40:43], v[96:99]
ds_read_b128 v[72:75], v8 offset:30720
v_mfma_f32_16x16x32_bf16 v[100:103], a[184:187], v[40:43], v[100:103]
s_waitcnt lgkmcnt(7)
v_mfma_f32_16x16x32_bf16 v[96:99], a[156:159], v[44:47], v[96:99]
ds_read_b128 v[76:79], v8 offset:31744
v_mfma_f32_16x16x32_bf16 v[100:103], a[188:191], v[44:47], v[100:103]
s_waitcnt lgkmcnt(7)
v_mfma_f32_16x16x32_bf16 v[96:99], a[192:195], v[48:51], v[96:99]
ds_read_b128 v[16:19], v8 offset:32768
v_mfma_f32_16x16x32_bf16 v[100:103], a[224:227], v[48:51], v[100:103]
s_waitcnt lgkmcnt(7)
v_mfma_f32_16x16x32_bf16 v[96:99], a[196:199], v[52:55], v[96:99]
ds_read_b128 v[20:23], v8 offset:33792
v_mfma_f32_16x16x32_bf16 v[100:103], a[228:231], v[52:55], v[100:103]
s_waitcnt lgkmcnt(7)
v_mfma_f32_16x16x32_bf16 v[96:99], a[200:203], v[56:59], v[96:99]
ds_read_b128 v[24:27], v8 offset:34816
v_mfma_f32_16x16x32_bf16 v[100:103], a[232:235], v[56:59], v[100:103]
s_waitcnt lgkmcnt(7)
v_mfma_f32_16x16x32_bf16 v[96:99], a[204:207], v[60:63], v[96:99]
ds_read_b128 v[28:31], v8 offset:35840
v_mfma_f32_16x16x32_bf16 v[100:103], a[236:239], v[60:63], v[100:103]
s_waitcnt lgkmcnt(7)
v_mfma_f32_16x16x32_bf16 v[96:99], a[208:211], v[64:67], v[96:99]
ds_read_b128 v[32:35], v8 offset:36864
v_mfma_f32_16x16x32_bf16 v[100:103], a[240:243], v[64:67], v[100:103]
s_waitcnt lgkmcnt(7)
v_mfma_f32_16x16x32_bf16 v[96:99], a[212:215], v[68:71], v[96:99]
ds_read_b128 v[36:39], v8 offset:37888
v_mfma_f32_16x16x32_bf16 v[100:103], a[244:247], v[68:71], v[100:103]
s_waitcnt lgkmcnt(7)
v_mfma_f32_16x16x32_bf16 v[96:99], a[216:219], v[72:75], v[96:99]
ds_read_b128 v[40:43], v8 offset:38912
v_mfma_f32_16x16x32_bf16 v[100:103], a[248:251], v[72:75], v[100:103]
s_waitcnt lgkmcnt(7)
v_mfma_f32_16x16x32_bf16 v[96:99], a[220:223], v[76:79], v[96:99]
ds_read_b128 v[44:47], v8 offset:39936
v_mfma_f32_16x16x32_bf16 v[100:103], a[252:255], v[76:79], v[100:103]
s_waitcnt lgkmcnt(7)
v_mfma_f32_16x16x32_bf16 v[104:107], a[0:3], v[16:19], 0
ds_read_b128 v[48:51], v8 offset:40960
v_mfma_f32_16x16x32_bf16 v[108:111], a[32:35], v[16:19], 0
s_waitcnt lgkmcnt(7)
v_mfma_f32_16x16x32_bf16 v[104:107], a[4:7], v[20:23], v[104:107]
ds_read_b128 v[52:55], v8 offset:41984
v_mfma_f32_16x16x32_bf16 v[108:111], a[36:39], v[20:23], v[108:111]
s_waitcnt lgkmcnt(7)
v_mfma_f32_16x16x32_bf16 v[104:107], a[8:11], v[24:27], v[104:107]
ds_read_b128 v[56:59], v8 offset:43008
v_mfma_f32_16x16x32_bf16 v[108:111], a[40:43], v[24:27], v[108:111]
s_waitcnt lgkmcnt(7)
v_mfma_f32_16x16x32_bf16 v[104:107], a[12:15], v[28:31], v[104:107]
ds_read_b128 v[60:63], v8 offset:44032
v_mfma_f32_16x16x32_bf16 v[108:111], a[44:47], v[28:31], v[108:111]
s_waitcnt lgkmcnt(7)
v_mfma_f32_16x16x32_bf16 v[104:107], a[16:19], v[32:35], v[104:107]
ds_read_b128 v[64:67], v8 offset:45056
v_mfma_f32_16x16x32_bf16 v[108:111], a[48:51], v[32:35], v[108:111]
s_waitcnt lgkmcnt(7)
v_mfma_f32_16x16x32_bf16 v[104:107], a[20:23], v[36:39], v[104:107]
ds_read_b128 v[68:71], v8 offset:46080
v_mfma_f32_16x16x32_bf16 v[108:111], a[52:55], v[36:39], v[108:111]
.if \sf == 0
buffer_store_dwordx4 v[96:99], v2, s[8:11], s47 offen offset:0
buffer_store_dwordx4 v[100:103], v2, s[8:11], s47 offen offset:1024
.else
buffer_store_dwordx4 v[96:99], v2, s[8:11], s47 offen offset:0 sc1
buffer_store_dwordx4 v[100:103], v2, s[8:11], s47 offen offset:1024 sc1
.endif
s_waitcnt lgkmcnt(7)
v_mfma_f32_16x16x32_bf16 v[104:107], a[24:27], v[40:43], v[104:107]
ds_read_b128 v[72:75], v8 offset:47104
v_mfma_f32_16x16x32_bf16 v[108:111], a[56:59], v[40:43], v[108:111]
s_waitcnt lgkmcnt(7)
v_mfma_f32_16x16x32_bf16 v[104:107], a[28:31], v[44:47], v[104:107]
ds_read_b128 v[76:79], v8 offset:48128
v_mfma_f32_16x16x32_bf16 v[108:111], a[60:63], v[44:47], v[108:111]
s_waitcnt lgkmcnt(7)
v_mfma_f32_16x16x32_bf16 v[104:107], a[64:67], v[48:51], v[104:107]
ds_read_b128 v[16:19], v8 offset:49152
v_mfma_f32_16x16x32_bf16 v[108:111], a[96:99], v[48:51], v[108:111]
s_waitcnt lgkmcnt(7)
v_mfma_f32_16x16x32_bf16 v[104:107], a[68:71], v[52:55], v[104:107]
ds_read_b128 v[20:23], v8 offset:50176
v_mfma_f32_16x16x32_bf16 v[108:111], a[100:103], v[52:55], v[108:111]
s_waitcnt lgkmcnt(7)
v_mfma_f32_16x16x32_bf16 v[104:107], a[72:75], v[56:59], v[104:107]
ds_read_b128 v[24:27], v8 offset:51200
v_mfma_f32_16x16x32_bf16 v[108:111], a[104:107], v[56:59], v[108:111]
s_waitcnt lgkmcnt(7)
v_mfma_f32_16x16x32_bf16 v[104:107], a[76:79], v[60:63], v[104:107]
ds_read_b128 v[28:31], v8 offset:52224
v_mfma_f32_16x16x32_bf16 v[108:111], a[108:111], v[60:63], v[108:111]
s_waitcnt lgkmcnt(7)
v_mfma_f32_16x16x32_bf16 v[104:107], a[80:83], v[64:67], v[104:107]
ds_read_b128 v[32:35], v8 offset:53248
v_mfma_f32_16x16x32_bf16 v[108:111], a[112:115], v[64:67], v[108:111]
s_waitcnt lgkmcnt(7)
v_mfma_f32_16x16x32_bf16 v[104:107], a[84:87], v[68:71], v[104:107]
ds_read_b128 v[36:39], v8 offset:54272
v_mfma_f32_16x16x32_bf16 v[108:111], a[116:119], v[68:71], v[108:111]
s_waitcnt lgkmcnt(7)
v_mfma_f32_16x16x32_bf16 v[104:107], a[88:91], v[72:75], v[104:107]
ds_read_b128 v[40:43], v8 offset:55296
v_mfma_f32_16x16x32_bf16 v[108:111], a[120:123], v[72:75], v[108:111]
s_waitcnt lgkmcnt(7)
v_mfma_f32_16x16x32_bf16 v[104:107], a[92:95], v[76:79], v[104:107]
ds_read_b128 v[44:47], v8 offset:56320
v_mfma_f32_16x16x32_bf16 v[108:111], a[124:127], v[76:79], v[108:111]
s_waitcnt lgkmcnt(7)
v_mfma_f32_16x16x32_bf16 v[104:107], a[128:131], v[16:19], v[104:107]
ds_read_b128 v[48:51], v8 offset:57344
v_mfma_f32_16x16x32_bf16 v[108:111], a[160:163], v[16:19], v[108:111]
s_waitcnt lgkmcnt(7)
v_mfma_f32_16x16x32_bf16 v[104:107], a[132:135], v[20:23], v[104:107]
ds_read_b128 v[52:55], v8 offset:58368
v_mfma_f32_16x16x32_bf16 v[108:111], a[164:167], v[20:23], v[108:111]
s_waitcnt lgkmcnt(7)
v_mfma_f32_16x16x32_bf16 v[104:107], a[136:139], v[24:27], v[104:107]
ds_read_b128 v[56:59], v8 offset:59392
v_mfma_f32_16x16x32_bf16 v[108:111], a[168:171], v[24:27], v[108:111]
s_waitcnt lgkmcnt(7)
v_mfma_f32_16x16x32_bf16 v[104:107], a[140:143], v[28:31], v[104:107]
ds_read_b128 v[60:63], v8 offset:60416
v_mfma_f32_16x16x32_bf16 v[108:111], a[172:175], v[28:31], v[108:111]
s_waitcnt lgkmcnt(7)
v_mfma_f32_16x16x32_bf16 v[104:107], a[144:147], v[32:35], v[104:107]
ds_read_b128 v[64:67], v8 offset:61440
v_mfma_f32_16x16x32_bf16 v[108:111], a[176:179], v[32:35], v[108:111]
s_waitcnt lgkmcnt(7)
v_mfma_f32_16x16x32_bf16 v[104:107], a[148:151], v[36:39], v[104:107]
ds_read_b128 v[68:71], v8 offset:62464
v_mfma_f32_16x16x32_bf16 v[108:111], a[180:183], v[36:39], v[108:111]
s_waitcnt lgkmcnt(7)
v_mfma_f32_16x16x32_bf16 v[104:107], a[152:155], v[40:43], v[104:107]
ds_read_b128 v[72:75], v8 offset:63488
v_mfma_f32_16x16x32_bf16 v[108:111], a[184:187], v[40:43], v[108:111]
s_waitcnt lgkmcnt(7)
v_mfma_f32_16x16x32_bf16 v[104:107], a[156:159], v[44:47], v[104:107]
ds_read_b128 v[76:79], v8 offset:64512
v_mfma_f32_16x16x32_bf16 v[108:111], a[188:191], v[44:47], v[108:111]
s_waitcnt lgkmcnt(7)
v_mfma_f32_16x16x32_bf16 v[104:107], a[192:195], v[48:51], v[104:107]
v_mfma_f32_16x16x32_bf16 v[108:111], a[224:227], v[48:51], v[108:111]
s_waitcnt lgkmcnt(6)
v_mfma_f32_16x16x32_bf16 v[104:107], a[196:199], v[52:55], v[104:107]
v_mfma_f32_16x16x32_bf16 v[108:111], a[228:231], v[52:55], v[108:111]
s_waitcnt lgkmcnt(5)
v_mfma_f32_16x16x32_bf16 v[104:107], a[200:203], v[56:59], v[104:107]
v_mfma_f32_16x16x32_bf16 v[108:111], a[232:235], v[56:59], v[108:111]
s_waitcnt lgkmcnt(4)
v_mfma_f32_16x16x32_bf16 v[104:107], a[204:207], v[60:63], v[104:107]
v_mfma_f32_16x16x32_bf16 v[108:111], a[236:239], v[60:63], v[108:111]
s_waitcnt lgkmcnt(3)
v_mfma_f32_16x16x32_bf16 v[104:107], a[208:211], v[64:67], v[104:107]
v_mfma_f32_16x16x32_bf16 v[108:111], a[240:243], v[64:67], v[108:111]
s_waitcnt lgkmcnt(2)
v_mfma_f32_16x16x32_bf16 v[104:107], a[212:215], v[68:71], v[104:107]
v_mfma_f32_16x16x32_bf16 v[108:111], a[244:247], v[68:71], v[108:111]
s_waitcnt lgkmcnt(1)
v_mfma_f32_16x16x32_bf16 v[104:107], a[216:219], v[72:75], v[104:107]
v_mfma_f32_16x16x32_bf16 v[108:111], a[248:251], v[72:75], v[108:111]
s_waitcnt lgkmcnt(0)
v_mfma_f32_16x16x32_bf16 v[104:107], a[220:223], v[76:79], v[104:107]
v_mfma_f32_16x16x32_bf16 v[108:111], a[252:255], v[76:79], v[108:111]
s_add_u32 s59, s59, 2
s_xor_b32 s63, s63, 2
s_nop 4
.if \sf == 0
buffer_store_dwordx4 v[104:107], v2, s[8:11], s45 offen offset:0
buffer_store_dwordx4 v[108:111], v2, s[8:11], s45 offen offset:1024
.else
buffer_store_dwordx4 v[104:107], v2, s[8:11], s45 offen offset:0 sc1
buffer_store_dwordx4 v[108:111], v2, s[8:11], s45 offen offset:1024 sc1
.endif
s_nop 1
w2j_172_\sf:
s_waitcnt vmcnt(0)
s_barrier
s_lshl_b32 s45, s92, 3
s_add_u32 s45, s45, s61
s_lshl_b32 s45, s45, 7
s_add_u32 s50, s45, 0x5505000
s_cmp_lg_u32 s94, 0
s_cbranch_scc1 w2p_173_\sf
s_lshl_b32 s45, s60, 2
v_mov_b32 v9, s45
v_mov_b32 v10, s49
s_mov_b64 exec, 1
.if \sf == 0
buffer_store_dword v10, v9, s[8:11], s50 offen
.else
buffer_store_dword v10, v9, s[8:11], s50 offen sc1
.endif
s_mov_b64 exec, -1
w2p_173_\sf:
s_add_u32 s59, s56, s94
s_cmp_ge_u32 s59, s49
s_cbranch_scc1 w2e_175_\sf
v_mov_b32 v9, 0
s_nop 1
w2q_176_\sf:
buffer_load_dwordx4 v[12:15], v9, s[8:11], s50 offen sc1
s_waitcnt vmcnt(0)
v_min3_u32 v12, v12, v13, v14
v_min_u32 v12, v12, v15
v_cmp_gt_u32 vcc, s49, v12
s_cbranch_vccz w2qd_177_\sf
s_sleep 1
s_add_u32 s44, s44, 1
s_cmp_lt_u32 s44, 0x40000
s_cbranch_scc1 w2q_176_\sf
w2qd_177_\sf:
s_lshr_b32 s43, s59, 1
s_lshl_b32 s43, s43, 2
s_add_u32 s43, s43, s92
s_lshl_b32 s43, s43, 1
s_and_b32 s48, s59, 1
s_add_u32 s43, s43, s48
s_lshl_b32 s45, s92, 23
s_lshl_b32 s46, s59, 18
s_add_u32 s45, s45, s46
s_lshl_b32 s46, s57, 11
s_add_u32 s45, s45, s46
s_add_u32 s45, s45, 0x7000000
buffer_load_dwordx4 v[188:191], v2, s[8:11], s45 offen offset:0 sc1
buffer_load_dwordx4 v[192:195], v2, s[8:11], s45 offen offset:1024 sc1
s_add_u32 s45, s45, 0x10000
buffer_load_dwordx4 v[196:199], v2, s[8:11], s45 offen offset:0 sc1
buffer_load_dwordx4 v[200:203], v2, s[8:11], s45 offen offset:1024 sc1
s_add_u32 s45, s45, 0x10000
buffer_load_dwordx4 v[204:207], v2, s[8:11], s45 offen offset:0 sc1
buffer_load_dwordx4 v[208:211], v2, s[8:11], s45 offen offset:1024 sc1
s_add_u32 s45, s45, 0x10000
buffer_load_dwordx4 v[212:215], v2, s[8:11], s45 offen offset:0 sc1
buffer_load_dwordx4 v[216:219], v2, s[8:11], s45 offen offset:1024 sc1
s_add_u32 s45, s45, 0x10000
s_waitcnt vmcnt(0)
v_pk_add_f32 v[188:189], v[188:189], v[196:197]
v_pk_add_f32 v[204:205], v[204:205], v[212:213]
v_pk_add_f32 v[190:191], v[190:191], v[198:199]
v_pk_add_f32 v[206:207], v[206:207], v[214:215]
v_pk_add_f32 v[192:193], v[192:193], v[200:201]
v_pk_add_f32 v[208:209], v[208:209], v[216:217]
v_pk_add_f32 v[194:195], v[194:195], v[202:203]
v_pk_add_f32 v[210:211], v[210:211], v[218:219]
v_pk_add_f32 v[188:189], v[188:189], v[204:205]
v_pk_add_f32 v[190:191], v[190:191], v[206:207]
v_pk_add_f32 v[192:193], v[192:193], v[208:209]
v_pk_add_f32 v[194:195], v[194:195], v[210:211]
v_cvt_pk_bf16_f32 v196, v188, v189
v_cvt_pk_bf16_f32 v197, v190, v191
v_cvt_pk_bf16_f32 v198, v192, v193
v_cvt_pk_bf16_f32 v199, v194, v195
v_lshlrev_b32 v188, 16, v196
v_and_b32 v189, 0xffff0000, v196
v_lshlrev_b32 v190, 16, v197
v_and_b32 v191, 0xffff0000, v197
v_lshlrev_b32 v192, 16, v198
v_and_b32 v193, 0xffff0000, v198
v_lshlrev_b32 v194, 16, v199
v_and_b32 v195, 0xffff0000, v199
v_lshlrev_b32 v204, 16, v152
v_and_b32 v205, 0xffff0000, v152
v_lshlrev_b32 v206, 16, v153
v_and_b32 v207, 0xffff0000, v153
v_lshlrev_b32 v208, 16, v154
v_and_b32 v209, 0xffff0000, v154
v_lshlrev_b32 v210, 16, v155
v_and_b32 v211, 0xffff0000, v155
s_mov_b32 s45, s43
s_lshr_b32 s46, s52, 4
s_lshr_b32 s47, s53, 4
s_cmp_eq_u32 s46, s45
s_cselect_b32 s48, 1, 0
s_cmp_eq_u32 s47, s45
s_cselect_b32 s48, 1, s48
s_cmp_eq_u32 s48, 0
s_cbranch_scc1 nomod_178_\sf
v_and_b32 v212, 15, v1
s_lshl_b32 s46, s45, 4
v_add_u32 v212, s46, v212
v_lshrrev_b32 v213, 4, v1
v_lshlrev_b32 v213, 5, v213
v_cmp_eq_u32 vcc, s52, v212
s_and_saveexec_b64 s[90:91], vcc
s_nop 3
s_cbranch_execz modc_179_\sf
s_lshl_b32 s46, s57, 7
s_add_u32 s46, s46, 0x540c000
v_mov_b32 v180, 0
v_mov_b32 v181, 0
v_mov_b32 v182, 0
v_mov_b32 v183, 0
v_mov_b32 v184, 0
v_mov_b32 v185, 0
v_mov_b32 v186, 0
v_mov_b32 v187, 0
buffer_load_dwordx4 v[164:167], v213, s[8:11], s46 offen sc1
buffer_load_dwordx4 v[168:171], v213, s[8:11], s46 offen offset:16 sc1
s_add_u32 s46, s46, 8192
s_waitcnt vmcnt(0)
v_pk_add_f32 v[180:181], v[180:181], v[164:165]
v_pk_add_f32 v[182:183], v[182:183], v[166:167]
v_pk_add_f32 v[184:185], v[184:185], v[168:169]
v_pk_add_f32 v[186:187], v[186:187], v[170:171]
buffer_load_dwordx4 v[164:167], v213, s[8:11], s46 offen sc1
buffer_load_dwordx4 v[168:171], v213, s[8:11], s46 offen offset:16 sc1
s_add_u32 s46, s46, 8192
s_waitcnt vmcnt(0)
v_pk_add_f32 v[180:181], v[180:181], v[164:165]
v_pk_add_f32 v[182:183], v[182:183], v[166:167]
v_pk_add_f32 v[184:185], v[184:185], v[168:169]
v_pk_add_f32 v[186:187], v[186:187], v[170:171]
buffer_load_dwordx4 v[164:167], v213, s[8:11], s46 offen sc1
buffer_load_dwordx4 v[168:171], v213, s[8:11], s46 offen offset:16 sc1
s_add_u32 s46, s46, 8192
s_waitcnt vmcnt(0)
v_pk_add_f32 v[180:181], v[180:181], v[164:165]
v_pk_add_f32 v[182:183], v[182:183], v[166:167]
v_pk_add_f32 v[184:185], v[184:185], v[168:169]
v_pk_add_f32 v[186:187], v[186:187], v[170:171]
buffer_load_dwordx4 v[164:167], v213, s[8:11], s46 offen sc1
buffer_load_dwordx4 v[168:171], v213, s[8:11], s46 offen offset:16 sc1
s_add_u32 s46, s46, 8192
s_waitcnt vmcnt(0)
v_pk_add_f32 v[180:181], v[180:181], v[164:165]
v_pk_add_f32 v[182:183], v[182:183], v[166:167]
v_pk_add_f32 v[184:185], v[184:185], v[168:169]
v_pk_add_f32 v[186:187], v[186:187], v[170:171]
buffer_load_dwordx4 v[164:167], v213, s[8:11], s46 offen sc1
buffer_load_dwordx4 v[168:171], v213, s[8:11], s46 offen offset:16 sc1
s_add_u32 s46, s46, 8192
s_waitcnt vmcnt(0)
v_pk_add_f32 v[180:181], v[180:181], v[164:165]
v_pk_add_f32 v[182:183], v[182:183], v[166:167]
v_pk_add_f32 v[184:185], v[184:185], v[168:169]
v_pk_add_f32 v[186:187], v[186:187], v[170:171]
buffer_load_dwordx4 v[164:167], v213, s[8:11], s46 offen sc1
buffer_load_dwordx4 v[168:171], v213, s[8:11], s46 offen offset:16 sc1
s_add_u32 s46, s46, 8192
s_waitcnt vmcnt(0)
v_pk_add_f32 v[180:181], v[180:181], v[164:165]
v_pk_add_f32 v[182:183], v[182:183], v[166:167]
v_pk_add_f32 v[184:185], v[184:185], v[168:169]
v_pk_add_f32 v[186:187], v[186:187], v[170:171]
buffer_load_dwordx4 v[164:167], v213, s[8:11], s46 offen sc1
buffer_load_dwordx4 v[168:171], v213, s[8:11], s46 offen offset:16 sc1
s_add_u32 s46, s46, 8192
s_waitcnt vmcnt(0)
v_pk_add_f32 v[180:181], v[180:181], v[164:165]
v_pk_add_f32 v[182:183], v[182:183], v[166:167]
v_pk_add_f32 v[184:185], v[184:185], v[168:169]
v_pk_add_f32 v[186:187], v[186:187], v[170:171]
s_mov_b32 s46, 0x541c008
v_mov_b32 v172, 0
buffer_load_dword v173, v172, s[8:11], s46 offen sc1
v_cvt_pk_bf16_f32 v164, v180, v181
v_cvt_pk_bf16_f32 v165, v182, v183
v_cvt_pk_bf16_f32 v166, v184, v185
v_cvt_pk_bf16_f32 v167, v186, v187
v_lshlrev_b32 v180, 16, v164
v_and_b32 v181, 0xffff0000, v164
v_lshlrev_b32 v182, 16, v165
v_and_b32 v183, 0xffff0000, v165
v_lshlrev_b32 v184, 16, v166
v_and_b32 v185, 0xffff0000, v166
v_lshlrev_b32 v186, 16, v167
v_and_b32 v187, 0xffff0000, v167
s_waitcnt vmcnt(0)
v_mul_f32 v180, v180, v173
v_mul_f32 v181, v181, v173
v_mul_f32 v182, v182, v173
v_mul_f32 v183, v183, v173
v_mul_f32 v184, v184, v173
v_mul_f32 v185, v185, v173
v_mul_f32 v186, v186, v173
v_mul_f32 v187, v187, v173
v_cvt_pk_bf16_f32 v164, v180, v181
v_cvt_pk_bf16_f32 v165, v182, v183
v_cvt_pk_bf16_f32 v166, v184, v185
v_cvt_pk_bf16_f32 v167, v186, v187
v_lshlrev_b32 v180, 16, v164
v_and_b32 v181, 0xffff0000, v164
v_lshlrev_b32 v182, 16, v165
v_and_b32 v183, 0xffff0000, v165
v_lshlrev_b32 v184, 16, v166
v_and_b32 v185, 0xffff0000, v166
v_lshlrev_b32 v186, 16, v167
v_and_b32 v187, 0xffff0000, v167
v_add_f32 v204, v204, v180
v_add_f32 v205, v205, v181
v_add_f32 v206, v206, v182
v_add_f32 v207, v207, v183
v_add_f32 v208, v208, v184
v_add_f32 v209, v209, v185
v_add_f32 v210, v210, v186
v_add_f32 v211, v211, v187
v_cvt_pk_bf16_f32 v164, v204, v205
v_cvt_pk_bf16_f32 v165, v206, v207
v_cvt_pk_bf16_f32 v166, v208, v209
v_cvt_pk_bf16_f32 v167, v210, v211
v_lshlrev_b32 v204, 16, v164
v_and_b32 v205, 0xffff0000, v164
v_lshlrev_b32 v206, 16, v165
v_and_b32 v207, 0xffff0000, v165
v_lshlrev_b32 v208, 16, v166
v_and_b32 v209, 0xffff0000, v166
v_lshlrev_b32 v210, 16, v167
v_and_b32 v211, 0xffff0000, v167
s_nop 1
modc_179_\sf:
s_mov_b64 exec, s[90:91]
v_cmp_eq_u32 vcc, s53, v212
s_and_saveexec_b64 s[90:91], vcc
s_nop 3
s_cbranch_execz modc_180_\sf
s_lshl_b32 s46, s57, 7
s_add_u32 s46, s46, 0x540d000
v_mov_b32 v180, 0
v_mov_b32 v181, 0
v_mov_b32 v182, 0
v_mov_b32 v183, 0
v_mov_b32 v184, 0
v_mov_b32 v185, 0
v_mov_b32 v186, 0
v_mov_b32 v187, 0
buffer_load_dwordx4 v[164:167], v213, s[8:11], s46 offen sc1
buffer_load_dwordx4 v[168:171], v213, s[8:11], s46 offen offset:16 sc1
s_add_u32 s46, s46, 8192
s_waitcnt vmcnt(0)
v_pk_add_f32 v[180:181], v[180:181], v[164:165]
v_pk_add_f32 v[182:183], v[182:183], v[166:167]
v_pk_add_f32 v[184:185], v[184:185], v[168:169]
v_pk_add_f32 v[186:187], v[186:187], v[170:171]
buffer_load_dwordx4 v[164:167], v213, s[8:11], s46 offen sc1
buffer_load_dwordx4 v[168:171], v213, s[8:11], s46 offen offset:16 sc1
s_add_u32 s46, s46, 8192
s_waitcnt vmcnt(0)
v_pk_add_f32 v[180:181], v[180:181], v[164:165]
v_pk_add_f32 v[182:183], v[182:183], v[166:167]
v_pk_add_f32 v[184:185], v[184:185], v[168:169]
v_pk_add_f32 v[186:187], v[186:187], v[170:171]
buffer_load_dwordx4 v[164:167], v213, s[8:11], s46 offen sc1
buffer_load_dwordx4 v[168:171], v213, s[8:11], s46 offen offset:16 sc1
s_add_u32 s46, s46, 8192
s_waitcnt vmcnt(0)
v_pk_add_f32 v[180:181], v[180:181], v[164:165]
v_pk_add_f32 v[182:183], v[182:183], v[166:167]
v_pk_add_f32 v[184:185], v[184:185], v[168:169]
v_pk_add_f32 v[186:187], v[186:187], v[170:171]
buffer_load_dwordx4 v[164:167], v213, s[8:11], s46 offen sc1
buffer_load_dwordx4 v[168:171], v213, s[8:11], s46 offen offset:16 sc1
s_add_u32 s46, s46, 8192
s_waitcnt vmcnt(0)
v_pk_add_f32 v[180:181], v[180:181], v[164:165]
v_pk_add_f32 v[182:183], v[182:183], v[166:167]
v_pk_add_f32 v[184:185], v[184:185], v[168:169]
v_pk_add_f32 v[186:187], v[186:187], v[170:171]
buffer_load_dwordx4 v[164:167], v213, s[8:11], s46 offen sc1
buffer_load_dwordx4 v[168:171], v213, s[8:11], s46 offen offset:16 sc1
s_add_u32 s46, s46, 8192
s_waitcnt vmcnt(0)
v_pk_add_f32 v[180:181], v[180:181], v[164:165]
v_pk_add_f32 v[182:183], v[182:183], v[166:167]
v_pk_add_f32 v[184:185], v[184:185], v[168:169]
v_pk_add_f32 v[186:187], v[186:187], v[170:171]
buffer_load_dwordx4 v[164:167], v213, s[8:11], s46 offen sc1
buffer_load_dwordx4 v[168:171], v213, s[8:11], s46 offen offset:16 sc1
s_add_u32 s46, s46, 8192
s_waitcnt vmcnt(0)
v_pk_add_f32 v[180:181], v[180:181], v[164:165]
v_pk_add_f32 v[182:183], v[182:183], v[166:167]
v_pk_add_f32 v[184:185], v[184:185], v[168:169]
v_pk_add_f32 v[186:187], v[186:187], v[170:171]
buffer_load_dwordx4 v[164:167], v213, s[8:11], s46 offen sc1
buffer_load_dwordx4 v[168:171], v213, s[8:11], s46 offen offset:16 sc1
s_add_u32 s46, s46, 8192
s_waitcnt vmcnt(0)
v_pk_add_f32 v[180:181], v[180:181], v[164:165]
v_pk_add_f32 v[182:183], v[182:183], v[166:167]
v_pk_add_f32 v[184:185], v[184:185], v[168:169]
v_pk_add_f32 v[186:187], v[186:187], v[170:171]
s_mov_b32 s46, 0x541c00c
v_mov_b32 v172, 0
buffer_load_dword v173, v172, s[8:11], s46 offen sc1
v_cvt_pk_bf16_f32 v164, v180, v181
v_cvt_pk_bf16_f32 v165, v182, v183
v_cvt_pk_bf16_f32 v166, v184, v185
v_cvt_pk_bf16_f32 v167, v186, v187
v_lshlrev_b32 v180, 16, v164
v_and_b32 v181, 0xffff0000, v164
v_lshlrev_b32 v182, 16, v165
v_and_b32 v183, 0xffff0000, v165
v_lshlrev_b32 v184, 16, v166
v_and_b32 v185, 0xffff0000, v166
v_lshlrev_b32 v186, 16, v167
v_and_b32 v187, 0xffff0000, v167
s_waitcnt vmcnt(0)
v_mul_f32 v180, v180, v173
v_mul_f32 v181, v181, v173
v_mul_f32 v182, v182, v173
v_mul_f32 v183, v183, v173
v_mul_f32 v184, v184, v173
v_mul_f32 v185, v185, v173
v_mul_f32 v186, v186, v173
v_mul_f32 v187, v187, v173
v_cvt_pk_bf16_f32 v164, v180, v181
v_cvt_pk_bf16_f32 v165, v182, v183
v_cvt_pk_bf16_f32 v166, v184, v185
v_cvt_pk_bf16_f32 v167, v186, v187
v_lshlrev_b32 v180, 16, v164
v_and_b32 v181, 0xffff0000, v164
v_lshlrev_b32 v182, 16, v165
v_and_b32 v183, 0xffff0000, v165
v_lshlrev_b32 v184, 16, v166
v_and_b32 v185, 0xffff0000, v166
v_lshlrev_b32 v186, 16, v167
v_and_b32 v187, 0xffff0000, v167
v_add_f32 v204, v204, v180
v_add_f32 v205, v205, v181
v_add_f32 v206, v206, v182
v_add_f32 v207, v207, v183
v_add_f32 v208, v208, v184
v_add_f32 v209, v209, v185
v_add_f32 v210, v210, v186
v_add_f32 v211, v211, v187
v_cvt_pk_bf16_f32 v164, v204, v205
v_cvt_pk_bf16_f32 v165, v206, v207
v_cvt_pk_bf16_f32 v166, v208, v209
v_cvt_pk_bf16_f32 v167, v210, v211
v_lshlrev_b32 v204, 16, v164
v_and_b32 v205, 0xffff0000, v164
v_lshlrev_b32 v206, 16, v165
v_and_b32 v207, 0xffff0000, v165
v_lshlrev_b32 v208, 16, v166
v_and_b32 v209, 0xffff0000, v166
v_lshlrev_b32 v210, 16, v167
v_and_b32 v211, 0xffff0000, v167
s_nop 1
modc_180_\sf:
s_mov_b64 exec, s[90:91]
nomod_178_\sf:
v_sub_f32 v212, 1.0, v160
v_cvt_pk_bf16_f32 v212, v212, v212
v_and_b32 v212, 0xffff0000, v212
v_mul_f32 v204, v204, v212
v_mul_f32 v205, v205, v212
v_mul_f32 v206, v206, v212
v_mul_f32 v207, v207, v212
v_mul_f32 v208, v208, v212
v_mul_f32 v209, v209, v212
v_mul_f32 v210, v210, v212
v_mul_f32 v211, v211, v212
v_fma_f32 v188, v188, v160, v204
v_fma_f32 v189, v189, v160, v205
v_fma_f32 v190, v190, v160, v206
v_fma_f32 v191, v191, v160, v207
v_fma_f32 v192, v192, v160, v208
v_fma_f32 v193, v193, v160, v209
v_fma_f32 v194, v194, v160, v210
v_fma_f32 v195, v195, v160, v211
v_cvt_pk_bf16_f32 v196, v188, v189
v_cvt_pk_bf16_f32 v197, v190, v191
v_cvt_pk_bf16_f32 v198, v192, v193
v_cvt_pk_bf16_f32 v199, v194, v195
s_lshl_b32 s45, s45, 15
s_lshl_b32 s46, s57, 6
s_add_u32 s45, s45, s46
buffer_store_dwordx4 v[196:199], v4, s[20:23], s45 offen
s_add_u32 s59, s59, 4
s_cmp_ge_u32 s59, s49
s_cbranch_scc1 w2e_175_\sf
s_lshr_b32 s43, s59, 1
s_lshl_b32 s43, s43, 2
s_add_u32 s43, s43, s92
s_lshl_b32 s43, s43, 1
s_and_b32 s48, s59, 1
s_add_u32 s43, s43, s48
s_lshl_b32 s45, s92, 23
s_lshl_b32 s46, s59, 18
s_add_u32 s45, s45, s46
s_lshl_b32 s46, s57, 11
s_add_u32 s45, s45, s46
s_add_u32 s45, s45, 0x7000000
buffer_load_dwordx4 v[188:191], v2, s[8:11], s45 offen offset:0 sc1
buffer_load_dwordx4 v[192:195], v2, s[8:11], s45 offen offset:1024 sc1
s_add_u32 s45, s45, 0x10000
buffer_load_dwordx4 v[196:199], v2, s[8:11], s45 offen offset:0 sc1
buffer_load_dwordx4 v[200:203], v2, s[8:11], s45 offen offset:1024 sc1
s_add_u32 s45, s45, 0x10000
buffer_load_dwordx4 v[204:207], v2, s[8:11], s45 offen offset:0 sc1
buffer_load_dwordx4 v[208:211], v2, s[8:11], s45 offen offset:1024 sc1
s_add_u32 s45, s45, 0x10000
buffer_load_dwordx4 v[212:215], v2, s[8:11], s45 offen offset:0 sc1
buffer_load_dwordx4 v[216:219], v2, s[8:11], s45 offen offset:1024 sc1
s_add_u32 s45, s45, 0x10000
s_waitcnt vmcnt(0)
v_pk_add_f32 v[188:189], v[188:189], v[196:197]
v_pk_add_f32 v[204:205], v[204:205], v[212:213]
v_pk_add_f32 v[190:191], v[190:191], v[198:199]
v_pk_add_f32 v[206:207], v[206:207], v[214:215]
v_pk_add_f32 v[192:193], v[192:193], v[200:201]
v_pk_add_f32 v[208:209], v[208:209], v[216:217]
v_pk_add_f32 v[194:195], v[194:195], v[202:203]
v_pk_add_f32 v[210:211], v[210:211], v[218:219]
v_pk_add_f32 v[188:189], v[188:189], v[204:205]
v_pk_add_f32 v[190:191], v[190:191], v[206:207]
v_pk_add_f32 v[192:193], v[192:193], v[208:209]
v_pk_add_f32 v[194:195], v[194:195], v[210:211]
v_cvt_pk_bf16_f32 v196, v188, v189
v_cvt_pk_bf16_f32 v197, v190, v191
v_cvt_pk_bf16_f32 v198, v192, v193
v_cvt_pk_bf16_f32 v199, v194, v195
v_lshlrev_b32 v188, 16, v196
v_and_b32 v189, 0xffff0000, v196
v_lshlrev_b32 v190, 16, v197
v_and_b32 v191, 0xffff0000, v197
v_lshlrev_b32 v192, 16, v198
v_and_b32 v193, 0xffff0000, v198
v_lshlrev_b32 v194, 16, v199
v_and_b32 v195, 0xffff0000, v199
v_lshlrev_b32 v204, 16, v156
v_and_b32 v205, 0xffff0000, v156
v_lshlrev_b32 v206, 16, v157
v_and_b32 v207, 0xffff0000, v157
v_lshlrev_b32 v208, 16, v158
v_and_b32 v209, 0xffff0000, v158
v_lshlrev_b32 v210, 16, v159
v_and_b32 v211, 0xffff0000, v159
s_mov_b32 s45, s43
s_lshr_b32 s46, s52, 4
s_lshr_b32 s47, s53, 4
s_cmp_eq_u32 s46, s45
s_cselect_b32 s48, 1, 0
s_cmp_eq_u32 s47, s45
s_cselect_b32 s48, 1, s48
s_cmp_eq_u32 s48, 0
s_cbranch_scc1 nomod_181_\sf
v_and_b32 v212, 15, v1
s_lshl_b32 s46, s45, 4
v_add_u32 v212, s46, v212
v_lshrrev_b32 v213, 4, v1
v_lshlrev_b32 v213, 5, v213
v_cmp_eq_u32 vcc, s52, v212
s_and_saveexec_b64 s[90:91], vcc
s_nop 3
s_cbranch_execz modc_182_\sf
s_lshl_b32 s46, s57, 7
s_add_u32 s46, s46, 0x540c000
v_mov_b32 v180, 0
v_mov_b32 v181, 0
v_mov_b32 v182, 0
v_mov_b32 v183, 0
v_mov_b32 v184, 0
v_mov_b32 v185, 0
v_mov_b32 v186, 0
v_mov_b32 v187, 0
buffer_load_dwordx4 v[164:167], v213, s[8:11], s46 offen sc1
buffer_load_dwordx4 v[168:171], v213, s[8:11], s46 offen offset:16 sc1
s_add_u32 s46, s46, 8192
s_waitcnt vmcnt(0)
v_pk_add_f32 v[180:181], v[180:181], v[164:165]
v_pk_add_f32 v[182:183], v[182:183], v[166:167]
v_pk_add_f32 v[184:185], v[184:185], v[168:169]
v_pk_add_f32 v[186:187], v[186:187], v[170:171]
buffer_load_dwordx4 v[164:167], v213, s[8:11], s46 offen sc1
buffer_load_dwordx4 v[168:171], v213, s[8:11], s46 offen offset:16 sc1
s_add_u32 s46, s46, 8192
s_waitcnt vmcnt(0)
v_pk_add_f32 v[180:181], v[180:181], v[164:165]
v_pk_add_f32 v[182:183], v[182:183], v[166:167]
v_pk_add_f32 v[184:185], v[184:185], v[168:169]
v_pk_add_f32 v[186:187], v[186:187], v[170:171]
buffer_load_dwordx4 v[164:167], v213, s[8:11], s46 offen sc1
buffer_load_dwordx4 v[168:171], v213, s[8:11], s46 offen offset:16 sc1
s_add_u32 s46, s46, 8192
s_waitcnt vmcnt(0)
v_pk_add_f32 v[180:181], v[180:181], v[164:165]
v_pk_add_f32 v[182:183], v[182:183], v[166:167]
v_pk_add_f32 v[184:185], v[184:185], v[168:169]
v_pk_add_f32 v[186:187], v[186:187], v[170:171]
buffer_load_dwordx4 v[164:167], v213, s[8:11], s46 offen sc1
buffer_load_dwordx4 v[168:171], v213, s[8:11], s46 offen offset:16 sc1
s_add_u32 s46, s46, 8192
s_waitcnt vmcnt(0)
v_pk_add_f32 v[180:181], v[180:181], v[164:165]
v_pk_add_f32 v[182:183], v[182:183], v[166:167]
v_pk_add_f32 v[184:185], v[184:185], v[168:169]
v_pk_add_f32 v[186:187], v[186:187], v[170:171]
buffer_load_dwordx4 v[164:167], v213, s[8:11], s46 offen sc1
buffer_load_dwordx4 v[168:171], v213, s[8:11], s46 offen offset:16 sc1
s_add_u32 s46, s46, 8192
s_waitcnt vmcnt(0)
v_pk_add_f32 v[180:181], v[180:181], v[164:165]
v_pk_add_f32 v[182:183], v[182:183], v[166:167]
v_pk_add_f32 v[184:185], v[184:185], v[168:169]
v_pk_add_f32 v[186:187], v[186:187], v[170:171]
buffer_load_dwordx4 v[164:167], v213, s[8:11], s46 offen sc1
buffer_load_dwordx4 v[168:171], v213, s[8:11], s46 offen offset:16 sc1
s_add_u32 s46, s46, 8192
s_waitcnt vmcnt(0)
v_pk_add_f32 v[180:181], v[180:181], v[164:165]
v_pk_add_f32 v[182:183], v[182:183], v[166:167]
v_pk_add_f32 v[184:185], v[184:185], v[168:169]
v_pk_add_f32 v[186:187], v[186:187], v[170:171]
buffer_load_dwordx4 v[164:167], v213, s[8:11], s46 offen sc1
buffer_load_dwordx4 v[168:171], v213, s[8:11], s46 offen offset:16 sc1
s_add_u32 s46, s46, 8192
s_waitcnt vmcnt(0)
v_pk_add_f32 v[180:181], v[180:181], v[164:165]
v_pk_add_f32 v[182:183], v[182:183], v[166:167]
v_pk_add_f32 v[184:185], v[184:185], v[168:169]
v_pk_add_f32 v[186:187], v[186:187], v[170:171]
s_mov_b32 s46, 0x541c008
v_mov_b32 v172, 0
buffer_load_dword v173, v172, s[8:11], s46 offen sc1
v_cvt_pk_bf16_f32 v164, v180, v181
v_cvt_pk_bf16_f32 v165, v182, v183
v_cvt_pk_bf16_f32 v166, v184, v185
v_cvt_pk_bf16_f32 v167, v186, v187
v_lshlrev_b32 v180, 16, v164
v_and_b32 v181, 0xffff0000, v164
v_lshlrev_b32 v182, 16, v165
v_and_b32 v183, 0xffff0000, v165
v_lshlrev_b32 v184, 16, v166
v_and_b32 v185, 0xffff0000, v166
v_lshlrev_b32 v186, 16, v167
v_and_b32 v187, 0xffff0000, v167
s_waitcnt vmcnt(0)
v_mul_f32 v180, v180, v173
v_mul_f32 v181, v181, v173
v_mul_f32 v182, v182, v173
v_mul_f32 v183, v183, v173
v_mul_f32 v184, v184, v173
v_mul_f32 v185, v185, v173
v_mul_f32 v186, v186, v173
v_mul_f32 v187, v187, v173
v_cvt_pk_bf16_f32 v164, v180, v181
v_cvt_pk_bf16_f32 v165, v182, v183
v_cvt_pk_bf16_f32 v166, v184, v185
v_cvt_pk_bf16_f32 v167, v186, v187
v_lshlrev_b32 v180, 16, v164
v_and_b32 v181, 0xffff0000, v164
v_lshlrev_b32 v182, 16, v165
v_and_b32 v183, 0xffff0000, v165
v_lshlrev_b32 v184, 16, v166
v_and_b32 v185, 0xffff0000, v166
v_lshlrev_b32 v186, 16, v167
v_and_b32 v187, 0xffff0000, v167
v_add_f32 v204, v204, v180
v_add_f32 v205, v205, v181
v_add_f32 v206, v206, v182
v_add_f32 v207, v207, v183
v_add_f32 v208, v208, v184
v_add_f32 v209, v209, v185
v_add_f32 v210, v210, v186
v_add_f32 v211, v211, v187
v_cvt_pk_bf16_f32 v164, v204, v205
v_cvt_pk_bf16_f32 v165, v206, v207
v_cvt_pk_bf16_f32 v166, v208, v209
v_cvt_pk_bf16_f32 v167, v210, v211
v_lshlrev_b32 v204, 16, v164
v_and_b32 v205, 0xffff0000, v164
v_lshlrev_b32 v206, 16, v165
v_and_b32 v207, 0xffff0000, v165
v_lshlrev_b32 v208, 16, v166
v_and_b32 v209, 0xffff0000, v166
v_lshlrev_b32 v210, 16, v167
v_and_b32 v211, 0xffff0000, v167
s_nop 1
modc_182_\sf:
s_mov_b64 exec, s[90:91]
v_cmp_eq_u32 vcc, s53, v212
s_and_saveexec_b64 s[90:91], vcc
s_nop 3
s_cbranch_execz modc_183_\sf
s_lshl_b32 s46, s57, 7
s_add_u32 s46, s46, 0x540d000
v_mov_b32 v180, 0
v_mov_b32 v181, 0
v_mov_b32 v182, 0
v_mov_b32 v183, 0
v_mov_b32 v184, 0
v_mov_b32 v185, 0
v_mov_b32 v186, 0
v_mov_b32 v187, 0
buffer_load_dwordx4 v[164:167], v213, s[8:11], s46 offen sc1
buffer_load_dwordx4 v[168:171], v213, s[8:11], s46 offen offset:16 sc1
s_add_u32 s46, s46, 8192
s_waitcnt vmcnt(0)
v_pk_add_f32 v[180:181], v[180:181], v[164:165]
v_pk_add_f32 v[182:183], v[182:183], v[166:167]
v_pk_add_f32 v[184:185], v[184:185], v[168:169]
v_pk_add_f32 v[186:187], v[186:187], v[170:171]
buffer_load_dwordx4 v[164:167], v213, s[8:11], s46 offen sc1
buffer_load_dwordx4 v[168:171], v213, s[8:11], s46 offen offset:16 sc1
s_add_u32 s46, s46, 8192
s_waitcnt vmcnt(0)
v_pk_add_f32 v[180:181], v[180:181], v[164:165]
v_pk_add_f32 v[182:183], v[182:183], v[166:167]
v_pk_add_f32 v[184:185], v[184:185], v[168:169]
v_pk_add_f32 v[186:187], v[186:187], v[170:171]
buffer_load_dwordx4 v[164:167], v213, s[8:11], s46 offen sc1
buffer_load_dwordx4 v[168:171], v213, s[8:11], s46 offen offset:16 sc1
s_add_u32 s46, s46, 8192
s_waitcnt vmcnt(0)
v_pk_add_f32 v[180:181], v[180:181], v[164:165]
v_pk_add_f32 v[182:183], v[182:183], v[166:167]
v_pk_add_f32 v[184:185], v[184:185], v[168:169]
v_pk_add_f32 v[186:187], v[186:187], v[170:171]
buffer_load_dwordx4 v[164:167], v213, s[8:11], s46 offen sc1
buffer_load_dwordx4 v[168:171], v213, s[8:11], s46 offen offset:16 sc1
s_add_u32 s46, s46, 8192
s_waitcnt vmcnt(0)
v_pk_add_f32 v[180:181], v[180:181], v[164:165]
v_pk_add_f32 v[182:183], v[182:183], v[166:167]
v_pk_add_f32 v[184:185], v[184:185], v[168:169]
v_pk_add_f32 v[186:187], v[186:187], v[170:171]
buffer_load_dwordx4 v[164:167], v213, s[8:11], s46 offen sc1
buffer_load_dwordx4 v[168:171], v213, s[8:11], s46 offen offset:16 sc1
s_add_u32 s46, s46, 8192
s_waitcnt vmcnt(0)
v_pk_add_f32 v[180:181], v[180:181], v[164:165]
v_pk_add_f32 v[182:183], v[182:183], v[166:167]
v_pk_add_f32 v[184:185], v[184:185], v[168:169]
v_pk_add_f32 v[186:187], v[186:187], v[170:171]
buffer_load_dwordx4 v[164:167], v213, s[8:11], s46 offen sc1
buffer_load_dwordx4 v[168:171], v213, s[8:11], s46 offen offset:16 sc1
s_add_u32 s46, s46, 8192
s_waitcnt vmcnt(0)
v_pk_add_f32 v[180:181], v[180:181], v[164:165]
v_pk_add_f32 v[182:183], v[182:183], v[166:167]
v_pk_add_f32 v[184:185], v[184:185], v[168:169]
v_pk_add_f32 v[186:187], v[186:187], v[170:171]
buffer_load_dwordx4 v[164:167], v213, s[8:11], s46 offen sc1
buffer_load_dwordx4 v[168:171], v213, s[8:11], s46 offen offset:16 sc1
s_add_u32 s46, s46, 8192
s_waitcnt vmcnt(0)
v_pk_add_f32 v[180:181], v[180:181], v[164:165]
v_pk_add_f32 v[182:183], v[182:183], v[166:167]
v_pk_add_f32 v[184:185], v[184:185], v[168:169]
v_pk_add_f32 v[186:187], v[186:187], v[170:171]
s_mov_b32 s46, 0x541c00c
v_mov_b32 v172, 0
buffer_load_dword v173, v172, s[8:11], s46 offen sc1
v_cvt_pk_bf16_f32 v164, v180, v181
v_cvt_pk_bf16_f32 v165, v182, v183
v_cvt_pk_bf16_f32 v166, v184, v185
v_cvt_pk_bf16_f32 v167, v186, v187
v_lshlrev_b32 v180, 16, v164
v_and_b32 v181, 0xffff0000, v164
v_lshlrev_b32 v182, 16, v165
v_and_b32 v183, 0xffff0000, v165
v_lshlrev_b32 v184, 16, v166
v_and_b32 v185, 0xffff0000, v166
v_lshlrev_b32 v186, 16, v167
v_and_b32 v187, 0xffff0000, v167
s_waitcnt vmcnt(0)
v_mul_f32 v180, v180, v173
v_mul_f32 v181, v181, v173
v_mul_f32 v182, v182, v173
v_mul_f32 v183, v183, v173
v_mul_f32 v184, v184, v173
v_mul_f32 v185, v185, v173
v_mul_f32 v186, v186, v173
v_mul_f32 v187, v187, v173
v_cvt_pk_bf16_f32 v164, v180, v181
v_cvt_pk_bf16_f32 v165, v182, v183
v_cvt_pk_bf16_f32 v166, v184, v185
v_cvt_pk_bf16_f32 v167, v186, v187
v_lshlrev_b32 v180, 16, v164
v_and_b32 v181, 0xffff0000, v164
v_lshlrev_b32 v182, 16, v165
v_and_b32 v183, 0xffff0000, v165
v_lshlrev_b32 v184, 16, v166
v_and_b32 v185, 0xffff0000, v166
v_lshlrev_b32 v186, 16, v167
v_and_b32 v187, 0xffff0000, v167
v_add_f32 v204, v204, v180
v_add_f32 v205, v205, v181
v_add_f32 v206, v206, v182
v_add_f32 v207, v207, v183
v_add_f32 v208, v208, v184
v_add_f32 v209, v209, v185
v_add_f32 v210, v210, v186
v_add_f32 v211, v211, v187
v_cvt_pk_bf16_f32 v164, v204, v205
v_cvt_pk_bf16_f32 v165, v206, v207
v_cvt_pk_bf16_f32 v166, v208, v209
v_cvt_pk_bf16_f32 v167, v210, v211
v_lshlrev_b32 v204, 16, v164
v_and_b32 v205, 0xffff0000, v164
v_lshlrev_b32 v206, 16, v165
v_and_b32 v207, 0xffff0000, v165
v_lshlrev_b32 v208, 16, v166
v_and_b32 v209, 0xffff0000, v166
v_lshlrev_b32 v210, 16, v167
v_and_b32 v211, 0xffff0000, v167
s_nop 1
modc_183_\sf:
s_mov_b64 exec, s[90:91]
nomod_181_\sf:
v_sub_f32 v212, 1.0, v161
v_cvt_pk_bf16_f32 v212, v212, v212
v_and_b32 v212, 0xffff0000, v212
v_mul_f32 v204, v204, v212
v_mul_f32 v205, v205, v212
v_mul_f32 v206, v206, v212
v_mul_f32 v207, v207, v212
v_mul_f32 v208, v208, v212
v_mul_f32 v209, v209, v212
v_mul_f32 v210, v210, v212
v_mul_f32 v211, v211, v212
v_fma_f32 v188, v188, v161, v204
v_fma_f32 v189, v189, v161, v205
v_fma_f32 v190, v190, v161, v206
v_fma_f32 v191, v191, v161, v207
v_fma_f32 v192, v192, v161, v208
v_fma_f32 v193, v193, v161, v209
v_fma_f32 v194, v194, v161, v210
v_fma_f32 v195, v195, v161, v211
v_cvt_pk_bf16_f32 v196, v188, v189
v_cvt_pk_bf16_f32 v197, v190, v191
v_cvt_pk_bf16_f32 v198, v192, v193
v_cvt_pk_bf16_f32 v199, v194, v195
s_lshl_b32 s45, s45, 15
s_lshl_b32 s46, s57, 6
s_add_u32 s45, s45, s46
buffer_store_dwordx4 v[196:199], v4, s[20:23], s45 offen
s_nop 1
w2e_175_\sf:
s_mov_b32 s73, 0
s_lshl_b32 s45, s93, 2
s_add_u32 s45, s45, s94
s_cmp_lg_u32 s45, 2
s_cbranch_scc1 nowb_184_\sf
s_cmp_lt_u32 s89, 12
s_cbranch_scc1 nowb_184_\sf
s_cmp_ge_u32 s89, 16
s_cbranch_scc1 nowb_184_\sf
buffer_wbl2 sc1
nowb_184_\sf:
s_mov_b32 s58, 1
nowo_167_\sf:
s_cmp_lg_u32 s58, 0
s_cbranch_scc1 nosleep_185_\sf
s_cmp_lt_u32 s89, s88
s_cbranch_scc1 nosleep_185_\sf
s_cmp_lg_u32 s94, 0
s_cbranch_scc1 nopf_186_\sf
s_lshl_b32 s45, s88, 2
s_add_u32 s45, s45, s92
s_lshl_b32 s45, s45, 5
s_add_u32 s41, s45, s93
s_add_u32 s45, s41, 1
s_cmp_eq_u32 s45, s73
s_cbranch_scc1 nopf_186_\sf
s_mov_b32 s73, s45
v_and_b32 v1, 63, v0
v_lshlrev_b32 v2, 4, v1
v_lshlrev_b32 v3, 3, v1
v_add_u32 v5, 0x1000, v2
v_lshrrev_b32 v8, 4, v1
v_and_b32 v9, 7, v1
v_lshl_add_u32 v4, v8, 3, v9
v_lshlrev_b32 v4, 4, v4
v_cmp_gt_u32 vcc, 32, v1
s_nop 1
v_cndmask_b32 v6, 0, -1, vcc
v_cndmask_b32 v7, -1, 0, vcc
v_cndmask_b32 v14, 0, 1.0, vcc
v_mov_b32 v15, 0xff7fffff
v_and_b32 v9, 15, v1
v_lshlrev_b32 v8, 2, v8
v_add_u32 v10, 0, v8
v_cmp_le_u32 s[80:81], v10, v9
v_add_u32 v10, 1, v8
v_cmp_le_u32 s[82:83], v10, v9
v_add_u32 v10, 2, v8
v_cmp_le_u32 s[84:85], v10, v9
v_add_u32 v10, 3, v8
v_cmp_le_u32 s[86:87], v10, v9
s_mov_b32 s65, 0x3e0293ee
s_lshl_b32 s45, s41, 13
s_add_u32 s46, s45, 0x1000000
s_add_u32 s47, s45, 0x2000000
buffer_load_dwordx4 v[16:19], v2, s[8:11], s45 offen offset:0 sc1
buffer_load_dwordx4 v[20:23], v2, s[8:11], s45 offen offset:1024 sc1
buffer_load_dwordx4 v[24:27], v2, s[8:11], s45 offen offset:2048 sc1
buffer_load_dwordx4 v[28:31], v2, s[8:11], s45 offen offset:3072 sc1
buffer_load_dwordx4 v[32:35], v5, s[8:11], s45 offen offset:0 sc1
buffer_load_dwordx4 v[36:39], v5, s[8:11], s45 offen offset:1024 sc1
buffer_load_dwordx4 v[40:43], v5, s[8:11], s45 offen offset:2048 sc1
buffer_load_dwordx4 v[44:47], v5, s[8:11], s45 offen offset:3072 sc1
buffer_load_dwordx4 v[48:51], v2, s[8:11], s46 offen offset:0 sc1
buffer_load_dwordx4 v[52:55], v2, s[8:11], s46 offen offset:1024 sc1
buffer_load_dwordx4 v[56:59], v2, s[8:11], s46 offen offset:2048 sc1
buffer_load_dwordx4 v[60:63], v2, s[8:11], s46 offen offset:3072 sc1
buffer_load_dwordx4 v[64:67], v5, s[8:11], s46 offen offset:0 sc1
buffer_load_dwordx4 v[68:71], v5, s[8:11], s46 offen offset:1024 sc1
buffer_load_dwordx4 v[72:75], v5, s[8:11], s46 offen offset:2048 sc1
buffer_load_dwordx4 v[76:79], v5, s[8:11], s46 offen offset:3072 sc1
buffer_load_dwordx4 v[96:99], v2, s[8:11], s47 offen offset:0 sc1
buffer_load_dwordx4 v[100:103], v2, s[8:11], s47 offen offset:1024 sc1
buffer_load_dwordx4 v[104:107], v2, s[8:11], s47 offen offset:2048 sc1
buffer_load_dwordx4 v[108:111], v2, s[8:11], s47 offen offset:3072 sc1
buffer_load_dwordx4 v[112:115], v5, s[8:11], s47 offen offset:0 sc1
buffer_load_dwordx4 v[116:119], v5, s[8:11], s47 offen offset:1024 sc1
buffer_load_dwordx4 v[120:123], v5, s[8:11], s47 offen offset:2048 sc1
buffer_load_dwordx4 v[124:127], v5, s[8:11], s47 offen offset:3072 sc1
nopf_186_\sf:
s_sleep 8
nosleep_185_\sf:
s_add_u32 s44, s44, 1
s_cmp_ge_u32 s44, 0x40000
s_cbranch_scc1 g2_done_\sf
s_cmp_lt_u32 s89, 16
s_cbranch_scc1 g2_loop_\sf
g2_done_\sf:
s_endpgm
.endm
.globl main_kernel
.p2align 8
.type main_kernel,@function
main_kernel:

    s_cmp_ge_u32 s2, 256
    s_cbranch_scc0 f_start
    s_endpgm
f_start:
    s_getpc_b64 s[4:5]
    s_and_b32 s4, s4, 0xffffff00
    s_lshr_b32 s6, s2, 3
    s_lshl_b32 s6, s6, 12
    v_lshlrev_b32 v1, 4, v0
    v_add_u32 v1, s6, v1
    v_mov_b32 v3, s5
    v_add_co_u32 v2, vcc, s4, v1
    s_nop 1
    v_addc_co_u32 v3, vcc, 0, v3, vcc
    global_load_dwordx4 v[244:247], v[2:3], off
    s_load_dwordx2 s[8:9], s[0:1], 120
    s_load_dwordx2 s[12:13], s[0:1], 16
    s_load_dwordx2 s[16:17], s[0:1], 24
    s_load_dwordx2 s[20:21], s[0:1], 32
    s_load_dwordx2 s[24:25], s[0:1], 40
    s_load_dwordx2 s[28:29], s[0:1], 8
    s_load_dwordx2 s[32:33], s[0:1], 112
    s_waitcnt lgkmcnt(0)
    s_and_b32 s9, s9, 0xffff
    s_mov_b32 s10, 0x10000000
    s_mov_b32 s11, 0x20000
    s_and_b32 s13, s13, 0xffff
    s_mov_b32 s14, 0x800000
    s_mov_b32 s15, 0x20000
    s_and_b32 s17, s17, 0xffff
    s_mov_b32 s18, 0x800000
    s_mov_b32 s19, 0x20000
    s_and_b32 s21, s21, 0xffff
    s_mov_b32 s22, 0x800000
    s_mov_b32 s23, 0x20000
    s_and_b32 s25, s25, 0xffff
    s_mov_b32 s26, 0x800000
    s_mov_b32 s27, 0x20000
    s_and_b32 s29, s29, 0xffff
    s_mov_b32 s30, 0x4000
    s_mov_b32 s31, 0x20000
    s_and_b32 s33, s33, 0xffff
    s_mov_b32 s34, 0x100
    s_mov_b32 s35, 0x20000
    s_mov_b32 s44, 0
    v_and_b32 v1, 63, v0
    v_lshlrev_b32 v2, 4, v1
    v_lshlrev_b32 v6, 3, v1
    v_lshrrev_b32 v12, 4, v1
    v_and_b32 v13, 7, v1
    v_bfe_u32 v14, v1, 3, 1
    v_lshl_add_u32 v15, v12, 3, v13
    v_lshlrev_b32 v4, 4, v15
    v_lshl_add_u32 v3, v14, 3, v4
    v_lshl_add_u32 v5, v14, 9, v4
    v_mov_b32 v8, -1
    v_mov_b32 v9, -1
    v_mov_b32 v10, -1
    v_mov_b32 v11, -1
    v_cmp_gt_u32 vcc, 32, v1
    s_nop 1
    v_cndmask_b32 v156, 0, -1, vcc
    v_cndmask_b32 v157, -1, 0, vcc
    v_cndmask_b32 v158, 0, 1.0, vcc
    v_lshrrev_b32 v12, 6, v0
    s_nop 0
    v_readfirstlane_b32 s42, v12
    s_getreg_b32 s40, hwreg(HW_REG_XCC_ID)
    s_and_b32 s40, s40, 7
    s_cmp_lg_u32 s42, 0
    s_nop 1
    s_cbranch_scc1 tk_1
    v_mov_b32 v12, 1
    s_lshl_b32 s45, s40, 2
    v_mov_b32 v14, s45
    s_mov_b64 exec, 1
    buffer_atomic_add v12, v14, s[32:35], 0 offen sc0 sc1
    v_mov_b32 v14, 65536
    s_waitcnt vmcnt(0)
    ds_write_b32 v14, v12
    s_waitcnt lgkmcnt(0)
    s_mov_b64 exec, -1
tk_1:
    s_barrier
    v_mov_b32 v14, 65536
    ds_read_b32 v12, v14
    s_waitcnt lgkmcnt(0)
    v_readfirstlane_b32 s41, v12
    s_cmp_lt_u32 s41, 32
    s_nop 3
    s_cbranch_scc1 f_census_ok
    s_cmp_lg_u32 s42, 0
    s_cbranch_scc1 ovf_2
    v_mov_b32 v12, 1
    v_mov_b32 v13, 140
    s_mov_b64 exec, 1
    buffer_atomic_add v12, v13, s[32:35], 0 offen sc1
    s_mov_b64 exec, -1
    s_waitcnt vmcnt(0)
    v_mov_b32 v12, 1
    v_mov_b32 v13, 136
    s_mov_b64 exec, 1
    buffer_atomic_add v12, v13, s[32:35], 0 offen sc1
    s_mov_b64 exec, -1
ovf_2:
    v_mov_b32 v14, 136
    s_nop 1
iw_3:
    buffer_load_dwordx2 v[12:13], v14, s[32:35], 0 offen sc1
    s_waitcnt vmcnt(0)
    v_cmp_gt_u32 vcc, 256, v12
    s_cbranch_vccz iwd_4
    s_sleep 2
    s_add_u32 s44, s44, 1
    s_cmp_lt_u32 s44, 0x40000
    s_cbranch_scc1 iw_3
iwd_4:
    v_readfirstlane_b32 s45, v13
    s_cmp_lg_u32 s45, 0
    s_nop 3
    s_cbranch_scc1 SAFE_ENTRY
    s_branch SAFE_ENTRY
f_census_ok:
ROLES 0
SAFE_ENTRY:
    s_mov_b64 exec, -1
    s_waitcnt vmcnt(0) lgkmcnt(0)
    s_barrier
    s_load_dwordx2 s[8:9], s[0:1], 120
    s_load_dwordx2 s[12:13], s[0:1], 16
    s_load_dwordx2 s[16:17], s[0:1], 24
    s_load_dwordx2 s[20:21], s[0:1], 32
    s_load_dwordx2 s[24:25], s[0:1], 40
    s_load_dwordx2 s[28:29], s[0:1], 8
    s_load_dwordx2 s[32:33], s[0:1], 112
    s_waitcnt lgkmcnt(0)
    s_and_b32 s9, s9, 0xffff
    s_mov_b32 s10, 0x10000000
    s_mov_b32 s11, 0x20000
    s_and_b32 s13, s13, 0xffff
    s_mov_b32 s14, 0x800000
    s_mov_b32 s15, 0x20000
    s_and_b32 s17, s17, 0xffff
    s_mov_b32 s18, 0x800000
    s_mov_b32 s19, 0x20000
    s_and_b32 s21, s21, 0xffff
    s_mov_b32 s22, 0x800000
    s_mov_b32 s23, 0x20000
    s_and_b32 s25, s25, 0xffff
    s_mov_b32 s26, 0x800000
    s_mov_b32 s27, 0x20000
    s_and_b32 s29, s29, 0xffff
    s_mov_b32 s30, 0x4000
    s_mov_b32 s31, 0x20000
    s_and_b32 s33, s33, 0xffff
    s_mov_b32 s34, 0x100
    s_mov_b32 s35, 0x20000
    s_mov_b32 s44, 0
    v_and_b32 v1, 63, v0
    v_lshlrev_b32 v2, 4, v1
    v_lshlrev_b32 v6, 3, v1
    v_lshrrev_b32 v12, 4, v1
    v_and_b32 v13, 7, v1
    v_bfe_u32 v14, v1, 3, 1
    v_lshl_add_u32 v15, v12, 3, v13
    v_lshlrev_b32 v4, 4, v15
    v_lshl_add_u32 v3, v14, 3, v4
    v_lshl_add_u32 v5, v14, 9, v4
    v_mov_b32 v8, -1
    v_mov_b32 v9, -1
    v_mov_b32 v10, -1
    v_mov_b32 v11, -1
    v_cmp_gt_u32 vcc, 32, v1
    s_nop 1
    v_cndmask_b32 v156, 0, -1, vcc
    v_cndmask_b32 v157, -1, 0, vcc
    v_cndmask_b32 v158, 0, 1.0, vcc
    v_lshrrev_b32 v12, 6, v0
    s_nop 0
    v_readfirstlane_b32 s42, v12
    s_lshr_b32 s40, s2, 5
    s_and_b32 s40, s40, 7
    s_and_b32 s41, s2, 31
    s_nop 1
ROLES 1
.section .rodata,"a"
.p2align 6
.amdhsa_kernel main_kernel
  .amdhsa_next_free_vgpr 512
  .amdhsa_next_free_sgpr 102
  .amdhsa_accum_offset 256
  .amdhsa_group_segment_fixed_size 0
  .amdhsa_kernarg_size 128
  .amdhsa_user_sgpr_count 2
  .amdhsa_user_sgpr_kernarg_segment_ptr 1
  .amdhsa_system_sgpr_workgroup_id_x 1
.end_amdhsa_kernel
```
